```python
import torch

def _softmax(x, axis=-1):
    return torch.softmax(x, dim=axis)
def _gelu(x):
    return torch.nn.functional.gelu(x, approximate="tanh")
def _silu(x):
    return torch.nn.functional.silu(x)
def _sigmoid(x):
    return torch.sigmoid(x)
def _layernorm(x, axis=-1, eps=1e-5):
    m = x.mean(dim=axis, keepdim=True)
    v = x.var(dim=axis, keepdim=True, unbiased=False)
    return (x - m) / torch.sqrt(v + eps)
def _scatter_add(tgt, idx, src, axis=0):
    return tgt.clone().index_add_(axis, idx, src)
def _segment_sum(src, seg, n):
    out = torch.zeros((n,) + src.shape[1:], dtype=src.dtype)
    return out.index_add_(0, seg, src)
def _pad(x, pw):
    flat = tuple(v for pair in reversed(pw) for v in pair)
    return torch.nn.functional.pad(x, flat)

kernel_name = 'parallel_sum__linear_attn_block__glu_gated_swiglu__prompt'

def setup_inputs():

    _w = (lambda a: (lambda t: t.to(torch.bfloat16) if t.is_floating_point() else t)(torch.as_tensor(a)))
    def _A_setup():
        B, S, D = 1, 2048, 640
        return {
            "x": _w((lambda *s: torch.randn(*s, dtype=torch.bfloat16) * 0.05)(B, S, D)),
            "wqkv": _w((lambda *s: torch.randn(*s, dtype=torch.bfloat16) * 0.05)(D, 3 * D)),
            "wo": _w((lambda *s: torch.randn(*s, dtype=torch.bfloat16) * 0.05)(D, D)),
        }
    _A_in = _A_setup()

    def _B_setup():
        B, S, D, F = 1, 2048, 640, 1536
        return {
            "x": _w((lambda *s: torch.randn(*s, dtype=torch.bfloat16) * 0.05)(B, S, D)),
            "w1": _w((lambda *s: torch.randn(*s, dtype=torch.bfloat16) * 0.2)(D, F) * (2.0 / D) ** 0.5),
            "w3": _w((lambda *s: torch.randn(*s, dtype=torch.bfloat16) * 0.2)(D, F) * (2.0 / D) ** 0.5),
            "w2": _w((lambda *s: torch.randn(*s, dtype=torch.bfloat16) * 0.2)(F, D) * (2.0 / F) ** 0.5),
        }
    _B_in = _B_setup()

    return {
        "A_x": _A_in["x"],
        "A_wqkv": _A_in["wqkv"],
        "A_wo": _A_in["wo"],
        "B_x": _B_in["x"],
        "B_w1": _B_in["w1"],
        "B_w3": _B_in["w3"],
        "B_w2": _B_in["w2"],
    }

def reference(A_x, A_wqkv, A_wo, B_x, B_w1, B_w3, B_w2):
    def _A_ref(x, wqkv, wo):
        B, S, D = x.shape
        H = 32; Dh = D // H
        qkv = (lambda x, *d: x.permute(*d))((x @ wqkv).reshape(B, S, 3, H, Dh), 2, 0, 3, 1, 4)
        q, k, v = qkv[0], qkv[1], qkv[2]
        phi = lambda t: torch.where(t > 0, t + 1, torch.exp(t)) + 1e-6
        pq, pk = phi(q), phi(k)
        kv = torch.einsum("bhsd,bhse->bhde", pk, v)
        z = torch.einsum("bhsd->bhd", pk)
        num = torch.einsum("bhqd,bhde->bhqe", pq, kv)
        den = torch.einsum("bhqd,bhd->bhq", pq, z)[..., None] + 1e-6
        o = num / den
        return (lambda x, *d: x.permute(*d))(o, 0, 2, 1, 3).reshape(B, S, D) @ wo

    def _B_ref(x, w1, w3, w2):
        gate = torch.einsum("bsd,df->bsf", x, w1)
        up = torch.einsum("bsd,df->bsf", x, w3)
        h = _silu(gate) * up
        out = torch.einsum("bsf,fd->bsd", h, w2)
        return out

    x = A_x
    xn = _layernorm(x, axis=-1)
    return x + _A_ref(xn, A_wqkv, A_wo) + _B_ref(xn, B_w1, B_w3, B_w2)
```

```asm
; @launch grid=(256,1,1) block=(256,1,1) lds=163840
.amdgcn_target "amdgcn-amd-amdhsa--gfx950"
.text
.globl parallel_sum__linear_attn_block__glu_gated_swiglu__prompt_kernel
.p2align 8
.type parallel_sum__linear_attn_block__glu_gated_swiglu__prompt_kernel,@function
parallel_sum__linear_attn_block__glu_gated_swiglu__prompt_kernel:
s_cmp_ge_u32 s2, 256
s_cbranch_scc1 K1_EXIT
s_load_dwordx4 s[4:7], s[0:1], 0
s_load_dwordx4 s[40:43], s[0:1], 32
s_load_dwordx2 s[44:45], s[0:1], 72
s_load_dwordx2 s[46:47], s[0:1], 64
s_load_dwordx2 s[76:77], s[0:1], 48
s_load_dwordx2 s[78:79], s[0:1], 16
s_load_dwordx2 s[86:87], s[0:1], 56
s_lshr_b32 s60, s2, 6
s_cmp_eq_u32 s60, 0
s_cbranch_scc1 K1_KV
s_cmp_eq_u32 s60, 1
s_cbranch_scc1 K1_Q
s_branch K1_F
K1_EXIT:
s_endpgm
K1_F:
s_getpc_b64 s[90:91]
v_and_b32 v1, 63, v0
v_lshrrev_b32 v32, 6, v0
s_nop 0
v_readfirstlane_b32 s48, v32
v_lshrrev_b32 v32, 3, v1
v_lshrrev_b32 v33, 1, v32
v_and_b32 v34, 7, v1
v_xor_b32 v34, v34, v33
v_mul_u32_u24 v32, 1280, v32
v_lshl_add_u32 v12, v34, 4, v32
v_xor_b32 v32, 64, v12
v_add_u32 v13, 9216, v32
v_add_u32 v14, 18432, v12
v_add_u32 v15, 27648, v32
s_and_b32 s60, s2, 7
s_lshr_b32 s61, s2, 3
s_and_b32 s49, s60, 1
s_lshl_b32 s49, s49, 3
s_and_b32 s62, s61, 7
s_add_u32 s49, s49, s62
s_lshr_b32 s50, s60, 1
s_lshl_b32 s50, s50, 2
s_lshr_b32 s63, s61, 3
s_add_u32 s50, s50, s63
s_mul_i32 s53, s48, 12288
s_add_u32 s53, s53, 98816
s_mul_i32 s56, s48, 40960
s_lshr_b32 s60, s48, 1
s_mul_i32 s52, s60, 12320
s_and_b32 s61, s48, 1
s_mul_i32 s62, s61, 6144
s_add_u32 s52, s52, s62
s_mul_i32 s54, s61, 98304
s_lshr_b32 s51, s50, 2
s_lshl_b32 s51, s51, 1
s_and_b32 s60, s50, 1
s_add_u32 s51, s51, s60
s_mul_i32 s61, s51, 320
s_add_u32 s62, s61, 128
s_add_u32 s63, s61, 192
s_cmp_eq_u32 s60, 0
s_cselect_b32 s64, s62, s61
s_cselect_b32 s66, s61, s63
s_mov_b32 s65, s64
s_mov_b32 s67, s66
s_lshl_b32 s58, s64, 5
s_lshl_b32 s59, s66, 5
v_add_u32 v32, 0, v1
v_mul_u32_u24 v33, 5462, v32
v_lshrrev_b32 v33, 16, v33
v_mul_u32_u24 v34, 12, v33
v_sub_u32 v34, v32, v34
v_mul_u32_u24 v33, 3072, v33
v_lshl_add_u32 v2, v34, 4, v33
v_add_u32 v32, 64, v1
v_mul_u32_u24 v33, 5462, v32
v_lshrrev_b32 v33, 16, v33
v_mul_u32_u24 v34, 12, v33
v_sub_u32 v34, v32, v34
v_mul_u32_u24 v33, 3072, v33
v_lshl_add_u32 v3, v34, 4, v33
v_subrev_u32 v3, 1024, v3
v_add_u32 v32, 128, v1
v_mul_u32_u24 v33, 5462, v32
v_lshrrev_b32 v33, 16, v33
v_mul_u32_u24 v34, 12, v33
v_sub_u32 v34, v32, v34
v_mul_u32_u24 v33, 3072, v33
v_lshl_add_u32 v4, v34, 4, v33
v_subrev_u32 v4, 2048, v4
s_waitcnt lgkmcnt(0)
s_mul_i32 s60, s49, 163840
s_add_u32 s8, s4, s60
s_addc_u32 s9, s5, 0
s_mov_b32 s10, 163840
s_mov_b32 s11, 0x20000
s_add_u32 m0, s53, 0
s_add_u32 s75, s56, 0
buffer_load_dwordx4 v12, s[8:11], s75 offen lds
buffer_load_dwordx4 v13, s[8:11], s75 offen offset:1024 lds
buffer_load_dwordx4 v14, s[8:11], s75 offen offset:2048 lds
buffer_load_dwordx4 v15, s[8:11], s75 offen offset:3072 lds
s_cmp_lt_u32 s48, 2
s_cselect_b32 s60, s40, s42
s_cselect_b32 s61, s41, s43
s_add_u32 s12, s60, s64
s_addc_u32 s13, s61, 0
s_sub_u32 s14, 1966080, s64
s_mov_b32 s15, 0x20000
s_add_u32 s74, s54, 0
s_add_u32 m0, s52, 0
s_nop 0
buffer_load_dwordx4 v2, s[12:15], s74 offen lds
buffer_load_dwordx4 v3, s[12:15], s74 offen offset:1024 lds
buffer_load_dwordx4 v4, s[12:15], s74 offen offset:2048 lds
s_add_u32 s74, s74, 49152
s_add_u32 m0, s52, 3072
s_nop 0
buffer_load_dwordx4 v2, s[12:15], s74 offen lds
buffer_load_dwordx4 v3, s[12:15], s74 offen offset:1024 lds
buffer_load_dwordx4 v4, s[12:15], s74 offen offset:2048 lds
s_mov_b32 s28, s46
s_mov_b32 s29, s47
s_mov_b32 s30, 256
s_mov_b32 s31, 0x20000
s_memrealtime s[98:99]
s_or_b32 s60, s2, s48
s_cmp_eq_u32 s60, 0
s_cselect_b32 s60, 0, 2147483647
v_mov_b32 v32, s60
v_mov_b32 v31, 2147483647
v_cmp_eq_u32 vcc, 0, v1
s_nop 1
v_cndmask_b32 v32, v31, v32, vcc
s_waitcnt lgkmcnt(0)
s_waitcnt lgkmcnt(0)
s_or_b32 s98, s98, 1
s_sub_u32 s92, s98, 2048
v_mov_b32 v33, s98
buffer_store_dword v33, v32, s[28:31], 0 offen sc1
s_lshr_b32 s60, s2, 3
s_and_b32 s60, s60, 7
s_lshl_b32 s60, s60, 2
s_add_u32 s60, s60, s48
s_and_b32 s60, s60, 7
s_lshl_b32 s60, s60, 12
s_add_u32 s60, s90, s60
s_addc_u32 s61, s91, 0
v_lshlrev_b32 v32, 6, v1
v_mov_b32 v33, s61
v_add_co_u32 v32, vcc, s60, v32
s_nop 1
v_addc_co_u32 v33, vcc, 0, v33, vcc
global_load_dword a255, v[32:33], off
s_cmp_lt_u32 s48, 2
s_cselect_b32 s60, s40, s42
s_cselect_b32 s61, s41, s43
s_add_u32 s16, s60, s66
s_addc_u32 s17, s61, 0
s_sub_u32 s18, 1966080, s66
s_mov_b32 s19, 0x20000
s_lshr_b32 s60, s48, 1
s_mul_i32 s80, s60, 8192
s_and_b32 s61, s48, 1
s_mul_i32 s62, s61, 4096
s_add_u32 s80, s80, s62
s_mul_i32 s55, s61, 98304
s_mov_b32 s24, s44
s_mov_b32 s25, s45
s_mov_b32 s26, 17825792
s_mov_b32 s27, 0x20000
s_mov_b32 s32, s76
s_mov_b32 s33, s77
s_mov_b32 s34, 1966080
s_mov_b32 s35, 0x20000
s_mov_b32 s36, s78
s_mov_b32 s37, s79
s_mov_b32 s38, 819200
s_mov_b32 s39, 0x20000
s_mov_b32 s84, 1069066811
s_mov_b32 s85, 0x358637bd
s_lshl_b32 s57, s49, 2
s_add_u32 s57, s57, s48
s_mul_i32 s57, s57, 139264
v_lshrrev_b32 v32, 3, v1
v_bfe_u32 v33, v1, 4, 1
s_lshr_b32 s60, s48, 1
s_lshl_b32 s60, s60, 1
v_add_u32 v33, s60, v33
v_lshlrev_b32 v33, 1, v33
v_and_b32 v34, 7, v1
v_xor_b32 v34, v34, v33
v_mul_u32_u24 v32, 3072, v32
v_lshl_add_u32 v7, v34, 4, v32
v_add_u32 v8, 23552, v7
v_add_u32 v9, 47104, v7
v_add_u32 v10, 70656, v7
v_and_b32 v32, 31, v1
v_lshrrev_b32 v33, 5, v1
v_bfe_u32 v34, v32, 1, 3
v_xor_b32 v34, v34, v33
v_lshlrev_b32 v34, 4, v34
v_lshl_add_u32 v35, v32, 7, v34
v_add_u32 v16, s53, v35
v_xor_b32 v17, 32, v16
v_xor_b32 v18, 64, v16
v_xor_b32 v19, 96, v16
v_lshlrev_b32 v22, 4, v1
v_lshlrev_b32 v29, 4, v33
v_add_u32 v29, 131072, v29
v_mov_b32 v32, 0x3f803f80
v_lshlrev_b32 v33, 2, v1
v_add_u32 v33, 131072, v33
ds_write_b32 v33, v32 offset:29952
v_bfe_u32 v32, v1, 2, 2
v_lshrrev_b32 v33, 5, v1
v_lshl_add_u32 v32, v33, 3, v32
v_bfe_u32 v34, v1, 4, 1
v_and_b32 v35, 3, v1
v_lshlrev_b32 v35, 3, v35
v_mul_u32_u24 v32, 192, v32
v_mul_u32_u24 v34, 12320, v34
v_add3_u32 v20, v32, v34, v35
v_add_u32 v21, 49408, v20
v_bfe_u32 v32, v1, 2, 2
v_lshrrev_b32 v33, 5, v1
v_lshl_add_u32 v32, v33, 3, v32
v_bfe_u32 v34, v1, 4, 1
v_and_b32 v35, 3, v1
v_lshlrev_b32 v35, 3, v35
v_bfe_u32 v36, v1, 3, 1
v_lshl_add_u32 v36, v34, 1, v36
v_lshlrev_b32 v36, 5, v36
v_lshlrev_b32 v32, 7, v32
v_lshlrev_b32 v34, 13, v34
v_add3_u32 v32, v32, v34, v35
v_add_u32 v32, v32, v36
v_xor_b32 v84, 0, v32
v_add_u32 v85, 49408, v84
v_xor_b32 v86, 32, v32
v_add_u32 v87, 49408, v86
v_xor_b32 v88, 64, v32
v_add_u32 v89, 49408, v88
v_xor_b32 v90, 96, v32
v_add_u32 v91, 49408, v90
s_add_u32 m0, s53, 4096
s_add_u32 s75, s56, 128
buffer_load_dwordx4 v12, s[8:11], s75 offen lds
buffer_load_dwordx4 v13, s[8:11], s75 offen offset:1024 lds
buffer_load_dwordx4 v14, s[8:11], s75 offen offset:2048 lds
buffer_load_dwordx4 v15, s[8:11], s75 offen offset:3072 lds
s_add_u32 s74, s54, 196608
s_add_u32 m0, s52, 24704
s_nop 0
buffer_load_dwordx4 v2, s[12:15], s74 offen lds
buffer_load_dwordx4 v3, s[12:15], s74 offen offset:1024 lds
buffer_load_dwordx4 v4, s[12:15], s74 offen offset:2048 lds
s_add_u32 s74, s74, 49152
s_add_u32 m0, s52, 27776
s_nop 0
buffer_load_dwordx4 v2, s[12:15], s74 offen lds
buffer_load_dwordx4 v3, s[12:15], s74 offen offset:1024 lds
buffer_load_dwordx4 v4, s[12:15], s74 offen offset:2048 lds
s_cmp_eq_u32 s48, 0
s_cselect_b32 s60, 0, 2147483647
v_mov_b32 v32, 0
buffer_load_dword v30, v32, s[28:31], s60 offen sc1
s_waitcnt vmcnt(13)
s_barrier
ds_read_b128 a[0:3], v16 offset:0
ds_read_b128 a[4:7], v17 offset:0
ds_read_b128 a[8:11], v18 offset:0
ds_read_b128 a[12:15], v19 offset:0
ds_read_b64_tr_b16 a[160:161], v20 offset:0
ds_read_b64_tr_b16 a[162:163], v20 offset:768
ds_read_b64_tr_b16 a[164:165], v20 offset:32
ds_read_b64_tr_b16 a[166:167], v20 offset:800
ds_read_b64_tr_b16 a[168:169], v20 offset:64
ds_read_b64_tr_b16 a[170:171], v20 offset:832
ds_read_b64_tr_b16 a[172:173], v20 offset:96
ds_read_b64_tr_b16 a[174:175], v20 offset:864
ds_read_b64_tr_b16 a[176:177], v20 offset:128
ds_read_b64_tr_b16 a[178:179], v20 offset:896
ds_read_b64_tr_b16 a[180:181], v20 offset:160
ds_read_b64_tr_b16 a[182:183], v20 offset:928
ds_read_b64_tr_b16 a[184:185], v20 offset:3072
ds_read_b64_tr_b16 a[186:187], v20 offset:3840
ds_read_b64_tr_b16 a[188:189], v20 offset:3104
ds_read_b64_tr_b16 a[190:191], v20 offset:3872
ds_read_b64_tr_b16 a[192:193], v20 offset:3136
ds_read_b64_tr_b16 a[194:195], v20 offset:3904
ds_read_b64_tr_b16 a[196:197], v20 offset:3168
ds_read_b64_tr_b16 a[198:199], v20 offset:3936
ds_read_b64_tr_b16 a[200:201], v20 offset:3200
ds_read_b64_tr_b16 a[202:203], v20 offset:3968
ds_read_b64_tr_b16 a[204:205], v20 offset:3232
ds_read_b64_tr_b16 a[206:207], v20 offset:4000
s_waitcnt lgkmcnt(12)
v_mfma_f32_32x32x16_bf16 v[96:111], a[160:163], a[0:3], 0
ds_read_b64_tr_b16 a[208:209], v20 offset:6144
ds_read_b64_tr_b16 a[210:211], v20 offset:6912
s_add_u32 m0, s53, 8192
s_add_u32 s75, s56, 256
buffer_load_dwordx4 v12, s[8:11], s75 offen lds
v_mfma_f32_32x32x16_bf16 v[112:127], a[164:167], a[0:3], 0
ds_read_b64_tr_b16 a[212:213], v20 offset:6176
ds_read_b64_tr_b16 a[214:215], v20 offset:6944
buffer_load_dwordx4 v13, s[8:11], s75 offen offset:1024 lds
v_mfma_f32_32x32x16_bf16 v[128:143], a[168:171], a[0:3], 0
ds_read_b64_tr_b16 a[216:217], v20 offset:6208
ds_read_b64_tr_b16 a[218:219], v20 offset:6976
buffer_load_dwordx4 v14, s[8:11], s75 offen offset:2048 lds
v_mfma_f32_32x32x16_bf16 v[144:159], a[172:175], a[0:3], 0
ds_read_b64_tr_b16 a[220:221], v20 offset:6240
ds_read_b64_tr_b16 a[222:223], v20 offset:7008
buffer_load_dwordx4 v15, s[8:11], s75 offen offset:3072 lds
v_mfma_f32_32x32x16_bf16 v[160:175], a[176:179], a[0:3], 0
ds_read_b64_tr_b16 a[224:225], v20 offset:6272
ds_read_b64_tr_b16 a[226:227], v20 offset:7040
s_add_u32 s74, s54, 393216
s_add_u32 m0, s52, 49408
s_nop 0
buffer_load_dwordx4 v2, s[12:15], s74 offen lds
v_mfma_f32_32x32x16_bf16 v[176:191], a[180:183], a[0:3], 0
ds_read_b64_tr_b16 a[228:229], v20 offset:6304
ds_read_b64_tr_b16 a[230:231], v20 offset:7072
buffer_load_dwordx4 v3, s[12:15], s74 offen offset:1024 lds
s_waitcnt lgkmcnt(12)
v_mfma_f32_32x32x16_bf16 v[96:111], a[184:187], a[4:7], v[96:111]
ds_read_b64_tr_b16 a[160:161], v20 offset:9216
ds_read_b64_tr_b16 a[162:163], v20 offset:9984
v_mfma_f32_32x32x16_bf16 v[112:127], a[188:191], a[4:7], v[112:127]
ds_read_b64_tr_b16 a[164:165], v20 offset:9248
ds_read_b64_tr_b16 a[166:167], v20 offset:10016
buffer_load_dwordx4 v4, s[12:15], s74 offen offset:2048 lds
v_mfma_f32_32x32x16_bf16 v[128:143], a[192:195], a[4:7], v[128:143]
ds_read_b64_tr_b16 a[168:169], v20 offset:9280
ds_read_b64_tr_b16 a[170:171], v20 offset:10048
v_mfma_f32_32x32x16_bf16 v[144:159], a[196:199], a[4:7], v[144:159]
ds_read_b64_tr_b16 a[172:173], v20 offset:9312
ds_read_b64_tr_b16 a[174:175], v20 offset:10080
s_add_u32 s74, s74, 49152
s_add_u32 m0, s52, 52480
s_nop 0
buffer_load_dwordx4 v2, s[12:15], s74 offen lds
v_lshrrev_b32 v32, 5, v1
s_lshl_b32 s60, s50, 3
s_lshl_b32 s61, s48, 1
s_add_u32 s60, s60, s61
v_add_u32 v32, s60, v32
v_mul_u32_u24 v33, 1280, v32
v_and_b32 v34, 31, v1
v_lshl_add_u32 v33, v34, 3, v33
buffer_load_dwordx2 v[192:193], v33, s[8:11], 0 offen
v_mfma_f32_32x32x16_bf16 v[160:175], a[200:203], a[4:7], v[160:175]
ds_read_b64_tr_b16 a[176:177], v20 offset:9344
ds_read_b64_tr_b16 a[178:179], v20 offset:10112
buffer_load_dwordx2 v[194:195], v33, s[8:11], 0 offen offset:256
buffer_load_dwordx2 v[196:197], v33, s[8:11], 0 offen offset:512
buffer_load_dwordx2 v[198:199], v33, s[8:11], 0 offen offset:768
buffer_load_dwordx2 v[200:201], v33, s[8:11], 0 offen offset:1024
s_and_b32 s63, s48, 1
s_cmp_eq_u32 s63, 0
s_cselect_b32 s68, s40, s42
s_cselect_b32 s69, s41, s43
s_cselect_b32 s70, s64, s65
s_cselect_b32 s71, s40, s42
s_cselect_b32 s72, s41, s43
s_cselect_b32 s73, s66, s67
s_cmp_lt_u32 s48, 2
s_cselect_b32 s68, s68, s71
s_cselect_b32 s69, s69, s72
s_cselect_b32 s70, s70, s73
s_mov_b32 s73, 1966080
s_cselect_b32 s71, 1966080, s73
s_mov_b32 s73, 3072
s_cselect_b32 s72, 3072, s73
s_cselect_b32 s73, 12, 8
s_add_u32 s20, s68, s70
s_addc_u32 s21, s69, 0
s_sub_u32 s22, s71, s70
s_mov_b32 s23, 0x20000
v_and_b32 v36, 15, v1
v_lshrrev_b32 v37, 4, v1
s_mul_i32 s60, s72, 10
v_mul_lo_u32 v37, s60, v37
v_lshl_add_u32 v37, v36, 4, v37
v_cmp_gt_u32 vcc, s73, v36
s_nop 1
v_cndmask_b32 v37, v31, v37, vcc
s_mul_i32 s96, s49, 40
s_mul_i32 s96, s96, s72
buffer_load_dwordx4 v[204:207], v37, s[20:23], s96 offen
v_mfma_f32_32x32x16_bf16 v[176:191], a[204:207], a[4:7], v[176:191]
ds_read_b64_tr_b16 a[180:181], v20 offset:9376
ds_read_b64_tr_b16 a[182:183], v20 offset:10144
buffer_load_dwordx4 v3, s[12:15], s74 offen offset:1024 lds
s_add_u32 s96, s96, s72
buffer_load_dwordx4 v[208:211], v37, s[20:23], s96 offen
s_add_u32 s96, s96, s72
buffer_load_dwordx4 v[212:215], v37, s[20:23], s96 offen
s_add_u32 s96, s96, s72
buffer_load_dwordx4 v[216:219], v37, s[20:23], s96 offen
s_waitcnt vmcnt(19)
s_barrier
s_waitcnt lgkmcnt(12)
v_mfma_f32_32x32x16_bf16 v[96:111], a[208:211], a[8:11], v[96:111]
ds_read_b64_tr_b16 a[184:185], v20 offset:24704
ds_read_b64_tr_b16 a[186:187], v20 offset:25472
ds_read_b128 a[16:19], v16 offset:4096
buffer_load_dwordx4 v4, s[12:15], s74 offen offset:2048 lds
s_add_u32 s96, s96, s72
buffer_load_dwordx4 v[220:223], v37, s[20:23], s96 offen
s_add_u32 s96, s96, s72
buffer_load_dwordx4 v[224:227], v37, s[20:23], s96 offen
s_add_u32 s96, s96, s72
buffer_load_dwordx4 v[228:231], v37, s[20:23], s96 offen
v_mfma_f32_32x32x16_bf16 v[112:127], a[212:215], a[8:11], v[112:127]
ds_read_b64_tr_b16 a[188:189], v20 offset:24736
ds_read_b64_tr_b16 a[190:191], v20 offset:25504
ds_read_b128 a[20:23], v17 offset:4096
s_add_u32 m0, s53, 0
s_add_u32 s75, s56, 384
buffer_load_dwordx4 v12, s[8:11], s75 offen lds
s_add_u32 s96, s96, s72
buffer_load_dwordx4 v[232:235], v37, s[20:23], s96 offen
s_add_u32 s96, s96, s72
buffer_load_dwordx4 v[236:239], v37, s[20:23], s96 offen
v_mfma_f32_32x32x16_bf16 v[128:143], a[216:219], a[8:11], v[128:143]
ds_read_b64_tr_b16 a[192:193], v20 offset:24768
ds_read_b64_tr_b16 a[194:195], v20 offset:25536
s_add_u32 s96, s96, s72
buffer_load_dwordx4 v[240:243], v37, s[20:23], s96 offen
s_lshl_b32 s60, s49, 4
s_add_u32 s60, s60, s50
s_lshl_b32 s60, s60, 2
s_add_u32 s60, s60, s48
s_lshl_b32 s60, s60, 7
s_add_u32 s60, s60, 14680064
v_add_u32 v32, s60, v22
v_cmp_gt_u32 vcc, 8, v1
s_nop 1
v_cndmask_b32 v95, v31, v32, vcc
s_lshl_b32 s60, s50, 4
s_add_u32 s60, s60, s49
s_lshl_b32 s60, s60, 2
s_add_u32 s60, s60, s48
s_lshl_b32 s60, s60, 9
s_add_u32 s60, s60, 15728640
v_add_u32 v34, s60, v22
v_cmp_gt_u32 vcc, 32, v1
s_nop 1
v_cndmask_b32 v94, v31, v34, vcc
v_mfma_f32_32x32x16_bf16 v[144:159], a[220:223], a[8:11], v[144:159]
ds_read_b64_tr_b16 a[196:197], v20 offset:24800
ds_read_b64_tr_b16 a[198:199], v20 offset:25568
ds_read_b128 a[24:27], v18 offset:4096
buffer_load_dwordx4 v13, s[8:11], s75 offen offset:1024 lds
s_sub_u32 s97, s2, 64
s_and_b32 s60, s97, 7
s_lshr_b32 s61, s97, 3
s_mul_i32 s98, s61, 81920
s_mul_i32 s62, s60, 160
s_add_u32 s98, s98, s62
s_mul_i32 s60, s60, 48
s_lshl_b32 s61, s61, 1
s_add_u32 s60, s60, s61
s_mul_i32 s99, s60, 5120
s_add_u32 s99, s99, 9437184
v_mfma_f32_32x32x16_bf16 v[160:175], a[224:227], a[8:11], v[160:175]
ds_read_b64_tr_b16 a[200:201], v20 offset:24832
ds_read_b64_tr_b16 a[202:203], v20 offset:25600
ds_read_b128 a[28:31], v19 offset:4096
s_lshl_b32 s60, s48, 6
v_add_u32 v80, s60, v1
v_mul_u32_u24 v81, 6554, v80
v_lshrrev_b32 v81, 16, v81
v_mul_u32_u24 v93, 10, v81
v_sub_u32 v93, v80, v93
v_mul_u32_u24 v81, 1280, v81
v_lshl_add_u32 v82, v93, 4, v81
v_mfma_f32_32x32x16_bf16 v[176:191], a[228:231], a[8:11], v[176:191]
ds_read_b64_tr_b16 a[204:205], v20 offset:24864
ds_read_b64_tr_b16 a[206:207], v20 offset:25632
buffer_load_dwordx4 v14, s[8:11], s75 offen offset:2048 lds
v_add_u32 v80, 256, v1
v_mul_u32_u24 v81, 6554, v80
v_lshrrev_b32 v81, 16, v81
v_mul_u32_u24 v93, 10, v81
v_sub_u32 v93, v80, v93
v_mul_u32_u24 v81, 1280, v81
v_lshl_add_u32 v83, v93, 4, v81
s_waitcnt lgkmcnt(15)
v_mfma_f32_32x32x16_bf16 v[96:111], a[160:163], a[12:15], v[96:111]
ds_read_b64_tr_b16 a[208:209], v20 offset:27776
ds_read_b64_tr_b16 a[210:211], v20 offset:28544
v_lshrrev_b32 v80, 5, v1
v_lshlrev_b32 v80, 4, v80
v_bfe_u32 v81, v1, 4, 1
v_lshl_add_u32 v80, v81, 2, v80
v_bfe_u32 v81, v1, 2, 2
v_add_u32 v80, v80, v81
v_mul_u32_u24 v80, 160, v80
v_mfma_f32_32x32x16_bf16 v[112:127], a[164:167], a[12:15], v[112:127]
ds_read_b64_tr_b16 a[212:213], v20 offset:27808
ds_read_b64_tr_b16 a[214:215], v20 offset:28576
buffer_load_dwordx4 v15, s[8:11], s75 offen offset:3072 lds
v_and_b32 v81, 3, v1
v_lshl_add_u32 v80, v81, 3, v80
v_add_u32 v81, 147968, v80
s_add_u32 s61, s98, 0
s_lshl_b32 s62, s48, 10
s_add_u32 m0, s62, 147968
s_cmp_eq_u32 s48, 0
buffer_load_dwordx4 v82, s[32:35], s61 offen lds
s_cselect_b32 s61, s61, 2147483647
s_cselect_b32 s62, 0, 1024
s_add_u32 m0, s62, 152064
s_nop 0
buffer_load_dwordx4 v83, s[32:35], s61 offen lds
v_mfma_f32_32x32x16_bf16 v[128:143], a[168:171], a[12:15], v[128:143]
ds_read_b64_tr_b16 a[216:217], v20 offset:27840
ds_read_b64_tr_b16 a[218:219], v20 offset:28608
v_mfma_f32_32x32x16_bf16 v[144:159], a[172:175], a[12:15], v[144:159]
ds_read_b64_tr_b16 a[220:221], v20 offset:27872
ds_read_b64_tr_b16 a[222:223], v20 offset:28640
s_add_u32 s74, s54, 589824
s_add_u32 m0, s52, 74112
s_nop 0
buffer_load_dwordx4 v2, s[12:15], s74 offen lds
v_mfma_f32_32x32x16_bf16 v[160:175], a[176:179], a[12:15], v[160:175]
ds_read_b64_tr_b16 a[224:225], v20 offset:27904
ds_read_b64_tr_b16 a[226:227], v20 offset:28672
v_mfma_f32_32x32x16_bf16 v[176:191], a[180:183], a[12:15], v[176:191]
ds_read_b64_tr_b16 a[228:229], v20 offset:27936
ds_read_b64_tr_b16 a[230:231], v20 offset:28704
buffer_load_dwordx4 v3, s[12:15], s74 offen offset:1024 lds
s_waitcnt lgkmcnt(12)
v_mfma_f32_32x32x16_bf16 v[96:111], a[184:187], a[16:19], v[96:111]
ds_read_b64_tr_b16 a[160:161], v20 offset:30848
ds_read_b64_tr_b16 a[162:163], v20 offset:31616
v_mfma_f32_32x32x16_bf16 v[112:127], a[188:191], a[16:19], v[112:127]
ds_read_b64_tr_b16 a[164:165], v20 offset:30880
ds_read_b64_tr_b16 a[166:167], v20 offset:31648
buffer_load_dwordx4 v4, s[12:15], s74 offen offset:2048 lds
v_mfma_f32_32x32x16_bf16 v[128:143], a[192:195], a[16:19], v[128:143]
ds_read_b64_tr_b16 a[168:169], v20 offset:30912
ds_read_b64_tr_b16 a[170:171], v20 offset:31680
v_mfma_f32_32x32x16_bf16 v[144:159], a[196:199], a[16:19], v[144:159]
ds_read_b64_tr_b16 a[172:173], v20 offset:30944
ds_read_b64_tr_b16 a[174:175], v20 offset:31712
s_add_u32 s74, s74, 49152
s_add_u32 m0, s52, 77184
s_nop 0
buffer_load_dwordx4 v2, s[12:15], s74 offen lds
v_mfma_f32_32x32x16_bf16 v[160:175], a[200:203], a[16:19], v[160:175]
ds_read_b64_tr_b16 a[176:177], v20 offset:30976
ds_read_b64_tr_b16 a[178:179], v20 offset:31744
v_mfma_f32_32x32x16_bf16 v[176:191], a[204:207], a[16:19], v[176:191]
ds_read_b64_tr_b16 a[180:181], v20 offset:31008
ds_read_b64_tr_b16 a[182:183], v20 offset:31776
buffer_load_dwordx4 v3, s[12:15], s74 offen offset:1024 lds
s_waitcnt lgkmcnt(12)
v_mfma_f32_32x32x16_bf16 v[96:111], a[208:211], a[20:23], v[96:111]
ds_read_b64_tr_b16 a[184:185], v20 offset:33920
ds_read_b64_tr_b16 a[186:187], v20 offset:34688
v_mfma_f32_32x32x16_bf16 v[112:127], a[212:215], a[20:23], v[112:127]
ds_read_b64_tr_b16 a[188:189], v20 offset:33952
ds_read_b64_tr_b16 a[190:191], v20 offset:34720
buffer_load_dwordx4 v4, s[12:15], s74 offen offset:2048 lds
v_mfma_f32_32x32x16_bf16 v[128:143], a[216:219], a[20:23], v[128:143]
ds_read_b64_tr_b16 a[192:193], v20 offset:33984
ds_read_b64_tr_b16 a[194:195], v20 offset:34752
v_mfma_f32_32x32x16_bf16 v[144:159], a[220:223], a[20:23], v[144:159]
ds_read_b64_tr_b16 a[196:197], v20 offset:34016
ds_read_b64_tr_b16 a[198:199], v20 offset:34784
s_add_u32 m0, s53, 4096
s_add_u32 s75, s56, 512
buffer_load_dwordx4 v12, s[8:11], s75 offen lds
v_mfma_f32_32x32x16_bf16 v[160:175], a[224:227], a[20:23], v[160:175]
ds_read_b64_tr_b16 a[200:201], v20 offset:34048
ds_read_b64_tr_b16 a[202:203], v20 offset:34816
v_mfma_f32_32x32x16_bf16 v[176:191], a[228:231], a[20:23], v[176:191]
ds_read_b64_tr_b16 a[204:205], v20 offset:34080
ds_read_b64_tr_b16 a[206:207], v20 offset:34848
buffer_load_dwordx4 v13, s[8:11], s75 offen offset:1024 lds
s_waitcnt vmcnt(20)
s_barrier
s_waitcnt lgkmcnt(12)
v_mfma_f32_32x32x16_bf16 v[96:111], a[160:163], a[24:27], v[96:111]
ds_read_b64_tr_b16 a[208:209], v21 offset:0
ds_read_b64_tr_b16 a[210:211], v21 offset:768
ds_read_b128 a[32:35], v16 offset:8192
v_mfma_f32_32x32x16_bf16 v[112:127], a[164:167], a[24:27], v[112:127]
ds_read_b64_tr_b16 a[212:213], v21 offset:32
ds_read_b64_tr_b16 a[214:215], v21 offset:800
ds_read_b128 a[36:39], v17 offset:8192
buffer_load_dwordx4 v14, s[8:11], s75 offen offset:2048 lds
v_mfma_f32_32x32x16_bf16 v[128:143], a[168:171], a[24:27], v[128:143]
ds_read_b64_tr_b16 a[216:217], v21 offset:64
ds_read_b64_tr_b16 a[218:219], v21 offset:832
v_mfma_f32_32x32x16_bf16 v[144:159], a[172:175], a[24:27], v[144:159]
ds_read_b64_tr_b16 a[220:221], v21 offset:96
ds_read_b64_tr_b16 a[222:223], v21 offset:864
ds_read_b128 a[40:43], v18 offset:8192
buffer_load_dwordx4 v15, s[8:11], s75 offen offset:3072 lds
v_mfma_f32_32x32x16_bf16 v[160:175], a[176:179], a[24:27], v[160:175]
ds_read_b64_tr_b16 a[224:225], v21 offset:128
ds_read_b64_tr_b16 a[226:227], v21 offset:896
ds_read_b128 a[44:47], v19 offset:8192
v_mfma_f32_32x32x16_bf16 v[176:191], a[180:183], a[24:27], v[176:191]
ds_read_b64_tr_b16 a[228:229], v21 offset:160
ds_read_b64_tr_b16 a[230:231], v21 offset:928
s_add_u32 s74, s54, 786432
s_add_u32 m0, s52, 0
s_nop 0
buffer_load_dwordx4 v2, s[12:15], s74 offen lds
s_waitcnt lgkmcnt(15)
v_mfma_f32_32x32x16_bf16 v[96:111], a[184:187], a[28:31], v[96:111]
ds_read_b64_tr_b16 a[160:161], v21 offset:3072
ds_read_b64_tr_b16 a[162:163], v21 offset:3840
v_mfma_f32_32x32x16_bf16 v[112:127], a[188:191], a[28:31], v[112:127]
ds_read_b64_tr_b16 a[164:165], v21 offset:3104
ds_read_b64_tr_b16 a[166:167], v21 offset:3872
buffer_load_dwordx4 v3, s[12:15], s74 offen offset:1024 lds
v_mfma_f32_32x32x16_bf16 v[128:143], a[192:195], a[28:31], v[128:143]
ds_read_b64_tr_b16 a[168:169], v21 offset:3136
ds_read_b64_tr_b16 a[170:171], v21 offset:3904
v_mfma_f32_32x32x16_bf16 v[144:159], a[196:199], a[28:31], v[144:159]
ds_read_b64_tr_b16 a[172:173], v21 offset:3168
ds_read_b64_tr_b16 a[174:175], v21 offset:3936
buffer_load_dwordx4 v4, s[12:15], s74 offen offset:2048 lds
v_mfma_f32_32x32x16_bf16 v[160:175], a[200:203], a[28:31], v[160:175]
ds_read_b64_tr_b16 a[176:177], v21 offset:3200
ds_read_b64_tr_b16 a[178:179], v21 offset:3968
v_mfma_f32_32x32x16_bf16 v[176:191], a[204:207], a[28:31], v[176:191]
ds_read_b64_tr_b16 a[180:181], v21 offset:3232
ds_read_b64_tr_b16 a[182:183], v21 offset:4000
s_add_u32 s74, s74, 49152
s_add_u32 m0, s52, 3072
s_nop 0
buffer_load_dwordx4 v2, s[12:15], s74 offen lds
v_mov_b32 v32, 0
v_mov_b32 v33, 0
v_mov_b32 v34, 0
s_waitcnt lgkmcnt(12)
v_mfma_f32_32x32x16_bf16 v[96:111], a[208:211], a[32:35], v[96:111]
ds_read_b64_tr_b16 a[184:185], v21 offset:6144
ds_read_b64_tr_b16 a[186:187], v21 offset:6912
v_mov_b32 v35, 0
v_lshlrev_b32 v36, 16, v192
v_and_b32 v37, 0xffff0000, v192
v_add_f32 v32, v32, v36
v_add_f32 v33, v33, v37
v_fmac_f32 v34, v36, v36
v_fmac_f32 v35, v37, v37
v_mfma_f32_32x32x16_bf16 v[112:127], a[212:215], a[32:35], v[112:127]
ds_read_b64_tr_b16 a[188:189], v21 offset:6176
ds_read_b64_tr_b16 a[190:191], v21 offset:6944
buffer_load_dwordx4 v3, s[12:15], s74 offen offset:1024 lds
v_lshlrev_b32 v36, 16, v193
v_and_b32 v37, 0xffff0000, v193
v_add_f32 v32, v32, v36
v_add_f32 v33, v33, v37
v_fmac_f32 v34, v36, v36
v_fmac_f32 v35, v37, v37
v_mfma_f32_32x32x16_bf16 v[128:143], a[216:219], a[32:35], v[128:143]
ds_read_b64_tr_b16 a[192:193], v21 offset:6208
ds_read_b64_tr_b16 a[194:195], v21 offset:6976
v_lshlrev_b32 v36, 16, v194
v_and_b32 v37, 0xffff0000, v194
v_add_f32 v32, v32, v36
v_add_f32 v33, v33, v37
v_fmac_f32 v34, v36, v36
v_fmac_f32 v35, v37, v37
v_lshlrev_b32 v36, 16, v195
v_mfma_f32_32x32x16_bf16 v[144:159], a[220:223], a[32:35], v[144:159]
ds_read_b64_tr_b16 a[196:197], v21 offset:6240
ds_read_b64_tr_b16 a[198:199], v21 offset:7008
buffer_load_dwordx4 v4, s[12:15], s74 offen offset:2048 lds
v_and_b32 v37, 0xffff0000, v195
v_add_f32 v32, v32, v36
v_add_f32 v33, v33, v37
v_fmac_f32 v34, v36, v36
v_fmac_f32 v35, v37, v37
v_lshlrev_b32 v36, 16, v196
v_mfma_f32_32x32x16_bf16 v[160:175], a[224:227], a[32:35], v[160:175]
ds_read_b64_tr_b16 a[200:201], v21 offset:6272
ds_read_b64_tr_b16 a[202:203], v21 offset:7040
v_and_b32 v37, 0xffff0000, v196
v_add_f32 v32, v32, v36
v_add_f32 v33, v33, v37
v_fmac_f32 v34, v36, v36
v_fmac_f32 v35, v37, v37
v_lshlrev_b32 v36, 16, v197
v_and_b32 v37, 0xffff0000, v197
v_mfma_f32_32x32x16_bf16 v[176:191], a[228:231], a[32:35], v[176:191]
ds_read_b64_tr_b16 a[204:205], v21 offset:6304
ds_read_b64_tr_b16 a[206:207], v21 offset:7072
s_add_u32 m0, s53, 8192
s_add_u32 s75, s56, 640
buffer_load_dwordx4 v12, s[8:11], s75 offen lds
v_add_f32 v32, v32, v36
v_add_f32 v33, v33, v37
v_fmac_f32 v34, v36, v36
v_fmac_f32 v35, v37, v37
s_waitcnt lgkmcnt(12)
v_mfma_f32_32x32x16_bf16 v[96:111], a[160:163], a[36:39], v[96:111]
ds_read_b64_tr_b16 a[208:209], v21 offset:9216
ds_read_b64_tr_b16 a[210:211], v21 offset:9984
v_lshlrev_b32 v36, 16, v198
v_and_b32 v37, 0xffff0000, v198
v_add_f32 v32, v32, v36
v_add_f32 v33, v33, v37
v_fmac_f32 v34, v36, v36
v_fmac_f32 v35, v37, v37
v_lshlrev_b32 v36, 16, v199
v_mfma_f32_32x32x16_bf16 v[112:127], a[164:167], a[36:39], v[112:127]
ds_read_b64_tr_b16 a[212:213], v21 offset:9248
ds_read_b64_tr_b16 a[214:215], v21 offset:10016
buffer_load_dwordx4 v13, s[8:11], s75 offen offset:1024 lds
v_and_b32 v37, 0xffff0000, v199
v_add_f32 v32, v32, v36
v_add_f32 v33, v33, v37
v_fmac_f32 v34, v36, v36
v_fmac_f32 v35, v37, v37
v_lshlrev_b32 v36, 16, v200
v_mfma_f32_32x32x16_bf16 v[128:143], a[168:171], a[36:39], v[128:143]
ds_read_b64_tr_b16 a[216:217], v21 offset:9280
ds_read_b64_tr_b16 a[218:219], v21 offset:10048
v_and_b32 v37, 0xffff0000, v200
v_add_f32 v32, v32, v36
v_add_f32 v33, v33, v37
v_fmac_f32 v34, v36, v36
v_fmac_f32 v35, v37, v37
v_lshlrev_b32 v36, 16, v201
v_and_b32 v37, 0xffff0000, v201
v_mfma_f32_32x32x16_bf16 v[144:159], a[172:175], a[36:39], v[144:159]
ds_read_b64_tr_b16 a[220:221], v21 offset:9312
ds_read_b64_tr_b16 a[222:223], v21 offset:10080
buffer_load_dwordx4 v14, s[8:11], s75 offen offset:2048 lds
v_add_f32 v32, v32, v36
v_add_f32 v33, v33, v37
v_fmac_f32 v34, v36, v36
v_fmac_f32 v35, v37, v37
v_add_f32 v32, v32, v33
v_add_f32 v34, v34, v35
v_mfma_f32_32x32x16_bf16 v[160:175], a[176:179], a[36:39], v[160:175]
ds_read_b64_tr_b16 a[224:225], v21 offset:9344
ds_read_b64_tr_b16 a[226:227], v21 offset:10112
v_add_f32_dpp v33, v32, v32 row_ror:8 row_mask:0xf bank_mask:0xf
v_add_f32_dpp v35, v34, v34 row_ror:8 row_mask:0xf bank_mask:0xf
s_nop 0
v_add_f32_dpp v32, v33, v33 row_ror:4 row_mask:0xf bank_mask:0xf
v_add_f32_dpp v34, v35, v35 row_ror:4 row_mask:0xf bank_mask:0xf
s_nop 0
v_add_f32_dpp v33, v32, v32 row_ror:2 row_mask:0xf bank_mask:0xf
v_add_f32_dpp v35, v34, v34 row_ror:2 row_mask:0xf bank_mask:0xf
s_nop 0
v_add_f32_dpp v32, v33, v33 row_ror:1 row_mask:0xf bank_mask:0xf
v_mfma_f32_32x32x16_bf16 v[176:191], a[180:183], a[36:39], v[176:191]
ds_read_b64_tr_b16 a[228:229], v21 offset:9376
ds_read_b64_tr_b16 a[230:231], v21 offset:10144
buffer_load_dwordx4 v15, s[8:11], s75 offen offset:3072 lds
v_add_f32_dpp v34, v35, v35 row_ror:1 row_mask:0xf bank_mask:0xf
v_mov_b32 v33, v32
v_mov_b32 v35, v34
s_nop 0
v_permlane16_swap_b32 v32, v33
v_permlane16_swap_b32 v34, v35
v_add_f32 v32, v32, v33
s_waitcnt vmcnt(14)
s_barrier
s_waitcnt lgkmcnt(12)
v_mfma_f32_32x32x16_bf16 v[96:111], a[184:187], a[40:43], v[96:111]
ds_read_b64_tr_b16 a[160:161], v21 offset:24704
ds_read_b64_tr_b16 a[162:163], v21 offset:25472
ds_read_b128 a[48:51], v16 offset:0
v_add_f32 v34, v34, v35
v_mul_f32 v32, 0x3acccccd, v32
v_mul_f32 v34, 0x3acccccd, v34
v_fma_f32 v34, -v32, v32, v34
v_max_f32 v34, 0, v34
v_add_f32 v34, 0x3727c5ac, v34
v_mfma_f32_32x32x16_bf16 v[112:127], a[188:191], a[40:43], v[112:127]
ds_read_b64_tr_b16 a[164:165], v21 offset:24736
ds_read_b64_tr_b16 a[166:167], v21 offset:25504
ds_read_b128 a[52:55], v17 offset:0
s_add_u32 s74, s54, 983040
s_add_u32 m0, s52, 24704
s_nop 0
buffer_load_dwordx4 v2, s[12:15], s74 offen lds
v_rsq_f32 v33, v34
v_mov_b32 v34, v32
v_mfma_f32_32x32x16_bf16 v[128:143], a[192:195], a[40:43], v[128:143]
ds_read_b64_tr_b16 a[168:169], v21 offset:24768
ds_read_b64_tr_b16 a[170:171], v21 offset:25536
v_mov_b32 v36, v32
v_and_b32 v38, 1, v1
v_mov_b32 v35, v33
v_mov_b32 v37, v33
v_permlane32_swap_b32 v36, v34
s_nop 0
v_permlane32_swap_b32 v37, v35
v_cmp_eq_u32 vcc, 1, v38
s_nop 1
v_cndmask_b32 v32, v32, v34, vcc
v_cndmask_b32 v33, v33, v35, vcc
v_mfma_f32_32x32x16_bf16 v[144:159], a[196:199], a[40:43], v[144:159]
ds_read_b64_tr_b16 a[172:173], v21 offset:24800
ds_read_b64_tr_b16 a[174:175], v21 offset:25568
ds_read_b128 a[56:59], v18 offset:0
buffer_load_dwordx4 v3, s[12:15], s74 offen offset:1024 lds
v_mov_b32 v30, v30
s_cmp_lg_u32 s48, 0
s_cbranch_scc1 NOKF
v_subrev_u32 v39, s92, v30
v_and_b32 v40, 1, v30
v_cmp_lt_u32 vcc, 0x40000000, v39
v_cmp_eq_u32 s[82:83], 0, v40
s_nop 3
s_or_b64 vcc, vcc, s[82:83]
s_cbranch_vccz NWRF
s_mov_b32 s68, 4000
v_mov_b32 v38, 0
NSPF:
s_sleep 8
buffer_load_dword v30, v38, s[28:31], 0 offen sc1
s_waitcnt vmcnt(0)
v_subrev_u32 v39, s92, v30
v_and_b32 v40, 1, v30
v_cmp_lt_u32 vcc, 0x40000000, v39
v_cmp_eq_u32 s[82:83], 0, v40
s_nop 3
s_or_b64 vcc, vcc, s[82:83]
s_sub_u32 s68, s68, 1
s_cbranch_vccz NWRF
s_cmp_lg_u32 s68, 0
s_cbranch_scc1 NSPF
NWRF:
v_mov_b32 v38, 131072
ds_write_b32 v38, v30 offset:30208
s_waitcnt lgkmcnt(0)
NOKF:
s_barrier
v_mov_b32 v38, 131072
ds_read_b32 v30, v38 offset:30208
v_mfma_f32_32x32x16_bf16 v[160:175], a[200:203], a[40:43], v[160:175]
ds_read_b64_tr_b16 a[176:177], v21 offset:24832
ds_read_b64_tr_b16 a[178:179], v21 offset:25600
ds_read_b128 a[60:63], v19 offset:0
s_waitcnt lgkmcnt(3)
v_mov_b32 v34, v30
v_mov_b32 v35, v30
buffer_store_dwordx4 v[32:35], v95, s[24:27], 0 offen sc1
s_barrier
s_lshl_b32 s60, s48, 5
v_add_u32 v80, s60, v81
ds_read_b64_tr_b16 a[232:233], v80
ds_read_b64_tr_b16 a[234:235], v80 offset:1280
ds_read_b64_tr_b16 a[236:237], v81 offset:128
ds_read_b64_tr_b16 a[238:239], v81 offset:1408
v_mfma_f32_32x32x16_bf16 v[176:191], a[204:207], a[40:43], v[176:191]
ds_read_b64_tr_b16 a[180:181], v21 offset:24864
ds_read_b64_tr_b16 a[182:183], v21 offset:25632
buffer_load_dwordx4 v4, s[12:15], s74 offen offset:2048 lds
s_lshl_b32 s60, s48, 10
s_add_u32 s60, s60, s99
s_add_u32 s60, s60, 0
s_waitcnt lgkmcnt(4)
buffer_store_dwordx4 a[232:235], v22, s[24:27], s60 offen sc1
s_add_u32 s60, s99, 4096
s_cmp_eq_u32 s48, 0
s_cselect_b32 s60, s60, 17825792
s_waitcnt lgkmcnt(2)
buffer_store_dwordx4 a[236:239], v22, s[24:27], s60 offen sc1
v_mfma_f32_32x32x16_bf16 v[96:111], a[208:211], a[44:47], v[96:111]
ds_read_b64_tr_b16 a[184:185], v21 offset:27776
ds_read_b64_tr_b16 a[186:187], v21 offset:28544
s_barrier
s_add_u32 s61, s98, 40960
s_lshl_b32 s62, s48, 10
s_add_u32 m0, s62, 147968
s_cmp_eq_u32 s48, 0
buffer_load_dwordx4 v82, s[32:35], s61 offen lds
s_cselect_b32 s61, s61, 2147483647
s_cselect_b32 s62, 0, 1024
s_add_u32 m0, s62, 152064
s_nop 0
buffer_load_dwordx4 v83, s[32:35], s61 offen lds
v_mfma_f32_32x32x16_bf16 v[112:127], a[212:215], a[44:47], v[112:127]
ds_read_b64_tr_b16 a[188:189], v21 offset:27808
ds_read_b64_tr_b16 a[190:191], v21 offset:28576
s_add_u32 s74, s74, 49152
s_add_u32 m0, s52, 27776
s_nop 0
buffer_load_dwordx4 v2, s[12:15], s74 offen lds
v_lshlrev_b32 v244, 16, v204
v_and_b32 v245, 0xffff0000, v204
v_lshlrev_b32 v246, 16, v205
v_mfma_f32_32x32x16_bf16 v[128:143], a[216:219], a[44:47], v[128:143]
ds_read_b64_tr_b16 a[192:193], v21 offset:27840
ds_read_b64_tr_b16 a[194:195], v21 offset:28608
v_and_b32 v247, 0xffff0000, v205
v_lshlrev_b32 v248, 16, v206
v_and_b32 v249, 0xffff0000, v206
v_lshlrev_b32 v250, 16, v207
v_and_b32 v251, 0xffff0000, v207
v_lshlrev_b32 v192, 16, v208
v_and_b32 v193, 0xffff0000, v208
v_mfma_f32_32x32x16_bf16 v[144:159], a[220:223], a[44:47], v[144:159]
ds_read_b64_tr_b16 a[196:197], v21 offset:27872
ds_read_b64_tr_b16 a[198:199], v21 offset:28640
buffer_load_dwordx4 v3, s[12:15], s74 offen offset:1024 lds
v_add_f32 v244, v244, v192
v_add_f32 v245, v245, v193
v_lshlrev_b32 v194, 16, v209
v_and_b32 v195, 0xffff0000, v209
v_add_f32 v246, v246, v194
v_add_f32 v247, v247, v195
v_mfma_f32_32x32x16_bf16 v[160:175], a[224:227], a[44:47], v[160:175]
ds_read_b64_tr_b16 a[200:201], v21 offset:27904
ds_read_b64_tr_b16 a[202:203], v21 offset:28672
v_lshlrev_b32 v196, 16, v210
v_and_b32 v197, 0xffff0000, v210
v_add_f32 v248, v248, v196
v_add_f32 v249, v249, v197
v_lshlrev_b32 v198, 16, v211
v_and_b32 v199, 0xffff0000, v211
v_add_f32 v250, v250, v198
v_mfma_f32_32x32x16_bf16 v[176:191], a[228:231], a[44:47], v[176:191]
ds_read_b64_tr_b16 a[204:205], v21 offset:27936
ds_read_b64_tr_b16 a[206:207], v21 offset:28704
buffer_load_dwordx4 v4, s[12:15], s74 offen offset:2048 lds
v_add_f32 v251, v251, v199
v_lshlrev_b32 v192, 16, v212
v_and_b32 v193, 0xffff0000, v212
v_add_f32 v244, v244, v192
v_add_f32 v245, v245, v193
v_lshlrev_b32 v194, 16, v213
s_waitcnt lgkmcnt(12)
v_mfma_f32_32x32x16_bf16 v[96:111], a[160:163], a[48:51], v[96:111]
ds_read_b64_tr_b16 a[208:209], v21 offset:30848
ds_read_b64_tr_b16 a[210:211], v21 offset:31616
v_and_b32 v195, 0xffff0000, v213
v_add_f32 v246, v246, v194
v_add_f32 v247, v247, v195
v_lshlrev_b32 v196, 16, v214
v_and_b32 v197, 0xffff0000, v214
v_add_f32 v248, v248, v196
v_add_f32 v249, v249, v197
v_mfma_f32_32x32x16_bf16 v[112:127], a[164:167], a[48:51], v[112:127]
ds_read_b64_tr_b16 a[212:213], v21 offset:30880
ds_read_b64_tr_b16 a[214:215], v21 offset:31648
s_add_u32 m0, s53, 0
s_add_u32 s75, s56, 768
buffer_load_dwordx4 v12, s[8:11], s75 offen lds
v_lshlrev_b32 v198, 16, v215
v_and_b32 v199, 0xffff0000, v215
v_add_f32 v250, v250, v198
v_add_f32 v251, v251, v199
v_mfma_f32_32x32x16_bf16 v[128:143], a[168:171], a[48:51], v[128:143]
ds_read_b64_tr_b16 a[216:217], v21 offset:30912
ds_read_b64_tr_b16 a[218:219], v21 offset:31680
v_lshlrev_b32 v192, 16, v216
v_and_b32 v193, 0xffff0000, v216
v_add_f32 v244, v244, v192
v_add_f32 v245, v245, v193
v_lshlrev_b32 v194, 16, v217
v_and_b32 v195, 0xffff0000, v217
v_add_f32 v246, v246, v194
v_mfma_f32_32x32x16_bf16 v[144:159], a[172:175], a[48:51], v[144:159]
ds_read_b64_tr_b16 a[220:221], v21 offset:30944
ds_read_b64_tr_b16 a[222:223], v21 offset:31712
buffer_load_dwordx4 v13, s[8:11], s75 offen offset:1024 lds
v_add_f32 v247, v247, v195
v_lshlrev_b32 v196, 16, v218
v_and_b32 v197, 0xffff0000, v218
v_add_f32 v248, v248, v196
v_add_f32 v249, v249, v197
v_lshlrev_b32 v198, 16, v219
v_mfma_f32_32x32x16_bf16 v[160:175], a[176:179], a[48:51], v[160:175]
ds_read_b64_tr_b16 a[224:225], v21 offset:30976
ds_read_b64_tr_b16 a[226:227], v21 offset:31744
v_and_b32 v199, 0xffff0000, v219
v_add_f32 v250, v250, v198
v_add_f32 v251, v251, v199
v_lshlrev_b32 v192, 16, v220
v_and_b32 v193, 0xffff0000, v220
v_add_f32 v244, v244, v192
v_add_f32 v245, v245, v193
v_mfma_f32_32x32x16_bf16 v[176:191], a[180:183], a[48:51], v[176:191]
ds_read_b64_tr_b16 a[228:229], v21 offset:31008
ds_read_b64_tr_b16 a[230:231], v21 offset:31776
buffer_load_dwordx4 v14, s[8:11], s75 offen offset:2048 lds
v_lshlrev_b32 v194, 16, v221
v_and_b32 v195, 0xffff0000, v221
v_add_f32 v246, v246, v194
v_add_f32 v247, v247, v195
v_lshlrev_b32 v196, 16, v222
v_and_b32 v197, 0xffff0000, v222
s_waitcnt lgkmcnt(12)
v_mfma_f32_32x32x16_bf16 v[96:111], a[184:187], a[52:55], v[96:111]
ds_read_b64_tr_b16 a[160:161], v21 offset:33920
ds_read_b64_tr_b16 a[162:163], v21 offset:34688
v_add_f32 v248, v248, v196
v_add_f32 v249, v249, v197
v_lshlrev_b32 v198, 16, v223
v_and_b32 v199, 0xffff0000, v223
v_add_f32 v250, v250, v198
v_add_f32 v251, v251, v199
v_lshlrev_b32 v192, 16, v224
v_mfma_f32_32x32x16_bf16 v[112:127], a[188:191], a[52:55], v[112:127]
ds_read_b64_tr_b16 a[164:165], v21 offset:33952
ds_read_b64_tr_b16 a[166:167], v21 offset:34720
buffer_load_dwordx4 v15, s[8:11], s75 offen offset:3072 lds
v_and_b32 v193, 0xffff0000, v224
v_add_f32 v244, v244, v192
v_add_f32 v245, v245, v193
v_lshlrev_b32 v194, 16, v225
v_and_b32 v195, 0xffff0000, v225
v_add_f32 v246, v246, v194
v_mfma_f32_32x32x16_bf16 v[128:143], a[192:195], a[52:55], v[128:143]
ds_read_b64_tr_b16 a[168:169], v21 offset:33984
ds_read_b64_tr_b16 a[170:171], v21 offset:34752
v_add_f32 v247, v247, v195
v_lshlrev_b32 v196, 16, v226
v_and_b32 v197, 0xffff0000, v226
v_add_f32 v248, v248, v196
v_add_f32 v249, v249, v197
v_lshlrev_b32 v198, 16, v227
v_and_b32 v199, 0xffff0000, v227
v_mfma_f32_32x32x16_bf16 v[144:159], a[196:199], a[52:55], v[144:159]
ds_read_b64_tr_b16 a[172:173], v21 offset:34016
ds_read_b64_tr_b16 a[174:175], v21 offset:34784
v_add_f32 v250, v250, v198
v_add_f32 v251, v251, v199
v_lshlrev_b32 v192, 16, v228
v_and_b32 v193, 0xffff0000, v228
v_add_f32 v244, v244, v192
v_add_f32 v245, v245, v193
v_lshlrev_b32 v194, 16, v229
v_mfma_f32_32x32x16_bf16 v[160:175], a[200:203], a[52:55], v[160:175]
ds_read_b64_tr_b16 a[176:177], v21 offset:34048
ds_read_b64_tr_b16 a[178:179], v21 offset:34816
v_and_b32 v195, 0xffff0000, v229
v_add_f32 v246, v246, v194
v_add_f32 v247, v247, v195
v_lshlrev_b32 v196, 16, v230
v_and_b32 v197, 0xffff0000, v230
v_add_f32 v248, v248, v196
v_add_f32 v249, v249, v197
v_mfma_f32_32x32x16_bf16 v[176:191], a[204:207], a[52:55], v[176:191]
ds_read_b64_tr_b16 a[180:181], v21 offset:34080
ds_read_b64_tr_b16 a[182:183], v21 offset:34848
v_lshlrev_b32 v198, 16, v231
v_and_b32 v199, 0xffff0000, v231
v_add_f32 v250, v250, v198
v_add_f32 v251, v251, v199
v_lshlrev_b32 v192, 16, v232
v_and_b32 v193, 0xffff0000, v232
v_add_f32 v244, v244, v192
s_waitcnt vmcnt(19)
s_barrier
s_waitcnt lgkmcnt(12)
v_mfma_f32_32x32x16_bf16 v[96:111], a[208:211], a[56:59], v[96:111]
ds_read_b64_tr_b16 a[184:185], v20 offset:0
ds_read_b64_tr_b16 a[186:187], v20 offset:768
ds_read_b128 a[64:67], v16 offset:4096
v_add_f32 v245, v245, v193
v_lshlrev_b32 v194, 16, v233
v_and_b32 v195, 0xffff0000, v233
v_add_f32 v246, v246, v194
v_add_f32 v247, v247, v195
v_lshlrev_b32 v196, 16, v234
v_mfma_f32_32x32x16_bf16 v[112:127], a[212:215], a[56:59], v[112:127]
ds_read_b64_tr_b16 a[188:189], v20 offset:32
ds_read_b64_tr_b16 a[190:191], v20 offset:800
ds_read_b128 a[68:71], v17 offset:4096
s_add_u32 s74, s54, 1179648
s_add_u32 m0, s52, 49408
s_nop 0
buffer_load_dwordx4 v2, s[12:15], s74 offen lds
v_and_b32 v197, 0xffff0000, v234
v_add_f32 v248, v248, v196
v_mfma_f32_32x32x16_bf16 v[128:143], a[216:219], a[56:59], v[128:143]
ds_read_b64_tr_b16 a[192:193], v20 offset:64
ds_read_b64_tr_b16 a[194:195], v20 offset:832
v_add_f32 v249, v249, v197
v_lshlrev_b32 v198, 16, v235
v_and_b32 v199, 0xffff0000, v235
v_add_f32 v250, v250, v198
v_add_f32 v251, v251, v199
v_lshlrev_b32 v192, 16, v236
v_and_b32 v193, 0xffff0000, v236
v_mfma_f32_32x32x16_bf16 v[144:159], a[220:223], a[56:59], v[144:159]
ds_read_b64_tr_b16 a[196:197], v20 offset:96
ds_read_b64_tr_b16 a[198:199], v20 offset:864
ds_read_b128 a[72:75], v18 offset:4096
buffer_load_dwordx4 v3, s[12:15], s74 offen offset:1024 lds
v_add_f32 v244, v244, v192
v_add_f32 v245, v245, v193
v_lshlrev_b32 v194, 16, v237
v_and_b32 v195, 0xffff0000, v237
v_add_f32 v246, v246, v194
v_mfma_f32_32x32x16_bf16 v[160:175], a[224:227], a[56:59], v[160:175]
ds_read_b64_tr_b16 a[200:201], v20 offset:128
ds_read_b64_tr_b16 a[202:203], v20 offset:896
ds_read_b128 a[76:79], v19 offset:4096
v_add_f32 v247, v247, v195
v_lshlrev_b32 v196, 16, v238
v_and_b32 v197, 0xffff0000, v238
v_add_f32 v248, v248, v196
v_add_f32 v249, v249, v197
v_lshlrev_b32 v198, 16, v239
v_mfma_f32_32x32x16_bf16 v[176:191], a[228:231], a[56:59], v[176:191]
ds_read_b64_tr_b16 a[204:205], v20 offset:160
ds_read_b64_tr_b16 a[206:207], v20 offset:928
buffer_load_dwordx4 v4, s[12:15], s74 offen offset:2048 lds
v_and_b32 v199, 0xffff0000, v239
v_add_f32 v250, v250, v198
v_add_f32 v251, v251, v199
v_lshlrev_b32 v192, 16, v240
v_and_b32 v193, 0xffff0000, v240
v_add_f32 v244, v244, v192
s_waitcnt lgkmcnt(15)
v_mfma_f32_32x32x16_bf16 v[96:111], a[160:163], a[60:63], v[96:111]
ds_read_b64_tr_b16 a[208:209], v20 offset:3072
ds_read_b64_tr_b16 a[210:211], v20 offset:3840
v_add_f32 v245, v245, v193
v_lshlrev_b32 v194, 16, v241
v_and_b32 v195, 0xffff0000, v241
v_add_f32 v246, v246, v194
v_add_f32 v247, v247, v195
v_lshlrev_b32 v196, 16, v242
v_and_b32 v197, 0xffff0000, v242
v_mfma_f32_32x32x16_bf16 v[112:127], a[164:167], a[60:63], v[112:127]
ds_read_b64_tr_b16 a[212:213], v20 offset:3104
ds_read_b64_tr_b16 a[214:215], v20 offset:3872
s_add_u32 s74, s74, 49152
s_add_u32 m0, s52, 52480
s_nop 0
buffer_load_dwordx4 v2, s[12:15], s74 offen lds
v_add_f32 v248, v248, v196
v_add_f32 v249, v249, v197
v_lshlrev_b32 v198, 16, v243
v_mfma_f32_32x32x16_bf16 v[128:143], a[168:171], a[60:63], v[128:143]
ds_read_b64_tr_b16 a[216:217], v20 offset:3136
ds_read_b64_tr_b16 a[218:219], v20 offset:3904
v_and_b32 v199, 0xffff0000, v243
v_add_f32 v250, v250, v198
v_add_f32 v251, v251, v199
v_mov_b32 v192, v244
v_mov_b32 v193, v245
v_mov_b32 v194, v246
v_mov_b32 v195, v247
v_mfma_f32_32x32x16_bf16 v[144:159], a[172:175], a[60:63], v[144:159]
ds_read_b64_tr_b16 a[220:221], v20 offset:3168
ds_read_b64_tr_b16 a[222:223], v20 offset:3936
buffer_load_dwordx4 v3, s[12:15], s74 offen offset:1024 lds
v_mov_b32 v196, v248
v_mov_b32 v197, v249
v_mov_b32 v198, v250
v_mov_b32 v199, v251
v_permlane16_swap_b32 v244, v192
v_permlane16_swap_b32 v245, v193
v_mfma_f32_32x32x16_bf16 v[160:175], a[176:179], a[60:63], v[160:175]
ds_read_b64_tr_b16 a[224:225], v20 offset:3200
ds_read_b64_tr_b16 a[226:227], v20 offset:3968
v_permlane16_swap_b32 v246, v194
v_permlane16_swap_b32 v247, v195
v_permlane16_swap_b32 v248, v196
v_permlane16_swap_b32 v249, v197
v_permlane16_swap_b32 v250, v198
v_permlane16_swap_b32 v251, v199
v_add_f32 v244, v244, v192
v_mfma_f32_32x32x16_bf16 v[176:191], a[180:183], a[60:63], v[176:191]
ds_read_b64_tr_b16 a[228:229], v20 offset:3232
ds_read_b64_tr_b16 a[230:231], v20 offset:4000
buffer_load_dwordx4 v4, s[12:15], s74 offen offset:2048 lds
v_add_f32 v245, v245, v193
v_add_f32 v246, v246, v194
v_add_f32 v247, v247, v195
v_add_f32 v248, v248, v196
v_add_f32 v249, v249, v197
v_add_f32 v250, v250, v198
s_waitcnt lgkmcnt(12)
v_mfma_f32_32x32x16_bf16 v[96:111], a[184:187], a[64:67], v[96:111]
ds_read_b64_tr_b16 a[160:161], v20 offset:6144
ds_read_b64_tr_b16 a[162:163], v20 offset:6912
v_add_f32 v251, v251, v199
v_mov_b32 v192, v244
v_mov_b32 v193, v245
v_mov_b32 v194, v246
v_mov_b32 v195, v247
v_mov_b32 v196, v248
v_mov_b32 v197, v249
v_mfma_f32_32x32x16_bf16 v[112:127], a[188:191], a[64:67], v[112:127]
ds_read_b64_tr_b16 a[164:165], v20 offset:6176
ds_read_b64_tr_b16 a[166:167], v20 offset:6944
s_add_u32 m0, s53, 4096
s_add_u32 s75, s56, 896
buffer_load_dwordx4 v12, s[8:11], s75 offen lds
v_mov_b32 v198, v250
v_mov_b32 v199, v251
v_permlane32_swap_b32 v244, v192
v_permlane32_swap_b32 v245, v193
v_mfma_f32_32x32x16_bf16 v[128:143], a[192:195], a[64:67], v[128:143]
ds_read_b64_tr_b16 a[168:169], v20 offset:6208
ds_read_b64_tr_b16 a[170:171], v20 offset:6976
v_permlane32_swap_b32 v246, v194
v_permlane32_swap_b32 v247, v195
v_permlane32_swap_b32 v248, v196
v_permlane32_swap_b32 v249, v197
v_permlane32_swap_b32 v250, v198
v_permlane32_swap_b32 v251, v199
v_add_f32 v244, v244, v192
v_mfma_f32_32x32x16_bf16 v[144:159], a[196:199], a[64:67], v[144:159]
ds_read_b64_tr_b16 a[172:173], v20 offset:6240
ds_read_b64_tr_b16 a[174:175], v20 offset:7008
buffer_load_dwordx4 v13, s[8:11], s75 offen offset:1024 lds
v_add_f32 v245, v245, v193
v_add_f32 v246, v246, v194
v_add_f32 v247, v247, v195
v_add_f32 v248, v248, v196
v_add_f32 v249, v249, v197
v_add_f32 v250, v250, v198
v_mfma_f32_32x32x16_bf16 v[160:175], a[200:203], a[64:67], v[160:175]
ds_read_b64_tr_b16 a[176:177], v20 offset:6272
ds_read_b64_tr_b16 a[178:179], v20 offset:7040
v_add_f32 v251, v251, v199
s_lshl_b32 s60, s48, 10
s_add_u32 s60, s60, 154112
v_lshlrev_b32 v192, 5, v1
v_add_u32 v192, s60, v192
v_and_b32 v193, 31, v1
v_mul_u32_u24 v193, 12, v193
v_add_u32 v193, s60, v193
s_mov_b64 s[82:83], exec
s_mov_b64 exec, 0xffff
ds_write_b128 v192, v[244:247]
ds_write_b128 v192, v[248:251] offset:16
s_mov_b64 exec, s[82:83]
v_mfma_f32_32x32x16_bf16 v[176:191], a[204:207], a[64:67], v[176:191]
ds_read_b64_tr_b16 a[180:181], v20 offset:6304
ds_read_b64_tr_b16 a[182:183], v20 offset:7072
buffer_load_dwordx4 v14, s[8:11], s75 offen offset:2048 lds
s_waitcnt lgkmcnt(2)
ds_read_b32 v196, v193
ds_read_b32 v197, v193 offset:4
ds_read_b32 v198, v193 offset:8
v_mov_b32 v199, v30
s_waitcnt lgkmcnt(0)
buffer_store_dwordx4 v[196:199], v94, s[24:27], 0 offen sc1
s_waitcnt vmcnt(17)
s_barrier
v_mfma_f32_32x32x16_bf16 v[96:111], a[208:211], a[68:71], v[96:111]
ds_read_b64_tr_b16 a[184:185], v20 offset:9216
ds_read_b64_tr_b16 a[186:187], v20 offset:9984
s_lshl_b32 s60, s48, 5
v_add_u32 v80, s60, v81
ds_read_b64_tr_b16 a[232:233], v80
ds_read_b64_tr_b16 a[234:235], v80 offset:1280
ds_read_b64_tr_b16 a[236:237], v81 offset:128
ds_read_b64_tr_b16 a[238:239], v81 offset:1408
s_lshl_b32 s60, s48, 10
s_add_u32 s60, s60, s99
s_add_u32 s60, s60, 5120
s_waitcnt lgkmcnt(2)
buffer_store_dwordx4 a[232:235], v22, s[24:27], s60 offen sc1
s_add_u32 s60, s99, 9216
s_cmp_eq_u32 s48, 0
s_cselect_b32 s60, s60, 17825792
s_waitcnt lgkmcnt(0)
buffer_store_dwordx4 a[236:239], v22, s[24:27], s60 offen sc1
v_mfma_f32_32x32x16_bf16 v[112:127], a[212:215], a[68:71], v[112:127]
ds_read_b64_tr_b16 a[188:189], v20 offset:9248
ds_read_b64_tr_b16 a[190:191], v20 offset:10016
buffer_load_dwordx4 v15, s[8:11], s75 offen offset:3072 lds
s_barrier
v_mfma_f32_32x32x16_bf16 v[128:143], a[216:219], a[68:71], v[128:143]
ds_read_b64_tr_b16 a[192:193], v20 offset:9280
ds_read_b64_tr_b16 a[194:195], v20 offset:10048
v_mfma_f32_32x32x16_bf16 v[144:159], a[220:223], a[68:71], v[144:159]
ds_read_b64_tr_b16 a[196:197], v20 offset:9312
ds_read_b64_tr_b16 a[198:199], v20 offset:10080
v_mfma_f32_32x32x16_bf16 v[160:175], a[224:227], a[68:71], v[160:175]
ds_read_b64_tr_b16 a[200:201], v20 offset:9344
ds_read_b64_tr_b16 a[202:203], v20 offset:10112
v_mfma_f32_32x32x16_bf16 v[176:191], a[228:231], a[68:71], v[176:191]
ds_read_b64_tr_b16 a[204:205], v20 offset:9376
ds_read_b64_tr_b16 a[206:207], v20 offset:10144
s_waitcnt vmcnt(17)
s_barrier
v_mfma_f32_32x32x16_bf16 v[96:111], a[160:163], a[72:75], v[96:111]
ds_read_b64_tr_b16 a[208:209], v20 offset:24704
ds_read_b64_tr_b16 a[210:211], v20 offset:25472
ds_read_b128 a[80:83], v16 offset:8192
v_mfma_f32_32x32x16_bf16 v[112:127], a[164:167], a[72:75], v[112:127]
ds_read_b64_tr_b16 a[212:213], v20 offset:24736
ds_read_b64_tr_b16 a[214:215], v20 offset:25504
ds_read_b128 a[84:87], v17 offset:8192
s_add_u32 s74, s54, 1376256
s_add_u32 m0, s52, 74112
s_nop 0
buffer_load_dwordx4 v2, s[12:15], s74 offen lds
v_mfma_f32_32x32x16_bf16 v[128:143], a[168:171], a[72:75], v[128:143]
ds_read_b64_tr_b16 a[216:217], v20 offset:24768
ds_read_b64_tr_b16 a[218:219], v20 offset:25536
v_mfma_f32_32x32x16_bf16 v[144:159], a[172:175], a[72:75], v[144:159]
ds_read_b64_tr_b16 a[220:221], v20 offset:24800
ds_read_b64_tr_b16 a[222:223], v20 offset:25568
ds_read_b128 a[88:91], v18 offset:8192
buffer_load_dwordx4 v3, s[12:15], s74 offen offset:1024 lds
v_mfma_f32_32x32x16_bf16 v[160:175], a[176:179], a[72:75], v[160:175]
ds_read_b64_tr_b16 a[224:225], v20 offset:24832
ds_read_b64_tr_b16 a[226:227], v20 offset:25600
ds_read_b128 a[92:95], v19 offset:8192
v_mfma_f32_32x32x16_bf16 v[176:191], a[180:183], a[72:75], v[176:191]
ds_read_b64_tr_b16 a[228:229], v20 offset:24864
ds_read_b64_tr_b16 a[230:231], v20 offset:25632
buffer_load_dwordx4 v4, s[12:15], s74 offen offset:2048 lds
s_waitcnt lgkmcnt(15)
v_mfma_f32_32x32x16_bf16 v[96:111], a[184:187], a[76:79], v[96:111]
ds_read_b64_tr_b16 a[160:161], v20 offset:27776
ds_read_b64_tr_b16 a[162:163], v20 offset:28544
v_mfma_f32_32x32x16_bf16 v[112:127], a[188:191], a[76:79], v[112:127]
ds_read_b64_tr_b16 a[164:165], v20 offset:27808
ds_read_b64_tr_b16 a[166:167], v20 offset:28576
s_add_u32 s74, s74, 49152
s_add_u32 m0, s52, 77184
s_nop 0
buffer_load_dwordx4 v2, s[12:15], s74 offen lds
v_mfma_f32_32x32x16_bf16 v[128:143], a[192:195], a[76:79], v[128:143]
ds_read_b64_tr_b16 a[168:169], v20 offset:27840
ds_read_b64_tr_b16 a[170:171], v20 offset:28608
v_mfma_f32_32x32x16_bf16 v[144:159], a[196:199], a[76:79], v[144:159]
ds_read_b64_tr_b16 a[172:173], v20 offset:27872
ds_read_b64_tr_b16 a[174:175], v20 offset:28640
buffer_load_dwordx4 v3, s[12:15], s74 offen offset:1024 lds
v_mfma_f32_32x32x16_bf16 v[160:175], a[200:203], a[76:79], v[160:175]
ds_read_b64_tr_b16 a[176:177], v20 offset:27904
ds_read_b64_tr_b16 a[178:179], v20 offset:28672
v_mfma_f32_32x32x16_bf16 v[176:191], a[204:207], a[76:79], v[176:191]
ds_read_b64_tr_b16 a[180:181], v20 offset:27936
ds_read_b64_tr_b16 a[182:183], v20 offset:28704
buffer_load_dwordx4 v4, s[12:15], s74 offen offset:2048 lds
s_waitcnt lgkmcnt(12)
v_mfma_f32_32x32x16_bf16 v[96:111], a[208:211], a[80:83], v[96:111]
ds_read_b64_tr_b16 a[184:185], v20 offset:30848
ds_read_b64_tr_b16 a[186:187], v20 offset:31616
v_mfma_f32_32x32x16_bf16 v[112:127], a[212:215], a[80:83], v[112:127]
ds_read_b64_tr_b16 a[188:189], v20 offset:30880
ds_read_b64_tr_b16 a[190:191], v20 offset:31648
s_add_u32 m0, s53, 8192
s_add_u32 s75, s56, 1024
buffer_load_dwordx4 v12, s[8:11], s75 offen lds
v_mfma_f32_32x32x16_bf16 v[128:143], a[216:219], a[80:83], v[128:143]
ds_read_b64_tr_b16 a[192:193], v20 offset:30912
ds_read_b64_tr_b16 a[194:195], v20 offset:31680
v_mfma_f32_32x32x16_bf16 v[144:159], a[220:223], a[80:83], v[144:159]
ds_read_b64_tr_b16 a[196:197], v20 offset:30944
ds_read_b64_tr_b16 a[198:199], v20 offset:31712
buffer_load_dwordx4 v13, s[8:11], s75 offen offset:1024 lds
v_mfma_f32_32x32x16_bf16 v[160:175], a[224:227], a[80:83], v[160:175]
ds_read_b64_tr_b16 a[200:201], v20 offset:30976
ds_read_b64_tr_b16 a[202:203], v20 offset:31744
v_mfma_f32_32x32x16_bf16 v[176:191], a[228:231], a[80:83], v[176:191]
ds_read_b64_tr_b16 a[204:205], v20 offset:31008
ds_read_b64_tr_b16 a[206:207], v20 offset:31776
buffer_load_dwordx4 v14, s[8:11], s75 offen offset:2048 lds
s_waitcnt lgkmcnt(12)
v_mfma_f32_32x32x16_bf16 v[96:111], a[160:163], a[84:87], v[96:111]
ds_read_b64_tr_b16 a[208:209], v20 offset:33920
ds_read_b64_tr_b16 a[210:211], v20 offset:34688
v_mfma_f32_32x32x16_bf16 v[112:127], a[164:167], a[84:87], v[112:127]
ds_read_b64_tr_b16 a[212:213], v20 offset:33952
ds_read_b64_tr_b16 a[214:215], v20 offset:34720
buffer_load_dwordx4 v15, s[8:11], s75 offen offset:3072 lds
v_mfma_f32_32x32x16_bf16 v[128:143], a[168:171], a[84:87], v[128:143]
ds_read_b64_tr_b16 a[216:217], v20 offset:33984
ds_read_b64_tr_b16 a[218:219], v20 offset:34752
v_mfma_f32_32x32x16_bf16 v[144:159], a[172:175], a[84:87], v[144:159]
ds_read_b64_tr_b16 a[220:221], v20 offset:34016
ds_read_b64_tr_b16 a[222:223], v20 offset:34784
v_mfma_f32_32x32x16_bf16 v[160:175], a[176:179], a[84:87], v[160:175]
ds_read_b64_tr_b16 a[224:225], v20 offset:34048
ds_read_b64_tr_b16 a[226:227], v20 offset:34816
v_mfma_f32_32x32x16_bf16 v[176:191], a[180:183], a[84:87], v[176:191]
ds_read_b64_tr_b16 a[228:229], v20 offset:34080
ds_read_b64_tr_b16 a[230:231], v20 offset:34848
s_waitcnt vmcnt(17)
s_barrier
s_waitcnt lgkmcnt(12)
v_mfma_f32_32x32x16_bf16 v[96:111], a[184:187], a[88:91], v[96:111]
ds_read_b64_tr_b16 a[160:161], v21 offset:0
ds_read_b64_tr_b16 a[162:163], v21 offset:768
ds_read_b128 a[96:99], v16 offset:0
v_mfma_f32_32x32x16_bf16 v[112:127], a[188:191], a[88:91], v[112:127]
ds_read_b64_tr_b16 a[164:165], v21 offset:32
ds_read_b64_tr_b16 a[166:167], v21 offset:800
ds_read_b128 a[100:103], v17 offset:0
s_add_u32 s74, s54, 1572864
s_add_u32 m0, s52, 0
s_nop 0
buffer_load_dwordx4 v2, s[12:15], s74 offen lds
v_mfma_f32_32x32x16_bf16 v[128:143], a[192:195], a[88:91], v[128:143]
ds_read_b64_tr_b16 a[168:169], v21 offset:64
ds_read_b64_tr_b16 a[170:171], v21 offset:832
v_mfma_f32_32x32x16_bf16 v[144:159], a[196:199], a[88:91], v[144:159]
ds_read_b64_tr_b16 a[172:173], v21 offset:96
ds_read_b64_tr_b16 a[174:175], v21 offset:864
ds_read_b128 a[104:107], v18 offset:0
buffer_load_dwordx4 v3, s[12:15], s74 offen offset:1024 lds
v_mfma_f32_32x32x16_bf16 v[160:175], a[200:203], a[88:91], v[160:175]
ds_read_b64_tr_b16 a[176:177], v21 offset:128
ds_read_b64_tr_b16 a[178:179], v21 offset:896
ds_read_b128 a[108:111], v19 offset:0
v_mfma_f32_32x32x16_bf16 v[176:191], a[204:207], a[88:91], v[176:191]
ds_read_b64_tr_b16 a[180:181], v21 offset:160
ds_read_b64_tr_b16 a[182:183], v21 offset:928
buffer_load_dwordx4 v4, s[12:15], s74 offen offset:2048 lds
s_waitcnt lgkmcnt(15)
v_mfma_f32_32x32x16_bf16 v[96:111], a[208:211], a[92:95], v[96:111]
ds_read_b64_tr_b16 a[184:185], v21 offset:3072
ds_read_b64_tr_b16 a[186:187], v21 offset:3840
v_mfma_f32_32x32x16_bf16 v[112:127], a[212:215], a[92:95], v[112:127]
ds_read_b64_tr_b16 a[188:189], v21 offset:3104
ds_read_b64_tr_b16 a[190:191], v21 offset:3872
s_add_u32 s74, s74, 49152
s_add_u32 m0, s52, 3072
s_nop 0
buffer_load_dwordx4 v2, s[12:15], s74 offen lds
v_mfma_f32_32x32x16_bf16 v[128:143], a[216:219], a[92:95], v[128:143]
ds_read_b64_tr_b16 a[192:193], v21 offset:3136
ds_read_b64_tr_b16 a[194:195], v21 offset:3904
v_mfma_f32_32x32x16_bf16 v[144:159], a[220:223], a[92:95], v[144:159]
ds_read_b64_tr_b16 a[196:197], v21 offset:3168
ds_read_b64_tr_b16 a[198:199], v21 offset:3936
buffer_load_dwordx4 v3, s[12:15], s74 offen offset:1024 lds
v_mfma_f32_32x32x16_bf16 v[160:175], a[224:227], a[92:95], v[160:175]
ds_read_b64_tr_b16 a[200:201], v21 offset:3200
ds_read_b64_tr_b16 a[202:203], v21 offset:3968
v_mfma_f32_32x32x16_bf16 v[176:191], a[228:231], a[92:95], v[176:191]
ds_read_b64_tr_b16 a[204:205], v21 offset:3232
ds_read_b64_tr_b16 a[206:207], v21 offset:4000
buffer_load_dwordx4 v4, s[12:15], s74 offen offset:2048 lds
s_waitcnt lgkmcnt(12)
v_mfma_f32_32x32x16_bf16 v[96:111], a[160:163], a[96:99], v[96:111]
ds_read_b64_tr_b16 a[208:209], v21 offset:6144
ds_read_b64_tr_b16 a[210:211], v21 offset:6912
v_mfma_f32_32x32x16_bf16 v[112:127], a[164:167], a[96:99], v[112:127]
ds_read_b64_tr_b16 a[212:213], v21 offset:6176
ds_read_b64_tr_b16 a[214:215], v21 offset:6944
s_add_u32 m0, s53, 0
s_add_u32 s75, s56, 1152
buffer_load_dwordx4 v12, s[8:11], s75 offen lds
v_mfma_f32_32x32x16_bf16 v[128:143], a[168:171], a[96:99], v[128:143]
ds_read_b64_tr_b16 a[216:217], v21 offset:6208
ds_read_b64_tr_b16 a[218:219], v21 offset:6976
v_mfma_f32_32x32x16_bf16 v[144:159], a[172:175], a[96:99], v[144:159]
ds_read_b64_tr_b16 a[220:221], v21 offset:6240
ds_read_b64_tr_b16 a[222:223], v21 offset:7008
buffer_load_dwordx4 v13, s[8:11], s75 offen offset:1024 lds
v_mfma_f32_32x32x16_bf16 v[160:175], a[176:179], a[96:99], v[160:175]
ds_read_b64_tr_b16 a[224:225], v21 offset:6272
ds_read_b64_tr_b16 a[226:227], v21 offset:7040
v_mfma_f32_32x32x16_bf16 v[176:191], a[180:183], a[96:99], v[176:191]
ds_read_b64_tr_b16 a[228:229], v21 offset:6304
ds_read_b64_tr_b16 a[230:231], v21 offset:7072
buffer_load_dwordx4 v14, s[8:11], s75 offen offset:2048 lds
s_waitcnt lgkmcnt(12)
v_mfma_f32_32x32x16_bf16 v[96:111], a[184:187], a[100:103], v[96:111]
ds_read_b64_tr_b16 a[160:161], v21 offset:9216
ds_read_b64_tr_b16 a[162:163], v21 offset:9984
v_mfma_f32_32x32x16_bf16 v[112:127], a[188:191], a[100:103], v[112:127]
ds_read_b64_tr_b16 a[164:165], v21 offset:9248
ds_read_b64_tr_b16 a[166:167], v21 offset:10016
buffer_load_dwordx4 v15, s[8:11], s75 offen offset:3072 lds
v_mfma_f32_32x32x16_bf16 v[128:143], a[192:195], a[100:103], v[128:143]
ds_read_b64_tr_b16 a[168:169], v21 offset:9280
ds_read_b64_tr_b16 a[170:171], v21 offset:10048
v_mfma_f32_32x32x16_bf16 v[144:159], a[196:199], a[100:103], v[144:159]
ds_read_b64_tr_b16 a[172:173], v21 offset:9312
ds_read_b64_tr_b16 a[174:175], v21 offset:10080
v_mfma_f32_32x32x16_bf16 v[160:175], a[200:203], a[100:103], v[160:175]
ds_read_b64_tr_b16 a[176:177], v21 offset:9344
ds_read_b64_tr_b16 a[178:179], v21 offset:10112
v_mfma_f32_32x32x16_bf16 v[176:191], a[204:207], a[100:103], v[176:191]
ds_read_b64_tr_b16 a[180:181], v21 offset:9376
ds_read_b64_tr_b16 a[182:183], v21 offset:10144
s_waitcnt vmcnt(14)
s_barrier
s_waitcnt lgkmcnt(12)
v_mfma_f32_32x32x16_bf16 v[96:111], a[208:211], a[104:107], v[96:111]
ds_read_b64_tr_b16 a[184:185], v21 offset:24704
ds_read_b64_tr_b16 a[186:187], v21 offset:25472
ds_read_b128 a[112:115], v16 offset:4096
v_mfma_f32_32x32x16_bf16 v[112:127], a[212:215], a[104:107], v[112:127]
ds_read_b64_tr_b16 a[188:189], v21 offset:24736
ds_read_b64_tr_b16 a[190:191], v21 offset:25504
ds_read_b128 a[116:119], v17 offset:4096
s_add_u32 s74, s54, 1769472
s_add_u32 m0, s52, 24704
s_nop 0
buffer_load_dwordx4 v2, s[12:15], s74 offen lds
v_mfma_f32_32x32x16_bf16 v[128:143], a[216:219], a[104:107], v[128:143]
ds_read_b64_tr_b16 a[192:193], v21 offset:24768
ds_read_b64_tr_b16 a[194:195], v21 offset:25536
v_mfma_f32_32x32x16_bf16 v[144:159], a[220:223], a[104:107], v[144:159]
ds_read_b64_tr_b16 a[196:197], v21 offset:24800
ds_read_b64_tr_b16 a[198:199], v21 offset:25568
ds_read_b128 a[120:123], v18 offset:4096
buffer_load_dwordx4 v3, s[12:15], s74 offen offset:1024 lds
v_mfma_f32_32x32x16_bf16 v[160:175], a[224:227], a[104:107], v[160:175]
ds_read_b64_tr_b16 a[200:201], v21 offset:24832
ds_read_b64_tr_b16 a[202:203], v21 offset:25600
ds_read_b128 a[124:127], v19 offset:4096
v_mfma_f32_32x32x16_bf16 v[176:191], a[228:231], a[104:107], v[176:191]
ds_read_b64_tr_b16 a[204:205], v21 offset:24864
ds_read_b64_tr_b16 a[206:207], v21 offset:25632
buffer_load_dwordx4 v4, s[12:15], s74 offen offset:2048 lds
s_waitcnt lgkmcnt(15)
v_mfma_f32_32x32x16_bf16 v[96:111], a[160:163], a[108:111], v[96:111]
ds_read_b64_tr_b16 a[208:209], v21 offset:27776
ds_read_b64_tr_b16 a[210:211], v21 offset:28544
v_mfma_f32_32x32x16_bf16 v[112:127], a[164:167], a[108:111], v[112:127]
ds_read_b64_tr_b16 a[212:213], v21 offset:27808
ds_read_b64_tr_b16 a[214:215], v21 offset:28576
s_add_u32 s74, s74, 49152
s_add_u32 m0, s52, 27776
s_nop 0
buffer_load_dwordx4 v2, s[12:15], s74 offen lds
v_mfma_f32_32x32x16_bf16 v[128:143], a[168:171], a[108:111], v[128:143]
ds_read_b64_tr_b16 a[216:217], v21 offset:27840
ds_read_b64_tr_b16 a[218:219], v21 offset:28608
v_mfma_f32_32x32x16_bf16 v[144:159], a[172:175], a[108:111], v[144:159]
ds_read_b64_tr_b16 a[220:221], v21 offset:27872
ds_read_b64_tr_b16 a[222:223], v21 offset:28640
buffer_load_dwordx4 v3, s[12:15], s74 offen offset:1024 lds
v_mfma_f32_32x32x16_bf16 v[160:175], a[176:179], a[108:111], v[160:175]
ds_read_b64_tr_b16 a[224:225], v21 offset:27904
ds_read_b64_tr_b16 a[226:227], v21 offset:28672
v_mfma_f32_32x32x16_bf16 v[176:191], a[180:183], a[108:111], v[176:191]
ds_read_b64_tr_b16 a[228:229], v21 offset:27936
ds_read_b64_tr_b16 a[230:231], v21 offset:28704
buffer_load_dwordx4 v4, s[12:15], s74 offen offset:2048 lds
s_waitcnt lgkmcnt(12)
v_mfma_f32_32x32x16_bf16 v[96:111], a[184:187], a[112:115], v[96:111]
ds_read_b64_tr_b16 a[160:161], v21 offset:30848
ds_read_b64_tr_b16 a[162:163], v21 offset:31616
v_mfma_f32_32x32x16_bf16 v[112:127], a[188:191], a[112:115], v[112:127]
ds_read_b64_tr_b16 a[164:165], v21 offset:30880
ds_read_b64_tr_b16 a[166:167], v21 offset:31648
v_mfma_f32_32x32x16_bf16 v[128:143], a[192:195], a[112:115], v[128:143]
ds_read_b64_tr_b16 a[168:169], v21 offset:30912
ds_read_b64_tr_b16 a[170:171], v21 offset:31680
v_mfma_f32_32x32x16_bf16 v[144:159], a[196:199], a[112:115], v[144:159]
ds_read_b64_tr_b16 a[172:173], v21 offset:30944
ds_read_b64_tr_b16 a[174:175], v21 offset:31712
v_mfma_f32_32x32x16_bf16 v[160:175], a[200:203], a[112:115], v[160:175]
ds_read_b64_tr_b16 a[176:177], v21 offset:30976
ds_read_b64_tr_b16 a[178:179], v21 offset:31744
v_mfma_f32_32x32x16_bf16 v[176:191], a[204:207], a[112:115], v[176:191]
ds_read_b64_tr_b16 a[180:181], v21 offset:31008
ds_read_b64_tr_b16 a[182:183], v21 offset:31776
s_waitcnt lgkmcnt(12)
v_mfma_f32_32x32x16_bf16 v[96:111], a[208:211], a[116:119], v[96:111]
ds_read_b64_tr_b16 a[184:185], v21 offset:33920
ds_read_b64_tr_b16 a[186:187], v21 offset:34688
v_mfma_f32_32x32x16_bf16 v[112:127], a[212:215], a[116:119], v[112:127]
ds_read_b64_tr_b16 a[188:189], v21 offset:33952
ds_read_b64_tr_b16 a[190:191], v21 offset:34720
v_mfma_f32_32x32x16_bf16 v[128:143], a[216:219], a[116:119], v[128:143]
ds_read_b64_tr_b16 a[192:193], v21 offset:33984
ds_read_b64_tr_b16 a[194:195], v21 offset:34752
v_mfma_f32_32x32x16_bf16 v[144:159], a[220:223], a[116:119], v[144:159]
ds_read_b64_tr_b16 a[196:197], v21 offset:34016
ds_read_b64_tr_b16 a[198:199], v21 offset:34784
v_mfma_f32_32x32x16_bf16 v[160:175], a[224:227], a[116:119], v[160:175]
ds_read_b64_tr_b16 a[200:201], v21 offset:34048
ds_read_b64_tr_b16 a[202:203], v21 offset:34816
v_mfma_f32_32x32x16_bf16 v[176:191], a[228:231], a[116:119], v[176:191]
ds_read_b64_tr_b16 a[204:205], v21 offset:34080
ds_read_b64_tr_b16 a[206:207], v21 offset:34848
v_and_b32 v36, 31, v1
v_lshrrev_b32 v37, 1, v36
v_lshlrev_b32 v37, 7, v37
v_and_b32 v38, 1, v36
v_lshl_add_u32 v41, v38, 4, v37
s_lshl_b32 s47, s49, 2
s_add_u32 s47, s47, s48
s_lshl_b32 s47, s47, 11
s_add_u32 s47, s47, 14680064
s_lshl_b32 s46, s50, 15
s_lshl_b32 s60, s48, 9
s_add_u32 s46, s46, s60
s_add_u32 s46, s46, 15728640
s_waitcnt vmcnt(10)
s_barrier
s_waitcnt lgkmcnt(12)
v_mfma_f32_32x32x16_bf16 v[96:111], a[160:163], a[120:123], v[96:111]
ds_read_b64_tr_b16 a[208:209], v20 offset:0
ds_read_b64_tr_b16 a[210:211], v20 offset:768
ds_read_b128 a[128:131], v16 offset:8192
v_lshrrev_b32 v37, 5, v1
v_lshlrev_b32 v37, 14, v37
v_lshl_add_u32 v37, v36, 4, v37
v_add_u32 v38, 4096, v37
v_add_u32 v39, 8192, v37
v_add_u32 v40, 12288, v37
v_mfma_f32_32x32x16_bf16 v[112:127], a[164:167], a[120:123], v[112:127]
ds_read_b64_tr_b16 a[212:213], v20 offset:32
ds_read_b64_tr_b16 a[214:215], v20 offset:800
ds_read_b128 a[132:135], v17 offset:8192
s_add_u32 s74, s55, 0
s_add_u32 m0, s80, 49408
s_nop 0
buffer_load_dwordx4 v7, s[16:19], s74 offen lds
v_mov_b32 v36, v41
buffer_load_dwordx4 v[44:47], v36, s[24:27], s47 offen sc1
v_mfma_f32_32x32x16_bf16 v[128:143], a[168:171], a[120:123], v[128:143]
ds_read_b64_tr_b16 a[216:217], v20 offset:64
ds_read_b64_tr_b16 a[218:219], v20 offset:832
buffer_load_dwordx4 v[48:51], v37, s[24:27], s46 offen sc1
buffer_load_dwordx4 v[52:55], v37, s[24:27], s46 offen offset:2048 sc1
buffer_load_dwordx4 v[56:59], v38, s[24:27], s46 offen sc1
buffer_load_dwordx4 v[60:63], v38, s[24:27], s46 offen offset:2048 sc1
buffer_load_dwordx4 v[64:67], v39, s[24:27], s46 offen sc1
buffer_load_dwordx4 v[68:71], v39, s[24:27], s46 offen offset:2048 sc1
buffer_load_dwordx4 v[72:75], v40, s[24:27], s46 offen sc1
v_mfma_f32_32x32x16_bf16 v[144:159], a[172:175], a[120:123], v[144:159]
ds_read_b64_tr_b16 a[220:221], v20 offset:96
ds_read_b64_tr_b16 a[222:223], v20 offset:864
ds_read_b128 a[136:139], v18 offset:8192
buffer_load_dwordx4 v8, s[16:19], s74 offen offset:1024 lds
buffer_load_dwordx4 v[76:79], v40, s[24:27], s46 offen offset:2048 sc1
v_mfma_f32_32x32x16_bf16 v[160:175], a[176:179], a[120:123], v[160:175]
ds_read_b64_tr_b16 a[224:225], v20 offset:128
ds_read_b64_tr_b16 a[226:227], v20 offset:896
ds_read_b128 a[140:143], v19 offset:8192
v_mfma_f32_32x32x16_bf16 v[176:191], a[180:183], a[120:123], v[176:191]
ds_read_b64_tr_b16 a[228:229], v20 offset:160
ds_read_b64_tr_b16 a[230:231], v20 offset:928
buffer_load_dwordx4 v9, s[16:19], s74 offen offset:2048 lds
s_waitcnt lgkmcnt(15)
v_mfma_f32_32x32x16_bf16 v[96:111], a[184:187], a[124:127], v[96:111]
ds_read_b64_tr_b16 a[160:161], v20 offset:3072
ds_read_b64_tr_b16 a[162:163], v20 offset:3840
v_mfma_f32_32x32x16_bf16 v[112:127], a[188:191], a[124:127], v[112:127]
ds_read_b64_tr_b16 a[164:165], v20 offset:3104
ds_read_b64_tr_b16 a[166:167], v20 offset:3872
buffer_load_dwordx4 v10, s[16:19], s74 offen offset:3072 lds
v_mfma_f32_32x32x16_bf16 v[128:143], a[192:195], a[124:127], v[128:143]
ds_read_b64_tr_b16 a[168:169], v20 offset:3136
ds_read_b64_tr_b16 a[170:171], v20 offset:3904
v_mfma_f32_32x32x16_bf16 v[144:159], a[196:199], a[124:127], v[144:159]
ds_read_b64_tr_b16 a[172:173], v20 offset:3168
ds_read_b64_tr_b16 a[174:175], v20 offset:3936
v_mfma_f32_32x32x16_bf16 v[160:175], a[200:203], a[124:127], v[160:175]
ds_read_b64_tr_b16 a[176:177], v20 offset:3200
ds_read_b64_tr_b16 a[178:179], v20 offset:3968
v_mfma_f32_32x32x16_bf16 v[176:191], a[204:207], a[124:127], v[176:191]
ds_read_b64_tr_b16 a[180:181], v20 offset:3232
ds_read_b64_tr_b16 a[182:183], v20 offset:4000
s_waitcnt lgkmcnt(12)
v_mfma_f32_32x32x16_bf16 v[96:111], a[208:211], a[128:131], v[96:111]
ds_read_b64_tr_b16 a[184:185], v20 offset:6144
ds_read_b64_tr_b16 a[186:187], v20 offset:6912
v_mfma_f32_32x32x16_bf16 v[112:127], a[212:215], a[128:131], v[112:127]
ds_read_b64_tr_b16 a[188:189], v20 offset:6176
ds_read_b64_tr_b16 a[190:191], v20 offset:6944
v_mfma_f32_32x32x16_bf16 v[128:143], a[216:219], a[128:131], v[128:143]
ds_read_b64_tr_b16 a[192:193], v20 offset:6208
ds_read_b64_tr_b16 a[194:195], v20 offset:6976
v_mfma_f32_32x32x16_bf16 v[144:159], a[220:223], a[128:131], v[144:159]
ds_read_b64_tr_b16 a[196:197], v20 offset:6240
ds_read_b64_tr_b16 a[198:199], v20 offset:7008
v_mfma_f32_32x32x16_bf16 v[160:175], a[224:227], a[128:131], v[160:175]
ds_read_b64_tr_b16 a[200:201], v20 offset:6272
ds_read_b64_tr_b16 a[202:203], v20 offset:7040
v_mfma_f32_32x32x16_bf16 v[176:191], a[228:231], a[128:131], v[176:191]
ds_read_b64_tr_b16 a[204:205], v20 offset:6304
ds_read_b64_tr_b16 a[206:207], v20 offset:7072
s_waitcnt lgkmcnt(12)
v_mfma_f32_32x32x16_bf16 v[96:111], a[160:163], a[132:135], v[96:111]
ds_read_b64_tr_b16 a[208:209], v20 offset:9216
ds_read_b64_tr_b16 a[210:211], v20 offset:9984
v_mfma_f32_32x32x16_bf16 v[112:127], a[164:167], a[132:135], v[112:127]
ds_read_b64_tr_b16 a[212:213], v20 offset:9248
ds_read_b64_tr_b16 a[214:215], v20 offset:10016
v_mfma_f32_32x32x16_bf16 v[128:143], a[168:171], a[132:135], v[128:143]
ds_read_b64_tr_b16 a[216:217], v20 offset:9280
ds_read_b64_tr_b16 a[218:219], v20 offset:10048
v_mfma_f32_32x32x16_bf16 v[144:159], a[172:175], a[132:135], v[144:159]
ds_read_b64_tr_b16 a[220:221], v20 offset:9312
ds_read_b64_tr_b16 a[222:223], v20 offset:10080
v_mfma_f32_32x32x16_bf16 v[160:175], a[176:179], a[132:135], v[160:175]
ds_read_b64_tr_b16 a[224:225], v20 offset:9344
ds_read_b64_tr_b16 a[226:227], v20 offset:10112
v_mfma_f32_32x32x16_bf16 v[176:191], a[180:183], a[132:135], v[176:191]
ds_read_b64_tr_b16 a[228:229], v20 offset:9376
ds_read_b64_tr_b16 a[230:231], v20 offset:10144
s_waitcnt vmcnt(13)
s_barrier
s_waitcnt lgkmcnt(12)
v_mfma_f32_32x32x16_bf16 v[96:111], a[184:187], a[136:139], v[96:111]
ds_read_b64_tr_b16 a[160:161], v20 offset:24704
ds_read_b64_tr_b16 a[162:163], v20 offset:25472
ds_read_b128 a[144:147], v16 offset:0
v_mfma_f32_32x32x16_bf16 v[112:127], a[188:191], a[136:139], v[112:127]
ds_read_b64_tr_b16 a[164:165], v20 offset:24736
ds_read_b64_tr_b16 a[166:167], v20 offset:25504
ds_read_b128 a[148:151], v17 offset:0
s_add_u32 s74, s55, 196608
s_add_u32 m0, s80, 74112
s_nop 0
buffer_load_dwordx4 v7, s[16:19], s74 offen lds
v_mfma_f32_32x32x16_bf16 v[128:143], a[192:195], a[136:139], v[128:143]
ds_read_b64_tr_b16 a[168:169], v20 offset:24768
ds_read_b64_tr_b16 a[170:171], v20 offset:25536
v_mfma_f32_32x32x16_bf16 v[144:159], a[196:199], a[136:139], v[144:159]
ds_read_b64_tr_b16 a[172:173], v20 offset:24800
ds_read_b64_tr_b16 a[174:175], v20 offset:25568
ds_read_b128 a[152:155], v18 offset:0
buffer_load_dwordx4 v8, s[16:19], s74 offen offset:1024 lds
v_mfma_f32_32x32x16_bf16 v[160:175], a[200:203], a[136:139], v[160:175]
ds_read_b64_tr_b16 a[176:177], v20 offset:24832
ds_read_b64_tr_b16 a[178:179], v20 offset:25600
ds_read_b128 a[156:159], v19 offset:0
v_mfma_f32_32x32x16_bf16 v[176:191], a[204:207], a[136:139], v[176:191]
ds_read_b64_tr_b16 a[180:181], v20 offset:24864
ds_read_b64_tr_b16 a[182:183], v20 offset:25632
buffer_load_dwordx4 v9, s[16:19], s74 offen offset:2048 lds
s_waitcnt lgkmcnt(15)
v_mfma_f32_32x32x16_bf16 v[96:111], a[208:211], a[140:143], v[96:111]
ds_read_b64_tr_b16 a[184:185], v20 offset:27776
ds_read_b64_tr_b16 a[186:187], v20 offset:28544
v_mfma_f32_32x32x16_bf16 v[112:127], a[212:215], a[140:143], v[112:127]
ds_read_b64_tr_b16 a[188:189], v20 offset:27808
ds_read_b64_tr_b16 a[190:191], v20 offset:28576
buffer_load_dwordx4 v10, s[16:19], s74 offen offset:3072 lds
v_mfma_f32_32x32x16_bf16 v[128:143], a[216:219], a[140:143], v[128:143]
ds_read_b64_tr_b16 a[192:193], v20 offset:27840
ds_read_b64_tr_b16 a[194:195], v20 offset:28608
v_mfma_f32_32x32x16_bf16 v[144:159], a[220:223], a[140:143], v[144:159]
ds_read_b64_tr_b16 a[196:197], v20 offset:27872
ds_read_b64_tr_b16 a[198:199], v20 offset:28640
v_mfma_f32_32x32x16_bf16 v[160:175], a[224:227], a[140:143], v[160:175]
ds_read_b64_tr_b16 a[200:201], v20 offset:27904
ds_read_b64_tr_b16 a[202:203], v20 offset:28672
v_mfma_f32_32x32x16_bf16 v[176:191], a[228:231], a[140:143], v[176:191]
ds_read_b64_tr_b16 a[204:205], v20 offset:27936
ds_read_b64_tr_b16 a[206:207], v20 offset:28704
s_waitcnt lgkmcnt(12)
v_mfma_f32_32x32x16_bf16 v[96:111], a[160:163], a[144:147], v[96:111]
ds_read_b64_tr_b16 a[208:209], v20 offset:30848
ds_read_b64_tr_b16 a[210:211], v20 offset:31616
v_mfma_f32_32x32x16_bf16 v[112:127], a[164:167], a[144:147], v[112:127]
ds_read_b64_tr_b16 a[212:213], v20 offset:30880
ds_read_b64_tr_b16 a[214:215], v20 offset:31648
v_mfma_f32_32x32x16_bf16 v[128:143], a[168:171], a[144:147], v[128:143]
ds_read_b64_tr_b16 a[216:217], v20 offset:30912
ds_read_b64_tr_b16 a[218:219], v20 offset:31680
v_mfma_f32_32x32x16_bf16 v[144:159], a[172:175], a[144:147], v[144:159]
ds_read_b64_tr_b16 a[220:221], v20 offset:30944
ds_read_b64_tr_b16 a[222:223], v20 offset:31712
v_mfma_f32_32x32x16_bf16 v[160:175], a[176:179], a[144:147], v[160:175]
ds_read_b64_tr_b16 a[224:225], v20 offset:30976
ds_read_b64_tr_b16 a[226:227], v20 offset:31744
v_mfma_f32_32x32x16_bf16 v[176:191], a[180:183], a[144:147], v[176:191]
ds_read_b64_tr_b16 a[228:229], v20 offset:31008
ds_read_b64_tr_b16 a[230:231], v20 offset:31776
s_waitcnt vmcnt(15)
v_xor_b32 v41, v46, v30
s_waitcnt vmcnt(14)
v_xor_b32 v42, v51, v30
v_or_b32 v41, v41, v42
s_waitcnt vmcnt(13)
v_xor_b32 v42, v55, v30
v_or_b32 v41, v41, v42
s_waitcnt vmcnt(12)
v_xor_b32 v42, v59, v30
v_or_b32 v41, v41, v42
s_waitcnt vmcnt(11)
v_xor_b32 v42, v63, v30
v_or_b32 v41, v41, v42
s_waitcnt vmcnt(10)
v_xor_b32 v42, v67, v30
v_or_b32 v41, v41, v42
s_waitcnt vmcnt(9)
v_xor_b32 v42, v71, v30
v_or_b32 v41, v41, v42
s_waitcnt vmcnt(8)
v_xor_b32 v42, v75, v30
v_or_b32 v41, v41, v42
s_waitcnt vmcnt(6)
v_xor_b32 v42, v79, v30
v_or_b32 v41, v41, v42
v_cmp_ne_u32 vcc, 0, v41
s_nop 3
s_cbranch_vccz COKF
s_mov_b32 s68, 4000
CSPF:
s_sleep 8
buffer_load_dwordx4 v[44:47], v36, s[24:27], s47 offen sc1
buffer_load_dwordx4 v[48:51], v37, s[24:27], s46 offen sc1
buffer_load_dwordx4 v[52:55], v37, s[24:27], s46 offen offset:2048 sc1
buffer_load_dwordx4 v[56:59], v38, s[24:27], s46 offen sc1
buffer_load_dwordx4 v[60:63], v38, s[24:27], s46 offen offset:2048 sc1
buffer_load_dwordx4 v[64:67], v39, s[24:27], s46 offen sc1
buffer_load_dwordx4 v[68:71], v39, s[24:27], s46 offen offset:2048 sc1
buffer_load_dwordx4 v[72:75], v40, s[24:27], s46 offen sc1
buffer_load_dwordx4 v[76:79], v40, s[24:27], s46 offen offset:2048 sc1
s_waitcnt vmcnt(0)
v_xor_b32 v41, v46, v30
v_xor_b32 v42, v51, v30
v_or_b32 v41, v41, v42
v_xor_b32 v42, v55, v30
v_or_b32 v41, v41, v42
v_xor_b32 v42, v59, v30
v_or_b32 v41, v41, v42
v_xor_b32 v42, v63, v30
v_or_b32 v41, v41, v42
v_xor_b32 v42, v67, v30
v_or_b32 v41, v41, v42
v_xor_b32 v42, v71, v30
v_or_b32 v41, v41, v42
v_xor_b32 v42, v75, v30
v_or_b32 v41, v41, v42
v_xor_b32 v42, v79, v30
v_or_b32 v41, v41, v42
v_cmp_ne_u32 vcc, 0, v41
s_sub_u32 s68, s68, 1
s_nop 2
s_cbranch_vccz COKF
s_cmp_lg_u32 s68, 0
s_cbranch_scc1 CSPF
COKF:
s_waitcnt lgkmcnt(12)
v_mfma_f32_32x32x16_bf16 v[96:111], a[184:187], a[148:151], v[96:111]
ds_read_b64_tr_b16 a[160:161], v20 offset:33920
ds_read_b64_tr_b16 a[162:163], v20 offset:34688
v_add_f32 v48, v48, v64
v_add_f32 v49, v49, v65
v_add_f32 v50, v50, v66
v_add_f32 v52, v52, v68
v_add_f32 v53, v53, v69
v_add_f32 v54, v54, v70
v_add_f32 v56, v56, v72
v_mfma_f32_32x32x16_bf16 v[112:127], a[188:191], a[148:151], v[112:127]
ds_read_b64_tr_b16 a[164:165], v20 offset:33952
ds_read_b64_tr_b16 a[166:167], v20 offset:34720
v_add_f32 v57, v57, v73
v_add_f32 v58, v58, v74
v_add_f32 v60, v60, v76
v_add_f32 v61, v61, v77
v_add_f32 v62, v62, v78
v_add_f32 v48, v48, v56
v_add_f32 v49, v49, v57
v_mfma_f32_32x32x16_bf16 v[128:143], a[192:195], a[148:151], v[128:143]
ds_read_b64_tr_b16 a[168:169], v20 offset:33984
ds_read_b64_tr_b16 a[170:171], v20 offset:34752
v_add_f32 v50, v50, v58
v_add_f32 v52, v52, v60
v_add_f32 v53, v53, v61
v_add_f32 v54, v54, v62
v_add_f32 v48, v48, v52
v_add_f32 v49, v49, v53
v_add_f32 v50, v50, v54
v_mfma_f32_32x32x16_bf16 v[144:159], a[196:199], a[148:151], v[144:159]
ds_read_b64_tr_b16 a[172:173], v20 offset:34016
ds_read_b64_tr_b16 a[174:175], v20 offset:34784
v_mov_b32 v52, v48
v_mov_b32 v53, v49
v_mov_b32 v54, v50
v_permlane32_swap_b32 v48, v52
v_permlane32_swap_b32 v49, v53
v_permlane32_swap_b32 v50, v54
v_add_f32 v48, v48, v52
v_mfma_f32_32x32x16_bf16 v[160:175], a[200:203], a[148:151], v[160:175]
ds_read_b64_tr_b16 a[176:177], v20 offset:34048
ds_read_b64_tr_b16 a[178:179], v20 offset:34816
v_add_f32 v49, v49, v53
v_add_f32 v50, v50, v54
v_mov_b32 v24, v44
v_mov_b32 v25, v45
s_mul_i32 s60, s48, 400
s_add_u32 s60, s60, 158208
v_mul_u32_u24 v36, 12, v1
v_add_u32 v36, s60, v36
s_mov_b64 s[82:83], exec
s_mov_b64 exec, 0xffffffff
ds_write_b32 v36, v48 offset:0
ds_write_b32 v36, v49 offset:4
ds_write_b32 v36, v50 offset:8
s_mov_b64 exec, s[82:83]
v_mfma_f32_32x32x16_bf16 v[176:191], a[204:207], a[148:151], v[176:191]
ds_read_b64_tr_b16 a[180:181], v20 offset:34080
ds_read_b64_tr_b16 a[182:183], v20 offset:34848
v_and_b32 v36, 31, v1
v_lshlrev_b32 v36, 2, v36
s_lshl_b32 s60, s48, 7
s_add_u32 s60, s60, 159808
v_add_u32 v36, s60, v36
ds_write_b32 v36, v24
ds_write_b32 v36, v25 offset:512
s_waitcnt vmcnt(4)
s_barrier
s_waitcnt lgkmcnt(15)
v_mfma_f32_32x32x16_bf16 v[96:111], a[208:211], a[152:155], v[96:111]
ds_read_b64_tr_b16 a[184:185], v85 offset:0
ds_read_b64_tr_b16 a[186:187], v85 offset:512
v_sub_f32 v24, 0, v24
v_mul_f32 v28, s84, v25
v_mul_f32 v27, v25, v25
v_sub_f32 v26, 0, v28
v_rcp_f32 v27, v27
v_cvt_pk_bf16_f32 v36, v24, v24
v_lshlrev_b32 v37, 16, v36
v_mfma_f32_32x32x16_bf16 v[112:127], a[212:215], a[152:155], v[112:127]
ds_read_b64_tr_b16 a[188:189], v87 offset:0
ds_read_b64_tr_b16 a[190:191], v87 offset:512
s_add_u32 s74, s55, 393216
s_add_u32 m0, s80, 0
s_nop 0
buffer_load_dwordx4 v7, s[16:19], s74 offen lds
v_sub_f32 v37, v24, v37
v_cvt_pk_bf16_f32 v36, v24, v37
v_and_b32 v38, 15, v1
v_mfma_f32_32x32x16_bf16 v[128:143], a[216:219], a[152:155], v[128:143]
ds_read_b64_tr_b16 a[192:193], v89 offset:0
ds_read_b64_tr_b16 a[194:195], v89 offset:512
v_bfe_u32 v39, v1, 4, 1
v_mul_u32_u24 v39, 100, v39
v_add_u32 v38, v38, v39
v_lshlrev_b32 v23, 2, v38
v_add_u32 v23, 131072, v23
v_cmp_gt_u32 vcc, 32, v1
s_nop 1
v_cndmask_b32 v36, 0, v36, vcc
v_mov_b32 v37, 0
v_accvgpr_write_b32 a244, v36
v_accvgpr_write_b32 a245, v36
v_accvgpr_write_b32 a246, v37
v_accvgpr_write_b32 a247, v37
v_mfma_f32_32x32x16_bf16 v[144:159], a[220:223], a[152:155], v[144:159]
ds_read_b64_tr_b16 a[196:197], v91 offset:0
ds_read_b64_tr_b16 a[198:199], v91 offset:512
buffer_load_dwordx4 v8, s[16:19], s74 offen offset:1024 lds
s_waitcnt lgkmcnt(8)
s_barrier
s_barrier
s_lshl_b32 s60, s97, 7
s_add_u32 s60, s60, 12550144
s_cmp_eq_u32 s48, 0
s_cselect_b32 s60, s60, 17825792
v_mov_b32 v80, v30
v_mov_b32 v81, v30
v_mov_b32 v82, v30
v_mov_b32 v83, v30
v_cmp_gt_u32 vcc, 8, v1
s_nop 1
v_cndmask_b32 v93, v31, v22, vcc
buffer_store_dwordx4 v[80:83], v93, s[24:27], s60 offen sc1
v_mfma_f32_32x32x16_bf16 v[160:175], a[224:227], a[152:155], v[160:175]
v_mfma_f32_32x32x16_bf16 v[176:191], a[228:231], a[152:155], v[176:191]
buffer_load_dwordx4 v9, s[16:19], s74 offen offset:2048 lds
v_mfma_f32_32x32x16_bf16 v[96:111], a[160:163], a[156:159], v[96:111]
ds_read_b64_tr_b16 a[208:209], v85 offset:2048
ds_read_b64_tr_b16 a[210:211], v85 offset:2560
v_mfma_f32_32x32x16_bf16 v[112:127], a[164:167], a[156:159], v[112:127]
ds_read_b64_tr_b16 a[212:213], v87 offset:2048
ds_read_b64_tr_b16 a[214:215], v87 offset:2560
buffer_load_dwordx4 v10, s[16:19], s74 offen offset:3072 lds
v_mfma_f32_32x32x16_bf16 v[128:143], a[168:171], a[156:159], v[128:143]
ds_read_b64_tr_b16 a[216:217], v89 offset:2048
ds_read_b64_tr_b16 a[218:219], v89 offset:2560
v_mfma_f32_32x32x16_bf16 v[144:159], a[172:175], a[156:159], v[144:159]
ds_read_b64_tr_b16 a[220:221], v91 offset:2048
ds_read_b64_tr_b16 a[222:223], v91 offset:2560
v_mfma_f32_32x32x16_bf16 v[160:175], a[176:179], a[156:159], v[160:175]
v_mfma_f32_32x32x16_bf16 v[176:191], a[180:183], a[156:159], v[176:191]
s_waitcnt lgkmcnt(8)
v_mfma_f32_32x32x16_bf16 v[192:207], a[184:187], a[0:3], 0
ds_read_b64_tr_b16 a[160:161], v85 offset:4096
ds_read_b64_tr_b16 a[162:163], v85 offset:4608
v_mfma_f32_32x32x16_bf16 v[208:223], a[188:191], a[0:3], 0
ds_read_b64_tr_b16 a[164:165], v87 offset:4096
ds_read_b64_tr_b16 a[166:167], v87 offset:4608
v_mfma_f32_32x32x16_bf16 v[224:239], a[192:195], a[0:3], 0
ds_read_b64_tr_b16 a[168:169], v89 offset:4096
ds_read_b64_tr_b16 a[170:171], v89 offset:4608
v_mov_b32 v34, 0
v_mov_b32 v35, 0
v_mov_b32 v38, 0
v_mov_b32 v39, 0
v_mfma_f32_32x32x16_bf16 v[240:255], a[196:199], a[0:3], 0
ds_read_b64_tr_b16 a[172:173], v91 offset:4096
ds_read_b64_tr_b16 a[174:175], v91 offset:4608
ds_read_b32 v40, v23 offset:27136
ds_read_b32 v41, v23 offset:27200
ds_read_b32 v42, v23 offset:27264
ds_read_b32 v43, v23 offset:27328
s_waitcnt lgkmcnt(12)
v_mfma_f32_32x32x16_bf16 v[192:207], a[208:211], a[4:7], v[192:207]
ds_read_b64_tr_b16 a[184:185], v85 offset:6144
ds_read_b64_tr_b16 a[186:187], v85 offset:6656
ds_read_b32 v44, v23 offset:27392
ds_read_b32 v45, v23 offset:27456
s_waitcnt lgkmcnt(7)
v_cvt_pk_bf16_f32 v32, v40, v40
v_lshlrev_b32 v46, 16, v32
v_mfma_f32_32x32x16_bf16 v[208:223], a[212:215], a[4:7], v[208:223]
ds_read_b64_tr_b16 a[188:189], v87 offset:6144
ds_read_b64_tr_b16 a[190:191], v87 offset:6656
v_sub_f32 v46, v40, v46
v_cvt_pk_bf16_f32 v33, v46, v46
s_nop 1
v_mfma_f32_32x32x16_bf16 v[96:111], v[32:35], a[244:247], v[96:111]
s_waitcnt lgkmcnt(8)
v_cvt_pk_bf16_f32 v36, v41, v41
v_mfma_f32_32x32x16_bf16 v[224:239], a[216:219], a[4:7], v[224:239]
ds_read_b64_tr_b16 a[192:193], v89 offset:6144
ds_read_b64_tr_b16 a[194:195], v89 offset:6656
v_lshlrev_b32 v47, 16, v36
v_sub_f32 v47, v41, v47
v_cvt_pk_bf16_f32 v37, v47, v47
s_nop 1
v_mfma_f32_32x32x16_bf16 v[112:127], v[36:39], a[244:247], v[112:127]
v_mfma_f32_32x32x16_bf16 v[240:255], a[220:223], a[4:7], v[240:255]
ds_read_b64_tr_b16 a[196:197], v91 offset:6144
ds_read_b64_tr_b16 a[198:199], v91 offset:6656
s_waitcnt lgkmcnt(11)
v_cvt_pk_bf16_f32 v32, v42, v42
v_lshlrev_b32 v46, 16, v32
v_sub_f32 v46, v42, v46
v_cvt_pk_bf16_f32 v33, v46, v46
s_waitcnt vmcnt(5)
s_barrier
v_mfma_f32_32x32x16_bf16 v[192:207], a[160:163], a[8:11], v[192:207]
ds_read_b64_tr_b16 a[208:209], v85 offset:24704
ds_read_b64_tr_b16 a[210:211], v85 offset:25216
v_mfma_f32_32x32x16_bf16 v[128:143], v[32:35], a[244:247], v[128:143]
s_waitcnt lgkmcnt(12)
v_cvt_pk_bf16_f32 v36, v43, v43
v_lshlrev_b32 v47, 16, v36
v_sub_f32 v47, v43, v47
v_mfma_f32_32x32x16_bf16 v[208:223], a[164:167], a[8:11], v[208:223]
ds_read_b64_tr_b16 a[212:213], v87 offset:24704
ds_read_b64_tr_b16 a[214:215], v87 offset:25216
s_add_u32 s74, s55, 589824
s_add_u32 m0, s80, 24704
s_nop 0
buffer_load_dwordx4 v7, s[16:19], s74 offen lds
v_mfma_f32_32x32x16_bf16 v[224:239], a[168:171], a[8:11], v[224:239]
ds_read_b64_tr_b16 a[216:217], v89 offset:24704
ds_read_b64_tr_b16 a[218:219], v89 offset:25216
v_cvt_pk_bf16_f32 v37, v47, v47
s_nop 1
v_mfma_f32_32x32x16_bf16 v[144:159], v[36:39], a[244:247], v[144:159]
s_waitcnt lgkmcnt(13)
v_cvt_pk_bf16_f32 v32, v44, v44
v_lshlrev_b32 v46, 16, v32
v_mfma_f32_32x32x16_bf16 v[240:255], a[172:175], a[8:11], v[240:255]
ds_read_b64_tr_b16 a[220:221], v91 offset:24704
ds_read_b64_tr_b16 a[222:223], v91 offset:25216
buffer_load_dwordx4 v8, s[16:19], s74 offen offset:1024 lds
v_sub_f32 v46, v44, v46
v_cvt_pk_bf16_f32 v33, v46, v46
s_nop 1
v_mfma_f32_32x32x16_bf16 v[160:175], v[32:35], a[244:247], v[160:175]
s_waitcnt lgkmcnt(8)
v_mfma_f32_32x32x16_bf16 v[192:207], a[184:187], a[12:15], v[192:207]
ds_read_b64_tr_b16 a[160:161], v85 offset:26752
ds_read_b64_tr_b16 a[162:163], v85 offset:27264
v_cvt_pk_bf16_f32 v36, v45, v45
v_lshlrev_b32 v47, 16, v36
v_sub_f32 v47, v45, v47
v_cvt_pk_bf16_f32 v37, v47, v47
v_mfma_f32_32x32x16_bf16 v[208:223], a[188:191], a[12:15], v[208:223]
ds_read_b64_tr_b16 a[164:165], v87 offset:26752
ds_read_b64_tr_b16 a[166:167], v87 offset:27264
buffer_load_dwordx4 v9, s[16:19], s74 offen offset:2048 lds
v_mfma_f32_32x32x16_bf16 v[176:191], v[36:39], a[244:247], v[176:191]
s_and_b32 s60, s2, 7
s_lshr_b32 s61, s2, 3
s_lshl_b32 s40, s60, 2
s_and_b32 s62, s61, 3
s_add_u32 s40, s40, s62
s_lshr_b32 s41, s61, 2
s_and_b32 s44, s2, 31
s_lshr_b32 s45, s2, 5
s_mul_i32 s60, s41, 245760
s_add_u32 s60, s60, 9437184
s_add_u32 s12, s24, s60
s_addc_u32 s13, s25, 0
s_mov_b32 s14, 245760
s_mov_b32 s15, 0x20000
s_lshl_b32 s42, s48, 11
s_mul_i32 s43, s48, 5120
v_mfma_f32_32x32x16_bf16 v[224:239], a[192:195], a[12:15], v[224:239]
ds_read_b64_tr_b16 a[168:169], v89 offset:26752
ds_read_b64_tr_b16 a[170:171], v89 offset:27264
v_lshlrev_b32 v4, 4, v1
v_add_u32 v5, 4096, v4
v_lshlrev_b32 v12, 3, v1
v_add_u32 v12, s41, v12
v_lshlrev_b32 v12, 7, v12
v_cmp_gt_u32 vcc, 24, v1
s_nop 1
v_cndmask_b32 v12, v31, v12, vcc
v_mfma_f32_32x32x16_bf16 v[240:255], a[196:199], a[12:15], v[240:255]
ds_read_b64_tr_b16 a[172:173], v91 offset:26752
ds_read_b64_tr_b16 a[174:175], v91 offset:27264
buffer_load_dwordx4 v10, s[16:19], s74 offen offset:3072 lds
s_mov_b32 s75, 12550144
s_cmp_eq_u32 s48, 0
s_cselect_b32 s75, s75, 17825792
buffer_load_dword v13, v12, s[24:27], s75 offen sc1
s_waitcnt lgkmcnt(8)
v_mfma_f32_32x32x16_bf16 v[192:207], a[208:211], a[16:19], v[192:207]
ds_read_b64_tr_b16 a[184:185], v85 offset:28800
ds_read_b64_tr_b16 a[186:187], v85 offset:29312
v_mul_f32 v64, v26, v96
v_mul_f32 v65, v26, v97
v_mul_f32 v66, v26, v98
v_mul_f32 v67, v26, v99
v_mfma_f32_32x32x16_bf16 v[208:223], a[212:215], a[16:19], v[208:223]
ds_read_b64_tr_b16 a[188:189], v87 offset:28800
ds_read_b64_tr_b16 a[190:191], v87 offset:29312
v_mul_f32 v68, v26, v100
v_mul_f32 v69, v26, v101
v_mul_f32 v70, v26, v102
v_mul_f32 v71, v26, v103
v_mfma_f32_32x32x16_bf16 v[224:239], a[216:219], a[16:19], v[224:239]
ds_read_b64_tr_b16 a[192:193], v89 offset:28800
ds_read_b64_tr_b16 a[194:195], v89 offset:29312
v_exp_f32 v64, v64
v_exp_f32 v65, v65
v_exp_f32 v66, v66
v_exp_f32 v67, v67
v_mfma_f32_32x32x16_bf16 v[240:255], a[220:223], a[16:19], v[240:255]
ds_read_b64_tr_b16 a[196:197], v91 offset:28800
ds_read_b64_tr_b16 a[198:199], v91 offset:29312
v_exp_f32 v68, v68
v_exp_f32 v69, v69
v_exp_f32 v70, v70
v_exp_f32 v71, v71
s_waitcnt lgkmcnt(8)
v_mfma_f32_32x32x16_bf16 v[192:207], a[160:163], a[20:23], v[192:207]
ds_read_b64_tr_b16 a[208:209], v85 offset:30848
ds_read_b64_tr_b16 a[210:211], v85 offset:31360
v_mul_f32 v96, v96, v104
v_mul_f32 v97, v97, v105
v_mul_f32 v98, v98, v106
v_mul_f32 v99, v99, v107
v_mfma_f32_32x32x16_bf16 v[208:223], a[164:167], a[20:23], v[208:223]
ds_read_b64_tr_b16 a[212:213], v87 offset:30848
ds_read_b64_tr_b16 a[214:215], v87 offset:31360
v_mul_f32 v100, v100, v108
v_mul_f32 v101, v101, v109
v_mul_f32 v102, v102, v110
v_mul_f32 v103, v103, v111
v_mfma_f32_32x32x16_bf16 v[224:239], a[168:171], a[20:23], v[224:239]
ds_read_b64_tr_b16 a[216:217], v89 offset:30848
ds_read_b64_tr_b16 a[218:219], v89 offset:31360
v_fma_f32 v64, v64, v27, v27
v_fma_f32 v65, v65, v27, v27
v_fma_f32 v66, v66, v27, v27
v_fma_f32 v67, v67, v27, v27
v_mfma_f32_32x32x16_bf16 v[240:255], a[172:175], a[20:23], v[240:255]
ds_read_b64_tr_b16 a[220:221], v91 offset:30848
ds_read_b64_tr_b16 a[222:223], v91 offset:31360
v_fma_f32 v68, v68, v27, v27
v_fma_f32 v69, v69, v27, v27
v_fma_f32 v70, v70, v27, v27
v_fma_f32 v71, v71, v27, v27
s_waitcnt vmcnt(5)
s_barrier
s_waitcnt lgkmcnt(8)
v_mfma_f32_32x32x16_bf16 v[192:207], a[184:187], a[24:27], v[192:207]
ds_read_b64_tr_b16 a[160:161], v84 offset:0
ds_read_b64_tr_b16 a[162:163], v84 offset:512
v_rcp_f32 v64, v64
v_rcp_f32 v65, v65
v_rcp_f32 v66, v66
v_rcp_f32 v67, v67
v_mfma_f32_32x32x16_bf16 v[208:223], a[188:191], a[24:27], v[208:223]
ds_read_b64_tr_b16 a[164:165], v86 offset:0
ds_read_b64_tr_b16 a[166:167], v86 offset:512
s_add_u32 s74, s55, 786432
s_add_u32 m0, s80, 49408
s_nop 0
buffer_load_dwordx4 v7, s[16:19], s74 offen lds
v_mfma_f32_32x32x16_bf16 v[224:239], a[192:195], a[24:27], v[224:239]
ds_read_b64_tr_b16 a[168:169], v88 offset:0
ds_read_b64_tr_b16 a[170:171], v88 offset:512
v_rcp_f32 v68, v68
v_rcp_f32 v69, v69
v_rcp_f32 v70, v70
v_rcp_f32 v71, v71
v_mfma_f32_32x32x16_bf16 v[240:255], a[196:199], a[24:27], v[240:255]
ds_read_b64_tr_b16 a[172:173], v90 offset:0
ds_read_b64_tr_b16 a[174:175], v90 offset:512
buffer_load_dwordx4 v8, s[16:19], s74 offen offset:1024 lds
v_mul_f32 v96, v96, v64
v_mul_f32 v97, v97, v65
v_mul_f32 v98, v98, v66
s_waitcnt lgkmcnt(8)
v_mfma_f32_32x32x16_bf16 v[192:207], a[208:211], a[28:31], v[192:207]
ds_read_b64_tr_b16 a[184:185], v84 offset:2048
ds_read_b64_tr_b16 a[186:187], v84 offset:2560
v_mul_f32 v99, v99, v67
v_mul_f32 v100, v100, v68
v_mul_f32 v101, v101, v69
v_mul_f32 v102, v102, v70
v_mfma_f32_32x32x16_bf16 v[208:223], a[212:215], a[28:31], v[208:223]
ds_read_b64_tr_b16 a[188:189], v86 offset:2048
ds_read_b64_tr_b16 a[190:191], v86 offset:2560
buffer_load_dwordx4 v9, s[16:19], s74 offen offset:2048 lds
v_mul_f32 v103, v103, v71
v_cvt_pk_bf16_f32 v104, v96, v97
v_cvt_pk_bf16_f32 v105, v98, v99
v_mfma_f32_32x32x16_bf16 v[224:239], a[216:219], a[28:31], v[224:239]
ds_read_b64_tr_b16 a[192:193], v88 offset:2048
ds_read_b64_tr_b16 a[194:195], v88 offset:2560
v_cvt_pk_bf16_f32 v106, v100, v101
v_cvt_pk_bf16_f32 v107, v102, v103
s_add_u32 s70, s57, s58
buffer_store_dwordx4 v[104:107], v22, s[24:27], s70 offen sc1
v_mfma_f32_32x32x16_bf16 v[240:255], a[220:223], a[28:31], v[240:255]
ds_read_b64_tr_b16 a[196:197], v90 offset:2048
ds_read_b64_tr_b16 a[198:199], v90 offset:2560
buffer_load_dwordx4 v10, s[16:19], s74 offen offset:3072 lds
v_mul_f32 v64, v26, v112
v_mul_f32 v65, v26, v113
v_mul_f32 v66, v26, v114
s_waitcnt lgkmcnt(8)
v_mfma_f32_32x32x16_bf16 v[192:207], a[160:163], a[32:35], v[192:207]
ds_read_b64_tr_b16 a[208:209], v84 offset:4096
ds_read_b64_tr_b16 a[210:211], v84 offset:4608
v_mul_f32 v67, v26, v115
v_mul_f32 v68, v26, v116
v_mul_f32 v69, v26, v117
v_mul_f32 v70, v26, v118
v_mfma_f32_32x32x16_bf16 v[208:223], a[164:167], a[32:35], v[208:223]
ds_read_b64_tr_b16 a[212:213], v86 offset:4096
ds_read_b64_tr_b16 a[214:215], v86 offset:4608
v_mul_f32 v71, v26, v119
v_exp_f32 v64, v64
v_exp_f32 v65, v65
v_exp_f32 v66, v66
v_mfma_f32_32x32x16_bf16 v[224:239], a[168:171], a[32:35], v[224:239]
ds_read_b64_tr_b16 a[216:217], v88 offset:4096
ds_read_b64_tr_b16 a[218:219], v88 offset:4608
v_exp_f32 v67, v67
v_exp_f32 v68, v68
v_exp_f32 v69, v69
v_exp_f32 v70, v70
v_mfma_f32_32x32x16_bf16 v[240:255], a[172:175], a[32:35], v[240:255]
ds_read_b64_tr_b16 a[220:221], v90 offset:4096
ds_read_b64_tr_b16 a[222:223], v90 offset:4608
v_exp_f32 v71, v71
v_mul_f32 v112, v112, v120
v_mul_f32 v113, v113, v121
v_mul_f32 v114, v114, v122
s_waitcnt lgkmcnt(8)
v_mfma_f32_32x32x16_bf16 v[192:207], a[184:187], a[36:39], v[192:207]
ds_read_b64_tr_b16 a[160:161], v84 offset:6144
ds_read_b64_tr_b16 a[162:163], v84 offset:6656
v_mul_f32 v115, v115, v123
v_mul_f32 v116, v116, v124
v_mul_f32 v117, v117, v125
v_mul_f32 v118, v118, v126
v_mfma_f32_32x32x16_bf16 v[208:223], a[188:191], a[36:39], v[208:223]
ds_read_b64_tr_b16 a[164:165], v86 offset:6144
ds_read_b64_tr_b16 a[166:167], v86 offset:6656
v_mul_f32 v119, v119, v127
v_fma_f32 v64, v64, v27, v27
v_fma_f32 v65, v65, v27, v27
v_fma_f32 v66, v66, v27, v27
v_mfma_f32_32x32x16_bf16 v[224:239], a[192:195], a[36:39], v[224:239]
ds_read_b64_tr_b16 a[168:169], v88 offset:6144
ds_read_b64_tr_b16 a[170:171], v88 offset:6656
v_fma_f32 v67, v67, v27, v27
v_fma_f32 v68, v68, v27, v27
v_fma_f32 v69, v69, v27, v27
v_fma_f32 v70, v70, v27, v27
v_mfma_f32_32x32x16_bf16 v[240:255], a[196:199], a[36:39], v[240:255]
ds_read_b64_tr_b16 a[172:173], v90 offset:6144
ds_read_b64_tr_b16 a[174:175], v90 offset:6656
v_fma_f32 v71, v71, v27, v27
v_rcp_f32 v64, v64
v_rcp_f32 v65, v65
v_rcp_f32 v66, v66
s_waitcnt vmcnt(6)
s_barrier
s_waitcnt lgkmcnt(8)
v_mfma_f32_32x32x16_bf16 v[192:207], a[208:211], a[40:43], v[192:207]
ds_read_b64_tr_b16 a[184:185], v84 offset:24704
ds_read_b64_tr_b16 a[186:187], v84 offset:25216
v_rcp_f32 v67, v67
v_rcp_f32 v68, v68
v_rcp_f32 v69, v69
v_rcp_f32 v70, v70
v_mfma_f32_32x32x16_bf16 v[208:223], a[212:215], a[40:43], v[208:223]
ds_read_b64_tr_b16 a[188:189], v86 offset:24704
ds_read_b64_tr_b16 a[190:191], v86 offset:25216
s_add_u32 s74, s55, 983040
s_add_u32 m0, s80, 74112
s_nop 0
buffer_load_dwordx4 v7, s[16:19], s74 offen lds
v_mfma_f32_32x32x16_bf16 v[224:239], a[216:219], a[40:43], v[224:239]
ds_read_b64_tr_b16 a[192:193], v88 offset:24704
ds_read_b64_tr_b16 a[194:195], v88 offset:25216
v_rcp_f32 v71, v71
v_mul_f32 v112, v112, v64
v_mul_f32 v113, v113, v65
v_mul_f32 v114, v114, v66
v_mfma_f32_32x32x16_bf16 v[240:255], a[220:223], a[40:43], v[240:255]
ds_read_b64_tr_b16 a[196:197], v90 offset:24704
ds_read_b64_tr_b16 a[198:199], v90 offset:25216
buffer_load_dwordx4 v8, s[16:19], s74 offen offset:1024 lds
v_mul_f32 v115, v115, v67
v_mul_f32 v116, v116, v68
v_mul_f32 v117, v117, v69
s_waitcnt lgkmcnt(8)
v_mfma_f32_32x32x16_bf16 v[192:207], a[160:163], a[44:47], v[192:207]
ds_read_b64_tr_b16 a[208:209], v84 offset:26752
ds_read_b64_tr_b16 a[210:211], v84 offset:27264
v_mul_f32 v118, v118, v70
v_mul_f32 v119, v119, v71
v_cvt_pk_bf16_f32 v120, v112, v113
v_cvt_pk_bf16_f32 v121, v114, v115
v_mfma_f32_32x32x16_bf16 v[208:223], a[164:167], a[44:47], v[208:223]
ds_read_b64_tr_b16 a[212:213], v86 offset:26752
ds_read_b64_tr_b16 a[214:215], v86 offset:27264
buffer_load_dwordx4 v9, s[16:19], s74 offen offset:2048 lds
v_cvt_pk_bf16_f32 v122, v116, v117
v_cvt_pk_bf16_f32 v123, v118, v119
s_add_u32 s70, s57, s58
buffer_store_dwordx4 v[120:123], v22, s[24:27], s70 offen offset:1024 sc1
v_mfma_f32_32x32x16_bf16 v[224:239], a[168:171], a[44:47], v[224:239]
ds_read_b64_tr_b16 a[216:217], v88 offset:26752
ds_read_b64_tr_b16 a[218:219], v88 offset:27264
v_mul_f32 v64, v26, v128
v_mul_f32 v65, v26, v129
v_mul_f32 v66, v26, v130
v_mul_f32 v67, v26, v131
v_mfma_f32_32x32x16_bf16 v[240:255], a[172:175], a[44:47], v[240:255]
ds_read_b64_tr_b16 a[220:221], v90 offset:26752
ds_read_b64_tr_b16 a[222:223], v90 offset:27264
buffer_load_dwordx4 v10, s[16:19], s74 offen offset:3072 lds
v_mul_f32 v68, v26, v132
v_mul_f32 v69, v26, v133
v_mul_f32 v70, v26, v134
s_waitcnt lgkmcnt(8)
v_mfma_f32_32x32x16_bf16 v[192:207], a[184:187], a[48:51], v[192:207]
ds_read_b64_tr_b16 a[160:161], v84 offset:28800
ds_read_b64_tr_b16 a[162:163], v84 offset:29312
v_mul_f32 v71, v26, v135
v_exp_f32 v64, v64
v_exp_f32 v65, v65
v_exp_f32 v66, v66
v_mfma_f32_32x32x16_bf16 v[208:223], a[188:191], a[48:51], v[208:223]
ds_read_b64_tr_b16 a[164:165], v86 offset:28800
ds_read_b64_tr_b16 a[166:167], v86 offset:29312
v_exp_f32 v67, v67
v_exp_f32 v68, v68
v_exp_f32 v69, v69
v_exp_f32 v70, v70
v_mfma_f32_32x32x16_bf16 v[224:239], a[192:195], a[48:51], v[224:239]
ds_read_b64_tr_b16 a[168:169], v88 offset:28800
ds_read_b64_tr_b16 a[170:171], v88 offset:29312
v_exp_f32 v71, v71
v_mul_f32 v128, v128, v136
v_mul_f32 v129, v129, v137
v_mul_f32 v130, v130, v138
v_mfma_f32_32x32x16_bf16 v[240:255], a[196:199], a[48:51], v[240:255]
ds_read_b64_tr_b16 a[172:173], v90 offset:28800
ds_read_b64_tr_b16 a[174:175], v90 offset:29312
v_mul_f32 v131, v131, v139
v_mul_f32 v132, v132, v140
v_mul_f32 v133, v133, v141
v_mul_f32 v134, v134, v142
s_waitcnt lgkmcnt(8)
v_mfma_f32_32x32x16_bf16 v[192:207], a[208:211], a[52:55], v[192:207]
ds_read_b64_tr_b16 a[184:185], v84 offset:30848
ds_read_b64_tr_b16 a[186:187], v84 offset:31360
v_mul_f32 v135, v135, v143
v_fma_f32 v64, v64, v27, v27
v_fma_f32 v65, v65, v27, v27
v_fma_f32 v66, v66, v27, v27
v_mfma_f32_32x32x16_bf16 v[208:223], a[212:215], a[52:55], v[208:223]
ds_read_b64_tr_b16 a[188:189], v86 offset:30848
ds_read_b64_tr_b16 a[190:191], v86 offset:31360
v_fma_f32 v67, v67, v27, v27
v_fma_f32 v68, v68, v27, v27
v_fma_f32 v69, v69, v27, v27
v_fma_f32 v70, v70, v27, v27
v_mfma_f32_32x32x16_bf16 v[224:239], a[216:219], a[52:55], v[224:239]
ds_read_b64_tr_b16 a[192:193], v88 offset:30848
ds_read_b64_tr_b16 a[194:195], v88 offset:31360
v_fma_f32 v71, v71, v27, v27
v_rcp_f32 v64, v64
v_rcp_f32 v65, v65
v_rcp_f32 v66, v66
v_mfma_f32_32x32x16_bf16 v[240:255], a[220:223], a[52:55], v[240:255]
ds_read_b64_tr_b16 a[196:197], v90 offset:30848
ds_read_b64_tr_b16 a[198:199], v90 offset:31360
v_rcp_f32 v67, v67
v_rcp_f32 v68, v68
v_rcp_f32 v69, v69
v_rcp_f32 v70, v70
s_waitcnt vmcnt(5)
s_barrier
s_waitcnt lgkmcnt(8)
v_mfma_f32_32x32x16_bf16 v[192:207], a[160:163], a[56:59], v[192:207]
ds_read_b64_tr_b16 a[208:209], v85 offset:0
ds_read_b64_tr_b16 a[210:211], v85 offset:512
v_rcp_f32 v71, v71
v_mul_f32 v128, v128, v64
v_mul_f32 v129, v129, v65
v_mul_f32 v130, v130, v66
v_mfma_f32_32x32x16_bf16 v[208:223], a[164:167], a[56:59], v[208:223]
ds_read_b64_tr_b16 a[212:213], v87 offset:0
ds_read_b64_tr_b16 a[214:215], v87 offset:512
s_add_u32 s74, s55, 1179648
s_add_u32 m0, s80, 0
s_nop 0
buffer_load_dwordx4 v7, s[16:19], s74 offen lds
v_mfma_f32_32x32x16_bf16 v[224:239], a[168:171], a[56:59], v[224:239]
ds_read_b64_tr_b16 a[216:217], v89 offset:0
ds_read_b64_tr_b16 a[218:219], v89 offset:512
v_mul_f32 v131, v131, v67
v_mul_f32 v132, v132, v68
v_mul_f32 v133, v133, v69
v_mul_f32 v134, v134, v70
v_mfma_f32_32x32x16_bf16 v[240:255], a[172:175], a[56:59], v[240:255]
ds_read_b64_tr_b16 a[220:221], v91 offset:0
ds_read_b64_tr_b16 a[222:223], v91 offset:512
buffer_load_dwordx4 v8, s[16:19], s74 offen offset:1024 lds
v_mul_f32 v135, v135, v71
v_cvt_pk_bf16_f32 v136, v128, v129
v_cvt_pk_bf16_f32 v137, v130, v131
s_waitcnt lgkmcnt(8)
v_mfma_f32_32x32x16_bf16 v[192:207], a[184:187], a[60:63], v[192:207]
ds_read_b64_tr_b16 a[160:161], v85 offset:2048
ds_read_b64_tr_b16 a[162:163], v85 offset:2560
v_cvt_pk_bf16_f32 v138, v132, v133
v_cvt_pk_bf16_f32 v139, v134, v135
s_add_u32 s70, s57, s58
buffer_store_dwordx4 v[136:139], v22, s[24:27], s70 offen offset:2048 sc1
v_mfma_f32_32x32x16_bf16 v[208:223], a[188:191], a[60:63], v[208:223]
ds_read_b64_tr_b16 a[164:165], v87 offset:2048
ds_read_b64_tr_b16 a[166:167], v87 offset:2560
buffer_load_dwordx4 v9, s[16:19], s74 offen offset:2048 lds
v_mul_f32 v64, v26, v144
v_mul_f32 v65, v26, v145
v_mul_f32 v66, v26, v146
v_mfma_f32_32x32x16_bf16 v[224:239], a[192:195], a[60:63], v[224:239]
ds_read_b64_tr_b16 a[168:169], v89 offset:2048
ds_read_b64_tr_b16 a[170:171], v89 offset:2560
v_mul_f32 v67, v26, v147
v_mul_f32 v68, v26, v148
v_mul_f32 v69, v26, v149
v_mul_f32 v70, v26, v150
v_mfma_f32_32x32x16_bf16 v[240:255], a[196:199], a[60:63], v[240:255]
ds_read_b64_tr_b16 a[172:173], v91 offset:2048
ds_read_b64_tr_b16 a[174:175], v91 offset:2560
buffer_load_dwordx4 v10, s[16:19], s74 offen offset:3072 lds
v_mul_f32 v71, v26, v151
v_exp_f32 v64, v64
v_exp_f32 v65, v65
s_waitcnt lgkmcnt(8)
v_mfma_f32_32x32x16_bf16 v[192:207], a[208:211], a[64:67], v[192:207]
ds_read_b64_tr_b16 a[184:185], v85 offset:4096
ds_read_b64_tr_b16 a[186:187], v85 offset:4608
v_exp_f32 v66, v66
v_exp_f32 v67, v67
v_exp_f32 v68, v68
v_exp_f32 v69, v69
v_mfma_f32_32x32x16_bf16 v[208:223], a[212:215], a[64:67], v[208:223]
ds_read_b64_tr_b16 a[188:189], v87 offset:4096
ds_read_b64_tr_b16 a[190:191], v87 offset:4608
v_exp_f32 v70, v70
v_exp_f32 v71, v71
v_mul_f32 v144, v144, v152
v_mul_f32 v145, v145, v153
v_mfma_f32_32x32x16_bf16 v[224:239], a[216:219], a[64:67], v[224:239]
ds_read_b64_tr_b16 a[192:193], v89 offset:4096
ds_read_b64_tr_b16 a[194:195], v89 offset:4608
v_mul_f32 v146, v146, v154
v_mul_f32 v147, v147, v155
v_mul_f32 v148, v148, v156
v_mul_f32 v149, v149, v157
v_mfma_f32_32x32x16_bf16 v[240:255], a[220:223], a[64:67], v[240:255]
ds_read_b64_tr_b16 a[196:197], v91 offset:4096
ds_read_b64_tr_b16 a[198:199], v91 offset:4608
v_mul_f32 v150, v150, v158
v_mul_f32 v151, v151, v159
v_fma_f32 v64, v64, v27, v27
v_fma_f32 v65, v65, v27, v27
s_waitcnt lgkmcnt(8)
v_mfma_f32_32x32x16_bf16 v[192:207], a[160:163], a[68:71], v[192:207]
ds_read_b64_tr_b16 a[208:209], v85 offset:6144
ds_read_b64_tr_b16 a[210:211], v85 offset:6656
v_fma_f32 v66, v66, v27, v27
v_fma_f32 v67, v67, v27, v27
v_fma_f32 v68, v68, v27, v27
v_fma_f32 v69, v69, v27, v27
v_mfma_f32_32x32x16_bf16 v[208:223], a[164:167], a[68:71], v[208:223]
ds_read_b64_tr_b16 a[212:213], v87 offset:6144
ds_read_b64_tr_b16 a[214:215], v87 offset:6656
v_fma_f32 v70, v70, v27, v27
v_fma_f32 v71, v71, v27, v27
v_rcp_f32 v64, v64
v_rcp_f32 v65, v65
v_mfma_f32_32x32x16_bf16 v[224:239], a[168:171], a[68:71], v[224:239]
ds_read_b64_tr_b16 a[216:217], v89 offset:6144
ds_read_b64_tr_b16 a[218:219], v89 offset:6656
v_rcp_f32 v66, v66
v_rcp_f32 v67, v67
v_rcp_f32 v68, v68
v_rcp_f32 v69, v69
v_mfma_f32_32x32x16_bf16 v[240:255], a[172:175], a[68:71], v[240:255]
ds_read_b64_tr_b16 a[220:221], v91 offset:6144
ds_read_b64_tr_b16 a[222:223], v91 offset:6656
v_rcp_f32 v70, v70
v_rcp_f32 v71, v71
v_mul_f32 v144, v144, v64
v_mul_f32 v145, v145, v65
s_waitcnt vmcnt(5)
s_barrier
s_waitcnt lgkmcnt(8)
v_mfma_f32_32x32x16_bf16 v[192:207], a[184:187], a[72:75], v[192:207]
ds_read_b64_tr_b16 a[160:161], v85 offset:24704
ds_read_b64_tr_b16 a[162:163], v85 offset:25216
v_mul_f32 v146, v146, v66
v_mul_f32 v147, v147, v67
v_mul_f32 v148, v148, v68
v_mul_f32 v149, v149, v69
v_mfma_f32_32x32x16_bf16 v[208:223], a[188:191], a[72:75], v[208:223]
ds_read_b64_tr_b16 a[164:165], v87 offset:24704
ds_read_b64_tr_b16 a[166:167], v87 offset:25216
s_add_u32 s74, s55, 1376256
s_add_u32 m0, s80, 24704
s_nop 0
buffer_load_dwordx4 v7, s[16:19], s74 offen lds
v_mfma_f32_32x32x16_bf16 v[224:239], a[192:195], a[72:75], v[224:239]
ds_read_b64_tr_b16 a[168:169], v89 offset:24704
ds_read_b64_tr_b16 a[170:171], v89 offset:25216
v_mul_f32 v150, v150, v70
v_mul_f32 v151, v151, v71
v_cvt_pk_bf16_f32 v152, v144, v145
v_cvt_pk_bf16_f32 v153, v146, v147
v_mfma_f32_32x32x16_bf16 v[240:255], a[196:199], a[72:75], v[240:255]
ds_read_b64_tr_b16 a[172:173], v91 offset:24704
ds_read_b64_tr_b16 a[174:175], v91 offset:25216
buffer_load_dwordx4 v8, s[16:19], s74 offen offset:1024 lds
v_cvt_pk_bf16_f32 v154, v148, v149
v_cvt_pk_bf16_f32 v155, v150, v151
s_add_u32 s70, s57, s58
buffer_store_dwordx4 v[152:155], v22, s[24:27], s70 offen offset:3072 sc1
s_waitcnt lgkmcnt(8)
v_mfma_f32_32x32x16_bf16 v[192:207], a[208:211], a[76:79], v[192:207]
ds_read_b64_tr_b16 a[184:185], v85 offset:26752
ds_read_b64_tr_b16 a[186:187], v85 offset:27264
v_mul_f32 v64, v26, v160
v_mul_f32 v65, v26, v161
v_mul_f32 v66, v26, v162
v_mul_f32 v67, v26, v163
v_mfma_f32_32x32x16_bf16 v[208:223], a[212:215], a[76:79], v[208:223]
ds_read_b64_tr_b16 a[188:189], v87 offset:26752
ds_read_b64_tr_b16 a[190:191], v87 offset:27264
buffer_load_dwordx4 v9, s[16:19], s74 offen offset:2048 lds
v_mul_f32 v68, v26, v164
v_mul_f32 v69, v26, v165
v_mul_f32 v70, v26, v166
v_mfma_f32_32x32x16_bf16 v[224:239], a[216:219], a[76:79], v[224:239]
ds_read_b64_tr_b16 a[192:193], v89 offset:26752
ds_read_b64_tr_b16 a[194:195], v89 offset:27264
v_mul_f32 v71, v26, v167
v_exp_f32 v64, v64
v_exp_f32 v65, v65
v_exp_f32 v66, v66
v_mfma_f32_32x32x16_bf16 v[240:255], a[220:223], a[76:79], v[240:255]
ds_read_b64_tr_b16 a[196:197], v91 offset:26752
ds_read_b64_tr_b16 a[198:199], v91 offset:27264
buffer_load_dwordx4 v10, s[16:19], s74 offen offset:3072 lds
v_exp_f32 v67, v67
v_exp_f32 v68, v68
v_exp_f32 v69, v69
s_waitcnt lgkmcnt(8)
v_mfma_f32_32x32x16_bf16 v[192:207], a[160:163], a[80:83], v[192:207]
ds_read_b64_tr_b16 a[208:209], v85 offset:28800
ds_read_b64_tr_b16 a[210:211], v85 offset:29312
v_exp_f32 v70, v70
v_exp_f32 v71, v71
v_mul_f32 v160, v160, v168
v_mul_f32 v161, v161, v169
v_mfma_f32_32x32x16_bf16 v[208:223], a[164:167], a[80:83], v[208:223]
ds_read_b64_tr_b16 a[212:213], v87 offset:28800
ds_read_b64_tr_b16 a[214:215], v87 offset:29312
v_mul_f32 v162, v162, v170
v_mul_f32 v163, v163, v171
v_mul_f32 v164, v164, v172
v_mul_f32 v165, v165, v173
v_mfma_f32_32x32x16_bf16 v[224:239], a[168:171], a[80:83], v[224:239]
ds_read_b64_tr_b16 a[216:217], v89 offset:28800
ds_read_b64_tr_b16 a[218:219], v89 offset:29312
v_mul_f32 v166, v166, v174
v_mul_f32 v167, v167, v175
v_fma_f32 v64, v64, v27, v27
v_fma_f32 v65, v65, v27, v27
v_mfma_f32_32x32x16_bf16 v[240:255], a[172:175], a[80:83], v[240:255]
ds_read_b64_tr_b16 a[220:221], v91 offset:28800
ds_read_b64_tr_b16 a[222:223], v91 offset:29312
v_fma_f32 v66, v66, v27, v27
v_fma_f32 v67, v67, v27, v27
v_fma_f32 v68, v68, v27, v27
v_fma_f32 v69, v69, v27, v27
s_waitcnt lgkmcnt(8)
v_mfma_f32_32x32x16_bf16 v[192:207], a[184:187], a[84:87], v[192:207]
ds_read_b64_tr_b16 a[160:161], v85 offset:30848
ds_read_b64_tr_b16 a[162:163], v85 offset:31360
v_fma_f32 v70, v70, v27, v27
v_fma_f32 v71, v71, v27, v27
v_rcp_f32 v64, v64
v_rcp_f32 v65, v65
v_mfma_f32_32x32x16_bf16 v[208:223], a[188:191], a[84:87], v[208:223]
ds_read_b64_tr_b16 a[164:165], v87 offset:30848
ds_read_b64_tr_b16 a[166:167], v87 offset:31360
v_rcp_f32 v66, v66
v_rcp_f32 v67, v67
v_rcp_f32 v68, v68
v_rcp_f32 v69, v69
v_mfma_f32_32x32x16_bf16 v[224:239], a[192:195], a[84:87], v[224:239]
ds_read_b64_tr_b16 a[168:169], v89 offset:30848
ds_read_b64_tr_b16 a[170:171], v89 offset:31360
v_rcp_f32 v70, v70
v_rcp_f32 v71, v71
v_mul_f32 v160, v160, v64
v_mul_f32 v161, v161, v65
v_mfma_f32_32x32x16_bf16 v[240:255], a[196:199], a[84:87], v[240:255]
ds_read_b64_tr_b16 a[172:173], v91 offset:30848
ds_read_b64_tr_b16 a[174:175], v91 offset:31360
v_mul_f32 v162, v162, v66
v_mul_f32 v163, v163, v67
v_mul_f32 v164, v164, v68
v_mul_f32 v165, v165, v69
s_waitcnt vmcnt(5)
s_barrier
s_waitcnt lgkmcnt(8)
v_mfma_f32_32x32x16_bf16 v[192:207], a[208:211], a[88:91], v[192:207]
ds_read_b64_tr_b16 a[184:185], v84 offset:0
ds_read_b64_tr_b16 a[186:187], v84 offset:512
v_mul_f32 v166, v166, v70
v_mul_f32 v167, v167, v71
v_mov_b32 v13, v13
s_cmp_lg_u32 s48, 0
s_cbranch_scc1 POKEBF
v_cmp_ne_u32 vcc, v13, v30
s_nop 3
s_and_b32 vcc_lo, vcc_lo, 16777215
s_and_b32 vcc_hi, vcc_hi, 0
s_or_b32 s76, vcc_lo, vcc_hi
s_cbranch_scc0 POKEBF
s_mov_b32 s77, 4000
s_mov_b32 s75, 12550144
PSPEBF:
s_sleep 3
buffer_load_dword v13, v12, s[24:27], s75 offen sc1
s_waitcnt vmcnt(0)
v_cmp_ne_u32 vcc, v13, v30
s_nop 3
s_and_b32 vcc_lo, vcc_lo, 16777215
s_and_b32 vcc_hi, vcc_hi, 0
s_or_b32 s76, vcc_lo, vcc_hi
s_cbranch_scc0 POKEBF
s_sub_u32 s77, s77, 1
s_cmp_lg_u32 s77, 0
s_cbranch_scc1 PSPEBF
POKEBF:
s_barrier
v_mfma_f32_32x32x16_bf16 v[208:223], a[212:215], a[88:91], v[208:223]
ds_read_b64_tr_b16 a[188:189], v86 offset:0
ds_read_b64_tr_b16 a[190:191], v86 offset:512
s_add_u32 s74, s55, 1572864
s_add_u32 m0, s80, 49408
s_nop 0
buffer_load_dwordx4 v7, s[16:19], s74 offen lds
buffer_load_dwordx4 a[0:3], v4, s[12:15], s43 offen offset:0 sc1
v_mfma_f32_32x32x16_bf16 v[224:239], a[216:219], a[88:91], v[224:239]
ds_read_b64_tr_b16 a[192:193], v88 offset:0
ds_read_b64_tr_b16 a[194:195], v88 offset:512
v_cvt_pk_bf16_f32 v168, v160, v161
v_cvt_pk_bf16_f32 v169, v162, v163
v_cvt_pk_bf16_f32 v170, v164, v165
v_cvt_pk_bf16_f32 v171, v166, v167
v_mfma_f32_32x32x16_bf16 v[240:255], a[220:223], a[88:91], v[240:255]
ds_read_b64_tr_b16 a[196:197], v90 offset:0
ds_read_b64_tr_b16 a[198:199], v90 offset:512
buffer_load_dwordx4 v8, s[16:19], s74 offen offset:1024 lds
buffer_load_dwordx4 a[4:7], v4, s[12:15], s43 offen offset:1024 sc1
s_add_u32 s70, s57, s58
s_add_u32 s70, s70, 4096
buffer_store_dwordx4 v[168:171], v22, s[24:27], s70 offen sc1
s_waitcnt lgkmcnt(8)
v_mfma_f32_32x32x16_bf16 v[192:207], a[160:163], a[92:95], v[192:207]
ds_read_b64_tr_b16 a[208:209], v84 offset:2048
ds_read_b64_tr_b16 a[210:211], v84 offset:2560
v_mul_f32 v64, v26, v176
v_mul_f32 v65, v26, v177
v_mul_f32 v66, v26, v178
v_mul_f32 v67, v26, v179
v_mfma_f32_32x32x16_bf16 v[208:223], a[164:167], a[92:95], v[208:223]
ds_read_b64_tr_b16 a[212:213], v86 offset:2048
ds_read_b64_tr_b16 a[214:215], v86 offset:2560
buffer_load_dwordx4 v9, s[16:19], s74 offen offset:2048 lds
buffer_load_dwordx4 a[8:11], v4, s[12:15], s43 offen offset:2048 sc1
v_mul_f32 v68, v26, v180
v_mul_f32 v69, v26, v181
v_mfma_f32_32x32x16_bf16 v[224:239], a[168:171], a[92:95], v[224:239]
ds_read_b64_tr_b16 a[216:217], v88 offset:2048
ds_read_b64_tr_b16 a[218:219], v88 offset:2560
v_mul_f32 v70, v26, v182
v_mul_f32 v71, v26, v183
v_exp_f32 v64, v64
v_exp_f32 v65, v65
v_mfma_f32_32x32x16_bf16 v[240:255], a[172:175], a[92:95], v[240:255]
ds_read_b64_tr_b16 a[220:221], v90 offset:2048
ds_read_b64_tr_b16 a[222:223], v90 offset:2560
buffer_load_dwordx4 v10, s[16:19], s74 offen offset:3072 lds
buffer_load_dwordx4 a[12:15], v4, s[12:15], s43 offen offset:3072 sc1
v_exp_f32 v66, v66
v_exp_f32 v67, v67
s_waitcnt lgkmcnt(8)
v_mfma_f32_32x32x16_bf16 v[192:207], a[184:187], a[96:99], v[192:207]
ds_read_b64_tr_b16 a[160:161], v84 offset:4096
ds_read_b64_tr_b16 a[162:163], v84 offset:4608
v_exp_f32 v68, v68
v_exp_f32 v69, v69
v_exp_f32 v70, v70
v_exp_f32 v71, v71
v_mfma_f32_32x32x16_bf16 v[208:223], a[188:191], a[96:99], v[208:223]
ds_read_b64_tr_b16 a[164:165], v86 offset:4096
ds_read_b64_tr_b16 a[166:167], v86 offset:4608
buffer_load_dwordx4 a[16:19], v5, s[12:15], s43 offen sc1
v_mul_f32 v176, v176, v184
v_mul_f32 v177, v177, v185
v_mul_f32 v178, v178, v186
v_mfma_f32_32x32x16_bf16 v[224:239], a[192:195], a[96:99], v[224:239]
ds_read_b64_tr_b16 a[168:169], v88 offset:4096
ds_read_b64_tr_b16 a[170:171], v88 offset:4608
v_mul_f32 v179, v179, v187
v_mul_f32 v180, v180, v188
v_mul_f32 v181, v181, v189
v_mul_f32 v182, v182, v190
v_mfma_f32_32x32x16_bf16 v[240:255], a[196:199], a[96:99], v[240:255]
ds_read_b64_tr_b16 a[172:173], v90 offset:4096
ds_read_b64_tr_b16 a[174:175], v90 offset:4608
s_add_u32 s43, s43, 20480
v_mul_f32 v183, v183, v191
v_fma_f32 v64, v64, v27, v27
v_fma_f32 v65, v65, v27, v27
s_waitcnt lgkmcnt(8)
v_mfma_f32_32x32x16_bf16 v[192:207], a[208:211], a[100:103], v[192:207]
ds_read_b64_tr_b16 a[184:185], v84 offset:6144
ds_read_b64_tr_b16 a[186:187], v84 offset:6656
v_fma_f32 v66, v66, v27, v27
v_fma_f32 v67, v67, v27, v27
v_fma_f32 v68, v68, v27, v27
v_fma_f32 v69, v69, v27, v27
v_mfma_f32_32x32x16_bf16 v[208:223], a[212:215], a[100:103], v[208:223]
ds_read_b64_tr_b16 a[188:189], v86 offset:6144
ds_read_b64_tr_b16 a[190:191], v86 offset:6656
buffer_load_dwordx4 a[20:23], v4, s[12:15], s43 offen offset:0 sc1
v_fma_f32 v70, v70, v27, v27
v_fma_f32 v71, v71, v27, v27
v_rcp_f32 v64, v64
v_mfma_f32_32x32x16_bf16 v[224:239], a[216:219], a[100:103], v[224:239]
ds_read_b64_tr_b16 a[192:193], v88 offset:6144
ds_read_b64_tr_b16 a[194:195], v88 offset:6656
v_rcp_f32 v65, v65
v_rcp_f32 v66, v66
v_rcp_f32 v67, v67
v_rcp_f32 v68, v68
v_mfma_f32_32x32x16_bf16 v[240:255], a[220:223], a[100:103], v[240:255]
ds_read_b64_tr_b16 a[196:197], v90 offset:6144
ds_read_b64_tr_b16 a[198:199], v90 offset:6656
buffer_load_dwordx4 a[24:27], v4, s[12:15], s43 offen offset:1024 sc1
v_rcp_f32 v69, v69
v_rcp_f32 v70, v70
v_rcp_f32 v71, v71
s_waitcnt vmcnt(12)
s_barrier
s_waitcnt lgkmcnt(8)
v_mfma_f32_32x32x16_bf16 v[192:207], a[160:163], a[104:107], v[192:207]
ds_read_b64_tr_b16 a[208:209], v84 offset:24704
ds_read_b64_tr_b16 a[210:211], v84 offset:25216
v_mul_f32 v176, v176, v64
v_mul_f32 v177, v177, v65
v_mul_f32 v178, v178, v66
v_mul_f32 v179, v179, v67
v_mfma_f32_32x32x16_bf16 v[208:223], a[164:167], a[104:107], v[208:223]
ds_read_b64_tr_b16 a[212:213], v86 offset:24704
ds_read_b64_tr_b16 a[214:215], v86 offset:25216
s_add_u32 s74, s55, 1769472
s_add_u32 m0, s80, 74112
s_nop 0
buffer_load_dwordx4 v7, s[16:19], s74 offen lds
buffer_load_dwordx4 a[28:31], v4, s[12:15], s43 offen offset:2048 sc1
v_mfma_f32_32x32x16_bf16 v[224:239], a[168:171], a[104:107], v[224:239]
ds_read_b64_tr_b16 a[216:217], v88 offset:24704
ds_read_b64_tr_b16 a[218:219], v88 offset:25216
v_mul_f32 v180, v180, v68
v_mul_f32 v181, v181, v69
v_mul_f32 v182, v182, v70
v_mul_f32 v183, v183, v71
v_mfma_f32_32x32x16_bf16 v[240:255], a[172:175], a[104:107], v[240:255]
ds_read_b64_tr_b16 a[220:221], v90 offset:24704
ds_read_b64_tr_b16 a[222:223], v90 offset:25216
buffer_load_dwordx4 v8, s[16:19], s74 offen offset:1024 lds
buffer_load_dwordx4 a[32:35], v4, s[12:15], s43 offen offset:3072 sc1
v_cvt_pk_bf16_f32 v184, v176, v177
v_cvt_pk_bf16_f32 v185, v178, v179
s_waitcnt lgkmcnt(8)
v_mfma_f32_32x32x16_bf16 v[192:207], a[184:187], a[108:111], v[192:207]
ds_read_b64_tr_b16 a[160:161], v84 offset:26752
ds_read_b64_tr_b16 a[162:163], v84 offset:27264
v_cvt_pk_bf16_f32 v186, v180, v181
v_cvt_pk_bf16_f32 v187, v182, v183
s_add_u32 s70, s57, s58
s_add_u32 s70, s70, 5120
buffer_store_dwordx4 v[184:187], v22, s[24:27], s70 offen sc1
v_mfma_f32_32x32x16_bf16 v[208:223], a[188:191], a[108:111], v[208:223]
ds_read_b64_tr_b16 a[164:165], v86 offset:26752
ds_read_b64_tr_b16 a[166:167], v86 offset:27264
buffer_load_dwordx4 v9, s[16:19], s74 offen offset:2048 lds
buffer_load_dwordx4 a[36:39], v5, s[12:15], s43 offen sc1
v_mfma_f32_32x32x16_bf16 v[224:239], a[192:195], a[108:111], v[224:239]
ds_read_b64_tr_b16 a[168:169], v88 offset:26752
ds_read_b64_tr_b16 a[170:171], v88 offset:27264
v_mfma_f32_32x32x16_bf16 v[240:255], a[196:199], a[108:111], v[240:255]
ds_read_b64_tr_b16 a[172:173], v90 offset:26752
ds_read_b64_tr_b16 a[174:175], v90 offset:27264
buffer_load_dwordx4 v10, s[16:19], s74 offen offset:3072 lds
s_add_u32 s43, s43, 20480
s_waitcnt lgkmcnt(8)
v_mfma_f32_32x32x16_bf16 v[192:207], a[208:211], a[112:115], v[192:207]
ds_read_b64_tr_b16 a[184:185], v84 offset:28800
ds_read_b64_tr_b16 a[186:187], v84 offset:29312
v_mfma_f32_32x32x16_bf16 v[208:223], a[212:215], a[112:115], v[208:223]
ds_read_b64_tr_b16 a[188:189], v86 offset:28800
ds_read_b64_tr_b16 a[190:191], v86 offset:29312
buffer_load_dwordx4 a[40:43], v4, s[12:15], s43 offen offset:0 sc1
v_mfma_f32_32x32x16_bf16 v[224:239], a[216:219], a[112:115], v[224:239]
ds_read_b64_tr_b16 a[192:193], v88 offset:28800
ds_read_b64_tr_b16 a[194:195], v88 offset:29312
v_mfma_f32_32x32x16_bf16 v[240:255], a[220:223], a[112:115], v[240:255]
ds_read_b64_tr_b16 a[196:197], v90 offset:28800
ds_read_b64_tr_b16 a[198:199], v90 offset:29312
buffer_load_dwordx4 a[44:47], v4, s[12:15], s43 offen offset:1024 sc1
s_waitcnt lgkmcnt(8)
v_mfma_f32_32x32x16_bf16 v[192:207], a[160:163], a[116:119], v[192:207]
ds_read_b64_tr_b16 a[208:209], v84 offset:30848
ds_read_b64_tr_b16 a[210:211], v84 offset:31360
v_mfma_f32_32x32x16_bf16 v[208:223], a[164:167], a[116:119], v[208:223]
ds_read_b64_tr_b16 a[212:213], v86 offset:30848
ds_read_b64_tr_b16 a[214:215], v86 offset:31360
buffer_load_dwordx4 a[48:51], v4, s[12:15], s43 offen offset:2048 sc1
v_mfma_f32_32x32x16_bf16 v[224:239], a[168:171], a[116:119], v[224:239]
ds_read_b64_tr_b16 a[216:217], v88 offset:30848
ds_read_b64_tr_b16 a[218:219], v88 offset:31360
v_mfma_f32_32x32x16_bf16 v[240:255], a[172:175], a[116:119], v[240:255]
ds_read_b64_tr_b16 a[220:221], v90 offset:30848
ds_read_b64_tr_b16 a[222:223], v90 offset:31360
buffer_load_dwordx4 a[52:55], v4, s[12:15], s43 offen offset:3072 sc1
s_waitcnt vmcnt(16)
s_barrier
s_waitcnt lgkmcnt(8)
v_mfma_f32_32x32x16_bf16 v[192:207], a[184:187], a[120:123], v[192:207]
ds_read_b64_tr_b16 a[160:161], v85 offset:0
ds_read_b64_tr_b16 a[162:163], v85 offset:512
v_mfma_f32_32x32x16_bf16 v[208:223], a[188:191], a[120:123], v[208:223]
ds_read_b64_tr_b16 a[164:165], v87 offset:0
ds_read_b64_tr_b16 a[166:167], v87 offset:512
buffer_load_dwordx4 a[56:59], v5, s[12:15], s43 offen sc1
v_mfma_f32_32x32x16_bf16 v[224:239], a[192:195], a[120:123], v[224:239]
ds_read_b64_tr_b16 a[168:169], v89 offset:0
ds_read_b64_tr_b16 a[170:171], v89 offset:512
v_mfma_f32_32x32x16_bf16 v[240:255], a[196:199], a[120:123], v[240:255]
ds_read_b64_tr_b16 a[172:173], v91 offset:0
ds_read_b64_tr_b16 a[174:175], v91 offset:512
s_add_u32 s43, s43, 20480
s_waitcnt lgkmcnt(8)
v_mfma_f32_32x32x16_bf16 v[192:207], a[208:211], a[124:127], v[192:207]
ds_read_b64_tr_b16 a[184:185], v85 offset:2048
ds_read_b64_tr_b16 a[186:187], v85 offset:2560
v_mfma_f32_32x32x16_bf16 v[208:223], a[212:215], a[124:127], v[208:223]
ds_read_b64_tr_b16 a[188:189], v87 offset:2048
ds_read_b64_tr_b16 a[190:191], v87 offset:2560
buffer_load_dwordx4 a[60:63], v4, s[12:15], s43 offen offset:0 sc1
v_mfma_f32_32x32x16_bf16 v[224:239], a[216:219], a[124:127], v[224:239]
ds_read_b64_tr_b16 a[192:193], v89 offset:2048
ds_read_b64_tr_b16 a[194:195], v89 offset:2560
v_mfma_f32_32x32x16_bf16 v[240:255], a[220:223], a[124:127], v[240:255]
ds_read_b64_tr_b16 a[196:197], v91 offset:2048
ds_read_b64_tr_b16 a[198:199], v91 offset:2560
buffer_load_dwordx4 a[64:67], v4, s[12:15], s43 offen offset:1024 sc1
s_waitcnt lgkmcnt(8)
v_mfma_f32_32x32x16_bf16 v[192:207], a[160:163], a[128:131], v[192:207]
ds_read_b64_tr_b16 a[208:209], v85 offset:4096
ds_read_b64_tr_b16 a[210:211], v85 offset:4608
v_mfma_f32_32x32x16_bf16 v[208:223], a[164:167], a[128:131], v[208:223]
ds_read_b64_tr_b16 a[212:213], v87 offset:4096
ds_read_b64_tr_b16 a[214:215], v87 offset:4608
buffer_load_dwordx4 a[68:71], v4, s[12:15], s43 offen offset:2048 sc1
v_mfma_f32_32x32x16_bf16 v[224:239], a[168:171], a[128:131], v[224:239]
ds_read_b64_tr_b16 a[216:217], v89 offset:4096
ds_read_b64_tr_b16 a[218:219], v89 offset:4608
v_mfma_f32_32x32x16_bf16 v[240:255], a[172:175], a[128:131], v[240:255]
ds_read_b64_tr_b16 a[220:221], v91 offset:4096
ds_read_b64_tr_b16 a[222:223], v91 offset:4608
buffer_load_dwordx4 a[72:75], v4, s[12:15], s43 offen offset:3072 sc1
s_waitcnt lgkmcnt(8)
v_mfma_f32_32x32x16_bf16 v[192:207], a[184:187], a[132:135], v[192:207]
ds_read_b64_tr_b16 a[160:161], v85 offset:6144
ds_read_b64_tr_b16 a[162:163], v85 offset:6656
v_mfma_f32_32x32x16_bf16 v[208:223], a[188:191], a[132:135], v[208:223]
ds_read_b64_tr_b16 a[164:165], v87 offset:6144
ds_read_b64_tr_b16 a[166:167], v87 offset:6656
buffer_load_dwordx4 a[76:79], v5, s[12:15], s43 offen sc1
v_mfma_f32_32x32x16_bf16 v[224:239], a[192:195], a[132:135], v[224:239]
ds_read_b64_tr_b16 a[168:169], v89 offset:6144
ds_read_b64_tr_b16 a[170:171], v89 offset:6656
v_mfma_f32_32x32x16_bf16 v[240:255], a[196:199], a[132:135], v[240:255]
ds_read_b64_tr_b16 a[172:173], v91 offset:6144
ds_read_b64_tr_b16 a[174:175], v91 offset:6656
s_add_u32 s43, s43, 20480
s_waitcnt vmcnt(10)
s_barrier
s_waitcnt lgkmcnt(8)
v_mfma_f32_32x32x16_bf16 v[192:207], a[208:211], a[136:139], v[192:207]
ds_read_b64_tr_b16 a[184:185], v85 offset:24704
ds_read_b64_tr_b16 a[186:187], v85 offset:25216
v_mfma_f32_32x32x16_bf16 v[208:223], a[212:215], a[136:139], v[208:223]
ds_read_b64_tr_b16 a[188:189], v87 offset:24704
ds_read_b64_tr_b16 a[190:191], v87 offset:25216
buffer_load_dwordx4 a[80:83], v4, s[12:15], s43 offen offset:0 sc1
v_mfma_f32_32x32x16_bf16 v[224:239], a[216:219], a[136:139], v[224:239]
ds_read_b64_tr_b16 a[192:193], v89 offset:24704
ds_read_b64_tr_b16 a[194:195], v89 offset:25216
v_mfma_f32_32x32x16_bf16 v[240:255], a[220:223], a[136:139], v[240:255]
ds_read_b64_tr_b16 a[196:197], v91 offset:24704
ds_read_b64_tr_b16 a[198:199], v91 offset:25216
buffer_load_dwordx4 a[84:87], v4, s[12:15], s43 offen offset:1024 sc1
s_waitcnt lgkmcnt(8)
v_mfma_f32_32x32x16_bf16 v[192:207], a[160:163], a[140:143], v[192:207]
ds_read_b64_tr_b16 a[208:209], v85 offset:26752
ds_read_b64_tr_b16 a[210:211], v85 offset:27264
v_mfma_f32_32x32x16_bf16 v[208:223], a[164:167], a[140:143], v[208:223]
ds_read_b64_tr_b16 a[212:213], v87 offset:26752
ds_read_b64_tr_b16 a[214:215], v87 offset:27264
buffer_load_dwordx4 a[88:91], v4, s[12:15], s43 offen offset:2048 sc1
v_mfma_f32_32x32x16_bf16 v[224:239], a[168:171], a[140:143], v[224:239]
ds_read_b64_tr_b16 a[216:217], v89 offset:26752
ds_read_b64_tr_b16 a[218:219], v89 offset:27264
v_mfma_f32_32x32x16_bf16 v[240:255], a[172:175], a[140:143], v[240:255]
ds_read_b64_tr_b16 a[220:221], v91 offset:26752
ds_read_b64_tr_b16 a[222:223], v91 offset:27264
buffer_load_dwordx4 a[92:95], v4, s[12:15], s43 offen offset:3072 sc1
s_waitcnt lgkmcnt(8)
v_mfma_f32_32x32x16_bf16 v[192:207], a[184:187], a[144:147], v[192:207]
ds_read_b64_tr_b16 a[160:161], v85 offset:28800
ds_read_b64_tr_b16 a[162:163], v85 offset:29312
v_mfma_f32_32x32x16_bf16 v[208:223], a[188:191], a[144:147], v[208:223]
ds_read_b64_tr_b16 a[164:165], v87 offset:28800
ds_read_b64_tr_b16 a[166:167], v87 offset:29312
buffer_load_dwordx4 a[96:99], v5, s[12:15], s43 offen sc1
v_mfma_f32_32x32x16_bf16 v[224:239], a[192:195], a[144:147], v[224:239]
ds_read_b64_tr_b16 a[168:169], v89 offset:28800
ds_read_b64_tr_b16 a[170:171], v89 offset:29312
v_mfma_f32_32x32x16_bf16 v[240:255], a[196:199], a[144:147], v[240:255]
ds_read_b64_tr_b16 a[172:173], v91 offset:28800
ds_read_b64_tr_b16 a[174:175], v91 offset:29312
s_add_u32 s43, s43, 20480
s_waitcnt lgkmcnt(8)
v_mfma_f32_32x32x16_bf16 v[192:207], a[208:211], a[148:151], v[192:207]
ds_read_b64_tr_b16 a[184:185], v85 offset:30848
ds_read_b64_tr_b16 a[186:187], v85 offset:31360
v_mfma_f32_32x32x16_bf16 v[208:223], a[212:215], a[148:151], v[208:223]
ds_read_b64_tr_b16 a[188:189], v87 offset:30848
ds_read_b64_tr_b16 a[190:191], v87 offset:31360
buffer_load_dwordx4 a[100:103], v4, s[12:15], s43 offen offset:0 sc1
v_mfma_f32_32x32x16_bf16 v[224:239], a[216:219], a[148:151], v[224:239]
ds_read_b64_tr_b16 a[192:193], v89 offset:30848
ds_read_b64_tr_b16 a[194:195], v89 offset:31360
v_mfma_f32_32x32x16_bf16 v[240:255], a[220:223], a[148:151], v[240:255]
ds_read_b64_tr_b16 a[196:197], v91 offset:30848
ds_read_b64_tr_b16 a[198:199], v91 offset:31360
buffer_load_dwordx4 a[104:107], v4, s[12:15], s43 offen offset:1024 sc1
s_waitcnt lgkmcnt(8)
v_mfma_f32_32x32x16_bf16 v[192:207], a[160:163], a[152:155], v[192:207]
v_mfma_f32_32x32x16_bf16 v[208:223], a[164:167], a[152:155], v[208:223]
buffer_load_dwordx4 a[108:111], v4, s[12:15], s43 offen offset:2048 sc1
v_mfma_f32_32x32x16_bf16 v[224:239], a[168:171], a[152:155], v[224:239]
v_mfma_f32_32x32x16_bf16 v[240:255], a[172:175], a[152:155], v[240:255]
buffer_load_dwordx4 a[112:115], v4, s[12:15], s43 offen offset:3072 sc1
s_waitcnt lgkmcnt(0)
v_mfma_f32_32x32x16_bf16 v[192:207], a[184:187], a[156:159], v[192:207]
v_mfma_f32_32x32x16_bf16 v[208:223], a[188:191], a[156:159], v[208:223]
buffer_load_dwordx4 a[116:119], v5, s[12:15], s43 offen sc1
v_mfma_f32_32x32x16_bf16 v[224:239], a[192:195], a[156:159], v[224:239]
v_mfma_f32_32x32x16_bf16 v[240:255], a[196:199], a[156:159], v[240:255]
s_add_u32 s43, s43, 20480
s_barrier
v_mov_b32 v34, 0
v_mov_b32 v35, 0
v_mov_b32 v38, 0
v_mov_b32 v39, 0
ds_read_b32 v40, v23 offset:27936
ds_read_b32 v41, v23 offset:28000
ds_read_b32 v42, v23 offset:28064
ds_read_b32 v43, v23 offset:28128
s_waitcnt lgkmcnt(3)
v_cvt_pk_bf16_f32 v32, v40, v40
v_lshlrev_b32 v46, 16, v32
v_sub_f32 v46, v40, v46
buffer_load_dwordx4 a[120:123], v4, s[12:15], s43 offen offset:0 sc1
v_cvt_pk_bf16_f32 v33, v46, v46
s_nop 1
v_mfma_f32_32x32x16_bf16 v[192:207], v[32:35], a[244:247], v[192:207]
s_waitcnt lgkmcnt(2)
v_cvt_pk_bf16_f32 v36, v41, v41
v_lshlrev_b32 v47, 16, v36
v_sub_f32 v47, v41, v47
v_cvt_pk_bf16_f32 v37, v47, v47
s_nop 1
v_mfma_f32_32x32x16_bf16 v[208:223], v[36:39], a[244:247], v[208:223]
s_waitcnt lgkmcnt(1)
v_cvt_pk_bf16_f32 v32, v42, v42
v_lshlrev_b32 v46, 16, v32
v_sub_f32 v46, v42, v46
v_cvt_pk_bf16_f32 v33, v46, v46
buffer_load_dwordx4 a[124:127], v4, s[12:15], s43 offen offset:1024 sc1
s_nop 0
v_mfma_f32_32x32x16_bf16 v[224:239], v[32:35], a[244:247], v[224:239]
s_waitcnt lgkmcnt(0)
v_cvt_pk_bf16_f32 v36, v43, v43
v_lshlrev_b32 v47, 16, v36
v_sub_f32 v47, v43, v47
v_cvt_pk_bf16_f32 v37, v47, v47
s_nop 1
v_mfma_f32_32x32x16_bf16 v[240:255], v[36:39], a[244:247], v[240:255]
v_mul_f32 v64, v26, v192
v_mul_f32 v65, v26, v193
v_mul_f32 v66, v26, v194
v_mul_f32 v67, v26, v195
v_mul_f32 v68, v26, v196
buffer_load_dwordx4 a[128:131], v4, s[12:15], s43 offen offset:2048 sc1
v_mul_f32 v69, v26, v197
v_mul_f32 v70, v26, v198
v_mul_f32 v71, v26, v199
v_exp_f32 v64, v64
v_exp_f32 v65, v65
v_exp_f32 v66, v66
v_exp_f32 v67, v67
v_exp_f32 v68, v68
v_exp_f32 v69, v69
v_exp_f32 v70, v70
v_exp_f32 v71, v71
buffer_load_dwordx4 a[132:135], v4, s[12:15], s43 offen offset:3072 sc1
v_mul_f32 v192, v192, v200
v_mul_f32 v193, v193, v201
v_mul_f32 v194, v194, v202
v_mul_f32 v195, v195, v203
v_mul_f32 v196, v196, v204
v_mul_f32 v197, v197, v205
v_mul_f32 v198, v198, v206
v_mul_f32 v199, v199, v207
v_fma_f32 v64, v64, v27, v27
v_fma_f32 v65, v65, v27, v27
v_fma_f32 v66, v66, v27, v27
buffer_load_dwordx4 a[136:139], v5, s[12:15], s43 offen sc1
v_fma_f32 v67, v67, v27, v27
v_fma_f32 v68, v68, v27, v27
v_fma_f32 v69, v69, v27, v27
v_fma_f32 v70, v70, v27, v27
v_fma_f32 v71, v71, v27, v27
v_rcp_f32 v64, v64
v_rcp_f32 v65, v65
v_rcp_f32 v66, v66
v_rcp_f32 v67, v67
v_rcp_f32 v68, v68
v_rcp_f32 v69, v69
s_add_u32 s43, s43, 20480
v_rcp_f32 v70, v70
v_rcp_f32 v71, v71
v_mul_f32 v192, v192, v64
v_mul_f32 v193, v193, v65
v_mul_f32 v194, v194, v66
v_mul_f32 v195, v195, v67
v_mul_f32 v196, v196, v68
v_mul_f32 v197, v197, v69
v_mul_f32 v198, v198, v70
v_mul_f32 v199, v199, v71
v_cvt_pk_bf16_f32 v200, v192, v193
buffer_load_dwordx4 a[140:143], v4, s[12:15], s43 offen offset:0 sc1
v_cvt_pk_bf16_f32 v201, v194, v195
v_cvt_pk_bf16_f32 v202, v196, v197
v_cvt_pk_bf16_f32 v203, v198, v199
s_add_u32 s70, s57, s59
buffer_store_dwordx4 v[200:203], v22, s[24:27], s70 offen sc1
v_mul_f32 v64, v26, v208
v_mul_f32 v65, v26, v209
v_mul_f32 v66, v26, v210
v_mul_f32 v67, v26, v211
v_mul_f32 v68, v26, v212
v_mul_f32 v69, v26, v213
v_mul_f32 v70, v26, v214
buffer_load_dwordx4 a[144:147], v4, s[12:15], s43 offen offset:1024 sc1
v_mul_f32 v71, v26, v215
v_exp_f32 v64, v64
v_exp_f32 v65, v65
v_exp_f32 v66, v66
v_exp_f32 v67, v67
v_exp_f32 v68, v68
v_exp_f32 v69, v69
v_exp_f32 v70, v70
v_exp_f32 v71, v71
v_mul_f32 v208, v208, v216
v_mul_f32 v209, v209, v217
buffer_load_dwordx4 a[148:151], v4, s[12:15], s43 offen offset:2048 sc1
v_mul_f32 v210, v210, v218
v_mul_f32 v211, v211, v219
v_mul_f32 v212, v212, v220
v_mul_f32 v213, v213, v221
v_mul_f32 v214, v214, v222
v_mul_f32 v215, v215, v223
v_fma_f32 v64, v64, v27, v27
v_fma_f32 v65, v65, v27, v27
v_fma_f32 v66, v66, v27, v27
v_fma_f32 v67, v67, v27, v27
v_fma_f32 v68, v68, v27, v27
buffer_load_dwordx4 a[152:155], v4, s[12:15], s43 offen offset:3072 sc1
v_fma_f32 v69, v69, v27, v27
v_fma_f32 v70, v70, v27, v27
v_fma_f32 v71, v71, v27, v27
v_rcp_f32 v64, v64
v_rcp_f32 v65, v65
v_rcp_f32 v66, v66
v_rcp_f32 v67, v67
v_rcp_f32 v68, v68
v_rcp_f32 v69, v69
v_rcp_f32 v70, v70
v_rcp_f32 v71, v71
buffer_load_dwordx4 a[156:159], v5, s[12:15], s43 offen sc1
v_mul_f32 v208, v208, v64
v_mul_f32 v209, v209, v65
v_mul_f32 v210, v210, v66
v_mul_f32 v211, v211, v67
v_mul_f32 v212, v212, v68
v_mul_f32 v213, v213, v69
v_mul_f32 v214, v214, v70
v_mul_f32 v215, v215, v71
v_cvt_pk_bf16_f32 v216, v208, v209
v_cvt_pk_bf16_f32 v217, v210, v211
v_cvt_pk_bf16_f32 v218, v212, v213
s_add_u32 s43, s43, 20480
v_cvt_pk_bf16_f32 v219, v214, v215
s_add_u32 s70, s57, s59
buffer_store_dwordx4 v[216:219], v22, s[24:27], s70 offen offset:1024 sc1
v_mul_f32 v64, v26, v224
v_mul_f32 v65, v26, v225
v_mul_f32 v66, v26, v226
v_mul_f32 v67, v26, v227
v_mul_f32 v68, v26, v228
v_mul_f32 v69, v26, v229
v_mul_f32 v70, v26, v230
v_mul_f32 v71, v26, v231
v_exp_f32 v64, v64
v_exp_f32 v65, v65
v_exp_f32 v66, v66
v_exp_f32 v67, v67
v_exp_f32 v68, v68
v_exp_f32 v69, v69
v_exp_f32 v70, v70
v_exp_f32 v71, v71
v_mul_f32 v224, v224, v232
v_mul_f32 v225, v225, v233
v_mul_f32 v226, v226, v234
v_mul_f32 v227, v227, v235
v_mul_f32 v228, v228, v236
v_mul_f32 v229, v229, v237
v_mul_f32 v230, v230, v238
v_mul_f32 v231, v231, v239
v_fma_f32 v64, v64, v27, v27
v_fma_f32 v65, v65, v27, v27
v_fma_f32 v66, v66, v27, v27
v_fma_f32 v67, v67, v27, v27
v_fma_f32 v68, v68, v27, v27
v_fma_f32 v69, v69, v27, v27
v_fma_f32 v70, v70, v27, v27
v_fma_f32 v71, v71, v27, v27
v_rcp_f32 v64, v64
v_rcp_f32 v65, v65
v_rcp_f32 v66, v66
v_rcp_f32 v67, v67
v_rcp_f32 v68, v68
v_rcp_f32 v69, v69
v_rcp_f32 v70, v70
v_rcp_f32 v71, v71
v_mul_f32 v224, v224, v64
v_mul_f32 v225, v225, v65
v_mul_f32 v226, v226, v66
v_mul_f32 v227, v227, v67
v_mul_f32 v228, v228, v68
v_mul_f32 v229, v229, v69
v_mul_f32 v230, v230, v70
v_mul_f32 v231, v231, v71
v_cvt_pk_bf16_f32 v232, v224, v225
v_cvt_pk_bf16_f32 v233, v226, v227
v_cvt_pk_bf16_f32 v234, v228, v229
v_cvt_pk_bf16_f32 v235, v230, v231
s_add_u32 s70, s57, s59
buffer_store_dwordx4 v[232:235], v22, s[24:27], s70 offen offset:2048 sc1
v_mul_f32 v64, v26, v240
v_mul_f32 v65, v26, v241
v_mul_f32 v66, v26, v242
v_mul_f32 v67, v26, v243
v_mul_f32 v68, v26, v244
v_mul_f32 v69, v26, v245
v_mul_f32 v70, v26, v246
v_mul_f32 v71, v26, v247
v_exp_f32 v64, v64
v_exp_f32 v65, v65
v_exp_f32 v66, v66
v_exp_f32 v67, v67
v_exp_f32 v68, v68
v_exp_f32 v69, v69
v_exp_f32 v70, v70
v_exp_f32 v71, v71
v_mul_f32 v240, v240, v248
v_mul_f32 v241, v241, v249
v_mul_f32 v242, v242, v250
v_mul_f32 v243, v243, v251
v_mul_f32 v244, v244, v252
v_mul_f32 v245, v245, v253
v_mul_f32 v246, v246, v254
v_mul_f32 v247, v247, v255
v_fma_f32 v64, v64, v27, v27
v_fma_f32 v65, v65, v27, v27
v_fma_f32 v66, v66, v27, v27
v_fma_f32 v67, v67, v27, v27
v_fma_f32 v68, v68, v27, v27
v_fma_f32 v69, v69, v27, v27
v_fma_f32 v70, v70, v27, v27
v_fma_f32 v71, v71, v27, v27
v_rcp_f32 v64, v64
v_rcp_f32 v65, v65
v_rcp_f32 v66, v66
v_rcp_f32 v67, v67
v_rcp_f32 v68, v68
v_rcp_f32 v69, v69
v_rcp_f32 v70, v70
v_rcp_f32 v71, v71
v_mul_f32 v240, v240, v64
v_mul_f32 v241, v241, v65
v_mul_f32 v242, v242, v66
v_mul_f32 v243, v243, v67
v_mul_f32 v244, v244, v68
v_mul_f32 v245, v245, v69
v_mul_f32 v246, v246, v70
v_mul_f32 v247, v247, v71
v_cvt_pk_bf16_f32 v248, v240, v241
v_cvt_pk_bf16_f32 v249, v242, v243
v_cvt_pk_bf16_f32 v250, v244, v245
v_cvt_pk_bf16_f32 v251, v246, v247
s_add_u32 s70, s57, s59
buffer_store_dwordx4 v[248:251], v22, s[24:27], s70 offen offset:3072 sc1
s_mul_i32 s51, s40, 278528
s_add_u32 s8, s24, s51
s_addc_u32 s9, s25, 0
s_mov_b32 s10, 278528
s_mov_b32 s11, 0x20000
s_mov_b32 s16, s4
s_mov_b32 s17, s5
s_mov_b32 s18, 2621440
s_mov_b32 s19, 0x20000
s_mov_b32 s20, s86
s_mov_b32 s21, s87
s_mov_b32 s22, 2621440
s_mov_b32 s23, 0x20000
s_mov_b32 s63, 0x358637bd
s_mul_i32 s62, s41, 3200
s_add_u32 s62, s62, 11534336
s_mul_i32 s46, s40, 81920
s_mul_i32 s51, s41, 160
s_add_u32 s46, s46, s51
v_and_b32 v52, 15, v1
v_lshrrev_b32 v53, 4, v1
v_lshrrev_b32 v54, 1, v53
v_lshlrev_b32 v56, 10, v54
v_and_b32 v55, 1, v53
v_lshl_add_u32 v56, v55, 9, v56
v_lshl_add_u32 v2, v52, 4, v56
v_add_u32 v3, 139264, v2
s_mul_i32 s51, s48, 20480
v_add_u32 v6, s51, v4
v_lshl_add_u32 v54, v54, 2, v55
s_mul_i32 s51, s48, 2048
s_add_u32 s51, s51, 96512
v_lshlrev_b32 v59, 5, v52
v_add_u32 v59, s51, v59
s_mul_i32 s52, s48, 204800
v_lshlrev_b32 v58, 3, v52
v_add_u32 v58, s52, v58
s_mov_b32 s53, 25600
s_mov_b32 s54, 52429
s_mov_b32 s55, -20
v_add_u32 v55, 0, v54
v_mul_u32_u24 v56, s54, v55
v_lshrrev_b32 v56, 18, v56
v_mad_i32_i24 v57, v56, -5, v55
v_lshl_add_u32 v42, v56, 2, v59
v_mad_u32_u24 v56, v56, s53, v58
v_lshl_add_u32 v32, v57, 7, v56
v_add_u32 v55, 2, v54
v_mul_u32_u24 v56, s54, v55
v_lshrrev_b32 v56, 18, v56
v_mad_i32_i24 v57, v56, -5, v55
v_lshl_add_u32 v43, v56, 2, v59
v_mad_u32_u24 v56, v56, s53, v58
v_lshl_add_u32 v33, v57, 7, v56
v_add_u32 v55, 8, v54
v_mul_u32_u24 v56, s54, v55
v_lshrrev_b32 v56, 18, v56
v_mad_i32_i24 v57, v56, -5, v55
v_lshl_add_u32 v44, v56, 2, v59
v_mad_u32_u24 v56, v56, s53, v58
v_lshl_add_u32 v34, v57, 7, v56
v_add_u32 v55, 10, v54
v_mul_u32_u24 v56, s54, v55
v_lshrrev_b32 v56, 18, v56
v_mad_i32_i24 v57, v56, -5, v55
v_lshl_add_u32 v45, v56, 2, v59
v_mad_u32_u24 v56, v56, s53, v58
v_lshl_add_u32 v35, v57, 7, v56
v_add_u32 v55, 16, v54
v_mul_u32_u24 v56, s54, v55
v_lshrrev_b32 v56, 18, v56
v_mad_i32_i24 v57, v56, -5, v55
v_lshl_add_u32 v46, v56, 2, v59
v_mad_u32_u24 v56, v56, s53, v58
v_lshl_add_u32 v36, v57, 7, v56
v_add_u32 v55, 18, v54
v_mul_u32_u24 v56, s54, v55
v_lshrrev_b32 v56, 18, v56
v_mad_i32_i24 v57, v56, -5, v55
v_lshl_add_u32 v47, v56, 2, v59
v_mad_u32_u24 v56, v56, s53, v58
v_lshl_add_u32 v37, v57, 7, v56
v_add_u32 v55, 24, v54
v_mul_u32_u24 v56, s54, v55
v_lshrrev_b32 v56, 18, v56
v_mad_i32_i24 v57, v56, -5, v55
v_lshl_add_u32 v48, v56, 2, v59
v_mad_u32_u24 v56, v56, s53, v58
v_lshl_add_u32 v38, v57, 7, v56
v_add_u32 v55, 26, v54
v_mul_u32_u24 v56, s54, v55
v_lshrrev_b32 v56, 18, v56
v_mad_i32_i24 v57, v56, -5, v55
v_lshl_add_u32 v49, v56, 2, v59
v_mad_u32_u24 v56, v56, s53, v58
v_lshl_add_u32 v39, v57, 7, v56
v_add_u32 v55, 32, v54
v_mul_u32_u24 v56, s54, v55
v_lshrrev_b32 v56, 18, v56
v_mad_i32_i24 v57, v56, -5, v55
v_lshl_add_u32 v50, v56, 2, v59
v_mad_u32_u24 v56, v56, s53, v58
v_lshl_add_u32 v40, v57, 7, v56
v_add_u32 v55, 34, v54
v_mul_u32_u24 v56, s54, v55
v_lshrrev_b32 v56, 18, v56
v_mad_i32_i24 v57, v56, -5, v55
v_lshl_add_u32 v51, v56, 2, v59
v_mad_u32_u24 v56, v56, s53, v58
v_lshl_add_u32 v41, v57, 7, v56
s_mul_i32 s51, s48, 5120
v_add_u32 v7, s51, v4
v_add_u32 v8, 40960, v7
s_lshl_b32 s51, s48, 4
v_add_u32 v12, s51, v52
v_mul_u32_u24 v12, 1280, v12
v_lshl_add_u32 v12, v53, 3, v12
s_mul_i32 s51, s48, 3072
s_add_u32 s51, s51, 110848
v_lshrrev_b32 v55, 3, v1
v_mul_u32_u24 v55, 360, v55
v_and_b32 v56, 7, v1
v_mul_u32_u24 v56, 6, v56
v_add3_u32 v17, v55, v56, s51
v_min_u32 v55, 8, v52
v_mul_u32_u24 v55, 320, v55
v_lshl_add_u32 v55, v54, 3, v55
v_add_u32 v28, s51, v55
v_add_u32 v55, s51, v4
v_mov_b32 v60, 0
v_mov_b32 v61, 0
v_mov_b32 v62, 0
v_mov_b32 v63, 0
ds_write_b128 v55, v[60:63]
ds_write_b128 v55, v[60:63] offset:1024
ds_write_b128 v55, v[60:63] offset:2048
s_waitcnt vmcnt(0)
s_barrier
s_lshl_b32 s51, s49, 4
s_add_u32 s51, s51, s50
s_lshl_b32 s51, s51, 7
s_add_u32 s51, s51, 12517376
s_cmp_eq_u32 s48, 0
s_cselect_b32 s51, s51, 17825792
v_mov_b32 v72, v30
v_mov_b32 v73, v30
v_mov_b32 v74, v30
v_mov_b32 v75, v30
v_cmp_gt_u32 vcc, 8, v1
s_nop 1
v_cndmask_b32 v76, v31, v4, vcc
buffer_store_dwordx4 v[72:75], v76, s[24:27], s51 offen sc1
s_lshr_b32 s51, s40, 1
s_lshl_b32 s51, s51, 4
v_add_u32 v84, s51, v1
v_lshlrev_b32 v84, 7, v84
v_cmp_gt_u32 vcc, 16, v1
s_nop 1
v_cndmask_b32 v84, v31, v84, vcc
buffer_load_dwordx2 v[18:19], v12, s[16:19], s46 offen
buffer_load_dwordx2 v[20:21], v12, s[16:19], s46 offen offset:32
buffer_load_dwordx2 v[22:23], v12, s[16:19], s46 offen offset:64
buffer_load_dwordx2 v[24:25], v12, s[16:19], s46 offen offset:96
buffer_load_dwordx2 v[26:27], v12, s[16:19], s46 offen offset:128
s_mul_i32 s51, s44, 25600
s_mul_i32 s52, s45, 160
s_add_u32 s65, s51, s52
s_lshl_b32 s51, s48, 6
v_add_u32 v55, s51, v1
v_mul_u32_u24 v56, 6554, v55
v_lshrrev_b32 v56, 16, v56
v_mad_i32_i24 v57, v56, -10, v55
v_mul_u32_u24 v56, 1280, v56
v_lshl_add_u32 v58, v57, 4, v56
v_add_u32 v55, 256, v1
v_mul_u32_u24 v56, 6554, v55
v_lshrrev_b32 v56, 16, v56
v_mad_i32_i24 v57, v56, -10, v55
v_mul_u32_u24 v56, 1280, v56
v_lshl_add_u32 v59, v57, 4, v56
s_lshl_b32 s51, s48, 10
s_add_u32 m0, s51, 88064
s_cmp_eq_u32 s48, 0
buffer_load_dwordx4 v58, s[36:39], s65 offen lds
s_cselect_b32 s51, s65, 2147483647
s_cselect_b32 s52, 0, 1024
s_add_u32 m0, s52, 92160
s_nop 0
buffer_load_dwordx4 v59, s[36:39], s51 offen lds
s_mov_b32 s75, 12517376
s_cmp_eq_u32 s48, 0
s_cselect_b32 s75, s75, 17825792
buffer_load_dword v86, v84, s[24:27], s75 offen sc1
s_waitcnt vmcnt(0)
v_mov_b32 v86, v86
s_cmp_lg_u32 s48, 0
s_cbranch_scc1 POKLBF
v_cmp_ne_u32 vcc, v86, v30
s_nop 3
s_and_b32 vcc_lo, vcc_lo, 61166
s_and_b32 vcc_hi, vcc_hi, 0
s_or_b32 s76, vcc_lo, vcc_hi
s_cbranch_scc0 POKLBF
s_mov_b32 s77, 4000
s_mov_b32 s75, 12517376
PSPLBF:
s_sleep 3
buffer_load_dword v86, v84, s[24:27], s75 offen sc1
s_waitcnt vmcnt(0)
v_cmp_ne_u32 vcc, v86, v30
s_nop 3
s_and_b32 vcc_lo, vcc_lo, 61166
s_and_b32 vcc_hi, vcc_hi, 0
s_or_b32 s76, vcc_lo, vcc_hi
s_cbranch_scc0 POKLBF
s_sub_u32 s77, s77, 1
s_cmp_lg_u32 s77, 0
s_cbranch_scc1 PSPLBF
POKLBF:
s_barrier
buffer_load_dwordx4 a[160:163], v2, s[8:11], s42 offen offset:0 sc1
buffer_load_dwordx4 a[164:167], v2, s[8:11], s42 offen offset:256 sc1
buffer_load_dwordx4 a[168:171], v3, s[8:11], s42 offen offset:0 sc1
buffer_load_dwordx4 a[172:175], v3, s[8:11], s42 offen offset:256 sc1
s_add_u32 s42, s42, 8192
buffer_load_dwordx4 a[176:179], v2, s[8:11], s42 offen offset:0 sc1
buffer_load_dwordx4 a[180:183], v2, s[8:11], s42 offen offset:256 sc1
buffer_load_dwordx4 a[184:187], v3, s[8:11], s42 offen offset:0 sc1
buffer_load_dwordx4 a[188:191], v3, s[8:11], s42 offen offset:256 sc1
s_add_u32 s42, s42, 8192
buffer_load_dwordx4 a[192:195], v2, s[8:11], s42 offen offset:0 sc1
buffer_load_dwordx4 a[196:199], v2, s[8:11], s42 offen offset:256 sc1
buffer_load_dwordx4 a[200:203], v3, s[8:11], s42 offen offset:0 sc1
buffer_load_dwordx4 a[204:207], v3, s[8:11], s42 offen offset:256 sc1
s_add_u32 s42, s42, 8192
s_waitcnt vmcnt(11)
v_mfma_f32_16x16x32_bf16 v[176:179], a[0:3], a[160:163], 0
buffer_load_dwordx4 a[208:211], v2, s[8:11], s42 offen offset:0 sc1
v_lshlrev_b32 v52, 4, v0
v_cmp_gt_u32 vcc, 160, v0
s_nop 1
v_cndmask_b32 v52, v31, v52, vcc
s_lshl_b32 s64, s44, 16
s_add_u32 s64, s64, 12582912
buffer_load_dwordx4 v[96:99], v52, s[24:27], s64 offen sc1
s_add_u32 s64, s64, 4096
buffer_load_dwordx4 v[100:103], v52, s[24:27], s64 offen sc1
s_add_u32 s64, s64, 4096
buffer_load_dwordx4 v[104:107], v52, s[24:27], s64 offen sc1
s_add_u32 s64, s64, 4096
buffer_load_dwordx4 v[108:111], v52, s[24:27], s64 offen sc1
s_add_u32 s64, s64, 4096
buffer_load_dwordx4 v[112:115], v52, s[24:27], s64 offen sc1
s_add_u32 s64, s64, 4096
buffer_load_dwordx4 v[116:119], v52, s[24:27], s64 offen sc1
s_add_u32 s64, s64, 4096
buffer_load_dwordx4 v[120:123], v52, s[24:27], s64 offen sc1
s_add_u32 s64, s64, 4096
buffer_load_dwordx4 v[124:127], v52, s[24:27], s64 offen sc1
s_add_u32 s64, s64, 4096
buffer_load_dwordx4 v[128:131], v52, s[24:27], s64 offen sc1
s_add_u32 s64, s64, 4096
buffer_load_dwordx4 v[132:135], v52, s[24:27], s64 offen sc1
s_add_u32 s64, s64, 4096
buffer_load_dwordx4 v[136:139], v52, s[24:27], s64 offen sc1
s_add_u32 s64, s64, 4096
buffer_load_dwordx4 v[140:143], v52, s[24:27], s64 offen sc1
s_add_u32 s64, s64, 4096
buffer_load_dwordx4 v[144:147], v52, s[24:27], s64 offen sc1
s_add_u32 s64, s64, 4096
buffer_load_dwordx4 v[148:151], v52, s[24:27], s64 offen sc1
s_add_u32 s64, s64, 4096
buffer_load_dwordx4 v[152:155], v52, s[24:27], s64 offen sc1
s_add_u32 s64, s64, 4096
buffer_load_dwordx4 v[156:159], v52, s[24:27], s64 offen sc1
v_mfma_f32_16x16x32_bf16 v[180:183], a[4:7], a[160:163], 0
buffer_load_dwordx4 a[212:215], v2, s[8:11], s42 offen offset:256 sc1
v_mfma_f32_16x16x32_bf16 v[184:187], a[8:11], a[160:163], 0
buffer_load_dwordx4 a[216:219], v3, s[8:11], s42 offen offset:0 sc1
v_mfma_f32_16x16x32_bf16 v[188:191], a[12:15], a[160:163], 0
buffer_load_dwordx4 a[220:223], v3, s[8:11], s42 offen offset:256 sc1
v_mfma_f32_16x16x32_bf16 v[192:195], a[16:19], a[160:163], 0
s_add_u32 s42, s42, 8192
s_waitcnt vmcnt(30)
v_mfma_f32_16x16x32_bf16 v[196:199], a[0:3], a[164:167], 0
v_mfma_f32_16x16x32_bf16 v[200:203], a[4:7], a[164:167], 0
v_mfma_f32_16x16x32_bf16 v[204:207], a[8:11], a[164:167], 0
v_mfma_f32_16x16x32_bf16 v[208:211], a[12:15], a[164:167], 0
v_mfma_f32_16x16x32_bf16 v[212:215], a[16:19], a[164:167], 0
s_waitcnt vmcnt(29)
v_mfma_f32_16x16x32_bf16 v[216:219], a[0:3], a[168:171], 0
v_mfma_f32_16x16x32_bf16 v[220:223], a[4:7], a[168:171], 0
v_mfma_f32_16x16x32_bf16 v[224:227], a[8:11], a[168:171], 0
v_mfma_f32_16x16x32_bf16 v[228:231], a[12:15], a[168:171], 0
v_mfma_f32_16x16x32_bf16 v[232:235], a[16:19], a[168:171], 0
s_waitcnt vmcnt(28)
v_mfma_f32_16x16x32_bf16 v[236:239], a[0:3], a[172:175], 0
v_mfma_f32_16x16x32_bf16 v[240:243], a[4:7], a[172:175], 0
v_mfma_f32_16x16x32_bf16 v[244:247], a[8:11], a[172:175], 0
v_mfma_f32_16x16x32_bf16 v[248:251], a[12:15], a[172:175], 0
v_mfma_f32_16x16x32_bf16 v[252:255], a[16:19], a[172:175], 0
s_waitcnt vmcnt(27)
v_mfma_f32_16x16x32_bf16 v[176:179], a[20:23], a[176:179], v[176:179]
buffer_load_dwordx4 a[160:163], v2, s[8:11], s42 offen offset:0 sc1
v_mfma_f32_16x16x32_bf16 v[180:183], a[24:27], a[176:179], v[180:183]
buffer_load_dwordx4 a[164:167], v2, s[8:11], s42 offen offset:256 sc1
v_mfma_f32_16x16x32_bf16 v[184:187], a[28:31], a[176:179], v[184:187]
buffer_load_dwordx4 a[168:171], v3, s[8:11], s42 offen offset:0 sc1
v_mfma_f32_16x16x32_bf16 v[188:191], a[32:35], a[176:179], v[188:191]
buffer_load_dwordx4 a[172:175], v3, s[8:11], s42 offen offset:256 sc1
v_mfma_f32_16x16x32_bf16 v[192:195], a[36:39], a[176:179], v[192:195]
s_add_u32 s42, s42, 8192
s_waitcnt vmcnt(30)
v_mfma_f32_16x16x32_bf16 v[196:199], a[20:23], a[180:183], v[196:199]
v_mfma_f32_16x16x32_bf16 v[200:203], a[24:27], a[180:183], v[200:203]
v_mfma_f32_16x16x32_bf16 v[204:207], a[28:31], a[180:183], v[204:207]
v_mfma_f32_16x16x32_bf16 v[208:211], a[32:35], a[180:183], v[208:211]
v_mfma_f32_16x16x32_bf16 v[212:215], a[36:39], a[180:183], v[212:215]
s_waitcnt vmcnt(29)
v_mfma_f32_16x16x32_bf16 v[216:219], a[20:23], a[184:187], v[216:219]
v_mfma_f32_16x16x32_bf16 v[220:223], a[24:27], a[184:187], v[220:223]
v_mfma_f32_16x16x32_bf16 v[224:227], a[28:31], a[184:187], v[224:227]
v_mfma_f32_16x16x32_bf16 v[228:231], a[32:35], a[184:187], v[228:231]
v_mfma_f32_16x16x32_bf16 v[232:235], a[36:39], a[184:187], v[232:235]
s_waitcnt vmcnt(28)
v_mfma_f32_16x16x32_bf16 v[236:239], a[20:23], a[188:191], v[236:239]
v_mfma_f32_16x16x32_bf16 v[240:243], a[24:27], a[188:191], v[240:243]
v_mfma_f32_16x16x32_bf16 v[244:247], a[28:31], a[188:191], v[244:247]
v_mfma_f32_16x16x32_bf16 v[248:251], a[32:35], a[188:191], v[248:251]
v_mfma_f32_16x16x32_bf16 v[252:255], a[36:39], a[188:191], v[252:255]
s_waitcnt vmcnt(22)
v_xor_b32 v53, v99, v30
s_waitcnt vmcnt(21)
v_xor_b32 v54, v103, v30
v_or_b32 v53, v53, v54
s_waitcnt vmcnt(20)
v_xor_b32 v54, v107, v30
v_or_b32 v53, v53, v54
s_waitcnt vmcnt(19)
v_xor_b32 v54, v111, v30
v_or_b32 v53, v53, v54
s_waitcnt vmcnt(18)
v_xor_b32 v54, v115, v30
v_or_b32 v53, v53, v54
s_waitcnt vmcnt(17)
v_xor_b32 v54, v119, v30
v_or_b32 v53, v53, v54
s_waitcnt vmcnt(16)
v_xor_b32 v54, v123, v30
v_or_b32 v53, v53, v54
s_waitcnt vmcnt(15)
v_xor_b32 v54, v127, v30
v_or_b32 v53, v53, v54
s_waitcnt vmcnt(14)
v_xor_b32 v54, v131, v30
v_or_b32 v53, v53, v54
s_waitcnt vmcnt(13)
v_xor_b32 v54, v135, v30
v_or_b32 v53, v53, v54
s_waitcnt vmcnt(12)
v_xor_b32 v54, v139, v30
v_or_b32 v53, v53, v54
s_waitcnt vmcnt(11)
v_xor_b32 v54, v143, v30
v_or_b32 v53, v53, v54
s_waitcnt vmcnt(10)
v_xor_b32 v54, v147, v30
v_or_b32 v53, v53, v54
s_waitcnt vmcnt(9)
v_xor_b32 v54, v151, v30
v_or_b32 v53, v53, v54
s_waitcnt vmcnt(8)
v_xor_b32 v54, v155, v30
v_or_b32 v53, v53, v54
s_waitcnt vmcnt(7)
v_xor_b32 v54, v159, v30
v_or_b32 v53, v53, v54
v_cmp_ne_u32 vcc, 0, v53
v_cmp_ne_u32 s[60:61], v31, v52
s_nop 3
s_and_b64 vcc, vcc, s[60:61]
s_cbranch_vccz PPOKBF
s_mov_b32 s77, 4000
PPSPBF:
s_sleep 3
s_lshl_b32 s64, s44, 16
s_add_u32 s64, s64, 12582912
buffer_load_dwordx4 v[96:99], v52, s[24:27], s64 offen sc1
s_add_u32 s64, s64, 4096
buffer_load_dwordx4 v[100:103], v52, s[24:27], s64 offen sc1
s_add_u32 s64, s64, 4096
buffer_load_dwordx4 v[104:107], v52, s[24:27], s64 offen sc1
s_add_u32 s64, s64, 4096
buffer_load_dwordx4 v[108:111], v52, s[24:27], s64 offen sc1
s_add_u32 s64, s64, 4096
buffer_load_dwordx4 v[112:115], v52, s[24:27], s64 offen sc1
s_add_u32 s64, s64, 4096
buffer_load_dwordx4 v[116:119], v52, s[24:27], s64 offen sc1
s_add_u32 s64, s64, 4096
buffer_load_dwordx4 v[120:123], v52, s[24:27], s64 offen sc1
s_add_u32 s64, s64, 4096
buffer_load_dwordx4 v[124:127], v52, s[24:27], s64 offen sc1
s_add_u32 s64, s64, 4096
buffer_load_dwordx4 v[128:131], v52, s[24:27], s64 offen sc1
s_add_u32 s64, s64, 4096
buffer_load_dwordx4 v[132:135], v52, s[24:27], s64 offen sc1
s_add_u32 s64, s64, 4096
buffer_load_dwordx4 v[136:139], v52, s[24:27], s64 offen sc1
s_add_u32 s64, s64, 4096
buffer_load_dwordx4 v[140:143], v52, s[24:27], s64 offen sc1
s_add_u32 s64, s64, 4096
buffer_load_dwordx4 v[144:147], v52, s[24:27], s64 offen sc1
s_add_u32 s64, s64, 4096
buffer_load_dwordx4 v[148:151], v52, s[24:27], s64 offen sc1
s_add_u32 s64, s64, 4096
buffer_load_dwordx4 v[152:155], v52, s[24:27], s64 offen sc1
s_add_u32 s64, s64, 4096
buffer_load_dwordx4 v[156:159], v52, s[24:27], s64 offen sc1
s_waitcnt vmcnt(0)
v_xor_b32 v53, v99, v30
v_xor_b32 v54, v103, v30
v_or_b32 v53, v53, v54
v_xor_b32 v54, v107, v30
v_or_b32 v53, v53, v54
v_xor_b32 v54, v111, v30
v_or_b32 v53, v53, v54
v_xor_b32 v54, v115, v30
v_or_b32 v53, v53, v54
v_xor_b32 v54, v119, v30
v_or_b32 v53, v53, v54
v_xor_b32 v54, v123, v30
v_or_b32 v53, v53, v54
v_xor_b32 v54, v127, v30
v_or_b32 v53, v53, v54
v_xor_b32 v54, v131, v30
v_or_b32 v53, v53, v54
v_xor_b32 v54, v135, v30
v_or_b32 v53, v53, v54
v_xor_b32 v54, v139, v30
v_or_b32 v53, v53, v54
v_xor_b32 v54, v143, v30
v_or_b32 v53, v53, v54
v_xor_b32 v54, v147, v30
v_or_b32 v53, v53, v54
v_xor_b32 v54, v151, v30
v_or_b32 v53, v53, v54
v_xor_b32 v54, v155, v30
v_or_b32 v53, v53, v54
v_xor_b32 v54, v159, v30
v_or_b32 v53, v53, v54
v_cmp_ne_u32 vcc, 0, v53
v_cmp_ne_u32 s[60:61], v31, v52
s_nop 3
s_and_b64 vcc, vcc, s[60:61]
s_sub_u32 s77, s77, 1
s_cbranch_vccz PPOKBF
s_cmp_lg_u32 s77, 0
s_cbranch_scc1 PPSPBF
PPOKBF:
v_mfma_f32_16x16x32_bf16 v[176:179], a[40:43], a[192:195], v[176:179]
buffer_load_dwordx4 a[176:179], v2, s[8:11], s42 offen offset:0 sc1
v_add_f32 v96, v96, v128
v_add_f32 v97, v97, v129
v_add_f32 v98, v98, v130
v_add_f32 v100, v100, v132
v_mfma_f32_16x16x32_bf16 v[180:183], a[44:47], a[192:195], v[180:183]
buffer_load_dwordx4 a[180:183], v2, s[8:11], s42 offen offset:256 sc1
v_add_f32 v101, v101, v133
v_add_f32 v102, v102, v134
v_add_f32 v104, v104, v136
v_add_f32 v105, v105, v137
v_mfma_f32_16x16x32_bf16 v[184:187], a[48:51], a[192:195], v[184:187]
buffer_load_dwordx4 a[184:187], v3, s[8:11], s42 offen offset:0 sc1
v_add_f32 v106, v106, v138
v_add_f32 v108, v108, v140
v_add_f32 v109, v109, v141
v_add_f32 v110, v110, v142
v_mfma_f32_16x16x32_bf16 v[188:191], a[52:55], a[192:195], v[188:191]
buffer_load_dwordx4 a[188:191], v3, s[8:11], s42 offen offset:256 sc1
v_add_f32 v112, v112, v144
v_add_f32 v113, v113, v145
v_add_f32 v114, v114, v146
v_add_f32 v116, v116, v148
v_mfma_f32_16x16x32_bf16 v[192:195], a[56:59], a[192:195], v[192:195]
s_add_u32 s42, s42, 8192
v_add_f32 v117, v117, v149
v_add_f32 v118, v118, v150
v_add_f32 v120, v120, v152
v_add_f32 v121, v121, v153
v_mfma_f32_16x16x32_bf16 v[196:199], a[40:43], a[196:199], v[196:199]
v_add_f32 v122, v122, v154
v_add_f32 v124, v124, v156
v_add_f32 v125, v125, v157
v_add_f32 v126, v126, v158
v_add_f32 v96, v96, v112
v_mfma_f32_16x16x32_bf16 v[200:203], a[44:47], a[196:199], v[200:203]
v_add_f32 v97, v97, v113
v_add_f32 v98, v98, v114
v_add_f32 v100, v100, v116
v_add_f32 v101, v101, v117
v_add_f32 v102, v102, v118
v_mfma_f32_16x16x32_bf16 v[204:207], a[48:51], a[196:199], v[204:207]
v_add_f32 v104, v104, v120
v_add_f32 v105, v105, v121
v_add_f32 v106, v106, v122
v_add_f32 v108, v108, v124
v_add_f32 v109, v109, v125
v_mfma_f32_16x16x32_bf16 v[208:211], a[52:55], a[196:199], v[208:211]
v_add_f32 v110, v110, v126
v_add_f32 v96, v96, v104
v_add_f32 v97, v97, v105
v_add_f32 v98, v98, v106
v_add_f32 v100, v100, v108
v_mfma_f32_16x16x32_bf16 v[212:215], a[56:59], a[196:199], v[212:215]
v_add_f32 v101, v101, v109
v_add_f32 v102, v102, v110
v_add_f32 v96, v96, v100
v_add_f32 v97, v97, v101
v_add_f32 v98, v98, v102
v_mfma_f32_16x16x32_bf16 v[216:219], a[40:43], a[200:203], v[216:219]
v_lshrrev_b32 v52, 3, v0
v_bfe_u32 v53, v0, 2, 1
v_and_b32 v54, 3, v0
v_mul_u32_u24 v54, 3, v54
v_lshlrev_b32 v53, 2, v53
v_mfma_f32_16x16x32_bf16 v[220:223], a[44:47], a[200:203], v[220:223]
v_lshlrev_b32 v59, 6, v52
v_add_u32 v59, 65536, v59
v_lshlrev_b32 v58, 2, v52
v_add_u32 v58, 73728, v58
v_cvt_pk_bf16_f32 v100, v96, v97
v_mfma_f32_16x16x32_bf16 v[224:227], a[48:51], a[200:203], v[224:227]
v_cvt_pk_bf16_f32 v101, v98, v98
v_add_u32 v55, 0, v54
v_lshrrev_b32 v56, 2, v55
v_and_b32 v55, 3, v55
v_lshl_add_u32 v55, v56, 3, v55
v_mfma_f32_16x16x32_bf16 v[228:231], a[52:55], a[200:203], v[228:231]
v_add_u32 v55, v55, v53
v_lshl_add_u32 v56, v55, 1, v59
v_cmp_gt_u32 vcc, 20, v55
s_nop 1
v_cndmask_b32 v57, 0, v100, vcc
ds_write_b16 v56, v57 offset:20480
v_mfma_f32_16x16x32_bf16 v[232:235], a[56:59], a[200:203], v[232:235]
v_add_u32 v55, 1, v54
v_lshrrev_b32 v56, 2, v55
v_and_b32 v55, 3, v55
v_lshl_add_u32 v55, v56, 3, v55
v_add_u32 v55, v55, v53
v_mfma_f32_16x16x32_bf16 v[236:239], a[40:43], a[204:207], v[236:239]
v_lshl_add_u32 v56, v55, 1, v59
v_cmp_gt_u32 vcc, 20, v55
s_nop 1
v_cndmask_b32 v57, 0, v100, vcc
ds_write_b16_d16_hi v56, v57 offset:20480
v_add_u32 v55, 2, v54
v_mfma_f32_16x16x32_bf16 v[240:243], a[44:47], a[204:207], v[240:243]
v_lshrrev_b32 v56, 2, v55
v_and_b32 v55, 3, v55
v_lshl_add_u32 v55, v56, 3, v55
v_add_u32 v55, v55, v53
v_lshl_add_u32 v56, v55, 1, v59
v_mfma_f32_16x16x32_bf16 v[244:247], a[48:51], a[204:207], v[244:247]
v_cmp_gt_u32 vcc, 20, v55
s_nop 1
v_cndmask_b32 v57, 0, v101, vcc
ds_write_b16 v56, v57 offset:20480
v_cmp_eq_u32 vcc, 20, v55
s_mov_b64 s[60:61], exec
s_nop 2
s_mov_b64 exec, vcc
ds_write_b32 v58, v98 offset:20480
s_mov_b64 exec, s[60:61]
v_and_b32 v55, 3, v0
v_mfma_f32_16x16x32_bf16 v[248:251], a[52:55], a[204:207], v[248:251]
v_cmp_eq_u32 vcc, 3, v55
v_lshlrev_b32 v56, 1, v53
v_add_u32 v56, v56, v59
v_mov_b32 v102, 0
v_mov_b32 v103, 0
v_mfma_f32_16x16x32_bf16 v[252:255], a[56:59], a[204:207], v[252:255]
s_mov_b64 s[60:61], exec
s_mov_b64 exec, vcc
ds_write_b64 v56, v[102:103] offset:20528
s_mov_b64 exec, s[60:61]
v_and_b32 v52, 15, v1
v_mfma_f32_16x16x32_bf16 v[176:179], a[60:63], a[208:211], v[176:179]
buffer_load_dwordx4 a[192:195], v2, s[8:11], s42 offen offset:0 sc1
v_lshrrev_b32 v53, 4, v1
v_lshlrev_b32 v54, 6, v52
v_lshl_add_u32 v54, v53, 4, v54
v_add_u32 v54, 65536, v54
v_mfma_f32_16x16x32_bf16 v[180:183], a[64:67], a[208:211], v[180:183]
buffer_load_dwordx4 a[196:199], v2, s[8:11], s42 offen offset:256 sc1
v_lshrrev_b32 v56, 2, v52
v_lshl_add_u32 v55, v53, 3, v56
v_mul_u32_u24 v55, 160, v55
v_and_b32 v56, 3, v1
v_mfma_f32_16x16x32_bf16 v[184:187], a[68:71], a[208:211], v[184:187]
buffer_load_dwordx4 a[200:203], v3, s[8:11], s42 offen offset:0 sc1
v_lshl_add_u32 v55, v56, 3, v55
v_add_u32 v55, 65536, v55
v_lshlrev_b32 v68, 7, v53
v_lshl_add_u32 v68, v52, 3, v68
v_mfma_f32_16x16x32_bf16 v[188:191], a[72:75], a[208:211], v[188:191]
buffer_load_dwordx4 a[204:207], v3, s[8:11], s42 offen offset:256 sc1
v_lshlrev_b32 v56, 3, v52
v_add_u32 v56, 512, v56
v_cmp_eq_u32 vcc, 0, v53
s_nop 1
v_cndmask_b32 v69, v31, v56, vcc
s_lshl_b32 s66, s44, 3
s_add_u32 s66, s66, s45
s_mul_i32 s66, s66, 3200
s_add_u32 s66, s66, 11534336
s_waitcnt lgkmcnt(0)
s_barrier
v_mfma_f32_16x16x32_bf16 v[192:195], a[76:79], a[208:211], v[192:195]
s_add_u32 s42, s42, 8192
ds_read_b128 v[60:63], v54 offset:20480
ds_read_b128 v[64:67], v54 offset:21504
s_lshl_b32 s51, s48, 5
v_add_u32 v56, s51, v55
s_waitcnt vmcnt(14)
v_mfma_f32_16x16x32_bf16 v[196:199], a[60:63], a[212:215], v[196:199]
v_add_u32 v57, 128, v55
ds_read_b64_tr_b16 v[72:73], v56 offset:22528
ds_read_b64_tr_b16 v[74:75], v56 offset:23168
ds_read_b64_tr_b16 v[84:85], v57 offset:22528
ds_read_b64_tr_b16 v[86:87], v57 offset:23168
v_mfma_f32_16x16x32_bf16 v[200:203], a[64:67], a[212:215], v[200:203]
s_mul_i32 s67, s48, 640
s_add_u32 s67, s67, s66
s_add_u32 s68, s66, 2560
s_cmp_eq_u32 s48, 0
s_cselect_b32 s68, s68, 17825792
s_waitcnt lgkmcnt(2)
v_mfma_f32_16x16x32_bf16 v[76:79], v[60:63], v[72:75], 0
v_mfma_f32_16x16x32_bf16 v[204:207], a[68:71], a[212:215], v[204:207]
v_mfma_f32_16x16x32_bf16 v[80:83], v[64:67], v[72:75], 0
s_waitcnt lgkmcnt(0)
v_mfma_f32_16x16x32_bf16 v[88:91], v[60:63], v[84:87], 0
v_mfma_f32_16x16x32_bf16 v[92:95], v[64:67], v[84:87], 0
s_nop 2
v_cvt_pk_bf16_f32 v76, v76, v77
v_cvt_pk_bf16_f32 v77, v78, v79
v_mfma_f32_16x16x32_bf16 v[208:211], a[72:75], a[212:215], v[208:211]
buffer_store_dwordx2 v[76:77], v68, s[24:27], s67 offen sc1
v_cvt_pk_bf16_f32 v80, v80, v81
v_cvt_pk_bf16_f32 v81, v82, v83
buffer_store_dwordx2 v[80:81], v69, s[24:27], s67 offen sc1
v_cvt_pk_bf16_f32 v88, v88, v89
v_mfma_f32_16x16x32_bf16 v[212:215], a[76:79], a[212:215], v[212:215]
v_cvt_pk_bf16_f32 v89, v90, v91
buffer_store_dwordx2 v[88:89], v68, s[24:27], s68 offen sc1
v_cvt_pk_bf16_f32 v92, v92, v93
v_cvt_pk_bf16_f32 v93, v94, v95
buffer_store_dwordx2 v[92:93], v69, s[24:27], s68 offen sc1
s_waitcnt vmcnt(17)
v_mfma_f32_16x16x32_bf16 v[216:219], a[60:63], a[216:219], v[216:219]
s_mul_i32 s64, s48, 10240
s_add_u32 s64, s64, 98304
buffer_load_dwordx4 v[96:99], v2, s[8:11], s64 offen offset:0 sc1
buffer_load_dwordx4 v[100:103], v2, s[8:11], s64 offen offset:256 sc1
buffer_load_dwordx4 v[104:107], v3, s[8:11], s64 offen offset:0 sc1
v_mfma_f32_16x16x32_bf16 v[220:223], a[64:67], a[216:219], v[220:223]
buffer_load_dwordx4 v[108:111], v3, s[8:11], s64 offen offset:256 sc1
s_add_u32 s64, s64, 2048
buffer_load_dwordx4 v[112:115], v2, s[8:11], s64 offen offset:0 sc1
buffer_load_dwordx4 v[116:119], v2, s[8:11], s64 offen offset:256 sc1
buffer_load_dwordx4 v[120:123], v3, s[8:11], s64 offen offset:0 sc1
v_mfma_f32_16x16x32_bf16 v[224:227], a[68:71], a[216:219], v[224:227]
buffer_load_dwordx4 v[124:127], v3, s[8:11], s64 offen offset:256 sc1
s_add_u32 s64, s64, 2048
buffer_load_dwordx4 v[128:131], v2, s[8:11], s64 offen offset:0 sc1
buffer_load_dwordx4 v[132:135], v2, s[8:11], s64 offen offset:256 sc1
buffer_load_dwordx4 v[136:139], v3, s[8:11], s64 offen offset:0 sc1
v_mfma_f32_16x16x32_bf16 v[228:231], a[72:75], a[216:219], v[228:231]
buffer_load_dwordx4 v[140:143], v3, s[8:11], s64 offen offset:256 sc1
s_add_u32 s64, s64, 2048
buffer_load_dwordx4 v[144:147], v2, s[8:11], s64 offen offset:0 sc1
buffer_load_dwordx4 v[148:151], v2, s[8:11], s64 offen offset:256 sc1
buffer_load_dwordx4 v[152:155], v3, s[8:11], s64 offen offset:0 sc1
v_mfma_f32_16x16x32_bf16 v[232:235], a[76:79], a[216:219], v[232:235]
buffer_load_dwordx4 v[156:159], v3, s[8:11], s64 offen offset:256 sc1
s_add_u32 s64, s64, 2048
buffer_load_dwordx4 v[160:163], v2, s[8:11], s64 offen offset:0 sc1
buffer_load_dwordx4 v[164:167], v2, s[8:11], s64 offen offset:256 sc1
buffer_load_dwordx4 v[168:171], v3, s[8:11], s64 offen offset:0 sc1
s_waitcnt vmcnt(35)
v_mfma_f32_16x16x32_bf16 v[236:239], a[60:63], a[220:223], v[236:239]
buffer_load_dwordx4 v[172:175], v3, s[8:11], s64 offen offset:256 sc1
s_add_u32 s64, s64, 2048
v_mfma_f32_16x16x32_bf16 v[240:243], a[64:67], a[220:223], v[240:243]
v_mfma_f32_16x16x32_bf16 v[244:247], a[68:71], a[220:223], v[244:247]
v_mfma_f32_16x16x32_bf16 v[248:251], a[72:75], a[220:223], v[248:251]
v_mfma_f32_16x16x32_bf16 v[252:255], a[76:79], a[220:223], v[252:255]
s_waitcnt vmcnt(35)
v_mfma_f32_16x16x32_bf16 v[176:179], a[80:83], a[160:163], v[176:179]
buffer_load_dwordx4 a[208:211], v2, s[8:11], s42 offen offset:0 sc1
v_mfma_f32_16x16x32_bf16 v[180:183], a[84:87], a[160:163], v[180:183]
buffer_load_dwordx4 a[212:215], v2, s[8:11], s42 offen offset:256 sc1
v_mfma_f32_16x16x32_bf16 v[184:187], a[88:91], a[160:163], v[184:187]
buffer_load_dwordx4 a[216:219], v3, s[8:11], s42 offen offset:0 sc1
v_mfma_f32_16x16x32_bf16 v[188:191], a[92:95], a[160:163], v[188:191]
buffer_load_dwordx4 a[220:223], v3, s[8:11], s42 offen offset:256 sc1
v_mfma_f32_16x16x32_bf16 v[192:195], a[96:99], a[160:163], v[192:195]
s_add_u32 s42, s42, 8192
s_waitcnt vmcnt(38)
v_mfma_f32_16x16x32_bf16 v[196:199], a[80:83], a[164:167], v[196:199]
buffer_load_dwordx4 a[0:3], v4, s[12:15], s43 offen offset:0 sc1
v_mfma_f32_16x16x32_bf16 v[200:203], a[84:87], a[164:167], v[200:203]
buffer_load_dwordx4 a[4:7], v4, s[12:15], s43 offen offset:1024 sc1
v_mfma_f32_16x16x32_bf16 v[204:207], a[88:91], a[164:167], v[204:207]
buffer_load_dwordx4 a[8:11], v4, s[12:15], s43 offen offset:2048 sc1
v_mfma_f32_16x16x32_bf16 v[208:211], a[92:95], a[164:167], v[208:211]
buffer_load_dwordx4 a[12:15], v4, s[12:15], s43 offen offset:3072 sc1
v_mfma_f32_16x16x32_bf16 v[212:215], a[96:99], a[164:167], v[212:215]
buffer_load_dwordx4 a[16:19], v5, s[12:15], s43 offen sc1
s_waitcnt vmcnt(42)
v_mfma_f32_16x16x32_bf16 v[216:219], a[80:83], a[168:171], v[216:219]
s_add_u32 s43, s43, 20480
v_mfma_f32_16x16x32_bf16 v[220:223], a[84:87], a[168:171], v[220:223]
v_mfma_f32_16x16x32_bf16 v[224:227], a[88:91], a[168:171], v[224:227]
v_mfma_f32_16x16x32_bf16 v[228:231], a[92:95], a[168:171], v[228:231]
v_mfma_f32_16x16x32_bf16 v[232:235], a[96:99], a[168:171], v[232:235]
s_waitcnt vmcnt(41)
v_mfma_f32_16x16x32_bf16 v[236:239], a[80:83], a[172:175], v[236:239]
v_mfma_f32_16x16x32_bf16 v[240:243], a[84:87], a[172:175], v[240:243]
v_mfma_f32_16x16x32_bf16 v[244:247], a[88:91], a[172:175], v[244:247]
v_mfma_f32_16x16x32_bf16 v[248:251], a[92:95], a[172:175], v[248:251]
v_mfma_f32_16x16x32_bf16 v[252:255], a[96:99], a[172:175], v[252:255]
s_waitcnt vmcnt(29)
s_barrier
v_mul_u32_u24 v52, 12, v1
v_add_u32 v52, 65536, v52
ds_read_b32 v60, v52 offset:28672
ds_read_b32 v61, v52 offset:28676
ds_read_b32 v62, v52 offset:28680
s_lshl_b32 s51, s44, 3
s_add_u32 s51, s51, s45
s_lshl_b32 s51, s51, 7
s_add_u32 s51, s51, 12386304
s_cmp_eq_u32 s48, 0
s_cselect_b32 s69, s51, 17825792
v_lshlrev_b32 v53, 4, v1
v_cmp_gt_u32 vcc, 8, v1
v_mov_b32 v63, v30
s_nop 0
v_cndmask_b32 v53, v31, v53, vcc
s_waitcnt lgkmcnt(0)
buffer_store_dwordx4 v[60:63], v53, s[24:27], s69 offen sc1
v_mfma_f32_16x16x32_bf16 v[176:179], a[100:103], a[176:179], v[176:179]
buffer_load_dwordx4 a[160:163], v2, s[8:11], s42 offen offset:0 sc1
v_mfma_f32_16x16x32_bf16 v[180:183], a[104:107], a[176:179], v[180:183]
buffer_load_dwordx4 a[164:167], v2, s[8:11], s42 offen offset:256 sc1
v_mfma_f32_16x16x32_bf16 v[184:187], a[108:111], a[176:179], v[184:187]
buffer_load_dwordx4 a[168:171], v3, s[8:11], s42 offen offset:0 sc1
v_mfma_f32_16x16x32_bf16 v[188:191], a[112:115], a[176:179], v[188:191]
buffer_load_dwordx4 a[172:175], v3, s[8:11], s42 offen offset:256 sc1
v_mfma_f32_16x16x32_bf16 v[192:195], a[116:119], a[176:179], v[192:195]
s_add_u32 s42, s42, 8192
v_mfma_f32_16x16x32_bf16 v[196:199], a[100:103], a[180:183], v[196:199]
buffer_load_dwordx4 a[20:23], v4, s[12:15], s43 offen offset:0 sc1
v_mfma_f32_16x16x32_bf16 v[200:203], a[104:107], a[180:183], v[200:203]
buffer_load_dwordx4 a[24:27], v4, s[12:15], s43 offen offset:1024 sc1
v_mfma_f32_16x16x32_bf16 v[204:207], a[108:111], a[180:183], v[204:207]
buffer_load_dwordx4 a[28:31], v4, s[12:15], s43 offen offset:2048 sc1
v_mfma_f32_16x16x32_bf16 v[208:211], a[112:115], a[180:183], v[208:211]
buffer_load_dwordx4 a[32:35], v4, s[12:15], s43 offen offset:3072 sc1
v_mfma_f32_16x16x32_bf16 v[212:215], a[116:119], a[180:183], v[212:215]
buffer_load_dwordx4 a[36:39], v5, s[12:15], s43 offen sc1
v_mfma_f32_16x16x32_bf16 v[216:219], a[100:103], a[184:187], v[216:219]
s_add_u32 s43, s43, 20480
v_mfma_f32_16x16x32_bf16 v[220:223], a[104:107], a[184:187], v[220:223]
v_mfma_f32_16x16x32_bf16 v[224:227], a[108:111], a[184:187], v[224:227]
v_mfma_f32_16x16x32_bf16 v[228:231], a[112:115], a[184:187], v[228:231]
v_mfma_f32_16x16x32_bf16 v[232:235], a[116:119], a[184:187], v[232:235]
v_mfma_f32_16x16x32_bf16 v[236:239], a[100:103], a[188:191], v[236:239]
v_mfma_f32_16x16x32_bf16 v[240:243], a[104:107], a[188:191], v[240:243]
v_mfma_f32_16x16x32_bf16 v[244:247], a[108:111], a[188:191], v[244:247]
v_mfma_f32_16x16x32_bf16 v[248:251], a[112:115], a[188:191], v[248:251]
v_mfma_f32_16x16x32_bf16 v[252:255], a[116:119], a[188:191], v[252:255]
v_mfma_f32_16x16x32_bf16 v[176:179], a[120:123], a[192:195], v[176:179]
buffer_load_dwordx4 a[176:179], v2, s[8:11], s42 offen offset:0 sc1
v_mfma_f32_16x16x32_bf16 v[180:183], a[124:127], a[192:195], v[180:183]
buffer_load_dwordx4 a[180:183], v2, s[8:11], s42 offen offset:256 sc1
v_mfma_f32_16x16x32_bf16 v[184:187], a[128:131], a[192:195], v[184:187]
buffer_load_dwordx4 a[184:187], v3, s[8:11], s42 offen offset:0 sc1
v_mfma_f32_16x16x32_bf16 v[188:191], a[132:135], a[192:195], v[188:191]
buffer_load_dwordx4 a[188:191], v3, s[8:11], s42 offen offset:256 sc1
v_mfma_f32_16x16x32_bf16 v[192:195], a[136:139], a[192:195], v[192:195]
s_add_u32 s42, s42, 8192
v_mfma_f32_16x16x32_bf16 v[196:199], a[120:123], a[196:199], v[196:199]
buffer_load_dwordx4 a[40:43], v4, s[12:15], s43 offen offset:0 sc1
v_mfma_f32_16x16x32_bf16 v[200:203], a[124:127], a[196:199], v[200:203]
buffer_load_dwordx4 a[44:47], v4, s[12:15], s43 offen offset:1024 sc1
v_mfma_f32_16x16x32_bf16 v[204:207], a[128:131], a[196:199], v[204:207]
buffer_load_dwordx4 a[48:51], v4, s[12:15], s43 offen offset:2048 sc1
v_mfma_f32_16x16x32_bf16 v[208:211], a[132:135], a[196:199], v[208:211]
buffer_load_dwordx4 a[52:55], v4, s[12:15], s43 offen offset:3072 sc1
v_mfma_f32_16x16x32_bf16 v[212:215], a[136:139], a[196:199], v[212:215]
buffer_load_dwordx4 a[56:59], v5, s[12:15], s43 offen sc1
v_mfma_f32_16x16x32_bf16 v[216:219], a[120:123], a[200:203], v[216:219]
s_add_u32 s43, s43, 20480
v_mfma_f32_16x16x32_bf16 v[220:223], a[124:127], a[200:203], v[220:223]
v_mfma_f32_16x16x32_bf16 v[224:227], a[128:131], a[200:203], v[224:227]
v_mfma_f32_16x16x32_bf16 v[228:231], a[132:135], a[200:203], v[228:231]
v_mfma_f32_16x16x32_bf16 v[232:235], a[136:139], a[200:203], v[232:235]
v_mfma_f32_16x16x32_bf16 v[236:239], a[120:123], a[204:207], v[236:239]
v_mfma_f32_16x16x32_bf16 v[240:243], a[124:127], a[204:207], v[240:243]
v_mfma_f32_16x16x32_bf16 v[244:247], a[128:131], a[204:207], v[244:247]
v_mfma_f32_16x16x32_bf16 v[248:251], a[132:135], a[204:207], v[248:251]
v_mfma_f32_16x16x32_bf16 v[252:255], a[136:139], a[204:207], v[252:255]
v_lshrrev_b32 v54, 3, v1
v_lshlrev_b32 v54, 10, v54
v_and_b32 v55, 7, v1
v_lshl_add_u32 v54, v55, 4, v54
s_lshl_b32 s65, s48, 6
s_add_u32 s65, s65, s41
s_lshl_b32 s65, s65, 7
s_add_u32 s65, s65, 12386304
buffer_load_dwordx4 v[64:67], v54, s[24:27], s65 offen sc1
s_waitcnt vmcnt(28)
v_mfma_f32_16x16x32_bf16 v[176:179], a[140:143], a[208:211], v[176:179]
buffer_load_dwordx4 a[192:195], v2, s[8:11], s42 offen offset:0 sc1
v_mfma_f32_16x16x32_bf16 v[180:183], a[144:147], a[208:211], v[180:183]
buffer_load_dwordx4 a[196:199], v2, s[8:11], s42 offen offset:256 sc1
v_mfma_f32_16x16x32_bf16 v[184:187], a[148:151], a[208:211], v[184:187]
buffer_load_dwordx4 a[200:203], v3, s[8:11], s42 offen offset:0 sc1
v_mfma_f32_16x16x32_bf16 v[188:191], a[152:155], a[208:211], v[188:191]
buffer_load_dwordx4 a[204:207], v3, s[8:11], s42 offen offset:256 sc1
v_mfma_f32_16x16x32_bf16 v[192:195], a[156:159], a[208:211], v[192:195]
s_add_u32 s42, s42, 8192
s_waitcnt vmcnt(31)
v_mfma_f32_16x16x32_bf16 v[196:199], a[140:143], a[212:215], v[196:199]
buffer_load_dwordx4 a[60:63], v4, s[12:15], s43 offen offset:0 sc1
v_mfma_f32_16x16x32_bf16 v[200:203], a[144:147], a[212:215], v[200:203]
buffer_load_dwordx4 a[64:67], v4, s[12:15], s43 offen offset:1024 sc1
v_mfma_f32_16x16x32_bf16 v[204:207], a[148:151], a[212:215], v[204:207]
buffer_load_dwordx4 a[68:71], v4, s[12:15], s43 offen offset:2048 sc1
v_mfma_f32_16x16x32_bf16 v[208:211], a[152:155], a[212:215], v[208:211]
buffer_load_dwordx4 a[72:75], v4, s[12:15], s43 offen offset:3072 sc1
v_mfma_f32_16x16x32_bf16 v[212:215], a[156:159], a[212:215], v[212:215]
buffer_load_dwordx4 a[76:79], v5, s[12:15], s43 offen sc1
s_waitcnt vmcnt(35)
v_mfma_f32_16x16x32_bf16 v[216:219], a[140:143], a[216:219], v[216:219]
s_add_u32 s43, s43, 20480
v_mfma_f32_16x16x32_bf16 v[220:223], a[144:147], a[216:219], v[220:223]
v_mfma_f32_16x16x32_bf16 v[224:227], a[148:151], a[216:219], v[224:227]
v_mfma_f32_16x16x32_bf16 v[228:231], a[152:155], a[216:219], v[228:231]
v_mfma_f32_16x16x32_bf16 v[232:235], a[156:159], a[216:219], v[232:235]
s_waitcnt vmcnt(34)
v_mfma_f32_16x16x32_bf16 v[236:239], a[140:143], a[220:223], v[236:239]
v_mfma_f32_16x16x32_bf16 v[240:243], a[144:147], a[220:223], v[240:243]
v_mfma_f32_16x16x32_bf16 v[244:247], a[148:151], a[220:223], v[244:247]
v_mfma_f32_16x16x32_bf16 v[248:251], a[152:155], a[220:223], v[248:251]
v_mfma_f32_16x16x32_bf16 v[252:255], a[156:159], a[220:223], v[252:255]
s_waitcnt vmcnt(27)
v_mfma_f32_16x16x32_bf16 v[176:179], a[0:3], a[160:163], v[176:179]
buffer_load_dwordx4 a[208:211], v2, s[8:11], s42 offen offset:0 sc1
v_mfma_f32_16x16x32_bf16 v[180:183], a[4:7], a[160:163], v[180:183]
buffer_load_dwordx4 a[212:215], v2, s[8:11], s42 offen offset:256 sc1
v_mfma_f32_16x16x32_bf16 v[184:187], a[8:11], a[160:163], v[184:187]
buffer_load_dwordx4 a[216:219], v3, s[8:11], s42 offen offset:0 sc1
v_mfma_f32_16x16x32_bf16 v[188:191], a[12:15], a[160:163], v[188:191]
buffer_load_dwordx4 a[220:223], v3, s[8:11], s42 offen offset:256 sc1
v_mfma_f32_16x16x32_bf16 v[192:195], a[16:19], a[160:163], v[192:195]
s_add_u32 s42, s42, 8192
s_waitcnt vmcnt(30)
v_mfma_f32_16x16x32_bf16 v[196:199], a[0:3], a[164:167], v[196:199]
v_mfma_f32_16x16x32_bf16 v[200:203], a[4:7], a[164:167], v[200:203]
v_mfma_f32_16x16x32_bf16 v[204:207], a[8:11], a[164:167], v[204:207]
v_mfma_f32_16x16x32_bf16 v[208:211], a[12:15], a[164:167], v[208:211]
v_mfma_f32_16x16x32_bf16 v[212:215], a[16:19], a[164:167], v[212:215]
s_waitcnt vmcnt(13)
v_cmp_ne_u32 vcc, v67, v30
s_nop 3
s_cbranch_vccz K2COKBF
s_mov_b32 s77, 4000
K2CSPBF:
s_sleep 3
buffer_load_dwordx4 v[64:67], v54, s[24:27], s65 offen sc1
s_waitcnt vmcnt(0)
v_cmp_ne_u32 vcc, v67, v30
s_sub_u32 s77, s77, 1
s_nop 2
s_cbranch_vccz K2COKBF
s_cmp_lg_u32 s77, 0
s_cbranch_scc1 K2CSPBF
K2COKBF:
v_mfma_f32_16x16x32_bf16 v[216:219], a[0:3], a[168:171], v[216:219]
v_cvt_pk_bf16_f32 v64, v64, v65
v_cvt_pk_bf16_f32 v66, v66, v66
s_mov_b64 s[60:61], exec
s_mov_b32 exec_lo, 0x7f7f7f7f
s_mov_b32 exec_hi, 0x7f7f7f7f
ds_write_b16 v17, v64
ds_write_b16_d16_hi v17, v64 offset:2
s_mov_b32 exec_lo, 0x3f3f3f3f
s_mov_b32 exec_hi, 0x3f3f3f3f
ds_write_b16 v17, v66 offset:4
s_mov_b64 exec, s[60:61]
v_mfma_f32_16x16x32_bf16 v[220:223], a[4:7], a[168:171], v[220:223]
s_waitcnt lgkmcnt(0)
ds_read_b64 v[72:73], v28 offset:0
ds_read_b64 v[74:75], v28 offset:16
ds_read_b64 v[76:77], v28 offset:64
ds_read_b64 v[78:79], v28 offset:80
ds_read_b64 v[80:81], v28 offset:128
ds_read_b64 v[82:83], v28 offset:144
ds_read_b64 v[84:85], v28 offset:192
ds_read_b64 v[86:87], v28 offset:208
ds_read_b64 v[88:89], v28 offset:256
ds_read_b64 v[90:91], v28 offset:272
v_mfma_f32_16x16x32_bf16 v[224:227], a[8:11], a[168:171], v[224:227]
s_waitcnt lgkmcnt(8)
v_mfma_f32_16x16x32_bf16 v[54:57], v[72:75], v[96:99], 0
v_mfma_f32_16x16x32_bf16 v[58:61], v[72:75], v[100:103], 0
v_mfma_f32_16x16x32_bf16 v[62:65], v[72:75], v[104:107], 0
v_mfma_f32_16x16x32_bf16 v[66:69], v[72:75], v[108:111], 0
s_waitcnt lgkmcnt(6)
v_mfma_f32_16x16x32_bf16 v[54:57], v[76:79], v[112:115], v[54:57]
v_mfma_f32_16x16x32_bf16 v[228:231], a[12:15], a[168:171], v[228:231]
v_mfma_f32_16x16x32_bf16 v[58:61], v[76:79], v[116:119], v[58:61]
v_mfma_f32_16x16x32_bf16 v[62:65], v[76:79], v[120:123], v[62:65]
v_mfma_f32_16x16x32_bf16 v[66:69], v[76:79], v[124:127], v[66:69]
s_waitcnt lgkmcnt(4)
v_mfma_f32_16x16x32_bf16 v[54:57], v[80:83], v[128:131], v[54:57]
v_mfma_f32_16x16x32_bf16 v[58:61], v[80:83], v[132:135], v[58:61]
v_mfma_f32_16x16x32_bf16 v[232:235], a[16:19], a[168:171], v[232:235]
v_mfma_f32_16x16x32_bf16 v[62:65], v[80:83], v[136:139], v[62:65]
v_mfma_f32_16x16x32_bf16 v[66:69], v[80:83], v[140:143], v[66:69]
s_waitcnt lgkmcnt(2)
v_mfma_f32_16x16x32_bf16 v[54:57], v[84:87], v[144:147], v[54:57]
v_mfma_f32_16x16x32_bf16 v[58:61], v[84:87], v[148:151], v[58:61]
v_mfma_f32_16x16x32_bf16 v[62:65], v[84:87], v[152:155], v[62:65]
v_mfma_f32_16x16x32_bf16 v[236:239], a[0:3], a[172:175], v[236:239]
v_mfma_f32_16x16x32_bf16 v[66:69], v[84:87], v[156:159], v[66:69]
s_waitcnt lgkmcnt(0)
v_mfma_f32_16x16x32_bf16 v[54:57], v[88:91], v[160:163], v[54:57]
v_mfma_f32_16x16x32_bf16 v[58:61], v[88:91], v[164:167], v[58:61]
v_mfma_f32_16x16x32_bf16 v[62:65], v[88:91], v[168:171], v[62:65]
v_mfma_f32_16x16x32_bf16 v[66:69], v[88:91], v[172:175], v[66:69]
v_mfma_f32_16x16x32_bf16 v[240:243], a[4:7], a[172:175], v[240:243]
v_and_b32 v70, 15, v1
v_lshlrev_b32 v70, 5, v70
v_lshrrev_b32 v71, 4, v1
v_lshl_add_u32 v70, v71, 4, v70
s_lshl_b32 s51, s48, 11
v_mfma_f32_16x16x32_bf16 v[244:247], a[8:11], a[172:175], v[244:247]
s_add_u32 s64, s51, 96512
v_add_u32 v70, s64, v70
v_add_f32 v54, s63, v54
v_add_f32 v55, s63, v55
v_add_f32 v56, s63, v56
v_mfma_f32_16x16x32_bf16 v[248:251], a[12:15], a[172:175], v[248:251]
v_add_f32 v57, s63, v57
v_add_f32 v58, s63, v58
v_add_f32 v59, s63, v59
v_add_f32 v60, s63, v60
v_add_f32 v61, s63, v61
v_mfma_f32_16x16x32_bf16 v[252:255], a[16:19], a[172:175], v[252:255]
v_add_f32 v62, s63, v62
v_add_f32 v63, s63, v63
v_add_f32 v64, s63, v64
v_add_f32 v65, s63, v65
v_add_f32 v66, s63, v66
v_mfma_f32_16x16x32_bf16 v[176:179], a[20:23], a[176:179], v[176:179]
buffer_load_dwordx2 a[80:81], v32, s[24:27], s62 offen offset:0 sc1
v_add_f32 v67, s63, v67
v_add_f32 v68, s63, v68
v_add_f32 v69, s63, v69
v_rcp_f32 v54, v54
v_mfma_f32_16x16x32_bf16 v[180:183], a[24:27], a[176:179], v[180:183]
buffer_load_dwordx2 a[82:83], v33, s[24:27], s62 offen offset:0 sc1
v_rcp_f32 v55, v55
v_rcp_f32 v56, v56
v_rcp_f32 v57, v57
v_rcp_f32 v58, v58
v_mfma_f32_16x16x32_bf16 v[184:187], a[28:31], a[176:179], v[184:187]
buffer_load_dwordx2 a[84:85], v32, s[24:27], s62 offen offset:640 sc1
v_rcp_f32 v59, v59
v_rcp_f32 v60, v60
v_rcp_f32 v61, v61
v_rcp_f32 v62, v62
v_mfma_f32_16x16x32_bf16 v[188:191], a[32:35], a[176:179], v[188:191]
buffer_load_dwordx2 a[86:87], v33, s[24:27], s62 offen offset:640 sc1
v_rcp_f32 v63, v63
v_rcp_f32 v64, v64
v_rcp_f32 v65, v65
v_rcp_f32 v66, v66
v_mfma_f32_16x16x32_bf16 v[192:195], a[36:39], a[176:179], v[192:195]
buffer_load_dwordx2 a[88:89], v32, s[24:27], s62 offen offset:1280 sc1
v_rcp_f32 v67, v67
v_rcp_f32 v68, v68
v_rcp_f32 v69, v69
s_mov_b64 s[60:61], exec
s_mov_b64 exec, 0xffffffff
ds_write_b128 v70, v[54:57] offset:0
ds_write_b128 v70, v[58:61] offset:512
ds_write_b128 v70, v[62:65] offset:1024
ds_write_b128 v70, v[66:69] offset:1536
s_mov_b64 exec, s[60:61]
v_mfma_f32_16x16x32_bf16 v[196:199], a[20:23], a[180:183], v[196:199]
buffer_load_dwordx2 a[90:91], v33, s[24:27], s62 offen offset:1280 sc1
s_waitcnt lgkmcnt(0)
ds_read_b32 v72, v42 offset:0
ds_read_b32 v73, v43 offset:0
ds_read_b32 v74, v42 offset:512
ds_read_b32 v75, v43 offset:512
ds_read_b32 v76, v42 offset:1024
ds_read_b32 v77, v43 offset:1024
ds_read_b32 v78, v42 offset:1536
ds_read_b32 v79, v43 offset:1536
v_mfma_f32_16x16x32_bf16 v[200:203], a[24:27], a[180:183], v[200:203]
buffer_load_dwordx2 a[92:93], v32, s[24:27], s62 offen offset:1920 sc1
v_lshlrev_b32 v88, 16, v96
v_and_b32 v89, 0xffff0000, v96
v_lshlrev_b32 v90, 16, v97
v_and_b32 v91, 0xffff0000, v97
v_mfma_f32_16x16x32_bf16 v[204:207], a[28:31], a[180:183], v[204:207]
buffer_load_dwordx2 a[94:95], v33, s[24:27], s62 offen offset:1920 sc1
v_lshlrev_b32 v92, 16, v98
v_and_b32 v93, 0xffff0000, v98
v_lshlrev_b32 v94, 16, v99
v_and_b32 v95, 0xffff0000, v99
v_mfma_f32_16x16x32_bf16 v[208:211], a[32:35], a[180:183], v[208:211]
buffer_load_dwordx2 a[96:97], v32, s[24:27], s62 offen offset:2560 sc1
s_waitcnt lgkmcnt(7)
v_mul_f32 v88, v88, v72
v_mul_f32 v89, v89, v72
v_mul_f32 v90, v90, v72
v_mul_f32 v91, v91, v72
v_mfma_f32_16x16x32_bf16 v[212:215], a[36:39], a[180:183], v[212:215]
buffer_load_dwordx2 a[98:99], v33, s[24:27], s62 offen offset:2560 sc1
s_waitcnt lgkmcnt(6)
v_mul_f32 v92, v92, v73
v_mul_f32 v93, v93, v73
v_mul_f32 v94, v94, v73
v_mul_f32 v95, v95, v73
v_mfma_f32_16x16x32_bf16 v[216:219], a[20:23], a[184:187], v[216:219]
buffer_load_dwordx2 a[100:101], v34, s[24:27], s62 offen offset:0 sc1
v_cvt_pk_bf16_f32 v96, v88, v89
v_cvt_pk_bf16_f32 v97, v90, v91
v_cvt_pk_bf16_f32 v98, v92, v93
v_cvt_pk_bf16_f32 v99, v94, v95
v_mfma_f32_16x16x32_bf16 v[220:223], a[24:27], a[184:187], v[220:223]
buffer_load_dwordx2 a[102:103], v35, s[24:27], s62 offen offset:0 sc1
v_lshlrev_b32 v88, 16, v100
v_and_b32 v89, 0xffff0000, v100
v_lshlrev_b32 v90, 16, v101
v_and_b32 v91, 0xffff0000, v101
v_mfma_f32_16x16x32_bf16 v[224:227], a[28:31], a[184:187], v[224:227]
buffer_load_dwordx2 a[104:105], v34, s[24:27], s62 offen offset:640 sc1
v_lshlrev_b32 v92, 16, v102
v_and_b32 v93, 0xffff0000, v102
v_lshlrev_b32 v94, 16, v103
v_and_b32 v95, 0xffff0000, v103
v_mfma_f32_16x16x32_bf16 v[228:231], a[32:35], a[184:187], v[228:231]
buffer_load_dwordx2 a[106:107], v35, s[24:27], s62 offen offset:640 sc1
s_waitcnt lgkmcnt(5)
v_mul_f32 v88, v88, v74
v_mul_f32 v89, v89, v74
v_mul_f32 v90, v90, v74
v_mul_f32 v91, v91, v74
v_mfma_f32_16x16x32_bf16 v[232:235], a[36:39], a[184:187], v[232:235]
buffer_load_dwordx2 a[108:109], v34, s[24:27], s62 offen offset:1280 sc1
s_waitcnt lgkmcnt(4)
v_mul_f32 v92, v92, v75
v_mul_f32 v93, v93, v75
v_mul_f32 v94, v94, v75
v_mul_f32 v95, v95, v75
v_mfma_f32_16x16x32_bf16 v[236:239], a[20:23], a[188:191], v[236:239]
buffer_load_dwordx2 a[110:111], v35, s[24:27], s62 offen offset:1280 sc1
v_cvt_pk_bf16_f32 v100, v88, v89
v_cvt_pk_bf16_f32 v101, v90, v91
v_cvt_pk_bf16_f32 v102, v92, v93
v_cvt_pk_bf16_f32 v103, v94, v95
v_mfma_f32_16x16x32_bf16 v[240:243], a[24:27], a[188:191], v[240:243]
buffer_load_dwordx2 a[112:113], v34, s[24:27], s62 offen offset:1920 sc1
v_lshlrev_b32 v88, 16, v104
v_and_b32 v89, 0xffff0000, v104
v_lshlrev_b32 v90, 16, v105
v_and_b32 v91, 0xffff0000, v105
v_mfma_f32_16x16x32_bf16 v[244:247], a[28:31], a[188:191], v[244:247]
buffer_load_dwordx2 a[114:115], v35, s[24:27], s62 offen offset:1920 sc1
v_lshlrev_b32 v92, 16, v106
v_and_b32 v93, 0xffff0000, v106
v_lshlrev_b32 v94, 16, v107
v_and_b32 v95, 0xffff0000, v107
v_mfma_f32_16x16x32_bf16 v[248:251], a[32:35], a[188:191], v[248:251]
buffer_load_dwordx2 a[116:117], v34, s[24:27], s62 offen offset:2560 sc1
s_waitcnt lgkmcnt(3)
v_mul_f32 v88, v88, v76
v_mul_f32 v89, v89, v76
v_mul_f32 v90, v90, v76
v_mul_f32 v91, v91, v76
v_mfma_f32_16x16x32_bf16 v[252:255], a[36:39], a[188:191], v[252:255]
buffer_load_dwordx2 a[118:119], v35, s[24:27], s62 offen offset:2560 sc1
s_waitcnt lgkmcnt(2)
v_mul_f32 v92, v92, v77
v_mul_f32 v93, v93, v77
v_mul_f32 v94, v94, v77
v_mul_f32 v95, v95, v77
s_waitcnt vmcnt(32)
v_mfma_f32_16x16x32_bf16 v[176:179], a[40:43], a[192:195], v[176:179]
buffer_load_dwordx2 a[120:121], v36, s[24:27], s62 offen offset:0 sc1
v_cvt_pk_bf16_f32 v104, v88, v89
v_cvt_pk_bf16_f32 v105, v90, v91
v_cvt_pk_bf16_f32 v106, v92, v93
v_cvt_pk_bf16_f32 v107, v94, v95
v_mfma_f32_16x16x32_bf16 v[180:183], a[44:47], a[192:195], v[180:183]
buffer_load_dwordx2 a[122:123], v37, s[24:27], s62 offen offset:0 sc1
v_lshlrev_b32 v88, 16, v108
v_and_b32 v89, 0xffff0000, v108
v_lshlrev_b32 v90, 16, v109
v_and_b32 v91, 0xffff0000, v109
v_mfma_f32_16x16x32_bf16 v[184:187], a[48:51], a[192:195], v[184:187]
buffer_load_dwordx2 a[124:125], v36, s[24:27], s62 offen offset:640 sc1
v_lshlrev_b32 v92, 16, v110
v_and_b32 v93, 0xffff0000, v110
v_lshlrev_b32 v94, 16, v111
v_and_b32 v95, 0xffff0000, v111
v_mfma_f32_16x16x32_bf16 v[188:191], a[52:55], a[192:195], v[188:191]
buffer_load_dwordx2 a[126:127], v37, s[24:27], s62 offen offset:640 sc1
s_waitcnt lgkmcnt(1)
v_mul_f32 v88, v88, v78
v_mul_f32 v89, v89, v78
v_mul_f32 v90, v90, v78
v_mul_f32 v91, v91, v78
v_mfma_f32_16x16x32_bf16 v[192:195], a[56:59], a[192:195], v[192:195]
buffer_load_dwordx2 a[128:129], v36, s[24:27], s62 offen offset:1280 sc1
s_waitcnt lgkmcnt(0)
v_mul_f32 v92, v92, v79
v_mul_f32 v93, v93, v79
v_mul_f32 v94, v94, v79
v_mul_f32 v95, v95, v79
s_waitcnt vmcnt(36)
v_mfma_f32_16x16x32_bf16 v[196:199], a[40:43], a[196:199], v[196:199]
buffer_load_dwordx2 a[130:131], v37, s[24:27], s62 offen offset:1280 sc1
v_cvt_pk_bf16_f32 v108, v88, v89
v_cvt_pk_bf16_f32 v109, v90, v91
v_cvt_pk_bf16_f32 v110, v92, v93
v_cvt_pk_bf16_f32 v111, v94, v95
v_mfma_f32_16x16x32_bf16 v[200:203], a[44:47], a[196:199], v[200:203]
buffer_load_dwordx2 a[132:133], v36, s[24:27], s62 offen offset:1920 sc1
ds_read_b32 v80, v44 offset:0
ds_read_b32 v81, v45 offset:0
ds_read_b32 v82, v44 offset:512
ds_read_b32 v83, v45 offset:512
ds_read_b32 v84, v44 offset:1024
ds_read_b32 v85, v45 offset:1024
ds_read_b32 v86, v44 offset:1536
ds_read_b32 v87, v45 offset:1536
v_mfma_f32_16x16x32_bf16 v[204:207], a[48:51], a[196:199], v[204:207]
buffer_load_dwordx2 a[134:135], v37, s[24:27], s62 offen offset:1920 sc1
v_lshlrev_b32 v88, 16, v112
v_and_b32 v89, 0xffff0000, v112
v_lshlrev_b32 v90, 16, v113
v_and_b32 v91, 0xffff0000, v113
v_mfma_f32_16x16x32_bf16 v[208:211], a[52:55], a[196:199], v[208:211]
buffer_load_dwordx2 a[136:137], v36, s[24:27], s62 offen offset:2560 sc1
v_lshlrev_b32 v92, 16, v114
v_and_b32 v93, 0xffff0000, v114
v_lshlrev_b32 v94, 16, v115
v_and_b32 v95, 0xffff0000, v115
v_mfma_f32_16x16x32_bf16 v[212:215], a[56:59], a[196:199], v[212:215]
buffer_load_dwordx2 a[138:139], v37, s[24:27], s62 offen offset:2560 sc1
s_waitcnt lgkmcnt(7)
v_mul_f32 v88, v88, v80
v_mul_f32 v89, v89, v80
v_mul_f32 v90, v90, v80
v_mul_f32 v91, v91, v80
s_waitcnt vmcnt(40)
v_mfma_f32_16x16x32_bf16 v[216:219], a[40:43], a[200:203], v[216:219]
s_waitcnt lgkmcnt(6)
v_mul_f32 v92, v92, v81
v_mul_f32 v93, v93, v81
v_mul_f32 v94, v94, v81
v_mul_f32 v95, v95, v81
v_cvt_pk_bf16_f32 v112, v88, v89
v_mfma_f32_16x16x32_bf16 v[220:223], a[44:47], a[200:203], v[220:223]
v_cvt_pk_bf16_f32 v113, v90, v91
v_cvt_pk_bf16_f32 v114, v92, v93
v_cvt_pk_bf16_f32 v115, v94, v95
v_lshlrev_b32 v88, 16, v116
v_and_b32 v89, 0xffff0000, v116
v_mfma_f32_16x16x32_bf16 v[224:227], a[48:51], a[200:203], v[224:227]
v_lshlrev_b32 v90, 16, v117
v_and_b32 v91, 0xffff0000, v117
v_lshlrev_b32 v92, 16, v118
v_and_b32 v93, 0xffff0000, v118
v_lshlrev_b32 v94, 16, v119
v_mfma_f32_16x16x32_bf16 v[228:231], a[52:55], a[200:203], v[228:231]
v_and_b32 v95, 0xffff0000, v119
s_waitcnt lgkmcnt(5)
v_mul_f32 v88, v88, v82
v_mul_f32 v89, v89, v82
v_mul_f32 v90, v90, v82
v_mul_f32 v91, v91, v82
v_mfma_f32_16x16x32_bf16 v[232:235], a[56:59], a[200:203], v[232:235]
s_waitcnt lgkmcnt(4)
v_mul_f32 v92, v92, v83
v_mul_f32 v93, v93, v83
v_mul_f32 v94, v94, v83
v_mul_f32 v95, v95, v83
v_cvt_pk_bf16_f32 v116, v88, v89
s_waitcnt vmcnt(39)
v_mfma_f32_16x16x32_bf16 v[236:239], a[40:43], a[204:207], v[236:239]
v_cvt_pk_bf16_f32 v117, v90, v91
v_cvt_pk_bf16_f32 v118, v92, v93
v_cvt_pk_bf16_f32 v119, v94, v95
v_lshlrev_b32 v88, 16, v120
v_and_b32 v89, 0xffff0000, v120
v_mfma_f32_16x16x32_bf16 v[240:243], a[44:47], a[204:207], v[240:243]
v_lshlrev_b32 v90, 16, v121
v_and_b32 v91, 0xffff0000, v121
v_lshlrev_b32 v92, 16, v122
v_and_b32 v93, 0xffff0000, v122
v_lshlrev_b32 v94, 16, v123
v_mfma_f32_16x16x32_bf16 v[244:247], a[48:51], a[204:207], v[244:247]
v_and_b32 v95, 0xffff0000, v123
s_waitcnt lgkmcnt(3)
v_mul_f32 v88, v88, v84
v_mul_f32 v89, v89, v84
v_mul_f32 v90, v90, v84
v_mul_f32 v91, v91, v84
v_mfma_f32_16x16x32_bf16 v[248:251], a[52:55], a[204:207], v[248:251]
s_waitcnt lgkmcnt(2)
v_mul_f32 v92, v92, v85
v_mul_f32 v93, v93, v85
v_mul_f32 v94, v94, v85
v_mul_f32 v95, v95, v85
v_cvt_pk_bf16_f32 v120, v88, v89
v_mfma_f32_16x16x32_bf16 v[252:255], a[56:59], a[204:207], v[252:255]
v_cvt_pk_bf16_f32 v121, v90, v91
v_cvt_pk_bf16_f32 v122, v92, v93
v_cvt_pk_bf16_f32 v123, v94, v95
v_lshlrev_b32 v88, 16, v124
v_and_b32 v89, 0xffff0000, v124
s_waitcnt vmcnt(33)
v_mfma_f32_16x16x32_bf16 v[176:179], a[60:63], a[208:211], v[176:179]
buffer_load_dwordx2 a[140:141], v38, s[24:27], s62 offen offset:0 sc1
v_lshlrev_b32 v90, 16, v125
v_and_b32 v91, 0xffff0000, v125
v_lshlrev_b32 v92, 16, v126
v_and_b32 v93, 0xffff0000, v126
v_mfma_f32_16x16x32_bf16 v[180:183], a[64:67], a[208:211], v[180:183]
buffer_load_dwordx2 a[142:143], v39, s[24:27], s62 offen offset:0 sc1
v_lshlrev_b32 v94, 16, v127
v_and_b32 v95, 0xffff0000, v127
s_waitcnt lgkmcnt(1)
v_mul_f32 v88, v88, v86
v_mul_f32 v89, v89, v86
v_mfma_f32_16x16x32_bf16 v[184:187], a[68:71], a[208:211], v[184:187]
buffer_load_dwordx2 a[144:145], v38, s[24:27], s62 offen offset:640 sc1
v_mul_f32 v90, v90, v86
v_mul_f32 v91, v91, v86
s_waitcnt lgkmcnt(0)
v_mul_f32 v92, v92, v87
v_mul_f32 v93, v93, v87
v_mfma_f32_16x16x32_bf16 v[188:191], a[72:75], a[208:211], v[188:191]
buffer_load_dwordx2 a[146:147], v39, s[24:27], s62 offen offset:640 sc1
v_mul_f32 v94, v94, v87
v_mul_f32 v95, v95, v87
v_cvt_pk_bf16_f32 v124, v88, v89
v_cvt_pk_bf16_f32 v125, v90, v91
v_mfma_f32_16x16x32_bf16 v[192:195], a[76:79], a[208:211], v[192:195]
buffer_load_dwordx2 a[148:149], v38, s[24:27], s62 offen offset:1280 sc1
v_cvt_pk_bf16_f32 v126, v92, v93
v_cvt_pk_bf16_f32 v127, v94, v95
ds_read_b32 v72, v46 offset:0
ds_read_b32 v73, v47 offset:0
ds_read_b32 v74, v46 offset:512
ds_read_b32 v75, v47 offset:512
ds_read_b32 v76, v46 offset:1024
ds_read_b32 v77, v47 offset:1024
ds_read_b32 v78, v46 offset:1536
ds_read_b32 v79, v47 offset:1536
s_waitcnt vmcnt(37)
v_mfma_f32_16x16x32_bf16 v[196:199], a[60:63], a[212:215], v[196:199]
buffer_load_dwordx2 a[150:151], v39, s[24:27], s62 offen offset:1280 sc1
v_lshlrev_b32 v88, 16, v128
v_and_b32 v89, 0xffff0000, v128
v_lshlrev_b32 v90, 16, v129
v_and_b32 v91, 0xffff0000, v129
v_mfma_f32_16x16x32_bf16 v[200:203], a[64:67], a[212:215], v[200:203]
buffer_load_dwordx2 a[152:153], v38, s[24:27], s62 offen offset:1920 sc1
v_lshlrev_b32 v92, 16, v130
v_and_b32 v93, 0xffff0000, v130
v_lshlrev_b32 v94, 16, v131
v_and_b32 v95, 0xffff0000, v131
v_mfma_f32_16x16x32_bf16 v[204:207], a[68:71], a[212:215], v[204:207]
buffer_load_dwordx2 a[154:155], v39, s[24:27], s62 offen offset:1920 sc1
s_waitcnt lgkmcnt(7)
v_mul_f32 v88, v88, v72
v_mul_f32 v89, v89, v72
v_mul_f32 v90, v90, v72
v_mul_f32 v91, v91, v72
v_mfma_f32_16x16x32_bf16 v[208:211], a[72:75], a[212:215], v[208:211]
buffer_load_dwordx2 a[156:157], v38, s[24:27], s62 offen offset:2560 sc1
s_waitcnt lgkmcnt(6)
v_mul_f32 v92, v92, v73
v_mul_f32 v93, v93, v73
v_mul_f32 v94, v94, v73
v_mul_f32 v95, v95, v73
v_mfma_f32_16x16x32_bf16 v[212:215], a[76:79], a[212:215], v[212:215]
buffer_load_dwordx2 a[158:159], v39, s[24:27], s62 offen offset:2560 sc1
v_cvt_pk_bf16_f32 v128, v88, v89
v_cvt_pk_bf16_f32 v129, v90, v91
v_cvt_pk_bf16_f32 v130, v92, v93
v_cvt_pk_bf16_f32 v131, v94, v95
s_waitcnt vmcnt(41)
v_mfma_f32_16x16x32_bf16 v[216:219], a[60:63], a[216:219], v[216:219]
v_lshlrev_b32 v88, 16, v132
v_and_b32 v89, 0xffff0000, v132
v_lshlrev_b32 v90, 16, v133
v_and_b32 v91, 0xffff0000, v133
v_lshlrev_b32 v92, 16, v134
v_mfma_f32_16x16x32_bf16 v[220:223], a[64:67], a[216:219], v[220:223]
v_and_b32 v93, 0xffff0000, v134
v_lshlrev_b32 v94, 16, v135
v_and_b32 v95, 0xffff0000, v135
s_waitcnt lgkmcnt(5)
v_mul_f32 v88, v88, v74
v_mul_f32 v89, v89, v74
v_mfma_f32_16x16x32_bf16 v[224:227], a[68:71], a[216:219], v[224:227]
v_mul_f32 v90, v90, v74
v_mul_f32 v91, v91, v74
s_waitcnt lgkmcnt(4)
v_mul_f32 v92, v92, v75
v_mul_f32 v93, v93, v75
v_mul_f32 v94, v94, v75
v_mfma_f32_16x16x32_bf16 v[228:231], a[72:75], a[216:219], v[228:231]
v_mul_f32 v95, v95, v75
v_cvt_pk_bf16_f32 v132, v88, v89
v_cvt_pk_bf16_f32 v133, v90, v91
v_cvt_pk_bf16_f32 v134, v92, v93
v_cvt_pk_bf16_f32 v135, v94, v95
v_mfma_f32_16x16x32_bf16 v[232:235], a[76:79], a[216:219], v[232:235]
v_lshlrev_b32 v88, 16, v136
v_and_b32 v89, 0xffff0000, v136
v_lshlrev_b32 v90, 16, v137
v_and_b32 v91, 0xffff0000, v137
v_lshlrev_b32 v92, 16, v138
s_waitcnt vmcnt(40)
v_mfma_f32_16x16x32_bf16 v[236:239], a[60:63], a[220:223], v[236:239]
v_and_b32 v93, 0xffff0000, v138
v_lshlrev_b32 v94, 16, v139
v_and_b32 v95, 0xffff0000, v139
s_waitcnt lgkmcnt(3)
v_mul_f32 v88, v88, v76
v_mul_f32 v89, v89, v76
v_mfma_f32_16x16x32_bf16 v[240:243], a[64:67], a[220:223], v[240:243]
v_mul_f32 v90, v90, v76
v_mul_f32 v91, v91, v76
s_waitcnt lgkmcnt(2)
v_mul_f32 v92, v92, v77
v_mul_f32 v93, v93, v77
v_mul_f32 v94, v94, v77
v_mfma_f32_16x16x32_bf16 v[244:247], a[68:71], a[220:223], v[244:247]
v_mul_f32 v95, v95, v77
v_cvt_pk_bf16_f32 v136, v88, v89
v_cvt_pk_bf16_f32 v137, v90, v91
v_cvt_pk_bf16_f32 v138, v92, v93
v_cvt_pk_bf16_f32 v139, v94, v95
v_mfma_f32_16x16x32_bf16 v[248:251], a[72:75], a[220:223], v[248:251]
v_lshlrev_b32 v88, 16, v140
v_and_b32 v89, 0xffff0000, v140
v_lshlrev_b32 v90, 16, v141
v_and_b32 v91, 0xffff0000, v141
v_lshlrev_b32 v92, 16, v142
v_mfma_f32_16x16x32_bf16 v[252:255], a[76:79], a[220:223], v[252:255]
v_and_b32 v93, 0xffff0000, v142
v_lshlrev_b32 v94, 16, v143
v_and_b32 v95, 0xffff0000, v143
s_waitcnt lgkmcnt(1)
v_mul_f32 v88, v88, v78
v_mul_f32 v89, v89, v78
s_waitcnt vmcnt(38)
v_mfma_f32_16x16x32_bf16 v[176:179], a[80:83], v[96:99], v[176:179]
buffer_load_dwordx2 a[0:1], v40, s[24:27], s62 offen offset:0 sc1
v_mul_f32 v90, v90, v78
v_mul_f32 v91, v91, v78
s_waitcnt lgkmcnt(0)
v_mul_f32 v92, v92, v79
v_mul_f32 v93, v93, v79
s_waitcnt vmcnt(37)
v_mfma_f32_16x16x32_bf16 v[180:183], a[84:87], v[96:99], v[180:183]
buffer_load_dwordx2 a[2:3], v41, s[24:27], s62 offen offset:0 sc1
v_mul_f32 v94, v94, v79
v_mul_f32 v95, v95, v79
v_cvt_pk_bf16_f32 v140, v88, v89
v_cvt_pk_bf16_f32 v141, v90, v91
s_waitcnt vmcnt(36)
v_mfma_f32_16x16x32_bf16 v[184:187], a[88:91], v[96:99], v[184:187]
buffer_load_dwordx2 a[4:5], v40, s[24:27], s62 offen offset:640 sc1
v_cvt_pk_bf16_f32 v142, v92, v93
v_cvt_pk_bf16_f32 v143, v94, v95
ds_read_b32 v80, v48 offset:0
ds_read_b32 v81, v49 offset:0
ds_read_b32 v82, v48 offset:512
ds_read_b32 v83, v49 offset:512
ds_read_b32 v84, v48 offset:1024
ds_read_b32 v85, v49 offset:1024
ds_read_b32 v86, v48 offset:1536
ds_read_b32 v87, v49 offset:1536
s_waitcnt vmcnt(35)
v_mfma_f32_16x16x32_bf16 v[188:191], a[92:95], v[96:99], v[188:191]
buffer_load_dwordx2 a[6:7], v41, s[24:27], s62 offen offset:640 sc1
v_lshlrev_b32 v88, 16, v144
v_and_b32 v89, 0xffff0000, v144
v_lshlrev_b32 v90, 16, v145
v_and_b32 v91, 0xffff0000, v145
s_waitcnt vmcnt(34)
v_mfma_f32_16x16x32_bf16 v[192:195], a[96:99], v[96:99], v[192:195]
buffer_load_dwordx2 a[8:9], v40, s[24:27], s62 offen offset:1280 sc1
v_lshlrev_b32 v92, 16, v146
v_and_b32 v93, 0xffff0000, v146
v_lshlrev_b32 v94, 16, v147
v_and_b32 v95, 0xffff0000, v147
v_mfma_f32_16x16x32_bf16 v[196:199], a[80:83], v[100:103], v[196:199]
buffer_load_dwordx2 a[10:11], v41, s[24:27], s62 offen offset:1280 sc1
s_waitcnt lgkmcnt(7)
v_mul_f32 v88, v88, v80
v_mul_f32 v89, v89, v80
v_mul_f32 v90, v90, v80
v_mul_f32 v91, v91, v80
v_mfma_f32_16x16x32_bf16 v[200:203], a[84:87], v[100:103], v[200:203]
buffer_load_dwordx2 a[12:13], v40, s[24:27], s62 offen offset:1920 sc1
s_waitcnt lgkmcnt(6)
v_mul_f32 v92, v92, v81
v_mul_f32 v93, v93, v81
v_mul_f32 v94, v94, v81
v_mul_f32 v95, v95, v81
v_mfma_f32_16x16x32_bf16 v[204:207], a[88:91], v[100:103], v[204:207]
buffer_load_dwordx2 a[14:15], v41, s[24:27], s62 offen offset:1920 sc1
v_cvt_pk_bf16_f32 v144, v88, v89
v_cvt_pk_bf16_f32 v145, v90, v91
v_cvt_pk_bf16_f32 v146, v92, v93
v_cvt_pk_bf16_f32 v147, v94, v95
v_mfma_f32_16x16x32_bf16 v[208:211], a[92:95], v[100:103], v[208:211]
buffer_load_dwordx2 a[16:17], v40, s[24:27], s62 offen offset:2560 sc1
v_lshlrev_b32 v88, 16, v148
v_and_b32 v89, 0xffff0000, v148
v_lshlrev_b32 v90, 16, v149
v_and_b32 v91, 0xffff0000, v149
v_mfma_f32_16x16x32_bf16 v[212:215], a[96:99], v[100:103], v[212:215]
buffer_load_dwordx2 a[18:19], v41, s[24:27], s62 offen offset:2560 sc1
v_lshlrev_b32 v92, 16, v150
v_and_b32 v93, 0xffff0000, v150
v_lshlrev_b32 v94, 16, v151
v_and_b32 v95, 0xffff0000, v151
v_mfma_f32_16x16x32_bf16 v[216:219], a[80:83], v[104:107], v[216:219]
s_waitcnt lgkmcnt(5)
v_mul_f32 v88, v88, v82
v_mul_f32 v89, v89, v82
v_mul_f32 v90, v90, v82
v_mul_f32 v91, v91, v82
s_waitcnt lgkmcnt(4)
v_mul_f32 v92, v92, v83
v_mfma_f32_16x16x32_bf16 v[220:223], a[84:87], v[104:107], v[220:223]
v_mul_f32 v93, v93, v83
v_mul_f32 v94, v94, v83
v_mul_f32 v95, v95, v83
v_cvt_pk_bf16_f32 v148, v88, v89
v_cvt_pk_bf16_f32 v149, v90, v91
v_mfma_f32_16x16x32_bf16 v[224:227], a[88:91], v[104:107], v[224:227]
v_cvt_pk_bf16_f32 v150, v92, v93
v_cvt_pk_bf16_f32 v151, v94, v95
v_lshlrev_b32 v88, 16, v152
v_and_b32 v89, 0xffff0000, v152
v_lshlrev_b32 v90, 16, v153
v_mfma_f32_16x16x32_bf16 v[228:231], a[92:95], v[104:107], v[228:231]
v_and_b32 v91, 0xffff0000, v153
v_lshlrev_b32 v92, 16, v154
v_and_b32 v93, 0xffff0000, v154
v_lshlrev_b32 v94, 16, v155
v_and_b32 v95, 0xffff0000, v155
v_mfma_f32_16x16x32_bf16 v[232:235], a[96:99], v[104:107], v[232:235]
s_waitcnt lgkmcnt(3)
v_mul_f32 v88, v88, v84
v_mul_f32 v89, v89, v84
v_mul_f32 v90, v90, v84
v_mul_f32 v91, v91, v84
s_waitcnt lgkmcnt(2)
v_mul_f32 v92, v92, v85
v_mfma_f32_16x16x32_bf16 v[236:239], a[80:83], v[108:111], v[236:239]
v_mul_f32 v93, v93, v85
v_mul_f32 v94, v94, v85
v_mul_f32 v95, v95, v85
v_cvt_pk_bf16_f32 v152, v88, v89
v_cvt_pk_bf16_f32 v153, v90, v91
v_mfma_f32_16x16x32_bf16 v[240:243], a[84:87], v[108:111], v[240:243]
v_cvt_pk_bf16_f32 v154, v92, v93
v_cvt_pk_bf16_f32 v155, v94, v95
v_lshlrev_b32 v88, 16, v156
v_and_b32 v89, 0xffff0000, v156
v_lshlrev_b32 v90, 16, v157
v_mfma_f32_16x16x32_bf16 v[244:247], a[88:91], v[108:111], v[244:247]
v_and_b32 v91, 0xffff0000, v157
v_lshlrev_b32 v92, 16, v158
v_and_b32 v93, 0xffff0000, v158
v_lshlrev_b32 v94, 16, v159
v_and_b32 v95, 0xffff0000, v159
v_mfma_f32_16x16x32_bf16 v[248:251], a[92:95], v[108:111], v[248:251]
s_waitcnt lgkmcnt(1)
v_mul_f32 v88, v88, v86
v_mul_f32 v89, v89, v86
v_mul_f32 v90, v90, v86
v_mul_f32 v91, v91, v86
s_waitcnt lgkmcnt(0)
v_mul_f32 v92, v92, v87
v_mfma_f32_16x16x32_bf16 v[252:255], a[96:99], v[108:111], v[252:255]
v_mul_f32 v93, v93, v87
v_mul_f32 v94, v94, v87
v_mul_f32 v95, v95, v87
v_cvt_pk_bf16_f32 v156, v88, v89
v_cvt_pk_bf16_f32 v157, v90, v91
s_waitcnt vmcnt(38)
v_mfma_f32_16x16x32_bf16 v[176:179], a[100:103], v[112:115], v[176:179]
v_cvt_pk_bf16_f32 v158, v92, v93
v_cvt_pk_bf16_f32 v159, v94, v95
ds_read_b32 v72, v50 offset:0
ds_read_b32 v73, v51 offset:0
ds_read_b32 v74, v50 offset:512
ds_read_b32 v75, v51 offset:512
ds_read_b32 v76, v50 offset:1024
ds_read_b32 v77, v51 offset:1024
ds_read_b32 v78, v50 offset:1536
ds_read_b32 v79, v51 offset:1536
s_waitcnt vmcnt(36)
v_mfma_f32_16x16x32_bf16 v[180:183], a[104:107], v[112:115], v[180:183]
v_lshlrev_b32 v88, 16, v160
v_and_b32 v89, 0xffff0000, v160
v_lshlrev_b32 v90, 16, v161
v_and_b32 v91, 0xffff0000, v161
v_lshlrev_b32 v92, 16, v162
s_waitcnt vmcnt(34)
v_mfma_f32_16x16x32_bf16 v[184:187], a[108:111], v[112:115], v[184:187]
v_and_b32 v93, 0xffff0000, v162
v_lshlrev_b32 v94, 16, v163
v_and_b32 v95, 0xffff0000, v163
s_waitcnt lgkmcnt(7)
v_mul_f32 v88, v88, v72
v_mul_f32 v89, v89, v72
s_waitcnt vmcnt(32)
v_mfma_f32_16x16x32_bf16 v[188:191], a[112:115], v[112:115], v[188:191]
v_mul_f32 v90, v90, v72
v_mul_f32 v91, v91, v72
s_waitcnt lgkmcnt(6)
v_mul_f32 v92, v92, v73
v_mul_f32 v93, v93, v73
v_mul_f32 v94, v94, v73
s_waitcnt vmcnt(30)
v_mfma_f32_16x16x32_bf16 v[192:195], a[116:119], v[112:115], v[192:195]
v_mul_f32 v95, v95, v73
v_cvt_pk_bf16_f32 v160, v88, v89
v_cvt_pk_bf16_f32 v161, v90, v91
v_cvt_pk_bf16_f32 v162, v92, v93
v_cvt_pk_bf16_f32 v163, v94, v95
v_mfma_f32_16x16x32_bf16 v[196:199], a[100:103], v[116:119], v[196:199]
v_lshlrev_b32 v88, 16, v164
v_and_b32 v89, 0xffff0000, v164
v_lshlrev_b32 v90, 16, v165
v_and_b32 v91, 0xffff0000, v165
v_lshlrev_b32 v92, 16, v166
v_mfma_f32_16x16x32_bf16 v[200:203], a[104:107], v[116:119], v[200:203]
v_and_b32 v93, 0xffff0000, v166
v_lshlrev_b32 v94, 16, v167
v_and_b32 v95, 0xffff0000, v167
s_waitcnt lgkmcnt(5)
v_mul_f32 v88, v88, v74
v_mul_f32 v89, v89, v74
v_mfma_f32_16x16x32_bf16 v[204:207], a[108:111], v[116:119], v[204:207]
v_mul_f32 v90, v90, v74
v_mul_f32 v91, v91, v74
s_waitcnt lgkmcnt(4)
v_mul_f32 v92, v92, v75
v_mul_f32 v93, v93, v75
v_mul_f32 v94, v94, v75
v_mfma_f32_16x16x32_bf16 v[208:211], a[112:115], v[116:119], v[208:211]
v_mul_f32 v95, v95, v75
v_cvt_pk_bf16_f32 v164, v88, v89
v_cvt_pk_bf16_f32 v165, v90, v91
v_cvt_pk_bf16_f32 v166, v92, v93
v_cvt_pk_bf16_f32 v167, v94, v95
v_mfma_f32_16x16x32_bf16 v[212:215], a[116:119], v[116:119], v[212:215]
v_lshlrev_b32 v88, 16, v168
v_and_b32 v89, 0xffff0000, v168
v_lshlrev_b32 v90, 16, v169
v_and_b32 v91, 0xffff0000, v169
v_lshlrev_b32 v92, 16, v170
v_mfma_f32_16x16x32_bf16 v[216:219], a[100:103], v[120:123], v[216:219]
v_and_b32 v93, 0xffff0000, v170
v_lshlrev_b32 v94, 16, v171
v_and_b32 v95, 0xffff0000, v171
s_waitcnt lgkmcnt(3)
v_mul_f32 v88, v88, v76
v_mul_f32 v89, v89, v76
v_mfma_f32_16x16x32_bf16 v[220:223], a[104:107], v[120:123], v[220:223]
v_mul_f32 v90, v90, v76
v_mul_f32 v91, v91, v76
s_waitcnt lgkmcnt(2)
v_mul_f32 v92, v92, v77
v_mul_f32 v93, v93, v77
v_mul_f32 v94, v94, v77
v_mfma_f32_16x16x32_bf16 v[224:227], a[108:111], v[120:123], v[224:227]
v_mul_f32 v95, v95, v77
v_cvt_pk_bf16_f32 v168, v88, v89
v_cvt_pk_bf16_f32 v169, v90, v91
v_cvt_pk_bf16_f32 v170, v92, v93
v_cvt_pk_bf16_f32 v171, v94, v95
v_mfma_f32_16x16x32_bf16 v[228:231], a[112:115], v[120:123], v[228:231]
v_lshlrev_b32 v88, 16, v172
v_and_b32 v89, 0xffff0000, v172
v_lshlrev_b32 v90, 16, v173
v_and_b32 v91, 0xffff0000, v173
v_lshlrev_b32 v92, 16, v174
v_mfma_f32_16x16x32_bf16 v[232:235], a[116:119], v[120:123], v[232:235]
v_and_b32 v93, 0xffff0000, v174
v_lshlrev_b32 v94, 16, v175
v_and_b32 v95, 0xffff0000, v175
s_waitcnt lgkmcnt(1)
v_mul_f32 v88, v88, v78
v_mul_f32 v89, v89, v78
v_mfma_f32_16x16x32_bf16 v[236:239], a[100:103], v[124:127], v[236:239]
v_mul_f32 v90, v90, v78
v_mul_f32 v91, v91, v78
s_waitcnt lgkmcnt(0)
v_mul_f32 v92, v92, v79
v_mul_f32 v93, v93, v79
v_mul_f32 v94, v94, v79
v_mfma_f32_16x16x32_bf16 v[240:243], a[104:107], v[124:127], v[240:243]
v_mul_f32 v95, v95, v79
v_cvt_pk_bf16_f32 v172, v88, v89
v_cvt_pk_bf16_f32 v173, v90, v91
v_cvt_pk_bf16_f32 v174, v92, v93
v_cvt_pk_bf16_f32 v175, v94, v95
v_mfma_f32_16x16x32_bf16 v[244:247], a[108:111], v[124:127], v[244:247]
v_mfma_f32_16x16x32_bf16 v[248:251], a[112:115], v[124:127], v[248:251]
v_mfma_f32_16x16x32_bf16 v[252:255], a[116:119], v[124:127], v[252:255]
s_waitcnt vmcnt(28)
v_mfma_f32_16x16x32_bf16 v[176:179], a[120:123], v[128:131], v[176:179]
s_waitcnt vmcnt(26)
v_mfma_f32_16x16x32_bf16 v[180:183], a[124:127], v[128:131], v[180:183]
s_waitcnt vmcnt(24)
v_mfma_f32_16x16x32_bf16 v[184:187], a[128:131], v[128:131], v[184:187]
s_waitcnt vmcnt(22)
v_mfma_f32_16x16x32_bf16 v[188:191], a[132:135], v[128:131], v[188:191]
s_waitcnt vmcnt(20)
v_mfma_f32_16x16x32_bf16 v[192:195], a[136:139], v[128:131], v[192:195]
v_mfma_f32_16x16x32_bf16 v[196:199], a[120:123], v[132:135], v[196:199]
v_mfma_f32_16x16x32_bf16 v[200:203], a[124:127], v[132:135], v[200:203]
v_mfma_f32_16x16x32_bf16 v[204:207], a[128:131], v[132:135], v[204:207]
v_mfma_f32_16x16x32_bf16 v[208:211], a[132:135], v[132:135], v[208:211]
v_mfma_f32_16x16x32_bf16 v[212:215], a[136:139], v[132:135], v[212:215]
v_mfma_f32_16x16x32_bf16 v[216:219], a[120:123], v[136:139], v[216:219]
v_mfma_f32_16x16x32_bf16 v[220:223], a[124:127], v[136:139], v[220:223]
v_mfma_f32_16x16x32_bf16 v[224:227], a[128:131], v[136:139], v[224:227]
v_mfma_f32_16x16x32_bf16 v[228:231], a[132:135], v[136:139], v[228:231]
v_mfma_f32_16x16x32_bf16 v[232:235], a[136:139], v[136:139], v[232:235]
v_mfma_f32_16x16x32_bf16 v[236:239], a[120:123], v[140:143], v[236:239]
v_mfma_f32_16x16x32_bf16 v[240:243], a[124:127], v[140:143], v[240:243]
v_mfma_f32_16x16x32_bf16 v[244:247], a[128:131], v[140:143], v[244:247]
v_mfma_f32_16x16x32_bf16 v[248:251], a[132:135], v[140:143], v[248:251]
v_mfma_f32_16x16x32_bf16 v[252:255], a[136:139], v[140:143], v[252:255]
s_waitcnt vmcnt(18)
v_mfma_f32_16x16x32_bf16 v[176:179], a[140:143], v[144:147], v[176:179]
s_waitcnt vmcnt(16)
v_mfma_f32_16x16x32_bf16 v[180:183], a[144:147], v[144:147], v[180:183]
s_waitcnt vmcnt(14)
v_mfma_f32_16x16x32_bf16 v[184:187], a[148:151], v[144:147], v[184:187]
s_waitcnt vmcnt(12)
v_mfma_f32_16x16x32_bf16 v[188:191], a[152:155], v[144:147], v[188:191]
s_waitcnt vmcnt(10)
v_mfma_f32_16x16x32_bf16 v[192:195], a[156:159], v[144:147], v[192:195]
v_mfma_f32_16x16x32_bf16 v[196:199], a[140:143], v[148:151], v[196:199]
v_mfma_f32_16x16x32_bf16 v[200:203], a[144:147], v[148:151], v[200:203]
v_mfma_f32_16x16x32_bf16 v[204:207], a[148:151], v[148:151], v[204:207]
v_mfma_f32_16x16x32_bf16 v[208:211], a[152:155], v[148:151], v[208:211]
v_mfma_f32_16x16x32_bf16 v[212:215], a[156:159], v[148:151], v[212:215]
v_mfma_f32_16x16x32_bf16 v[216:219], a[140:143], v[152:155], v[216:219]
v_mfma_f32_16x16x32_bf16 v[220:223], a[144:147], v[152:155], v[220:223]
v_mfma_f32_16x16x32_bf16 v[224:227], a[148:151], v[152:155], v[224:227]
v_mfma_f32_16x16x32_bf16 v[228:231], a[152:155], v[152:155], v[228:231]
v_mfma_f32_16x16x32_bf16 v[232:235], a[156:159], v[152:155], v[232:235]
v_mfma_f32_16x16x32_bf16 v[236:239], a[140:143], v[156:159], v[236:239]
v_mfma_f32_16x16x32_bf16 v[240:243], a[144:147], v[156:159], v[240:243]
v_mfma_f32_16x16x32_bf16 v[244:247], a[148:151], v[156:159], v[244:247]
v_mfma_f32_16x16x32_bf16 v[248:251], a[152:155], v[156:159], v[248:251]
v_mfma_f32_16x16x32_bf16 v[252:255], a[156:159], v[156:159], v[252:255]
s_waitcnt vmcnt(8)
v_mfma_f32_16x16x32_bf16 v[176:179], a[0:3], v[160:163], v[176:179]
s_waitcnt vmcnt(6)
v_mfma_f32_16x16x32_bf16 v[180:183], a[4:7], v[160:163], v[180:183]
s_waitcnt vmcnt(4)
v_mfma_f32_16x16x32_bf16 v[184:187], a[8:11], v[160:163], v[184:187]
s_waitcnt vmcnt(2)
v_mfma_f32_16x16x32_bf16 v[188:191], a[12:15], v[160:163], v[188:191]
s_waitcnt vmcnt(0)
v_mfma_f32_16x16x32_bf16 v[192:195], a[16:19], v[160:163], v[192:195]
v_mfma_f32_16x16x32_bf16 v[196:199], a[0:3], v[164:167], v[196:199]
v_mfma_f32_16x16x32_bf16 v[200:203], a[4:7], v[164:167], v[200:203]
v_mfma_f32_16x16x32_bf16 v[204:207], a[8:11], v[164:167], v[204:207]
v_mfma_f32_16x16x32_bf16 v[208:211], a[12:15], v[164:167], v[208:211]
v_mfma_f32_16x16x32_bf16 v[212:215], a[16:19], v[164:167], v[212:215]
ds_write_b128 v6, v[176:179] offset:0
v_mfma_f32_16x16x32_bf16 v[216:219], a[0:3], v[168:171], v[216:219]
ds_write_b128 v6, v[180:183] offset:1024
v_mfma_f32_16x16x32_bf16 v[220:223], a[4:7], v[168:171], v[220:223]
ds_write_b128 v6, v[184:187] offset:2048
v_mfma_f32_16x16x32_bf16 v[224:227], a[8:11], v[168:171], v[224:227]
ds_write_b128 v6, v[188:191] offset:3072
v_mfma_f32_16x16x32_bf16 v[228:231], a[12:15], v[168:171], v[228:231]
ds_write_b128 v6, v[192:195] offset:4096
v_mfma_f32_16x16x32_bf16 v[232:235], a[16:19], v[168:171], v[232:235]
ds_write_b128 v6, v[196:199] offset:5120
v_mfma_f32_16x16x32_bf16 v[236:239], a[0:3], v[172:175], v[236:239]
ds_write_b128 v6, v[200:203] offset:6144
v_mfma_f32_16x16x32_bf16 v[240:243], a[4:7], v[172:175], v[240:243]
ds_write_b128 v6, v[204:207] offset:7168
v_mfma_f32_16x16x32_bf16 v[244:247], a[8:11], v[172:175], v[244:247]
ds_write_b128 v6, v[208:211] offset:8192
v_mfma_f32_16x16x32_bf16 v[248:251], a[12:15], v[172:175], v[248:251]
ds_write_b128 v6, v[212:215] offset:9216
v_mfma_f32_16x16x32_bf16 v[252:255], a[16:19], v[172:175], v[252:255]
ds_write_b128 v6, v[216:219] offset:10240
ds_write_b128 v6, v[220:223] offset:11264
ds_write_b128 v6, v[224:227] offset:12288
ds_write_b128 v6, v[228:231] offset:13312
ds_write_b128 v6, v[232:235] offset:14336
ds_write_b128 v6, v[236:239] offset:15360
ds_write_b128 v6, v[240:243] offset:16384
ds_write_b128 v6, v[244:247] offset:17408
ds_write_b128 v6, v[248:251] offset:18432
ds_write_b128 v6, v[252:255] offset:19456
s_waitcnt lgkmcnt(0)
s_barrier
ds_read_b128 v[96:99], v7 offset:0
ds_read_b128 v[100:103], v7 offset:20480
ds_read_b128 v[104:107], v8 offset:0
ds_read_b128 v[108:111], v8 offset:20480
ds_read_b128 v[112:115], v7 offset:1024
ds_read_b128 v[116:119], v7 offset:21504
ds_read_b128 v[120:123], v8 offset:1024
ds_read_b128 v[124:127], v8 offset:21504
ds_read_b128 v[128:131], v7 offset:2048
ds_read_b128 v[132:135], v7 offset:22528
ds_read_b128 v[136:139], v8 offset:2048
ds_read_b128 v[140:143], v8 offset:22528
ds_read_b128 v[144:147], v7 offset:3072
ds_read_b128 v[148:151], v7 offset:23552
ds_read_b128 v[152:155], v8 offset:3072
ds_read_b128 v[156:159], v8 offset:23552
ds_read_b128 v[160:163], v7 offset:4096
ds_read_b128 v[164:167], v7 offset:24576
ds_read_b128 v[168:171], v8 offset:4096
ds_read_b128 v[172:175], v8 offset:24576
v_lshlrev_b32 v176, 16, v18
v_and_b32 v177, 0xffff0000, v18
v_lshlrev_b32 v178, 16, v19
v_and_b32 v179, 0xffff0000, v19
s_waitcnt lgkmcnt(15)
v_add_f32 v96, v96, v100
v_add_f32 v97, v97, v101
v_add_f32 v98, v98, v102
v_add_f32 v99, v99, v103
v_add_f32 v104, v104, v108
v_add_f32 v105, v105, v109
v_add_f32 v106, v106, v110
v_add_f32 v107, v107, v111
v_add_f32 v176, v176, v96
v_add_f32 v177, v177, v97
v_add_f32 v178, v178, v98
v_add_f32 v179, v179, v99
v_add_f32 v176, v176, v104
v_add_f32 v177, v177, v105
v_add_f32 v178, v178, v106
v_add_f32 v179, v179, v107
v_cvt_pk_bf16_f32 v180, v176, v177
v_cvt_pk_bf16_f32 v181, v178, v179
buffer_store_dwordx2 v[180:181], v12, s[20:23], s46 offen
v_lshlrev_b32 v182, 16, v20
v_and_b32 v183, 0xffff0000, v20
v_lshlrev_b32 v184, 16, v21
v_and_b32 v185, 0xffff0000, v21
s_waitcnt lgkmcnt(14)
v_add_f32 v112, v112, v116
v_add_f32 v113, v113, v117
v_add_f32 v114, v114, v118
v_add_f32 v115, v115, v119
s_waitcnt lgkmcnt(12)
v_add_f32 v120, v120, v124
v_add_f32 v121, v121, v125
v_add_f32 v122, v122, v126
v_add_f32 v123, v123, v127
v_add_f32 v182, v182, v112
v_add_f32 v183, v183, v113
v_add_f32 v184, v184, v114
v_add_f32 v185, v185, v115
v_add_f32 v182, v182, v120
v_add_f32 v183, v183, v121
v_add_f32 v184, v184, v122
v_add_f32 v185, v185, v123
v_cvt_pk_bf16_f32 v186, v182, v183
v_cvt_pk_bf16_f32 v187, v184, v185
buffer_store_dwordx2 v[186:187], v12, s[20:23], s46 offen offset:32
v_lshlrev_b32 v188, 16, v22
v_and_b32 v189, 0xffff0000, v22
v_lshlrev_b32 v190, 16, v23
v_and_b32 v191, 0xffff0000, v23
s_waitcnt lgkmcnt(10)
v_add_f32 v128, v128, v132
v_add_f32 v129, v129, v133
v_add_f32 v130, v130, v134
v_add_f32 v131, v131, v135
s_waitcnt lgkmcnt(8)
v_add_f32 v136, v136, v140
v_add_f32 v137, v137, v141
v_add_f32 v138, v138, v142
v_add_f32 v139, v139, v143
v_add_f32 v188, v188, v128
v_add_f32 v189, v189, v129
v_add_f32 v190, v190, v130
v_add_f32 v191, v191, v131
v_add_f32 v188, v188, v136
v_add_f32 v189, v189, v137
v_add_f32 v190, v190, v138
v_add_f32 v191, v191, v139
v_cvt_pk_bf16_f32 v192, v188, v189
v_cvt_pk_bf16_f32 v193, v190, v191
buffer_store_dwordx2 v[192:193], v12, s[20:23], s46 offen offset:64
v_lshlrev_b32 v194, 16, v24
v_and_b32 v195, 0xffff0000, v24
v_lshlrev_b32 v196, 16, v25
v_and_b32 v197, 0xffff0000, v25
s_waitcnt lgkmcnt(6)
v_add_f32 v144, v144, v148
v_add_f32 v145, v145, v149
v_add_f32 v146, v146, v150
v_add_f32 v147, v147, v151
s_waitcnt lgkmcnt(4)
v_add_f32 v152, v152, v156
v_add_f32 v153, v153, v157
v_add_f32 v154, v154, v158
v_add_f32 v155, v155, v159
v_add_f32 v194, v194, v144
v_add_f32 v195, v195, v145
v_add_f32 v196, v196, v146
v_add_f32 v197, v197, v147
v_add_f32 v194, v194, v152
v_add_f32 v195, v195, v153
v_add_f32 v196, v196, v154
v_add_f32 v197, v197, v155
v_cvt_pk_bf16_f32 v198, v194, v195
v_cvt_pk_bf16_f32 v199, v196, v197
buffer_store_dwordx2 v[198:199], v12, s[20:23], s46 offen offset:96
v_lshlrev_b32 v200, 16, v26
v_and_b32 v201, 0xffff0000, v26
v_lshlrev_b32 v202, 16, v27
v_and_b32 v203, 0xffff0000, v27
s_waitcnt lgkmcnt(2)
v_add_f32 v160, v160, v164
v_add_f32 v161, v161, v165
v_add_f32 v162, v162, v166
v_add_f32 v163, v163, v167
s_waitcnt lgkmcnt(0)
v_add_f32 v168, v168, v172
v_add_f32 v169, v169, v173
v_add_f32 v170, v170, v174
v_add_f32 v171, v171, v175
v_add_f32 v200, v200, v160
v_add_f32 v201, v201, v161
v_add_f32 v202, v202, v162
v_add_f32 v203, v203, v163
v_add_f32 v200, v200, v168
v_add_f32 v201, v201, v169
v_add_f32 v202, v202, v170
v_add_f32 v203, v203, v171
v_cvt_pk_bf16_f32 v204, v200, v201
v_cvt_pk_bf16_f32 v205, v202, v203
buffer_store_dwordx2 v[204:205], v12, s[20:23], s46 offen offset:128
s_endpgm
K1_KV:
s_getpc_b64 s[90:91]
v_and_b32 v1, 63, v0
v_lshrrev_b32 v32, 6, v0
s_nop 0
v_readfirstlane_b32 s48, v32
v_lshrrev_b32 v32, 3, v1
v_lshrrev_b32 v33, 1, v32
v_and_b32 v34, 7, v1
v_xor_b32 v34, v34, v33
v_mul_u32_u24 v32, 1280, v32
v_lshl_add_u32 v12, v34, 4, v32
v_xor_b32 v32, 64, v12
v_add_u32 v13, 9216, v32
v_add_u32 v14, 18432, v12
v_add_u32 v15, 27648, v32
s_and_b32 s60, s2, 7
s_lshr_b32 s61, s2, 3
s_and_b32 s49, s60, 1
s_lshl_b32 s49, s49, 3
s_and_b32 s62, s61, 7
s_add_u32 s49, s49, s62
s_lshr_b32 s50, s60, 1
s_lshl_b32 s50, s50, 2
s_lshr_b32 s63, s61, 3
s_add_u32 s50, s50, s63
s_mul_i32 s53, s48, 12288
s_add_u32 s53, s53, 98816
s_mul_i32 s56, s48, 40960
s_mul_i32 s52, s48, 5120
s_mul_i32 s54, s48, 61440
s_lshr_b32 s51, s50, 2
s_mul_i32 s60, s51, 320
s_add_u32 s64, s60, 1280
s_add_u32 s65, s64, 160
s_add_u32 s66, s60, 2560
s_add_u32 s67, s66, 160
v_add_u32 v32, 0, v1
v_mul_u32_u24 v33, 3277, v32
v_lshrrev_b32 v33, 16, v33
v_mul_u32_u24 v34, 20, v33
v_sub_u32 v34, v32, v34
v_mul_u32_u24 v33, 3840, v33
v_lshl_add_u32 v2, v34, 4, v33
v_add_u32 v32, 64, v1
v_mul_u32_u24 v33, 3277, v32
v_lshrrev_b32 v33, 16, v33
v_mul_u32_u24 v34, 20, v33
v_sub_u32 v34, v32, v34
v_mul_u32_u24 v33, 3840, v33
v_lshl_add_u32 v3, v34, 4, v33
v_subrev_u32 v3, 1024, v3
v_add_u32 v32, 128, v1
v_mul_u32_u24 v33, 3277, v32
v_lshrrev_b32 v33, 16, v33
v_mul_u32_u24 v34, 20, v33
v_sub_u32 v34, v32, v34
v_mul_u32_u24 v33, 3840, v33
v_lshl_add_u32 v4, v34, 4, v33
v_subrev_u32 v4, 2048, v4
v_add_u32 v32, 192, v1
v_mul_u32_u24 v33, 3277, v32
v_lshrrev_b32 v33, 16, v33
v_mul_u32_u24 v34, 20, v33
v_sub_u32 v34, v32, v34
v_mul_u32_u24 v33, 3840, v33
v_lshl_add_u32 v5, v34, 4, v33
v_subrev_u32 v5, 3072, v5
v_add_u32 v32, 256, v1
v_mul_u32_u24 v33, 3277, v32
v_lshrrev_b32 v33, 16, v33
v_mul_u32_u24 v34, 20, v33
v_sub_u32 v34, v32, v34
v_mul_u32_u24 v33, 3840, v33
v_lshl_add_u32 v6, v34, 4, v33
s_waitcnt lgkmcnt(0)
s_mul_i32 s60, s49, 163840
s_add_u32 s8, s4, s60
s_addc_u32 s9, s5, 0
s_mov_b32 s10, 163840
s_mov_b32 s11, 0x20000
s_add_u32 m0, s53, 0
s_add_u32 s75, s56, 0
buffer_load_dwordx4 v12, s[8:11], s75 offen lds
buffer_load_dwordx4 v13, s[8:11], s75 offen offset:1024 lds
buffer_load_dwordx4 v14, s[8:11], s75 offen offset:2048 lds
buffer_load_dwordx4 v15, s[8:11], s75 offen offset:3072 lds
s_add_u32 s12, s6, s64
s_addc_u32 s13, s7, 0
s_sub_u32 s14, 2457600, s64
s_mov_b32 s15, 0x20000
s_add_u32 s74, s54, 0
s_add_u32 m0, s52, 0
s_nop 0
buffer_load_dwordx4 v2, s[12:15], s74 offen lds
buffer_load_dwordx4 v3, s[12:15], s74 offen offset:1024 lds
buffer_load_dwordx4 v4, s[12:15], s74 offen offset:2048 lds
buffer_load_dwordx4 v5, s[12:15], s74 offen offset:3072 lds
s_add_u32 m0, s52, 4096
s_nop 0
buffer_load_dwordx4 v6, s[12:15], s74 offen lds
s_mov_b32 s28, s46
s_mov_b32 s29, s47
s_mov_b32 s30, 256
s_mov_b32 s31, 0x20000
s_memrealtime s[98:99]
s_or_b32 s60, s2, s48
s_cmp_eq_u32 s60, 0
s_cselect_b32 s60, 0, 2147483647
v_mov_b32 v32, s60
v_mov_b32 v31, 2147483647
v_cmp_eq_u32 vcc, 0, v1
s_nop 1
v_cndmask_b32 v32, v31, v32, vcc
s_waitcnt lgkmcnt(0)
s_waitcnt lgkmcnt(0)
s_or_b32 s98, s98, 1
s_sub_u32 s92, s98, 2048
v_mov_b32 v33, s98
buffer_store_dword v33, v32, s[28:31], 0 offen sc1
s_lshr_b32 s60, s2, 3
s_and_b32 s60, s60, 7
s_lshl_b32 s60, s60, 2
s_add_u32 s60, s60, s48
s_and_b32 s60, s60, 7
s_lshl_b32 s60, s60, 12
s_add_u32 s60, s90, s60
s_addc_u32 s61, s91, 0
v_lshlrev_b32 v32, 6, v1
v_mov_b32 v33, s61
v_add_co_u32 v32, vcc, s60, v32
s_nop 1
v_addc_co_u32 v33, vcc, 0, v33, vcc
global_load_dword a255, v[32:33], off
s_add_u32 s16, s6, s66
s_addc_u32 s17, s7, 0
s_sub_u32 s18, 2457600, s66
s_mov_b32 s19, 0x20000
s_mul_i32 s80, s48, 5120
s_mul_i32 s55, s48, 61440
s_mov_b32 s24, s44
s_mov_b32 s25, s45
s_mov_b32 s26, 17825792
s_mov_b32 s27, 0x20000
s_mov_b32 s32, s76
s_mov_b32 s33, s77
s_mov_b32 s34, 1966080
s_mov_b32 s35, 0x20000
s_mov_b32 s36, s78
s_mov_b32 s37, s79
s_mov_b32 s38, 819200
s_mov_b32 s39, 0x20000
s_mov_b32 s84, 1069066811
s_mov_b32 s85, 0x358637bd
s_lshl_b32 s57, s49, 2
s_add_u32 s57, s57, s48
s_mul_i32 s57, s57, 139264
v_add_u32 v32, 0, v1
v_mul_u32_u24 v33, 3277, v32
v_lshrrev_b32 v33, 16, v33
v_mul_u32_u24 v34, 20, v33
v_sub_u32 v34, v32, v34
v_mul_u32_u24 v33, 3840, v33
v_lshl_add_u32 v7, v34, 4, v33
v_add_u32 v32, 64, v1
v_mul_u32_u24 v33, 3277, v32
v_lshrrev_b32 v33, 16, v33
v_mul_u32_u24 v34, 20, v33
v_sub_u32 v34, v32, v34
v_mul_u32_u24 v33, 3840, v33
v_lshl_add_u32 v8, v34, 4, v33
v_subrev_u32 v8, 1024, v8
v_add_u32 v32, 128, v1
v_mul_u32_u24 v33, 3277, v32
v_lshrrev_b32 v33, 16, v33
v_mul_u32_u24 v34, 20, v33
v_sub_u32 v34, v32, v34
v_mul_u32_u24 v33, 3840, v33
v_lshl_add_u32 v9, v34, 4, v33
v_subrev_u32 v9, 2048, v9
v_add_u32 v32, 192, v1
v_mul_u32_u24 v33, 3277, v32
v_lshrrev_b32 v33, 16, v33
v_mul_u32_u24 v34, 20, v33
v_sub_u32 v34, v32, v34
v_mul_u32_u24 v33, 3840, v33
v_lshl_add_u32 v10, v34, 4, v33
v_subrev_u32 v10, 3072, v10
v_add_u32 v32, 256, v1
v_mul_u32_u24 v33, 3277, v32
v_lshrrev_b32 v33, 16, v33
v_mul_u32_u24 v34, 20, v33
v_sub_u32 v34, v32, v34
v_mul_u32_u24 v33, 3840, v33
v_lshl_add_u32 v11, v34, 4, v33
v_and_b32 v32, 31, v1
v_lshrrev_b32 v33, 5, v1
v_bfe_u32 v34, v32, 1, 3
v_xor_b32 v34, v34, v33
v_lshlrev_b32 v34, 4, v34
v_lshl_add_u32 v35, v32, 7, v34
v_add_u32 v16, s53, v35
v_xor_b32 v17, 32, v16
v_xor_b32 v18, 64, v16
v_xor_b32 v19, 96, v16
v_lshlrev_b32 v22, 4, v1
v_lshlrev_b32 v29, 4, v33
v_add_u32 v29, 131072, v29
v_mov_b32 v32, 0x3f803f80
v_lshlrev_b32 v33, 2, v1
v_add_u32 v33, 131072, v33
ds_write_b32 v33, v32 offset:29952
v_bfe_u32 v32, v1, 2, 2
v_lshrrev_b32 v33, 5, v1
v_lshl_add_u32 v32, v33, 3, v32
v_bfe_u32 v34, v1, 4, 1
v_and_b32 v35, 3, v1
v_lshlrev_b32 v35, 3, v35
v_mul_u32_u24 v32, 320, v32
v_mul_u32_u24 v34, 160, v34
v_add3_u32 v20, v32, v34, v35
v_add_u32 v21, 49408, v20
v_bfe_u32 v32, v1, 2, 2
v_lshrrev_b32 v33, 5, v1
v_lshl_add_u32 v32, v33, 3, v32
v_bfe_u32 v34, v1, 4, 1
v_and_b32 v35, 3, v1
v_lshlrev_b32 v35, 3, v35
v_mul_u32_u24 v32, 320, v32
v_mul_u32_u24 v34, 160, v34
v_add3_u32 v84, v32, v34, v35
v_add_u32 v85, 49408, v84
s_add_u32 m0, s53, 4096
s_add_u32 s75, s56, 128
buffer_load_dwordx4 v12, s[8:11], s75 offen lds
buffer_load_dwordx4 v13, s[8:11], s75 offen offset:1024 lds
buffer_load_dwordx4 v14, s[8:11], s75 offen offset:2048 lds
buffer_load_dwordx4 v15, s[8:11], s75 offen offset:3072 lds
s_add_u32 s74, s54, 245760
s_add_u32 m0, s52, 24704
s_nop 0
buffer_load_dwordx4 v2, s[12:15], s74 offen lds
buffer_load_dwordx4 v3, s[12:15], s74 offen offset:1024 lds
buffer_load_dwordx4 v4, s[12:15], s74 offen offset:2048 lds
buffer_load_dwordx4 v5, s[12:15], s74 offen offset:3072 lds
s_add_u32 m0, s52, 28800
s_nop 0
buffer_load_dwordx4 v6, s[12:15], s74 offen lds
s_cmp_eq_u32 s48, 0
s_cselect_b32 s60, 0, 2147483647
v_mov_b32 v32, 0
buffer_load_dword v30, v32, s[28:31], s60 offen sc1
s_waitcnt vmcnt(12)
s_barrier
ds_read_b128 a[0:3], v16 offset:0
ds_read_b128 a[4:7], v17 offset:0
ds_read_b128 a[8:11], v18 offset:0
ds_read_b128 a[12:15], v19 offset:0
ds_read_b64_tr_b16 a[160:161], v20 offset:0
ds_read_b64_tr_b16 a[162:163], v20 offset:1280
ds_read_b64_tr_b16 a[164:165], v20 offset:32
ds_read_b64_tr_b16 a[166:167], v20 offset:1312
ds_read_b64_tr_b16 a[168:169], v20 offset:64
ds_read_b64_tr_b16 a[170:171], v20 offset:1344
ds_read_b64_tr_b16 a[172:173], v20 offset:96
ds_read_b64_tr_b16 a[174:175], v20 offset:1376
ds_read_b64_tr_b16 a[176:177], v20 offset:128
ds_read_b64_tr_b16 a[178:179], v20 offset:1408
ds_read_b64_tr_b16 a[184:185], v20 offset:5120
ds_read_b64_tr_b16 a[186:187], v20 offset:6400
ds_read_b64_tr_b16 a[188:189], v20 offset:5152
ds_read_b64_tr_b16 a[190:191], v20 offset:6432
ds_read_b64_tr_b16 a[192:193], v20 offset:5184
ds_read_b64_tr_b16 a[194:195], v20 offset:6464
ds_read_b64_tr_b16 a[196:197], v20 offset:5216
ds_read_b64_tr_b16 a[198:199], v20 offset:6496
ds_read_b64_tr_b16 a[200:201], v20 offset:5248
ds_read_b64_tr_b16 a[202:203], v20 offset:6528
s_waitcnt lgkmcnt(10)
v_mfma_f32_32x32x16_bf16 v[96:111], a[0:3], a[160:163], 0
ds_read_b64_tr_b16 a[208:209], v20 offset:10240
ds_read_b64_tr_b16 a[210:211], v20 offset:11520
s_add_u32 m0, s53, 8192
s_add_u32 s75, s56, 256
buffer_load_dwordx4 v12, s[8:11], s75 offen lds
v_mfma_f32_32x32x16_bf16 v[112:127], a[0:3], a[164:167], 0
ds_read_b64_tr_b16 a[212:213], v20 offset:10272
ds_read_b64_tr_b16 a[214:215], v20 offset:11552
buffer_load_dwordx4 v13, s[8:11], s75 offen offset:1024 lds
v_mfma_f32_32x32x16_bf16 v[128:143], a[0:3], a[168:171], 0
ds_read_b64_tr_b16 a[216:217], v20 offset:10304
ds_read_b64_tr_b16 a[218:219], v20 offset:11584
buffer_load_dwordx4 v14, s[8:11], s75 offen offset:2048 lds
v_mfma_f32_32x32x16_bf16 v[144:159], a[0:3], a[172:175], 0
ds_read_b64_tr_b16 a[220:221], v20 offset:10336
ds_read_b64_tr_b16 a[222:223], v20 offset:11616
buffer_load_dwordx4 v15, s[8:11], s75 offen offset:3072 lds
v_mfma_f32_32x32x16_bf16 v[160:175], a[0:3], a[176:179], 0
ds_read_b64_tr_b16 a[224:225], v20 offset:10368
ds_read_b64_tr_b16 a[226:227], v20 offset:11648
s_waitcnt lgkmcnt(10)
v_mfma_f32_32x32x16_bf16 v[96:111], a[4:7], a[184:187], v[96:111]
ds_read_b64_tr_b16 a[160:161], v20 offset:15360
ds_read_b64_tr_b16 a[162:163], v20 offset:16640
s_add_u32 s74, s54, 491520
s_add_u32 m0, s52, 49408
s_nop 0
buffer_load_dwordx4 v2, s[12:15], s74 offen lds
v_mfma_f32_32x32x16_bf16 v[112:127], a[4:7], a[188:191], v[112:127]
ds_read_b64_tr_b16 a[164:165], v20 offset:15392
ds_read_b64_tr_b16 a[166:167], v20 offset:16672
v_mfma_f32_32x32x16_bf16 v[128:143], a[4:7], a[192:195], v[128:143]
ds_read_b64_tr_b16 a[168:169], v20 offset:15424
ds_read_b64_tr_b16 a[170:171], v20 offset:16704
buffer_load_dwordx4 v3, s[12:15], s74 offen offset:1024 lds
v_mfma_f32_32x32x16_bf16 v[144:159], a[4:7], a[196:199], v[144:159]
ds_read_b64_tr_b16 a[172:173], v20 offset:15456
ds_read_b64_tr_b16 a[174:175], v20 offset:16736
v_mfma_f32_32x32x16_bf16 v[160:175], a[4:7], a[200:203], v[160:175]
ds_read_b64_tr_b16 a[176:177], v20 offset:15488
ds_read_b64_tr_b16 a[178:179], v20 offset:16768
buffer_load_dwordx4 v4, s[12:15], s74 offen offset:2048 lds
v_lshrrev_b32 v32, 5, v1
s_lshl_b32 s60, s50, 3
s_lshl_b32 s61, s48, 1
s_add_u32 s60, s60, s61
v_add_u32 v32, s60, v32
v_mul_u32_u24 v33, 1280, v32
v_and_b32 v34, 31, v1
v_lshl_add_u32 v33, v34, 3, v33
buffer_load_dwordx2 v[192:193], v33, s[8:11], 0 offen
s_waitcnt vmcnt(9)
s_barrier
s_waitcnt lgkmcnt(10)
v_mfma_f32_32x32x16_bf16 v[96:111], a[8:11], a[208:211], v[96:111]
ds_read_b64_tr_b16 a[184:185], v20 offset:24704
ds_read_b64_tr_b16 a[186:187], v20 offset:25984
ds_read_b128 a[16:19], v16 offset:4096
buffer_load_dwordx4 v5, s[12:15], s74 offen offset:3072 lds
buffer_load_dwordx2 v[194:195], v33, s[8:11], 0 offen offset:256
buffer_load_dwordx2 v[196:197], v33, s[8:11], 0 offen offset:512
buffer_load_dwordx2 v[198:199], v33, s[8:11], 0 offen offset:768
buffer_load_dwordx2 v[200:201], v33, s[8:11], 0 offen offset:1024
s_and_b32 s63, s48, 1
s_cmp_eq_u32 s63, 0
s_cselect_b32 s68, s6, s6
s_cselect_b32 s69, s7, s7
s_cselect_b32 s70, s64, s65
s_cselect_b32 s71, s6, s6
s_cselect_b32 s72, s7, s7
s_cselect_b32 s73, s66, s67
s_cmp_lt_u32 s48, 2
s_cselect_b32 s68, s68, s71
s_cselect_b32 s69, s69, s72
s_cselect_b32 s70, s70, s73
s_mov_b32 s73, 2457600
s_cselect_b32 s71, 2457600, s73
s_mov_b32 s73, 3840
s_cselect_b32 s72, 3840, s73
s_cselect_b32 s73, 10, 10
s_add_u32 s20, s68, s70
s_addc_u32 s21, s69, 0
s_sub_u32 s22, s71, s70
s_mov_b32 s23, 0x20000
v_and_b32 v36, 15, v1
v_lshrrev_b32 v37, 4, v1
s_mul_i32 s60, s72, 10
v_mul_lo_u32 v37, s60, v37
v_lshl_add_u32 v37, v36, 4, v37
v_cmp_gt_u32 vcc, s73, v36
s_nop 1
v_cndmask_b32 v37, v31, v37, vcc
s_mul_i32 s96, s49, 40
s_mul_i32 s96, s96, s72
buffer_load_dwordx4 v[204:207], v37, s[20:23], s96 offen
v_mfma_f32_32x32x16_bf16 v[112:127], a[8:11], a[212:215], v[112:127]
ds_read_b64_tr_b16 a[188:189], v20 offset:24736
ds_read_b64_tr_b16 a[190:191], v20 offset:26016
ds_read_b128 a[20:23], v17 offset:4096
s_add_u32 m0, s52, 53504
s_nop 0
buffer_load_dwordx4 v6, s[12:15], s74 offen lds
s_add_u32 s96, s96, s72
buffer_load_dwordx4 v[208:211], v37, s[20:23], s96 offen
s_add_u32 s96, s96, s72
buffer_load_dwordx4 v[212:215], v37, s[20:23], s96 offen
v_mfma_f32_32x32x16_bf16 v[128:143], a[8:11], a[216:219], v[128:143]
ds_read_b64_tr_b16 a[192:193], v20 offset:24768
ds_read_b64_tr_b16 a[194:195], v20 offset:26048
ds_read_b128 a[24:27], v18 offset:4096
s_add_u32 s96, s96, s72
buffer_load_dwordx4 v[216:219], v37, s[20:23], s96 offen
s_add_u32 s96, s96, s72
buffer_load_dwordx4 v[220:223], v37, s[20:23], s96 offen
s_add_u32 s96, s96, s72
buffer_load_dwordx4 v[224:227], v37, s[20:23], s96 offen
v_mfma_f32_32x32x16_bf16 v[144:159], a[8:11], a[220:223], v[144:159]
ds_read_b64_tr_b16 a[196:197], v20 offset:24800
ds_read_b64_tr_b16 a[198:199], v20 offset:26080
ds_read_b128 a[28:31], v19 offset:4096
s_add_u32 m0, s53, 0
s_add_u32 s75, s56, 384
buffer_load_dwordx4 v12, s[8:11], s75 offen lds
s_add_u32 s96, s96, s72
buffer_load_dwordx4 v[228:231], v37, s[20:23], s96 offen
s_add_u32 s96, s96, s72
buffer_load_dwordx4 v[232:235], v37, s[20:23], s96 offen
v_mfma_f32_32x32x16_bf16 v[160:175], a[8:11], a[224:227], v[160:175]
ds_read_b64_tr_b16 a[200:201], v20 offset:24832
ds_read_b64_tr_b16 a[202:203], v20 offset:26112
s_add_u32 s96, s96, s72
buffer_load_dwordx4 v[236:239], v37, s[20:23], s96 offen
s_add_u32 s96, s96, s72
buffer_load_dwordx4 v[240:243], v37, s[20:23], s96 offen
s_lshl_b32 s60, s49, 4
s_add_u32 s60, s60, s50
s_lshl_b32 s60, s60, 2
s_add_u32 s60, s60, s48
s_lshl_b32 s60, s60, 7
s_add_u32 s60, s60, 14680064
v_add_u32 v32, s60, v22
v_cmp_gt_u32 vcc, 8, v1
s_nop 1
v_cndmask_b32 v95, v31, v32, vcc
s_lshl_b32 s60, s50, 4
s_add_u32 s60, s60, s49
s_lshl_b32 s60, s60, 2
s_add_u32 s60, s60, s48
s_lshl_b32 s60, s60, 9
s_add_u32 s60, s60, 15728640
v_add_u32 v34, s60, v22
v_cmp_gt_u32 vcc, 32, v1
s_nop 1
v_cndmask_b32 v94, v31, v34, vcc
s_waitcnt lgkmcnt(14)
v_mfma_f32_32x32x16_bf16 v[96:111], a[12:15], a[160:163], v[96:111]
ds_read_b64_tr_b16 a[208:209], v20 offset:29824
ds_read_b64_tr_b16 a[210:211], v20 offset:31104
buffer_load_dwordx4 v13, s[8:11], s75 offen offset:1024 lds
v_mfma_f32_32x32x16_bf16 v[112:127], a[12:15], a[164:167], v[112:127]
ds_read_b64_tr_b16 a[212:213], v20 offset:29856
ds_read_b64_tr_b16 a[214:215], v20 offset:31136
v_mfma_f32_32x32x16_bf16 v[128:143], a[12:15], a[168:171], v[128:143]
ds_read_b64_tr_b16 a[216:217], v20 offset:29888
ds_read_b64_tr_b16 a[218:219], v20 offset:31168
buffer_load_dwordx4 v14, s[8:11], s75 offen offset:2048 lds
v_mfma_f32_32x32x16_bf16 v[144:159], a[12:15], a[172:175], v[144:159]
ds_read_b64_tr_b16 a[220:221], v20 offset:29920
ds_read_b64_tr_b16 a[222:223], v20 offset:31200
v_mfma_f32_32x32x16_bf16 v[160:175], a[12:15], a[176:179], v[160:175]
ds_read_b64_tr_b16 a[224:225], v20 offset:29952
ds_read_b64_tr_b16 a[226:227], v20 offset:31232
buffer_load_dwordx4 v15, s[8:11], s75 offen offset:3072 lds
s_waitcnt lgkmcnt(10)
v_mfma_f32_32x32x16_bf16 v[96:111], a[16:19], a[184:187], v[96:111]
ds_read_b64_tr_b16 a[160:161], v20 offset:34944
ds_read_b64_tr_b16 a[162:163], v20 offset:36224
v_mfma_f32_32x32x16_bf16 v[112:127], a[16:19], a[188:191], v[112:127]
ds_read_b64_tr_b16 a[164:165], v20 offset:34976
ds_read_b64_tr_b16 a[166:167], v20 offset:36256
s_add_u32 s74, s54, 737280
s_add_u32 m0, s52, 74112
s_nop 0
buffer_load_dwordx4 v2, s[12:15], s74 offen lds
v_mfma_f32_32x32x16_bf16 v[128:143], a[16:19], a[192:195], v[128:143]
ds_read_b64_tr_b16 a[168:169], v20 offset:35008
ds_read_b64_tr_b16 a[170:171], v20 offset:36288
v_mfma_f32_32x32x16_bf16 v[144:159], a[16:19], a[196:199], v[144:159]
ds_read_b64_tr_b16 a[172:173], v20 offset:35040
ds_read_b64_tr_b16 a[174:175], v20 offset:36320
buffer_load_dwordx4 v3, s[12:15], s74 offen offset:1024 lds
v_mfma_f32_32x32x16_bf16 v[160:175], a[16:19], a[200:203], v[160:175]
ds_read_b64_tr_b16 a[176:177], v20 offset:35072
ds_read_b64_tr_b16 a[178:179], v20 offset:36352
s_waitcnt lgkmcnt(10)
v_mfma_f32_32x32x16_bf16 v[96:111], a[20:23], a[208:211], v[96:111]
ds_read_b64_tr_b16 a[184:185], v20 offset:40064
ds_read_b64_tr_b16 a[186:187], v20 offset:41344
buffer_load_dwordx4 v4, s[12:15], s74 offen offset:2048 lds
v_mfma_f32_32x32x16_bf16 v[112:127], a[20:23], a[212:215], v[112:127]
ds_read_b64_tr_b16 a[188:189], v20 offset:40096
ds_read_b64_tr_b16 a[190:191], v20 offset:41376
v_mfma_f32_32x32x16_bf16 v[128:143], a[20:23], a[216:219], v[128:143]
ds_read_b64_tr_b16 a[192:193], v20 offset:40128
ds_read_b64_tr_b16 a[194:195], v20 offset:41408
buffer_load_dwordx4 v5, s[12:15], s74 offen offset:3072 lds
v_mfma_f32_32x32x16_bf16 v[144:159], a[20:23], a[220:223], v[144:159]
ds_read_b64_tr_b16 a[196:197], v20 offset:40160
ds_read_b64_tr_b16 a[198:199], v20 offset:41440
v_mfma_f32_32x32x16_bf16 v[160:175], a[20:23], a[224:227], v[160:175]
ds_read_b64_tr_b16 a[200:201], v20 offset:40192
ds_read_b64_tr_b16 a[202:203], v20 offset:41472
s_add_u32 m0, s52, 78208
s_nop 0
buffer_load_dwordx4 v6, s[12:15], s74 offen lds
s_waitcnt vmcnt(18)
s_barrier
s_waitcnt lgkmcnt(10)
v_mfma_f32_32x32x16_bf16 v[96:111], a[24:27], a[160:163], v[96:111]
ds_read_b64_tr_b16 a[208:209], v21 offset:0
ds_read_b64_tr_b16 a[210:211], v21 offset:1280
ds_read_b128 a[32:35], v16 offset:8192
v_mfma_f32_32x32x16_bf16 v[112:127], a[24:27], a[164:167], v[112:127]
ds_read_b64_tr_b16 a[212:213], v21 offset:32
ds_read_b64_tr_b16 a[214:215], v21 offset:1312
ds_read_b128 a[36:39], v17 offset:8192
s_add_u32 m0, s53, 4096
s_add_u32 s75, s56, 512
buffer_load_dwordx4 v12, s[8:11], s75 offen lds
v_mfma_f32_32x32x16_bf16 v[128:143], a[24:27], a[168:171], v[128:143]
ds_read_b64_tr_b16 a[216:217], v21 offset:64
ds_read_b64_tr_b16 a[218:219], v21 offset:1344
ds_read_b128 a[40:43], v18 offset:8192
v_mfma_f32_32x32x16_bf16 v[144:159], a[24:27], a[172:175], v[144:159]
ds_read_b64_tr_b16 a[220:221], v21 offset:96
ds_read_b64_tr_b16 a[222:223], v21 offset:1376
ds_read_b128 a[44:47], v19 offset:8192
buffer_load_dwordx4 v13, s[8:11], s75 offen offset:1024 lds
v_mfma_f32_32x32x16_bf16 v[160:175], a[24:27], a[176:179], v[160:175]
ds_read_b64_tr_b16 a[224:225], v21 offset:128
ds_read_b64_tr_b16 a[226:227], v21 offset:1408
s_waitcnt lgkmcnt(14)
v_mfma_f32_32x32x16_bf16 v[96:111], a[28:31], a[184:187], v[96:111]
ds_read_b64_tr_b16 a[160:161], v21 offset:5120
ds_read_b64_tr_b16 a[162:163], v21 offset:6400
buffer_load_dwordx4 v14, s[8:11], s75 offen offset:2048 lds
v_mfma_f32_32x32x16_bf16 v[112:127], a[28:31], a[188:191], v[112:127]
ds_read_b64_tr_b16 a[164:165], v21 offset:5152
ds_read_b64_tr_b16 a[166:167], v21 offset:6432
v_mfma_f32_32x32x16_bf16 v[128:143], a[28:31], a[192:195], v[128:143]
ds_read_b64_tr_b16 a[168:169], v21 offset:5184
ds_read_b64_tr_b16 a[170:171], v21 offset:6464
buffer_load_dwordx4 v15, s[8:11], s75 offen offset:3072 lds
v_mfma_f32_32x32x16_bf16 v[144:159], a[28:31], a[196:199], v[144:159]
ds_read_b64_tr_b16 a[172:173], v21 offset:5216
ds_read_b64_tr_b16 a[174:175], v21 offset:6496
v_mfma_f32_32x32x16_bf16 v[160:175], a[28:31], a[200:203], v[160:175]
ds_read_b64_tr_b16 a[176:177], v21 offset:5248
ds_read_b64_tr_b16 a[178:179], v21 offset:6528
s_add_u32 s74, s54, 983040
s_add_u32 m0, s52, 0
s_nop 0
buffer_load_dwordx4 v2, s[12:15], s74 offen lds
v_mov_b32 v32, 0
v_mov_b32 v33, 0
v_mov_b32 v34, 0
s_waitcnt lgkmcnt(10)
v_mfma_f32_32x32x16_bf16 v[96:111], a[32:35], a[208:211], v[96:111]
ds_read_b64_tr_b16 a[184:185], v21 offset:10240
ds_read_b64_tr_b16 a[186:187], v21 offset:11520
v_mov_b32 v35, 0
v_lshlrev_b32 v36, 16, v192
v_and_b32 v37, 0xffff0000, v192
v_add_f32 v32, v32, v36
v_add_f32 v33, v33, v37
v_fmac_f32 v34, v36, v36
v_fmac_f32 v35, v37, v37
v_mfma_f32_32x32x16_bf16 v[112:127], a[32:35], a[212:215], v[112:127]
ds_read_b64_tr_b16 a[188:189], v21 offset:10272
ds_read_b64_tr_b16 a[190:191], v21 offset:11552
buffer_load_dwordx4 v3, s[12:15], s74 offen offset:1024 lds
v_lshlrev_b32 v36, 16, v193
v_and_b32 v37, 0xffff0000, v193
v_add_f32 v32, v32, v36
v_add_f32 v33, v33, v37
v_fmac_f32 v34, v36, v36
v_fmac_f32 v35, v37, v37
v_mfma_f32_32x32x16_bf16 v[128:143], a[32:35], a[216:219], v[128:143]
ds_read_b64_tr_b16 a[192:193], v21 offset:10304
ds_read_b64_tr_b16 a[194:195], v21 offset:11584
v_lshlrev_b32 v36, 16, v194
v_and_b32 v37, 0xffff0000, v194
v_add_f32 v32, v32, v36
v_add_f32 v33, v33, v37
v_fmac_f32 v34, v36, v36
v_fmac_f32 v35, v37, v37
v_lshlrev_b32 v36, 16, v195
v_mfma_f32_32x32x16_bf16 v[144:159], a[32:35], a[220:223], v[144:159]
ds_read_b64_tr_b16 a[196:197], v21 offset:10336
ds_read_b64_tr_b16 a[198:199], v21 offset:11616
buffer_load_dwordx4 v4, s[12:15], s74 offen offset:2048 lds
v_and_b32 v37, 0xffff0000, v195
v_add_f32 v32, v32, v36
v_add_f32 v33, v33, v37
v_fmac_f32 v34, v36, v36
v_fmac_f32 v35, v37, v37
v_lshlrev_b32 v36, 16, v196
v_mfma_f32_32x32x16_bf16 v[160:175], a[32:35], a[224:227], v[160:175]
ds_read_b64_tr_b16 a[200:201], v21 offset:10368
ds_read_b64_tr_b16 a[202:203], v21 offset:11648
v_and_b32 v37, 0xffff0000, v196
v_add_f32 v32, v32, v36
v_add_f32 v33, v33, v37
v_fmac_f32 v34, v36, v36
v_fmac_f32 v35, v37, v37
v_lshlrev_b32 v36, 16, v197
v_and_b32 v37, 0xffff0000, v197
s_waitcnt lgkmcnt(10)
v_mfma_f32_32x32x16_bf16 v[96:111], a[36:39], a[160:163], v[96:111]
ds_read_b64_tr_b16 a[208:209], v21 offset:15360
ds_read_b64_tr_b16 a[210:211], v21 offset:16640
buffer_load_dwordx4 v5, s[12:15], s74 offen offset:3072 lds
v_add_f32 v32, v32, v36
v_add_f32 v33, v33, v37
v_fmac_f32 v34, v36, v36
v_fmac_f32 v35, v37, v37
v_lshlrev_b32 v36, 16, v198
v_and_b32 v37, 0xffff0000, v198
v_mfma_f32_32x32x16_bf16 v[112:127], a[36:39], a[164:167], v[112:127]
ds_read_b64_tr_b16 a[212:213], v21 offset:15392
ds_read_b64_tr_b16 a[214:215], v21 offset:16672
v_add_f32 v32, v32, v36
v_add_f32 v33, v33, v37
v_fmac_f32 v34, v36, v36
v_fmac_f32 v35, v37, v37
v_lshlrev_b32 v36, 16, v199
v_and_b32 v37, 0xffff0000, v199
v_add_f32 v32, v32, v36
v_mfma_f32_32x32x16_bf16 v[128:143], a[36:39], a[168:171], v[128:143]
ds_read_b64_tr_b16 a[216:217], v21 offset:15424
ds_read_b64_tr_b16 a[218:219], v21 offset:16704
s_add_u32 m0, s52, 4096
s_nop 0
buffer_load_dwordx4 v6, s[12:15], s74 offen lds
v_add_f32 v33, v33, v37
v_fmac_f32 v34, v36, v36
v_fmac_f32 v35, v37, v37
v_lshlrev_b32 v36, 16, v200
v_mfma_f32_32x32x16_bf16 v[144:159], a[36:39], a[172:175], v[144:159]
ds_read_b64_tr_b16 a[220:221], v21 offset:15456
ds_read_b64_tr_b16 a[222:223], v21 offset:16736
v_and_b32 v37, 0xffff0000, v200
v_add_f32 v32, v32, v36
v_add_f32 v33, v33, v37
v_fmac_f32 v34, v36, v36
v_fmac_f32 v35, v37, v37
v_lshlrev_b32 v36, 16, v201
v_and_b32 v37, 0xffff0000, v201
v_mfma_f32_32x32x16_bf16 v[160:175], a[36:39], a[176:179], v[160:175]
ds_read_b64_tr_b16 a[224:225], v21 offset:15488
ds_read_b64_tr_b16 a[226:227], v21 offset:16768
s_add_u32 m0, s53, 8192
s_add_u32 s75, s56, 640
buffer_load_dwordx4 v12, s[8:11], s75 offen lds
v_add_f32 v32, v32, v36
v_add_f32 v33, v33, v37
v_fmac_f32 v34, v36, v36
v_fmac_f32 v35, v37, v37
s_waitcnt vmcnt(10)
s_barrier
s_waitcnt lgkmcnt(10)
v_mfma_f32_32x32x16_bf16 v[96:111], a[40:43], a[184:187], v[96:111]
ds_read_b64_tr_b16 a[160:161], v21 offset:24704
ds_read_b64_tr_b16 a[162:163], v21 offset:25984
ds_read_b128 a[48:51], v16 offset:0
v_add_f32 v32, v32, v33
v_add_f32 v34, v34, v35
s_nop 0
v_add_f32_dpp v33, v32, v32 row_ror:8 row_mask:0xf bank_mask:0xf
v_add_f32_dpp v35, v34, v34 row_ror:8 row_mask:0xf bank_mask:0xf
s_nop 0
v_add_f32_dpp v32, v33, v33 row_ror:4 row_mask:0xf bank_mask:0xf
v_add_f32_dpp v34, v35, v35 row_ror:4 row_mask:0xf bank_mask:0xf
v_mfma_f32_32x32x16_bf16 v[112:127], a[40:43], a[188:191], v[112:127]
ds_read_b64_tr_b16 a[164:165], v21 offset:24736
ds_read_b64_tr_b16 a[166:167], v21 offset:26016
ds_read_b128 a[52:55], v17 offset:0
buffer_load_dwordx4 v13, s[8:11], s75 offen offset:1024 lds
v_add_f32_dpp v33, v32, v32 row_ror:2 row_mask:0xf bank_mask:0xf
v_add_f32_dpp v35, v34, v34 row_ror:2 row_mask:0xf bank_mask:0xf
s_nop 0
v_add_f32_dpp v32, v33, v33 row_ror:1 row_mask:0xf bank_mask:0xf
v_add_f32_dpp v34, v35, v35 row_ror:1 row_mask:0xf bank_mask:0xf
v_mov_b32 v33, v32
v_mfma_f32_32x32x16_bf16 v[128:143], a[40:43], a[192:195], v[128:143]
ds_read_b64_tr_b16 a[168:169], v21 offset:24768
ds_read_b64_tr_b16 a[170:171], v21 offset:26048
ds_read_b128 a[56:59], v18 offset:0
v_mov_b32 v35, v34
v_permlane16_swap_b32 v32, v33
s_nop 0
v_permlane16_swap_b32 v34, v35
v_add_f32 v32, v32, v33
v_add_f32 v34, v34, v35
v_mul_f32 v32, 0x3acccccd, v32
v_mfma_f32_32x32x16_bf16 v[144:159], a[40:43], a[196:199], v[144:159]
ds_read_b64_tr_b16 a[172:173], v21 offset:24800
ds_read_b64_tr_b16 a[174:175], v21 offset:26080
ds_read_b128 a[60:63], v19 offset:0
buffer_load_dwordx4 v14, s[8:11], s75 offen offset:2048 lds
v_mul_f32 v34, 0x3acccccd, v34
v_fma_f32 v34, -v32, v32, v34
v_max_f32 v34, 0, v34
v_add_f32 v34, 0x3727c5ac, v34
v_rsq_f32 v33, v34
v_mfma_f32_32x32x16_bf16 v[160:175], a[40:43], a[200:203], v[160:175]
ds_read_b64_tr_b16 a[176:177], v21 offset:24832
ds_read_b64_tr_b16 a[178:179], v21 offset:26112
v_mov_b32 v34, v32
v_mov_b32 v36, v32
v_and_b32 v38, 1, v1
v_mov_b32 v35, v33
v_mov_b32 v37, v33
v_permlane32_swap_b32 v36, v34
s_nop 0
v_permlane32_swap_b32 v37, v35
s_waitcnt lgkmcnt(14)
v_mfma_f32_32x32x16_bf16 v[96:111], a[44:47], a[208:211], v[96:111]
ds_read_b64_tr_b16 a[184:185], v21 offset:29824
ds_read_b64_tr_b16 a[186:187], v21 offset:31104
buffer_load_dwordx4 v15, s[8:11], s75 offen offset:3072 lds
v_cmp_eq_u32 vcc, 1, v38
s_nop 1
v_cndmask_b32 v32, v32, v34, vcc
v_cndmask_b32 v33, v33, v35, vcc
v_mov_b32 v30, v30
s_cmp_lg_u32 s48, 0
s_cbranch_scc1 NOKKV
v_subrev_u32 v39, s92, v30
v_and_b32 v40, 1, v30
v_cmp_lt_u32 vcc, 0x40000000, v39
v_cmp_eq_u32 s[82:83], 0, v40
s_nop 3
s_or_b64 vcc, vcc, s[82:83]
s_cbranch_vccz NWRKV
s_mov_b32 s68, 4000
v_mov_b32 v38, 0
NSPKV:
s_sleep 8
buffer_load_dword v30, v38, s[28:31], 0 offen sc1
s_waitcnt vmcnt(0)
v_subrev_u32 v39, s92, v30
v_and_b32 v40, 1, v30
v_cmp_lt_u32 vcc, 0x40000000, v39
v_cmp_eq_u32 s[82:83], 0, v40
s_nop 3
s_or_b64 vcc, vcc, s[82:83]
s_sub_u32 s68, s68, 1
s_cbranch_vccz NWRKV
s_cmp_lg_u32 s68, 0
s_cbranch_scc1 NSPKV
NWRKV:
v_mov_b32 v38, 131072
ds_write_b32 v38, v30 offset:30208
s_waitcnt lgkmcnt(0)
NOKKV:
s_barrier
v_mov_b32 v38, 131072
ds_read_b32 v30, v38 offset:30208
v_mfma_f32_32x32x16_bf16 v[112:127], a[44:47], a[212:215], v[112:127]
ds_read_b64_tr_b16 a[188:189], v21 offset:29856
ds_read_b64_tr_b16 a[190:191], v21 offset:31136
s_waitcnt lgkmcnt(2)
v_mov_b32 v34, v30
v_mov_b32 v35, v30
buffer_store_dwordx4 v[32:35], v95, s[24:27], 0 offen sc1
v_lshlrev_b32 v244, 16, v204
v_and_b32 v245, 0xffff0000, v204
v_lshlrev_b32 v246, 16, v205
v_and_b32 v247, 0xffff0000, v205
v_mfma_f32_32x32x16_bf16 v[128:143], a[44:47], a[216:219], v[128:143]
ds_read_b64_tr_b16 a[192:193], v21 offset:29888
ds_read_b64_tr_b16 a[194:195], v21 offset:31168
s_add_u32 s74, s54, 1228800
s_add_u32 m0, s52, 24704
s_nop 0
buffer_load_dwordx4 v2, s[12:15], s74 offen lds
v_lshlrev_b32 v248, 16, v206
v_and_b32 v249, 0xffff0000, v206
v_lshlrev_b32 v250, 16, v207
v_mfma_f32_32x32x16_bf16 v[144:159], a[44:47], a[220:223], v[144:159]
ds_read_b64_tr_b16 a[196:197], v21 offset:29920
ds_read_b64_tr_b16 a[198:199], v21 offset:31200
v_and_b32 v251, 0xffff0000, v207
v_lshlrev_b32 v192, 16, v208
v_and_b32 v193, 0xffff0000, v208
v_add_f32 v244, v244, v192
v_add_f32 v245, v245, v193
v_lshlrev_b32 v194, 16, v209
v_and_b32 v195, 0xffff0000, v209
v_mfma_f32_32x32x16_bf16 v[160:175], a[44:47], a[224:227], v[160:175]
ds_read_b64_tr_b16 a[200:201], v21 offset:29952
ds_read_b64_tr_b16 a[202:203], v21 offset:31232
buffer_load_dwordx4 v3, s[12:15], s74 offen offset:1024 lds
v_add_f32 v246, v246, v194
v_add_f32 v247, v247, v195
v_lshlrev_b32 v196, 16, v210
v_and_b32 v197, 0xffff0000, v210
v_add_f32 v248, v248, v196
v_add_f32 v249, v249, v197
v_mfma_f32_32x32x16_bf16 v[96:111], a[48:51], a[160:163], v[96:111]
ds_read_b64_tr_b16 a[208:209], v21 offset:34944
ds_read_b64_tr_b16 a[210:211], v21 offset:36224
v_lshlrev_b32 v198, 16, v211
v_and_b32 v199, 0xffff0000, v211
v_add_f32 v250, v250, v198
v_add_f32 v251, v251, v199
v_lshlrev_b32 v192, 16, v212
v_and_b32 v193, 0xffff0000, v212
v_add_f32 v244, v244, v192
v_mfma_f32_32x32x16_bf16 v[112:127], a[48:51], a[164:167], v[112:127]
ds_read_b64_tr_b16 a[212:213], v21 offset:34976
ds_read_b64_tr_b16 a[214:215], v21 offset:36256
buffer_load_dwordx4 v4, s[12:15], s74 offen offset:2048 lds
v_add_f32 v245, v245, v193
v_lshlrev_b32 v194, 16, v213
v_and_b32 v195, 0xffff0000, v213
v_add_f32 v246, v246, v194
v_add_f32 v247, v247, v195
v_lshlrev_b32 v196, 16, v214
v_mfma_f32_32x32x16_bf16 v[128:143], a[48:51], a[168:171], v[128:143]
ds_read_b64_tr_b16 a[216:217], v21 offset:35008
ds_read_b64_tr_b16 a[218:219], v21 offset:36288
v_and_b32 v197, 0xffff0000, v214
v_add_f32 v248, v248, v196
v_add_f32 v249, v249, v197
v_lshlrev_b32 v198, 16, v215
v_and_b32 v199, 0xffff0000, v215
v_add_f32 v250, v250, v198
v_add_f32 v251, v251, v199
v_mfma_f32_32x32x16_bf16 v[144:159], a[48:51], a[172:175], v[144:159]
ds_read_b64_tr_b16 a[220:221], v21 offset:35040
ds_read_b64_tr_b16 a[222:223], v21 offset:36320
buffer_load_dwordx4 v5, s[12:15], s74 offen offset:3072 lds
v_lshlrev_b32 v192, 16, v216
v_and_b32 v193, 0xffff0000, v216
v_add_f32 v244, v244, v192
v_add_f32 v245, v245, v193
v_lshlrev_b32 v194, 16, v217
v_and_b32 v195, 0xffff0000, v217
v_mfma_f32_32x32x16_bf16 v[160:175], a[48:51], a[176:179], v[160:175]
ds_read_b64_tr_b16 a[224:225], v21 offset:35072
ds_read_b64_tr_b16 a[226:227], v21 offset:36352
v_add_f32 v246, v246, v194
v_add_f32 v247, v247, v195
v_lshlrev_b32 v196, 16, v218
v_and_b32 v197, 0xffff0000, v218
v_add_f32 v248, v248, v196
v_add_f32 v249, v249, v197
v_lshlrev_b32 v198, 16, v219
s_waitcnt lgkmcnt(10)
v_mfma_f32_32x32x16_bf16 v[96:111], a[52:55], a[184:187], v[96:111]
ds_read_b64_tr_b16 a[160:161], v21 offset:40064
ds_read_b64_tr_b16 a[162:163], v21 offset:41344
s_add_u32 m0, s52, 28800
s_nop 0
buffer_load_dwordx4 v6, s[12:15], s74 offen lds
v_and_b32 v199, 0xffff0000, v219
v_add_f32 v250, v250, v198
v_add_f32 v251, v251, v199
v_lshlrev_b32 v192, 16, v220
v_mfma_f32_32x32x16_bf16 v[112:127], a[52:55], a[188:191], v[112:127]
ds_read_b64_tr_b16 a[164:165], v21 offset:40096
ds_read_b64_tr_b16 a[166:167], v21 offset:41376
v_and_b32 v193, 0xffff0000, v220
v_add_f32 v244, v244, v192
v_add_f32 v245, v245, v193
v_lshlrev_b32 v194, 16, v221
v_and_b32 v195, 0xffff0000, v221
v_add_f32 v246, v246, v194
v_add_f32 v247, v247, v195
v_mfma_f32_32x32x16_bf16 v[128:143], a[52:55], a[192:195], v[128:143]
ds_read_b64_tr_b16 a[168:169], v21 offset:40128
ds_read_b64_tr_b16 a[170:171], v21 offset:41408
s_add_u32 m0, s53, 0
s_add_u32 s75, s56, 768
buffer_load_dwordx4 v12, s[8:11], s75 offen lds
v_lshlrev_b32 v196, 16, v222
v_and_b32 v197, 0xffff0000, v222
v_add_f32 v248, v248, v196
v_add_f32 v249, v249, v197
v_mfma_f32_32x32x16_bf16 v[144:159], a[52:55], a[196:199], v[144:159]
ds_read_b64_tr_b16 a[172:173], v21 offset:40160
ds_read_b64_tr_b16 a[174:175], v21 offset:41440
v_lshlrev_b32 v198, 16, v223
v_and_b32 v199, 0xffff0000, v223
v_add_f32 v250, v250, v198
v_add_f32 v251, v251, v199
v_lshlrev_b32 v192, 16, v224
v_and_b32 v193, 0xffff0000, v224
v_add_f32 v244, v244, v192
v_mfma_f32_32x32x16_bf16 v[160:175], a[52:55], a[200:203], v[160:175]
ds_read_b64_tr_b16 a[176:177], v21 offset:40192
ds_read_b64_tr_b16 a[178:179], v21 offset:41472
buffer_load_dwordx4 v13, s[8:11], s75 offen offset:1024 lds
v_add_f32 v245, v245, v193
v_lshlrev_b32 v194, 16, v225
v_and_b32 v195, 0xffff0000, v225
v_add_f32 v246, v246, v194
v_add_f32 v247, v247, v195
v_lshlrev_b32 v196, 16, v226
s_waitcnt vmcnt(12)
s_barrier
s_waitcnt lgkmcnt(10)
v_mfma_f32_32x32x16_bf16 v[96:111], a[56:59], a[208:211], v[96:111]
ds_read_b64_tr_b16 a[184:185], v20 offset:0
ds_read_b64_tr_b16 a[186:187], v20 offset:1280
ds_read_b128 a[64:67], v16 offset:4096
v_and_b32 v197, 0xffff0000, v226
v_add_f32 v248, v248, v196
v_add_f32 v249, v249, v197
v_lshlrev_b32 v198, 16, v227
v_and_b32 v199, 0xffff0000, v227
v_add_f32 v250, v250, v198
v_mfma_f32_32x32x16_bf16 v[112:127], a[56:59], a[212:215], v[112:127]
ds_read_b64_tr_b16 a[188:189], v20 offset:32
ds_read_b64_tr_b16 a[190:191], v20 offset:1312
ds_read_b128 a[68:71], v17 offset:4096
buffer_load_dwordx4 v14, s[8:11], s75 offen offset:2048 lds
v_add_f32 v251, v251, v199
v_lshlrev_b32 v192, 16, v228
v_and_b32 v193, 0xffff0000, v228
v_add_f32 v244, v244, v192
v_add_f32 v245, v245, v193
v_mfma_f32_32x32x16_bf16 v[128:143], a[56:59], a[216:219], v[128:143]
ds_read_b64_tr_b16 a[192:193], v20 offset:64
ds_read_b64_tr_b16 a[194:195], v20 offset:1344
ds_read_b128 a[72:75], v18 offset:4096
v_lshlrev_b32 v194, 16, v229
v_and_b32 v195, 0xffff0000, v229
v_add_f32 v246, v246, v194
v_add_f32 v247, v247, v195
v_lshlrev_b32 v196, 16, v230
v_and_b32 v197, 0xffff0000, v230
v_mfma_f32_32x32x16_bf16 v[144:159], a[56:59], a[220:223], v[144:159]
ds_read_b64_tr_b16 a[196:197], v20 offset:96
ds_read_b64_tr_b16 a[198:199], v20 offset:1376
ds_read_b128 a[76:79], v19 offset:4096
buffer_load_dwordx4 v15, s[8:11], s75 offen offset:3072 lds
v_add_f32 v248, v248, v196
v_add_f32 v249, v249, v197
v_lshlrev_b32 v198, 16, v231
v_and_b32 v199, 0xffff0000, v231
v_add_f32 v250, v250, v198
v_mfma_f32_32x32x16_bf16 v[160:175], a[56:59], a[224:227], v[160:175]
ds_read_b64_tr_b16 a[200:201], v20 offset:128
ds_read_b64_tr_b16 a[202:203], v20 offset:1408
v_add_f32 v251, v251, v199
v_lshlrev_b32 v192, 16, v232
v_and_b32 v193, 0xffff0000, v232
v_add_f32 v244, v244, v192
v_add_f32 v245, v245, v193
v_lshlrev_b32 v194, 16, v233
v_and_b32 v195, 0xffff0000, v233
s_waitcnt lgkmcnt(14)
v_mfma_f32_32x32x16_bf16 v[96:111], a[60:63], a[160:163], v[96:111]
ds_read_b64_tr_b16 a[208:209], v20 offset:5120
ds_read_b64_tr_b16 a[210:211], v20 offset:6400
s_add_u32 s74, s54, 1474560
s_add_u32 m0, s52, 49408
s_nop 0
buffer_load_dwordx4 v2, s[12:15], s74 offen lds
v_add_f32 v246, v246, v194
v_add_f32 v247, v247, v195
v_lshlrev_b32 v196, 16, v234
v_mfma_f32_32x32x16_bf16 v[112:127], a[60:63], a[164:167], v[112:127]
ds_read_b64_tr_b16 a[212:213], v20 offset:5152
ds_read_b64_tr_b16 a[214:215], v20 offset:6432
v_and_b32 v197, 0xffff0000, v234
v_add_f32 v248, v248, v196
v_add_f32 v249, v249, v197
v_lshlrev_b32 v198, 16, v235
v_and_b32 v199, 0xffff0000, v235
v_add_f32 v250, v250, v198
v_add_f32 v251, v251, v199
v_mfma_f32_32x32x16_bf16 v[128:143], a[60:63], a[168:171], v[128:143]
ds_read_b64_tr_b16 a[216:217], v20 offset:5184
ds_read_b64_tr_b16 a[218:219], v20 offset:6464
buffer_load_dwordx4 v3, s[12:15], s74 offen offset:1024 lds
v_lshlrev_b32 v192, 16, v236
v_and_b32 v193, 0xffff0000, v236
v_add_f32 v244, v244, v192
v_add_f32 v245, v245, v193
v_lshlrev_b32 v194, 16, v237
v_and_b32 v195, 0xffff0000, v237
v_mfma_f32_32x32x16_bf16 v[144:159], a[60:63], a[172:175], v[144:159]
ds_read_b64_tr_b16 a[220:221], v20 offset:5216
ds_read_b64_tr_b16 a[222:223], v20 offset:6496
v_add_f32 v246, v246, v194
v_add_f32 v247, v247, v195
v_lshlrev_b32 v196, 16, v238
v_and_b32 v197, 0xffff0000, v238
v_add_f32 v248, v248, v196
v_add_f32 v249, v249, v197
v_lshlrev_b32 v198, 16, v239
v_mfma_f32_32x32x16_bf16 v[160:175], a[60:63], a[176:179], v[160:175]
ds_read_b64_tr_b16 a[224:225], v20 offset:5248
ds_read_b64_tr_b16 a[226:227], v20 offset:6528
buffer_load_dwordx4 v4, s[12:15], s74 offen offset:2048 lds
v_and_b32 v199, 0xffff0000, v239
v_add_f32 v250, v250, v198
v_add_f32 v251, v251, v199
v_lshlrev_b32 v192, 16, v240
v_and_b32 v193, 0xffff0000, v240
v_add_f32 v244, v244, v192
s_waitcnt lgkmcnt(10)
v_mfma_f32_32x32x16_bf16 v[96:111], a[64:67], a[184:187], v[96:111]
ds_read_b64_tr_b16 a[160:161], v20 offset:10240
ds_read_b64_tr_b16 a[162:163], v20 offset:11520
v_add_f32 v245, v245, v193
v_lshlrev_b32 v194, 16, v241
v_and_b32 v195, 0xffff0000, v241
v_add_f32 v246, v246, v194
v_add_f32 v247, v247, v195
v_lshlrev_b32 v196, 16, v242
v_and_b32 v197, 0xffff0000, v242
v_mfma_f32_32x32x16_bf16 v[112:127], a[64:67], a[188:191], v[112:127]
ds_read_b64_tr_b16 a[164:165], v20 offset:10272
ds_read_b64_tr_b16 a[166:167], v20 offset:11552
buffer_load_dwordx4 v5, s[12:15], s74 offen offset:3072 lds
v_add_f32 v248, v248, v196
v_add_f32 v249, v249, v197
v_lshlrev_b32 v198, 16, v243
v_and_b32 v199, 0xffff0000, v243
v_add_f32 v250, v250, v198
v_add_f32 v251, v251, v199
v_mfma_f32_32x32x16_bf16 v[128:143], a[64:67], a[192:195], v[128:143]
ds_read_b64_tr_b16 a[168:169], v20 offset:10304
ds_read_b64_tr_b16 a[170:171], v20 offset:11584
v_mov_b32 v192, v244
v_mov_b32 v193, v245
v_mov_b32 v194, v246
v_mov_b32 v195, v247
v_mov_b32 v196, v248
v_mov_b32 v197, v249
v_mov_b32 v198, v250
v_mfma_f32_32x32x16_bf16 v[144:159], a[64:67], a[196:199], v[144:159]
ds_read_b64_tr_b16 a[172:173], v20 offset:10336
ds_read_b64_tr_b16 a[174:175], v20 offset:11616
s_add_u32 m0, s52, 53504
s_nop 0
buffer_load_dwordx4 v6, s[12:15], s74 offen lds
v_mov_b32 v199, v251
v_permlane16_swap_b32 v244, v192
v_permlane16_swap_b32 v245, v193
v_permlane16_swap_b32 v246, v194
v_mfma_f32_32x32x16_bf16 v[160:175], a[64:67], a[200:203], v[160:175]
ds_read_b64_tr_b16 a[176:177], v20 offset:10368
ds_read_b64_tr_b16 a[178:179], v20 offset:11648
v_permlane16_swap_b32 v247, v195
v_permlane16_swap_b32 v248, v196
v_permlane16_swap_b32 v249, v197
v_permlane16_swap_b32 v250, v198
v_permlane16_swap_b32 v251, v199
v_add_f32 v244, v244, v192
v_add_f32 v245, v245, v193
s_waitcnt lgkmcnt(10)
v_mfma_f32_32x32x16_bf16 v[96:111], a[68:71], a[208:211], v[96:111]
ds_read_b64_tr_b16 a[184:185], v20 offset:15360
ds_read_b64_tr_b16 a[186:187], v20 offset:16640
s_add_u32 m0, s53, 4096
s_add_u32 s75, s56, 896
buffer_load_dwordx4 v12, s[8:11], s75 offen lds
v_add_f32 v246, v246, v194
v_add_f32 v247, v247, v195
v_add_f32 v248, v248, v196
v_add_f32 v249, v249, v197
v_mfma_f32_32x32x16_bf16 v[112:127], a[68:71], a[212:215], v[112:127]
ds_read_b64_tr_b16 a[188:189], v20 offset:15392
ds_read_b64_tr_b16 a[190:191], v20 offset:16672
v_add_f32 v250, v250, v198
v_add_f32 v251, v251, v199
v_mov_b32 v192, v244
v_mov_b32 v193, v245
v_mov_b32 v194, v246
v_mov_b32 v195, v247
v_mov_b32 v196, v248
v_mfma_f32_32x32x16_bf16 v[128:143], a[68:71], a[216:219], v[128:143]
ds_read_b64_tr_b16 a[192:193], v20 offset:15424
ds_read_b64_tr_b16 a[194:195], v20 offset:16704
buffer_load_dwordx4 v13, s[8:11], s75 offen offset:1024 lds
v_mov_b32 v197, v249
v_mov_b32 v198, v250
v_mov_b32 v199, v251
v_permlane32_swap_b32 v244, v192
v_permlane32_swap_b32 v245, v193
v_permlane32_swap_b32 v246, v194
v_mfma_f32_32x32x16_bf16 v[144:159], a[68:71], a[220:223], v[144:159]
ds_read_b64_tr_b16 a[196:197], v20 offset:15456
ds_read_b64_tr_b16 a[198:199], v20 offset:16736
v_permlane32_swap_b32 v247, v195
v_permlane32_swap_b32 v248, v196
v_permlane32_swap_b32 v249, v197
v_permlane32_swap_b32 v250, v198
v_permlane32_swap_b32 v251, v199
v_add_f32 v244, v244, v192
v_add_f32 v245, v245, v193
v_mfma_f32_32x32x16_bf16 v[160:175], a[68:71], a[224:227], v[160:175]
ds_read_b64_tr_b16 a[200:201], v20 offset:15488
ds_read_b64_tr_b16 a[202:203], v20 offset:16768
buffer_load_dwordx4 v14, s[8:11], s75 offen offset:2048 lds
v_add_f32 v246, v246, v194
v_add_f32 v247, v247, v195
v_add_f32 v248, v248, v196
v_add_f32 v249, v249, v197
v_add_f32 v250, v250, v198
v_add_f32 v251, v251, v199
s_waitcnt vmcnt(12)
s_barrier
s_waitcnt lgkmcnt(10)
v_mfma_f32_32x32x16_bf16 v[96:111], a[72:75], a[160:163], v[96:111]
ds_read_b64_tr_b16 a[208:209], v20 offset:24704
ds_read_b64_tr_b16 a[210:211], v20 offset:25984
ds_read_b128 a[80:83], v16 offset:8192
s_lshl_b32 s60, s48, 10
s_add_u32 s60, s60, 154112
v_lshlrev_b32 v192, 5, v1
v_add_u32 v192, s60, v192
v_and_b32 v193, 31, v1
v_mul_u32_u24 v193, 12, v193
v_add_u32 v193, s60, v193
s_mov_b64 s[82:83], exec
s_mov_b64 exec, 0xffff
ds_write_b128 v192, v[244:247]
ds_write_b128 v192, v[248:251] offset:16
s_mov_b64 exec, s[82:83]
v_mfma_f32_32x32x16_bf16 v[112:127], a[72:75], a[164:167], v[112:127]
ds_read_b64_tr_b16 a[212:213], v20 offset:24736
ds_read_b64_tr_b16 a[214:215], v20 offset:26016
ds_read_b128 a[84:87], v17 offset:8192
buffer_load_dwordx4 v15, s[8:11], s75 offen offset:3072 lds
s_waitcnt lgkmcnt(3)
ds_read_b32 v196, v193
ds_read_b32 v197, v193 offset:4
ds_read_b32 v198, v193 offset:8
v_mov_b32 v199, v30
s_waitcnt lgkmcnt(0)
buffer_store_dwordx4 v[196:199], v94, s[24:27], 0 offen sc1
v_mfma_f32_32x32x16_bf16 v[128:143], a[72:75], a[168:171], v[128:143]
ds_read_b64_tr_b16 a[216:217], v20 offset:24768
ds_read_b64_tr_b16 a[218:219], v20 offset:26048
ds_read_b128 a[88:91], v18 offset:8192
v_mfma_f32_32x32x16_bf16 v[144:159], a[72:75], a[172:175], v[144:159]
ds_read_b64_tr_b16 a[220:221], v20 offset:24800
ds_read_b64_tr_b16 a[222:223], v20 offset:26080
ds_read_b128 a[92:95], v19 offset:8192
s_add_u32 s74, s54, 1720320
s_add_u32 m0, s52, 74112
s_nop 0
buffer_load_dwordx4 v2, s[12:15], s74 offen lds
v_mfma_f32_32x32x16_bf16 v[160:175], a[72:75], a[176:179], v[160:175]
ds_read_b64_tr_b16 a[224:225], v20 offset:24832
ds_read_b64_tr_b16 a[226:227], v20 offset:26112
v_mfma_f32_32x32x16_bf16 v[96:111], a[76:79], a[184:187], v[96:111]
ds_read_b64_tr_b16 a[160:161], v20 offset:29824
ds_read_b64_tr_b16 a[162:163], v20 offset:31104
buffer_load_dwordx4 v3, s[12:15], s74 offen offset:1024 lds
v_mfma_f32_32x32x16_bf16 v[112:127], a[76:79], a[188:191], v[112:127]
ds_read_b64_tr_b16 a[164:165], v20 offset:29856
ds_read_b64_tr_b16 a[166:167], v20 offset:31136
v_mfma_f32_32x32x16_bf16 v[128:143], a[76:79], a[192:195], v[128:143]
ds_read_b64_tr_b16 a[168:169], v20 offset:29888
ds_read_b64_tr_b16 a[170:171], v20 offset:31168
buffer_load_dwordx4 v4, s[12:15], s74 offen offset:2048 lds
v_mfma_f32_32x32x16_bf16 v[144:159], a[76:79], a[196:199], v[144:159]
ds_read_b64_tr_b16 a[172:173], v20 offset:29920
ds_read_b64_tr_b16 a[174:175], v20 offset:31200
v_mfma_f32_32x32x16_bf16 v[160:175], a[76:79], a[200:203], v[160:175]
ds_read_b64_tr_b16 a[176:177], v20 offset:29952
ds_read_b64_tr_b16 a[178:179], v20 offset:31232
buffer_load_dwordx4 v5, s[12:15], s74 offen offset:3072 lds
s_waitcnt lgkmcnt(10)
v_mfma_f32_32x32x16_bf16 v[96:111], a[80:83], a[208:211], v[96:111]
ds_read_b64_tr_b16 a[184:185], v20 offset:34944
ds_read_b64_tr_b16 a[186:187], v20 offset:36224
v_mfma_f32_32x32x16_bf16 v[112:127], a[80:83], a[212:215], v[112:127]
ds_read_b64_tr_b16 a[188:189], v20 offset:34976
ds_read_b64_tr_b16 a[190:191], v20 offset:36256
s_add_u32 m0, s52, 78208
s_nop 0
buffer_load_dwordx4 v6, s[12:15], s74 offen lds
v_mfma_f32_32x32x16_bf16 v[128:143], a[80:83], a[216:219], v[128:143]
ds_read_b64_tr_b16 a[192:193], v20 offset:35008
ds_read_b64_tr_b16 a[194:195], v20 offset:36288
v_mfma_f32_32x32x16_bf16 v[144:159], a[80:83], a[220:223], v[144:159]
ds_read_b64_tr_b16 a[196:197], v20 offset:35040
ds_read_b64_tr_b16 a[198:199], v20 offset:36320
s_add_u32 m0, s53, 8192
s_add_u32 s75, s56, 1024
buffer_load_dwordx4 v12, s[8:11], s75 offen lds
v_mfma_f32_32x32x16_bf16 v[160:175], a[80:83], a[224:227], v[160:175]
ds_read_b64_tr_b16 a[200:201], v20 offset:35072
ds_read_b64_tr_b16 a[202:203], v20 offset:36352
s_waitcnt lgkmcnt(10)
v_mfma_f32_32x32x16_bf16 v[96:111], a[84:87], a[160:163], v[96:111]
ds_read_b64_tr_b16 a[208:209], v20 offset:40064
ds_read_b64_tr_b16 a[210:211], v20 offset:41344
buffer_load_dwordx4 v13, s[8:11], s75 offen offset:1024 lds
v_mfma_f32_32x32x16_bf16 v[112:127], a[84:87], a[164:167], v[112:127]
ds_read_b64_tr_b16 a[212:213], v20 offset:40096
ds_read_b64_tr_b16 a[214:215], v20 offset:41376
v_mfma_f32_32x32x16_bf16 v[128:143], a[84:87], a[168:171], v[128:143]
ds_read_b64_tr_b16 a[216:217], v20 offset:40128
ds_read_b64_tr_b16 a[218:219], v20 offset:41408
buffer_load_dwordx4 v14, s[8:11], s75 offen offset:2048 lds
v_mfma_f32_32x32x16_bf16 v[144:159], a[84:87], a[172:175], v[144:159]
ds_read_b64_tr_b16 a[220:221], v20 offset:40160
ds_read_b64_tr_b16 a[222:223], v20 offset:41440
v_mfma_f32_32x32x16_bf16 v[160:175], a[84:87], a[176:179], v[160:175]
ds_read_b64_tr_b16 a[224:225], v20 offset:40192
ds_read_b64_tr_b16 a[226:227], v20 offset:41472
buffer_load_dwordx4 v15, s[8:11], s75 offen offset:3072 lds
s_waitcnt vmcnt(14)
s_barrier
s_waitcnt lgkmcnt(10)
v_mfma_f32_32x32x16_bf16 v[96:111], a[88:91], a[184:187], v[96:111]
ds_read_b64_tr_b16 a[160:161], v21 offset:0
ds_read_b64_tr_b16 a[162:163], v21 offset:1280
ds_read_b128 a[96:99], v16 offset:0
v_mfma_f32_32x32x16_bf16 v[112:127], a[88:91], a[188:191], v[112:127]
ds_read_b64_tr_b16 a[164:165], v21 offset:32
ds_read_b64_tr_b16 a[166:167], v21 offset:1312
ds_read_b128 a[100:103], v17 offset:0
s_add_u32 s74, s54, 1966080
s_add_u32 m0, s52, 0
s_nop 0
buffer_load_dwordx4 v2, s[12:15], s74 offen lds
v_mfma_f32_32x32x16_bf16 v[128:143], a[88:91], a[192:195], v[128:143]
ds_read_b64_tr_b16 a[168:169], v21 offset:64
ds_read_b64_tr_b16 a[170:171], v21 offset:1344
ds_read_b128 a[104:107], v18 offset:0
v_mfma_f32_32x32x16_bf16 v[144:159], a[88:91], a[196:199], v[144:159]
ds_read_b64_tr_b16 a[172:173], v21 offset:96
ds_read_b64_tr_b16 a[174:175], v21 offset:1376
ds_read_b128 a[108:111], v19 offset:0
buffer_load_dwordx4 v3, s[12:15], s74 offen offset:1024 lds
v_mfma_f32_32x32x16_bf16 v[160:175], a[88:91], a[200:203], v[160:175]
ds_read_b64_tr_b16 a[176:177], v21 offset:128
ds_read_b64_tr_b16 a[178:179], v21 offset:1408
s_waitcnt lgkmcnt(14)
v_mfma_f32_32x32x16_bf16 v[96:111], a[92:95], a[208:211], v[96:111]
ds_read_b64_tr_b16 a[184:185], v21 offset:5120
ds_read_b64_tr_b16 a[186:187], v21 offset:6400
buffer_load_dwordx4 v4, s[12:15], s74 offen offset:2048 lds
v_mfma_f32_32x32x16_bf16 v[112:127], a[92:95], a[212:215], v[112:127]
ds_read_b64_tr_b16 a[188:189], v21 offset:5152
ds_read_b64_tr_b16 a[190:191], v21 offset:6432
v_mfma_f32_32x32x16_bf16 v[128:143], a[92:95], a[216:219], v[128:143]
ds_read_b64_tr_b16 a[192:193], v21 offset:5184
ds_read_b64_tr_b16 a[194:195], v21 offset:6464
buffer_load_dwordx4 v5, s[12:15], s74 offen offset:3072 lds
v_mfma_f32_32x32x16_bf16 v[144:159], a[92:95], a[220:223], v[144:159]
ds_read_b64_tr_b16 a[196:197], v21 offset:5216
ds_read_b64_tr_b16 a[198:199], v21 offset:6496
v_mfma_f32_32x32x16_bf16 v[160:175], a[92:95], a[224:227], v[160:175]
ds_read_b64_tr_b16 a[200:201], v21 offset:5248
ds_read_b64_tr_b16 a[202:203], v21 offset:6528
s_add_u32 m0, s52, 4096
s_nop 0
buffer_load_dwordx4 v6, s[12:15], s74 offen lds
s_waitcnt lgkmcnt(10)
v_mfma_f32_32x32x16_bf16 v[96:111], a[96:99], a[160:163], v[96:111]
ds_read_b64_tr_b16 a[208:209], v21 offset:10240
ds_read_b64_tr_b16 a[210:211], v21 offset:11520
v_mfma_f32_32x32x16_bf16 v[112:127], a[96:99], a[164:167], v[112:127]
ds_read_b64_tr_b16 a[212:213], v21 offset:10272
ds_read_b64_tr_b16 a[214:215], v21 offset:11552
s_add_u32 m0, s53, 0
s_add_u32 s75, s56, 1152
buffer_load_dwordx4 v12, s[8:11], s75 offen lds
v_mfma_f32_32x32x16_bf16 v[128:143], a[96:99], a[168:171], v[128:143]
ds_read_b64_tr_b16 a[216:217], v21 offset:10304
ds_read_b64_tr_b16 a[218:219], v21 offset:11584
v_mfma_f32_32x32x16_bf16 v[144:159], a[96:99], a[172:175], v[144:159]
ds_read_b64_tr_b16 a[220:221], v21 offset:10336
ds_read_b64_tr_b16 a[222:223], v21 offset:11616
buffer_load_dwordx4 v13, s[8:11], s75 offen offset:1024 lds
v_mfma_f32_32x32x16_bf16 v[160:175], a[96:99], a[176:179], v[160:175]
ds_read_b64_tr_b16 a[224:225], v21 offset:10368
ds_read_b64_tr_b16 a[226:227], v21 offset:11648
s_waitcnt lgkmcnt(10)
v_mfma_f32_32x32x16_bf16 v[96:111], a[100:103], a[184:187], v[96:111]
ds_read_b64_tr_b16 a[160:161], v21 offset:15360
ds_read_b64_tr_b16 a[162:163], v21 offset:16640
buffer_load_dwordx4 v14, s[8:11], s75 offen offset:2048 lds
v_mfma_f32_32x32x16_bf16 v[112:127], a[100:103], a[188:191], v[112:127]
ds_read_b64_tr_b16 a[164:165], v21 offset:15392
ds_read_b64_tr_b16 a[166:167], v21 offset:16672
v_mfma_f32_32x32x16_bf16 v[128:143], a[100:103], a[192:195], v[128:143]
ds_read_b64_tr_b16 a[168:169], v21 offset:15424
ds_read_b64_tr_b16 a[170:171], v21 offset:16704
buffer_load_dwordx4 v15, s[8:11], s75 offen offset:3072 lds
v_mfma_f32_32x32x16_bf16 v[144:159], a[100:103], a[196:199], v[144:159]
ds_read_b64_tr_b16 a[172:173], v21 offset:15456
ds_read_b64_tr_b16 a[174:175], v21 offset:16736
v_mfma_f32_32x32x16_bf16 v[160:175], a[100:103], a[200:203], v[160:175]
ds_read_b64_tr_b16 a[176:177], v21 offset:15488
ds_read_b64_tr_b16 a[178:179], v21 offset:16768
s_waitcnt vmcnt(13)
s_barrier
s_waitcnt lgkmcnt(10)
v_mfma_f32_32x32x16_bf16 v[96:111], a[104:107], a[208:211], v[96:111]
ds_read_b64_tr_b16 a[184:185], v21 offset:24704
ds_read_b64_tr_b16 a[186:187], v21 offset:25984
ds_read_b128 a[112:115], v16 offset:4096
v_mfma_f32_32x32x16_bf16 v[112:127], a[104:107], a[212:215], v[112:127]
ds_read_b64_tr_b16 a[188:189], v21 offset:24736
ds_read_b64_tr_b16 a[190:191], v21 offset:26016
ds_read_b128 a[116:119], v17 offset:4096
s_add_u32 s74, s54, 2211840
s_add_u32 m0, s52, 24704
s_nop 0
buffer_load_dwordx4 v2, s[12:15], s74 offen lds
v_mfma_f32_32x32x16_bf16 v[128:143], a[104:107], a[216:219], v[128:143]
ds_read_b64_tr_b16 a[192:193], v21 offset:24768
ds_read_b64_tr_b16 a[194:195], v21 offset:26048
ds_read_b128 a[120:123], v18 offset:4096
v_mfma_f32_32x32x16_bf16 v[144:159], a[104:107], a[220:223], v[144:159]
ds_read_b64_tr_b16 a[196:197], v21 offset:24800
ds_read_b64_tr_b16 a[198:199], v21 offset:26080
ds_read_b128 a[124:127], v19 offset:4096
buffer_load_dwordx4 v3, s[12:15], s74 offen offset:1024 lds
v_mfma_f32_32x32x16_bf16 v[160:175], a[104:107], a[224:227], v[160:175]
ds_read_b64_tr_b16 a[200:201], v21 offset:24832
ds_read_b64_tr_b16 a[202:203], v21 offset:26112
s_waitcnt lgkmcnt(14)
v_mfma_f32_32x32x16_bf16 v[96:111], a[108:111], a[160:163], v[96:111]
ds_read_b64_tr_b16 a[208:209], v21 offset:29824
ds_read_b64_tr_b16 a[210:211], v21 offset:31104
buffer_load_dwordx4 v4, s[12:15], s74 offen offset:2048 lds
v_mfma_f32_32x32x16_bf16 v[112:127], a[108:111], a[164:167], v[112:127]
ds_read_b64_tr_b16 a[212:213], v21 offset:29856
ds_read_b64_tr_b16 a[214:215], v21 offset:31136
v_mfma_f32_32x32x16_bf16 v[128:143], a[108:111], a[168:171], v[128:143]
ds_read_b64_tr_b16 a[216:217], v21 offset:29888
ds_read_b64_tr_b16 a[218:219], v21 offset:31168
buffer_load_dwordx4 v5, s[12:15], s74 offen offset:3072 lds
v_mfma_f32_32x32x16_bf16 v[144:159], a[108:111], a[172:175], v[144:159]
ds_read_b64_tr_b16 a[220:221], v21 offset:29920
ds_read_b64_tr_b16 a[222:223], v21 offset:31200
v_mfma_f32_32x32x16_bf16 v[160:175], a[108:111], a[176:179], v[160:175]
ds_read_b64_tr_b16 a[224:225], v21 offset:29952
ds_read_b64_tr_b16 a[226:227], v21 offset:31232
s_add_u32 m0, s52, 28800
s_nop 0
buffer_load_dwordx4 v6, s[12:15], s74 offen lds
s_waitcnt lgkmcnt(10)
v_mfma_f32_32x32x16_bf16 v[96:111], a[112:115], a[184:187], v[96:111]
ds_read_b64_tr_b16 a[160:161], v21 offset:34944
ds_read_b64_tr_b16 a[162:163], v21 offset:36224
v_mfma_f32_32x32x16_bf16 v[112:127], a[112:115], a[188:191], v[112:127]
ds_read_b64_tr_b16 a[164:165], v21 offset:34976
ds_read_b64_tr_b16 a[166:167], v21 offset:36256
v_mfma_f32_32x32x16_bf16 v[128:143], a[112:115], a[192:195], v[128:143]
ds_read_b64_tr_b16 a[168:169], v21 offset:35008
ds_read_b64_tr_b16 a[170:171], v21 offset:36288
v_mfma_f32_32x32x16_bf16 v[144:159], a[112:115], a[196:199], v[144:159]
ds_read_b64_tr_b16 a[172:173], v21 offset:35040
ds_read_b64_tr_b16 a[174:175], v21 offset:36320
v_mfma_f32_32x32x16_bf16 v[160:175], a[112:115], a[200:203], v[160:175]
ds_read_b64_tr_b16 a[176:177], v21 offset:35072
ds_read_b64_tr_b16 a[178:179], v21 offset:36352
s_waitcnt lgkmcnt(10)
v_mfma_f32_32x32x16_bf16 v[96:111], a[116:119], a[208:211], v[96:111]
ds_read_b64_tr_b16 a[184:185], v21 offset:40064
ds_read_b64_tr_b16 a[186:187], v21 offset:41344
v_mfma_f32_32x32x16_bf16 v[112:127], a[116:119], a[212:215], v[112:127]
ds_read_b64_tr_b16 a[188:189], v21 offset:40096
ds_read_b64_tr_b16 a[190:191], v21 offset:41376
v_mfma_f32_32x32x16_bf16 v[128:143], a[116:119], a[216:219], v[128:143]
ds_read_b64_tr_b16 a[192:193], v21 offset:40128
ds_read_b64_tr_b16 a[194:195], v21 offset:41408
v_mfma_f32_32x32x16_bf16 v[144:159], a[116:119], a[220:223], v[144:159]
ds_read_b64_tr_b16 a[196:197], v21 offset:40160
ds_read_b64_tr_b16 a[198:199], v21 offset:41440
v_mfma_f32_32x32x16_bf16 v[160:175], a[116:119], a[224:227], v[160:175]
ds_read_b64_tr_b16 a[200:201], v21 offset:40192
ds_read_b64_tr_b16 a[202:203], v21 offset:41472
v_and_b32 v36, 31, v1
v_lshrrev_b32 v37, 1, v36
v_lshlrev_b32 v37, 7, v37
v_and_b32 v38, 1, v36
v_lshl_add_u32 v41, v38, 4, v37
s_lshl_b32 s47, s49, 2
s_add_u32 s47, s47, s48
s_lshl_b32 s47, s47, 11
s_add_u32 s47, s47, 14680064
s_lshl_b32 s46, s50, 15
s_lshl_b32 s60, s48, 9
s_add_u32 s46, s46, s60
s_add_u32 s46, s46, 15728640
s_waitcnt vmcnt(9)
s_barrier
s_waitcnt lgkmcnt(10)
v_mfma_f32_32x32x16_bf16 v[96:111], a[120:123], a[160:163], v[96:111]
ds_read_b64_tr_b16 a[208:209], v20 offset:0
ds_read_b64_tr_b16 a[210:211], v20 offset:1280
ds_read_b128 a[128:131], v16 offset:8192
v_lshrrev_b32 v37, 5, v1
v_lshlrev_b32 v37, 14, v37
v_lshl_add_u32 v37, v36, 4, v37
v_add_u32 v38, 4096, v37
v_add_u32 v39, 8192, v37
v_add_u32 v40, 12288, v37
v_mfma_f32_32x32x16_bf16 v[112:127], a[120:123], a[164:167], v[112:127]
ds_read_b64_tr_b16 a[212:213], v20 offset:32
ds_read_b64_tr_b16 a[214:215], v20 offset:1312
ds_read_b128 a[132:135], v17 offset:8192
s_add_u32 s74, s55, 0
s_add_u32 m0, s80, 49408
s_nop 0
buffer_load_dwordx4 v7, s[16:19], s74 offen lds
v_mov_b32 v36, v41
buffer_load_dwordx4 v[44:47], v36, s[24:27], s47 offen sc1
v_mfma_f32_32x32x16_bf16 v[128:143], a[120:123], a[168:171], v[128:143]
ds_read_b64_tr_b16 a[216:217], v20 offset:64
ds_read_b64_tr_b16 a[218:219], v20 offset:1344
ds_read_b128 a[136:139], v18 offset:8192
buffer_load_dwordx4 v[48:51], v37, s[24:27], s46 offen sc1
buffer_load_dwordx4 v[52:55], v37, s[24:27], s46 offen offset:2048 sc1
buffer_load_dwordx4 v[56:59], v38, s[24:27], s46 offen sc1
buffer_load_dwordx4 v[60:63], v38, s[24:27], s46 offen offset:2048 sc1
buffer_load_dwordx4 v[64:67], v39, s[24:27], s46 offen sc1
buffer_load_dwordx4 v[68:71], v39, s[24:27], s46 offen offset:2048 sc1
v_mfma_f32_32x32x16_bf16 v[144:159], a[120:123], a[172:175], v[144:159]
ds_read_b64_tr_b16 a[220:221], v20 offset:96
ds_read_b64_tr_b16 a[222:223], v20 offset:1376
ds_read_b128 a[140:143], v19 offset:8192
buffer_load_dwordx4 v8, s[16:19], s74 offen offset:1024 lds
buffer_load_dwordx4 v[72:75], v40, s[24:27], s46 offen sc1
buffer_load_dwordx4 v[76:79], v40, s[24:27], s46 offen offset:2048 sc1
v_mfma_f32_32x32x16_bf16 v[160:175], a[120:123], a[176:179], v[160:175]
ds_read_b64_tr_b16 a[224:225], v20 offset:128
ds_read_b64_tr_b16 a[226:227], v20 offset:1408
s_waitcnt lgkmcnt(14)
v_mfma_f32_32x32x16_bf16 v[96:111], a[124:127], a[184:187], v[96:111]
ds_read_b64_tr_b16 a[160:161], v20 offset:5120
ds_read_b64_tr_b16 a[162:163], v20 offset:6400
buffer_load_dwordx4 v9, s[16:19], s74 offen offset:2048 lds
v_mfma_f32_32x32x16_bf16 v[112:127], a[124:127], a[188:191], v[112:127]
ds_read_b64_tr_b16 a[164:165], v20 offset:5152
ds_read_b64_tr_b16 a[166:167], v20 offset:6432
v_mfma_f32_32x32x16_bf16 v[128:143], a[124:127], a[192:195], v[128:143]
ds_read_b64_tr_b16 a[168:169], v20 offset:5184
ds_read_b64_tr_b16 a[170:171], v20 offset:6464
buffer_load_dwordx4 v10, s[16:19], s74 offen offset:3072 lds
v_mfma_f32_32x32x16_bf16 v[144:159], a[124:127], a[196:199], v[144:159]
ds_read_b64_tr_b16 a[172:173], v20 offset:5216
ds_read_b64_tr_b16 a[174:175], v20 offset:6496
v_mfma_f32_32x32x16_bf16 v[160:175], a[124:127], a[200:203], v[160:175]
ds_read_b64_tr_b16 a[176:177], v20 offset:5248
ds_read_b64_tr_b16 a[178:179], v20 offset:6528
s_add_u32 m0, s80, 53504
s_nop 0
buffer_load_dwordx4 v11, s[16:19], s74 offen lds
s_waitcnt lgkmcnt(10)
v_mfma_f32_32x32x16_bf16 v[96:111], a[128:131], a[208:211], v[96:111]
ds_read_b64_tr_b16 a[184:185], v20 offset:10240
ds_read_b64_tr_b16 a[186:187], v20 offset:11520
v_mfma_f32_32x32x16_bf16 v[112:127], a[128:131], a[212:215], v[112:127]
ds_read_b64_tr_b16 a[188:189], v20 offset:10272
ds_read_b64_tr_b16 a[190:191], v20 offset:11552
v_mfma_f32_32x32x16_bf16 v[128:143], a[128:131], a[216:219], v[128:143]
ds_read_b64_tr_b16 a[192:193], v20 offset:10304
ds_read_b64_tr_b16 a[194:195], v20 offset:11584
v_mfma_f32_32x32x16_bf16 v[144:159], a[128:131], a[220:223], v[144:159]
ds_read_b64_tr_b16 a[196:197], v20 offset:10336
ds_read_b64_tr_b16 a[198:199], v20 offset:11616
v_mfma_f32_32x32x16_bf16 v[160:175], a[128:131], a[224:227], v[160:175]
ds_read_b64_tr_b16 a[200:201], v20 offset:10368
ds_read_b64_tr_b16 a[202:203], v20 offset:11648
s_waitcnt lgkmcnt(10)
v_mfma_f32_32x32x16_bf16 v[96:111], a[132:135], a[160:163], v[96:111]
ds_read_b64_tr_b16 a[208:209], v20 offset:15360
ds_read_b64_tr_b16 a[210:211], v20 offset:16640
v_mfma_f32_32x32x16_bf16 v[112:127], a[132:135], a[164:167], v[112:127]
ds_read_b64_tr_b16 a[212:213], v20 offset:15392
ds_read_b64_tr_b16 a[214:215], v20 offset:16672
v_mfma_f32_32x32x16_bf16 v[128:143], a[132:135], a[168:171], v[128:143]
ds_read_b64_tr_b16 a[216:217], v20 offset:15424
ds_read_b64_tr_b16 a[218:219], v20 offset:16704
v_mfma_f32_32x32x16_bf16 v[144:159], a[132:135], a[172:175], v[144:159]
ds_read_b64_tr_b16 a[220:221], v20 offset:15456
ds_read_b64_tr_b16 a[222:223], v20 offset:16736
v_mfma_f32_32x32x16_bf16 v[160:175], a[132:135], a[176:179], v[160:175]
ds_read_b64_tr_b16 a[224:225], v20 offset:15488
ds_read_b64_tr_b16 a[226:227], v20 offset:16768
s_waitcnt vmcnt(14)
s_barrier
s_waitcnt lgkmcnt(10)
v_mfma_f32_32x32x16_bf16 v[96:111], a[136:139], a[184:187], v[96:111]
ds_read_b64_tr_b16 a[160:161], v20 offset:24704
ds_read_b64_tr_b16 a[162:163], v20 offset:25984
ds_read_b128 a[144:147], v16 offset:0
v_mfma_f32_32x32x16_bf16 v[112:127], a[136:139], a[188:191], v[112:127]
ds_read_b64_tr_b16 a[164:165], v20 offset:24736
ds_read_b64_tr_b16 a[166:167], v20 offset:26016
ds_read_b128 a[148:151], v17 offset:0
s_add_u32 s74, s55, 245760
s_add_u32 m0, s80, 74112
s_nop 0
buffer_load_dwordx4 v7, s[16:19], s74 offen lds
v_mfma_f32_32x32x16_bf16 v[128:143], a[136:139], a[192:195], v[128:143]
ds_read_b64_tr_b16 a[168:169], v20 offset:24768
ds_read_b64_tr_b16 a[170:171], v20 offset:26048
ds_read_b128 a[152:155], v18 offset:0
v_mfma_f32_32x32x16_bf16 v[144:159], a[136:139], a[196:199], v[144:159]
ds_read_b64_tr_b16 a[172:173], v20 offset:24800
ds_read_b64_tr_b16 a[174:175], v20 offset:26080
ds_read_b128 a[156:159], v19 offset:0
buffer_load_dwordx4 v8, s[16:19], s74 offen offset:1024 lds
v_mfma_f32_32x32x16_bf16 v[160:175], a[136:139], a[200:203], v[160:175]
ds_read_b64_tr_b16 a[176:177], v20 offset:24832
ds_read_b64_tr_b16 a[178:179], v20 offset:26112
s_waitcnt lgkmcnt(14)
v_mfma_f32_32x32x16_bf16 v[96:111], a[140:143], a[208:211], v[96:111]
ds_read_b64_tr_b16 a[184:185], v20 offset:29824
ds_read_b64_tr_b16 a[186:187], v20 offset:31104
buffer_load_dwordx4 v9, s[16:19], s74 offen offset:2048 lds
v_mfma_f32_32x32x16_bf16 v[112:127], a[140:143], a[212:215], v[112:127]
ds_read_b64_tr_b16 a[188:189], v20 offset:29856
ds_read_b64_tr_b16 a[190:191], v20 offset:31136
v_mfma_f32_32x32x16_bf16 v[128:143], a[140:143], a[216:219], v[128:143]
ds_read_b64_tr_b16 a[192:193], v20 offset:29888
ds_read_b64_tr_b16 a[194:195], v20 offset:31168
buffer_load_dwordx4 v10, s[16:19], s74 offen offset:3072 lds
v_mfma_f32_32x32x16_bf16 v[144:159], a[140:143], a[220:223], v[144:159]
ds_read_b64_tr_b16 a[196:197], v20 offset:29920
ds_read_b64_tr_b16 a[198:199], v20 offset:31200
v_mfma_f32_32x32x16_bf16 v[160:175], a[140:143], a[224:227], v[160:175]
ds_read_b64_tr_b16 a[200:201], v20 offset:29952
ds_read_b64_tr_b16 a[202:203], v20 offset:31232
s_add_u32 m0, s80, 78208
s_nop 0
buffer_load_dwordx4 v11, s[16:19], s74 offen lds
s_waitcnt lgkmcnt(10)
v_mfma_f32_32x32x16_bf16 v[96:111], a[144:147], a[160:163], v[96:111]
ds_read_b64_tr_b16 a[208:209], v20 offset:34944
ds_read_b64_tr_b16 a[210:211], v20 offset:36224
v_mfma_f32_32x32x16_bf16 v[112:127], a[144:147], a[164:167], v[112:127]
ds_read_b64_tr_b16 a[212:213], v20 offset:34976
ds_read_b64_tr_b16 a[214:215], v20 offset:36256
v_mfma_f32_32x32x16_bf16 v[128:143], a[144:147], a[168:171], v[128:143]
ds_read_b64_tr_b16 a[216:217], v20 offset:35008
ds_read_b64_tr_b16 a[218:219], v20 offset:36288
v_mfma_f32_32x32x16_bf16 v[144:159], a[144:147], a[172:175], v[144:159]
ds_read_b64_tr_b16 a[220:221], v20 offset:35040
ds_read_b64_tr_b16 a[222:223], v20 offset:36320
v_mfma_f32_32x32x16_bf16 v[160:175], a[144:147], a[176:179], v[160:175]
ds_read_b64_tr_b16 a[224:225], v20 offset:35072
ds_read_b64_tr_b16 a[226:227], v20 offset:36352
s_waitcnt vmcnt(17)
v_xor_b32 v41, v46, v30
s_waitcnt vmcnt(16)
v_xor_b32 v42, v51, v30
v_or_b32 v41, v41, v42
s_waitcnt vmcnt(15)
v_xor_b32 v42, v55, v30
v_or_b32 v41, v41, v42
s_waitcnt vmcnt(14)
v_xor_b32 v42, v59, v30
v_or_b32 v41, v41, v42
s_waitcnt vmcnt(13)
v_xor_b32 v42, v63, v30
v_or_b32 v41, v41, v42
s_waitcnt vmcnt(12)
v_xor_b32 v42, v67, v30
v_or_b32 v41, v41, v42
s_waitcnt vmcnt(11)
v_xor_b32 v42, v71, v30
v_or_b32 v41, v41, v42
s_waitcnt vmcnt(9)
v_xor_b32 v42, v75, v30
v_or_b32 v41, v41, v42
s_waitcnt vmcnt(8)
v_xor_b32 v42, v79, v30
v_or_b32 v41, v41, v42
v_cmp_ne_u32 vcc, 0, v41
s_nop 3
s_cbranch_vccz COKKV
s_mov_b32 s68, 4000
CSPKV:
s_sleep 8
buffer_load_dwordx4 v[44:47], v36, s[24:27], s47 offen sc1
buffer_load_dwordx4 v[48:51], v37, s[24:27], s46 offen sc1
buffer_load_dwordx4 v[52:55], v37, s[24:27], s46 offen offset:2048 sc1
buffer_load_dwordx4 v[56:59], v38, s[24:27], s46 offen sc1
buffer_load_dwordx4 v[60:63], v38, s[24:27], s46 offen offset:2048 sc1
buffer_load_dwordx4 v[64:67], v39, s[24:27], s46 offen sc1
buffer_load_dwordx4 v[68:71], v39, s[24:27], s46 offen offset:2048 sc1
buffer_load_dwordx4 v[72:75], v40, s[24:27], s46 offen sc1
buffer_load_dwordx4 v[76:79], v40, s[24:27], s46 offen offset:2048 sc1
s_waitcnt vmcnt(0)
v_xor_b32 v41, v46, v30
v_xor_b32 v42, v51, v30
v_or_b32 v41, v41, v42
v_xor_b32 v42, v55, v30
v_or_b32 v41, v41, v42
v_xor_b32 v42, v59, v30
v_or_b32 v41, v41, v42
v_xor_b32 v42, v63, v30
v_or_b32 v41, v41, v42
v_xor_b32 v42, v67, v30
v_or_b32 v41, v41, v42
v_xor_b32 v42, v71, v30
v_or_b32 v41, v41, v42
v_xor_b32 v42, v75, v30
v_or_b32 v41, v41, v42
v_xor_b32 v42, v79, v30
v_or_b32 v41, v41, v42
v_cmp_ne_u32 vcc, 0, v41
s_sub_u32 s68, s68, 1
s_nop 2
s_cbranch_vccz COKKV
s_cmp_lg_u32 s68, 0
s_cbranch_scc1 CSPKV
COKKV:
s_waitcnt lgkmcnt(10)
v_mfma_f32_32x32x16_bf16 v[96:111], a[148:151], a[184:187], v[96:111]
ds_read_b64_tr_b16 a[160:161], v20 offset:40064
ds_read_b64_tr_b16 a[162:163], v20 offset:41344
v_add_f32 v48, v48, v64
v_add_f32 v49, v49, v65
v_add_f32 v50, v50, v66
v_add_f32 v52, v52, v68
v_add_f32 v53, v53, v69
v_add_f32 v54, v54, v70
v_add_f32 v56, v56, v72
v_mfma_f32_32x32x16_bf16 v[112:127], a[148:151], a[188:191], v[112:127]
ds_read_b64_tr_b16 a[164:165], v20 offset:40096
ds_read_b64_tr_b16 a[166:167], v20 offset:41376
v_add_f32 v57, v57, v73
v_add_f32 v58, v58, v74
v_add_f32 v60, v60, v76
v_add_f32 v61, v61, v77
v_add_f32 v62, v62, v78
v_add_f32 v48, v48, v56
v_add_f32 v49, v49, v57
v_mfma_f32_32x32x16_bf16 v[128:143], a[148:151], a[192:195], v[128:143]
ds_read_b64_tr_b16 a[168:169], v20 offset:40128
ds_read_b64_tr_b16 a[170:171], v20 offset:41408
v_add_f32 v50, v50, v58
v_add_f32 v52, v52, v60
v_add_f32 v53, v53, v61
v_add_f32 v54, v54, v62
v_add_f32 v48, v48, v52
v_add_f32 v49, v49, v53
v_add_f32 v50, v50, v54
v_mfma_f32_32x32x16_bf16 v[144:159], a[148:151], a[196:199], v[144:159]
ds_read_b64_tr_b16 a[172:173], v20 offset:40160
ds_read_b64_tr_b16 a[174:175], v20 offset:41440
v_mov_b32 v52, v48
v_mov_b32 v53, v49
v_mov_b32 v54, v50
v_permlane32_swap_b32 v48, v52
v_permlane32_swap_b32 v49, v53
v_permlane32_swap_b32 v50, v54
v_add_f32 v48, v48, v52
v_mfma_f32_32x32x16_bf16 v[160:175], a[148:151], a[200:203], v[160:175]
ds_read_b64_tr_b16 a[176:177], v20 offset:40192
ds_read_b64_tr_b16 a[178:179], v20 offset:41472
v_add_f32 v49, v49, v53
v_add_f32 v50, v50, v54
v_mov_b32 v24, v44
v_mov_b32 v25, v45
s_mul_i32 s60, s48, 400
s_add_u32 s60, s60, 158208
v_mul_u32_u24 v36, 12, v1
v_add_u32 v36, s60, v36
s_mov_b64 s[82:83], exec
s_mov_b64 exec, 0xffffffff
ds_write_b32 v36, v48 offset:0
ds_write_b32 v36, v49 offset:4
ds_write_b32 v36, v50 offset:8
s_mov_b64 exec, s[82:83]
s_waitcnt vmcnt(5)
s_barrier
s_waitcnt lgkmcnt(13)
v_mfma_f32_32x32x16_bf16 v[96:111], a[152:155], a[208:211], v[96:111]
ds_read_b64_tr_b16 a[184:185], v85 offset:0
ds_read_b64_tr_b16 a[186:187], v85 offset:1280
v_and_b32 v36, 31, v1
v_lshlrev_b32 v36, 2, v36
s_lshl_b32 s60, s48, 7
s_add_u32 s60, s60, 159808
v_add_u32 v36, s60, v36
ds_write_b32 v36, v24
ds_write_b32 v36, v25 offset:512
v_mfma_f32_32x32x16_bf16 v[112:127], a[152:155], a[212:215], v[112:127]
ds_read_b64_tr_b16 a[188:189], v85 offset:32
ds_read_b64_tr_b16 a[190:191], v85 offset:1312
s_add_u32 s74, s55, 491520
s_add_u32 m0, s80, 0
s_nop 0
buffer_load_dwordx4 v7, s[16:19], s74 offen lds
v_sub_f32 v24, 0, v24
v_mul_f32 v28, s84, v25
v_mul_f32 v27, v25, v25
v_mfma_f32_32x32x16_bf16 v[128:143], a[152:155], a[216:219], v[128:143]
ds_read_b64_tr_b16 a[192:193], v85 offset:64
ds_read_b64_tr_b16 a[194:195], v85 offset:1344
v_sub_f32 v26, 0, v28
v_rcp_f32 v27, v27
v_cvt_pk_bf16_f32 v36, v24, v24
v_lshlrev_b32 v37, 16, v36
v_sub_f32 v37, v24, v37
v_cvt_pk_bf16_f32 v36, v24, v37
v_and_b32 v38, 15, v1
v_mfma_f32_32x32x16_bf16 v[144:159], a[152:155], a[220:223], v[144:159]
ds_read_b64_tr_b16 a[196:197], v85 offset:96
ds_read_b64_tr_b16 a[198:199], v85 offset:1376
buffer_load_dwordx4 v8, s[16:19], s74 offen offset:1024 lds
v_bfe_u32 v39, v1, 4, 1
v_mul_u32_u24 v39, 100, v39
v_add_u32 v38, v38, v39
v_lshlrev_b32 v23, 2, v38
v_add_u32 v23, 131072, v23
v_cmp_gt_u32 vcc, 32, v1
s_nop 1
v_cndmask_b32 v36, 0, v36, vcc
v_mov_b32 v37, 0
v_accvgpr_write_b32 a244, v36
v_accvgpr_write_b32 a245, v36
v_accvgpr_write_b32 a246, v37
v_accvgpr_write_b32 a247, v37
v_mfma_f32_32x32x16_bf16 v[160:175], a[152:155], a[224:227], v[160:175]
ds_read_b64_tr_b16 a[200:201], v85 offset:128
ds_read_b64_tr_b16 a[202:203], v85 offset:1408
s_waitcnt lgkmcnt(8)
s_barrier
v_mfma_f32_32x32x16_bf16 v[96:111], a[156:159], a[160:163], v[96:111]
ds_read_b64_tr_b16 a[208:209], v85 offset:5120
ds_read_b64_tr_b16 a[210:211], v85 offset:6400
buffer_load_dwordx4 v9, s[16:19], s74 offen offset:2048 lds
v_mfma_f32_32x32x16_bf16 v[112:127], a[156:159], a[164:167], v[112:127]
ds_read_b64_tr_b16 a[212:213], v85 offset:5152
ds_read_b64_tr_b16 a[214:215], v85 offset:6432
v_mfma_f32_32x32x16_bf16 v[128:143], a[156:159], a[168:171], v[128:143]
ds_read_b64_tr_b16 a[216:217], v85 offset:5184
ds_read_b64_tr_b16 a[218:219], v85 offset:6464
buffer_load_dwordx4 v10, s[16:19], s74 offen offset:3072 lds
v_mfma_f32_32x32x16_bf16 v[144:159], a[156:159], a[172:175], v[144:159]
ds_read_b64_tr_b16 a[220:221], v85 offset:5216
ds_read_b64_tr_b16 a[222:223], v85 offset:6496
v_mfma_f32_32x32x16_bf16 v[160:175], a[156:159], a[176:179], v[160:175]
ds_read_b64_tr_b16 a[224:225], v85 offset:5248
ds_read_b64_tr_b16 a[226:227], v85 offset:6528
s_add_u32 m0, s80, 4096
s_nop 0
buffer_load_dwordx4 v11, s[16:19], s74 offen lds
s_waitcnt lgkmcnt(10)
v_mfma_f32_32x32x16_bf16 v[176:191], a[0:3], a[184:187], 0
ds_read_b64_tr_b16 a[160:161], v85 offset:10240
ds_read_b64_tr_b16 a[162:163], v85 offset:11520
v_mfma_f32_32x32x16_bf16 v[192:207], a[0:3], a[188:191], 0
ds_read_b64_tr_b16 a[164:165], v85 offset:10272
ds_read_b64_tr_b16 a[166:167], v85 offset:11552
v_mfma_f32_32x32x16_bf16 v[208:223], a[0:3], a[192:195], 0
ds_read_b64_tr_b16 a[168:169], v85 offset:10304
ds_read_b64_tr_b16 a[170:171], v85 offset:11584
v_mov_b32 v64, s85
v_mul_f32 v64, s84, v64
v_sub_f32 v64, 0, v64
v_and_b32 v77, 15, v1
v_mfma_f32_32x32x16_bf16 v[224:239], a[0:3], a[196:199], 0
ds_read_b64_tr_b16 a[172:173], v85 offset:10336
ds_read_b64_tr_b16 a[174:175], v85 offset:11616
v_bfe_u32 v78, v1, 4, 1
v_mul_u32_u24 v79, 100, v78
v_add_u32 v79, v77, v79
v_lshlrev_b32 v67, 2, v79
v_mfma_f32_32x32x16_bf16 v[240:255], a[0:3], a[200:203], 0
ds_read_b64_tr_b16 a[176:177], v85 offset:10368
ds_read_b64_tr_b16 a[178:179], v85 offset:11648
v_add_u32 v67, 131072, v67
v_mul_u32_u24 v78, 80, v78
v_add_u32 v77, v77, v78
v_lshrrev_b32 v78, 5, v1
s_waitcnt lgkmcnt(10)
v_mfma_f32_32x32x16_bf16 v[176:191], a[4:7], a[208:211], v[176:191]
ds_read_b64_tr_b16 a[184:185], v85 offset:15360
ds_read_b64_tr_b16 a[186:187], v85 offset:16640
v_lshlrev_b32 v78, 1, v78
s_lshl_b32 s60, s48, 2
v_add_u32 v78, s60, v78
v_and_b32 v79, 15, v77
v_mfma_f32_32x32x16_bf16 v[192:207], a[4:7], a[212:215], v[192:207]
ds_read_b64_tr_b16 a[188:189], v85 offset:15392
ds_read_b64_tr_b16 a[190:191], v85 offset:16672
v_xor_b32 v78, v78, v79
v_lshlrev_b32 v78, 4, v78
v_lshl_add_u32 v76, v77, 8, v78
s_lshl_b32 s60, s48, 7
v_add_u32 v77, s60, v29
v_mfma_f32_32x32x16_bf16 v[208:223], a[4:7], a[216:219], v[208:223]
ds_read_b64_tr_b16 a[192:193], v85 offset:15424
ds_read_b64_tr_b16 a[194:195], v85 offset:16704
ds_read_b128 v[48:51], v77 offset:29248
ds_read_b128 v[52:55], v77 offset:29280
ds_read_b128 v[56:59], v77 offset:29312
ds_read_b128 v[60:63], v77 offset:29344
v_mfma_f32_32x32x16_bf16 v[224:239], a[4:7], a[220:223], v[224:239]
ds_read_b64_tr_b16 a[196:197], v85 offset:15456
ds_read_b64_tr_b16 a[198:199], v85 offset:16736
v_mov_b32 v34, 0
v_mov_b32 v35, 0
v_mov_b32 v38, 0
v_mov_b32 v39, 0
v_mfma_f32_32x32x16_bf16 v[240:255], a[4:7], a[224:227], v[240:255]
ds_read_b64_tr_b16 a[200:201], v85 offset:15488
ds_read_b64_tr_b16 a[202:203], v85 offset:16768
ds_read_b32 v40, v23 offset:27136
ds_read_b32 v41, v23 offset:27200
ds_read_b32 v42, v23 offset:27264
ds_read_b32 v43, v23 offset:27328
s_waitcnt vmcnt(5)
s_barrier
s_waitcnt lgkmcnt(15)
v_mfma_f32_32x32x16_bf16 v[176:191], a[8:11], a[160:163], v[176:191]
ds_read_b64_tr_b16 a[208:209], v85 offset:24704
ds_read_b64_tr_b16 a[210:211], v85 offset:25984
ds_read_b32 v44, v23 offset:27392
s_waitcnt lgkmcnt(6)
v_cvt_pk_bf16_f32 v32, v40, v40
v_lshlrev_b32 v46, 16, v32
v_sub_f32 v46, v40, v46
v_mfma_f32_32x32x16_bf16 v[192:207], a[8:11], a[164:167], v[192:207]
ds_read_b64_tr_b16 a[212:213], v85 offset:24736
ds_read_b64_tr_b16 a[214:215], v85 offset:26016
s_add_u32 s74, s55, 737280
s_add_u32 m0, s80, 24704
s_nop 0
buffer_load_dwordx4 v7, s[16:19], s74 offen lds
v_mfma_f32_32x32x16_bf16 v[208:223], a[8:11], a[168:171], v[208:223]
ds_read_b64_tr_b16 a[216:217], v85 offset:24768
ds_read_b64_tr_b16 a[218:219], v85 offset:26048
v_cvt_pk_bf16_f32 v33, v46, v46
s_nop 1
v_mfma_f32_32x32x16_bf16 v[96:111], a[244:247], v[32:35], v[96:111]
s_waitcnt lgkmcnt(9)
v_cvt_pk_bf16_f32 v36, v41, v41
v_lshlrev_b32 v47, 16, v36
v_mfma_f32_32x32x16_bf16 v[224:239], a[8:11], a[172:175], v[224:239]
ds_read_b64_tr_b16 a[220:221], v85 offset:24800
ds_read_b64_tr_b16 a[222:223], v85 offset:26080
buffer_load_dwordx4 v8, s[16:19], s74 offen offset:1024 lds
v_sub_f32 v47, v41, v47
s_and_b32 s60, s2, 7
s_lshr_b32 s61, s2, 3
s_lshl_b32 s40, s60, 2
s_and_b32 s62, s61, 3
s_add_u32 s40, s40, s62
s_lshr_b32 s41, s61, 2
s_and_b32 s44, s2, 31
s_lshr_b32 s45, s2, 5
s_mul_i32 s60, s41, 245760
s_add_u32 s60, s60, 9437184
s_add_u32 s12, s24, s60
s_addc_u32 s13, s25, 0
s_mov_b32 s14, 245760
s_mov_b32 s15, 0x20000
s_lshl_b32 s42, s48, 11
s_mul_i32 s43, s48, 5120
v_mfma_f32_32x32x16_bf16 v[240:255], a[8:11], a[176:179], v[240:255]
ds_read_b64_tr_b16 a[224:225], v85 offset:24832
ds_read_b64_tr_b16 a[226:227], v85 offset:26112
v_lshlrev_b32 v4, 4, v1
v_add_u32 v5, 4096, v4
v_lshlrev_b32 v12, 3, v1
v_add_u32 v12, s41, v12
v_lshlrev_b32 v12, 7, v12
v_cmp_gt_u32 vcc, 24, v1
s_nop 1
v_cndmask_b32 v12, v31, v12, vcc
v_mfma_f32_32x32x16_bf16 v[176:191], a[12:15], a[184:187], v[176:191]
ds_read_b64_tr_b16 a[160:161], v85 offset:29824
ds_read_b64_tr_b16 a[162:163], v85 offset:31104
buffer_load_dwordx4 v9, s[16:19], s74 offen offset:2048 lds
s_mov_b32 s75, 12550144
s_cmp_eq_u32 s48, 0
s_cselect_b32 s75, s75, 17825792
buffer_load_dword v13, v12, s[24:27], s75 offen sc1
v_mfma_f32_32x32x16_bf16 v[192:207], a[12:15], a[188:191], v[192:207]
ds_read_b64_tr_b16 a[164:165], v85 offset:29856
ds_read_b64_tr_b16 a[166:167], v85 offset:31136
v_cvt_pk_bf16_f32 v37, v47, v47
s_nop 1
v_mfma_f32_32x32x16_bf16 v[112:127], a[244:247], v[36:39], v[112:127]
s_waitcnt lgkmcnt(15)
v_cvt_pk_bf16_f32 v32, v42, v42
v_lshlrev_b32 v46, 16, v32
v_mfma_f32_32x32x16_bf16 v[208:223], a[12:15], a[192:195], v[208:223]
ds_read_b64_tr_b16 a[168:169], v85 offset:29888
ds_read_b64_tr_b16 a[170:171], v85 offset:31168
buffer_load_dwordx4 v10, s[16:19], s74 offen offset:3072 lds
v_sub_f32 v46, v42, v46
v_cvt_pk_bf16_f32 v33, v46, v46
s_nop 1
v_mfma_f32_32x32x16_bf16 v[128:143], a[244:247], v[32:35], v[128:143]
v_mfma_f32_32x32x16_bf16 v[224:239], a[12:15], a[196:199], v[224:239]
ds_read_b64_tr_b16 a[172:173], v85 offset:29920
ds_read_b64_tr_b16 a[174:175], v85 offset:31200
v_cvt_pk_bf16_f32 v36, v43, v43
v_lshlrev_b32 v47, 16, v36
v_sub_f32 v47, v43, v47
v_cvt_pk_bf16_f32 v37, v47, v47
v_mfma_f32_32x32x16_bf16 v[240:255], a[12:15], a[200:203], v[240:255]
ds_read_b64_tr_b16 a[176:177], v85 offset:29952
ds_read_b64_tr_b16 a[178:179], v85 offset:31232
s_add_u32 m0, s80, 28800
s_nop 0
buffer_load_dwordx4 v11, s[16:19], s74 offen lds
v_mfma_f32_32x32x16_bf16 v[144:159], a[244:247], v[36:39], v[144:159]
s_waitcnt lgkmcnt(10)
v_mfma_f32_32x32x16_bf16 v[176:191], a[16:19], a[208:211], v[176:191]
ds_read_b64_tr_b16 a[184:185], v85 offset:34944
ds_read_b64_tr_b16 a[186:187], v85 offset:36224
v_cvt_pk_bf16_f32 v32, v44, v44
v_lshlrev_b32 v46, 16, v32
v_sub_f32 v46, v44, v46
v_cvt_pk_bf16_f32 v33, v46, v46
v_mfma_f32_32x32x16_bf16 v[192:207], a[16:19], a[212:215], v[192:207]
ds_read_b64_tr_b16 a[188:189], v85 offset:34976
ds_read_b64_tr_b16 a[190:191], v85 offset:36256
v_mfma_f32_32x32x16_bf16 v[160:175], a[244:247], v[32:35], v[160:175]
v_add_u32 v78, 98816, v76
v_xor_b32 v79, 16, v78
v_fma_f32 v96, v96, v48, s85
v_mfma_f32_32x32x16_bf16 v[208:223], a[16:19], a[216:219], v[208:223]
ds_read_b64_tr_b16 a[192:193], v85 offset:35008
ds_read_b64_tr_b16 a[194:195], v85 offset:36288
v_fma_f32 v97, v97, v49, s85
v_fma_f32 v98, v98, v50, s85
v_fma_f32 v99, v99, v51, s85
v_fma_f32 v100, v100, v52, s85
v_mfma_f32_32x32x16_bf16 v[224:239], a[16:19], a[220:223], v[224:239]
ds_read_b64_tr_b16 a[196:197], v85 offset:35040
ds_read_b64_tr_b16 a[198:199], v85 offset:36320
v_fma_f32 v101, v101, v53, s85
v_fma_f32 v102, v102, v54, s85
v_fma_f32 v103, v103, v55, s85
v_fma_f32 v104, v104, v56, s85
v_mfma_f32_32x32x16_bf16 v[240:255], a[16:19], a[224:227], v[240:255]
ds_read_b64_tr_b16 a[200:201], v85 offset:35072
ds_read_b64_tr_b16 a[202:203], v85 offset:36352
v_fma_f32 v105, v105, v57, s85
v_fma_f32 v106, v106, v58, s85
v_fma_f32 v107, v107, v59, s85
v_fma_f32 v108, v108, v60, s85
s_waitcnt lgkmcnt(10)
v_mfma_f32_32x32x16_bf16 v[176:191], a[20:23], a[160:163], v[176:191]
ds_read_b64_tr_b16 a[208:209], v85 offset:40064
ds_read_b64_tr_b16 a[210:211], v85 offset:41344
v_fma_f32 v109, v109, v61, s85
v_fma_f32 v110, v110, v62, s85
v_fma_f32 v111, v111, v63, s85
v_fma_f32 v68, v96, s84, v64
v_mfma_f32_32x32x16_bf16 v[192:207], a[20:23], a[164:167], v[192:207]
ds_read_b64_tr_b16 a[212:213], v85 offset:40096
ds_read_b64_tr_b16 a[214:215], v85 offset:41376
v_fma_f32 v69, v97, s84, v64
v_fma_f32 v70, v98, s84, v64
v_fma_f32 v71, v99, s84, v64
v_fma_f32 v72, v100, s84, v64
v_mfma_f32_32x32x16_bf16 v[208:223], a[20:23], a[168:171], v[208:223]
ds_read_b64_tr_b16 a[216:217], v85 offset:40128
ds_read_b64_tr_b16 a[218:219], v85 offset:41408
v_fma_f32 v73, v101, s84, v64
v_fma_f32 v74, v102, s84, v64
v_fma_f32 v75, v103, s84, v64
v_exp_f32_e64 v68, v68 clamp
v_mfma_f32_32x32x16_bf16 v[224:239], a[20:23], a[172:175], v[224:239]
ds_read_b64_tr_b16 a[220:221], v85 offset:40160
ds_read_b64_tr_b16 a[222:223], v85 offset:41440
v_exp_f32_e64 v69, v69 clamp
v_exp_f32_e64 v70, v70 clamp
v_exp_f32_e64 v71, v71 clamp
v_exp_f32_e64 v72, v72 clamp
v_mfma_f32_32x32x16_bf16 v[240:255], a[20:23], a[176:179], v[240:255]
ds_read_b64_tr_b16 a[224:225], v85 offset:40192
ds_read_b64_tr_b16 a[226:227], v85 offset:41472
v_exp_f32_e64 v73, v73 clamp
v_exp_f32_e64 v74, v74 clamp
v_exp_f32_e64 v75, v75 clamp
v_max_f32 v96, s85, v96
s_waitcnt vmcnt(6)
s_barrier
s_waitcnt lgkmcnt(10)
v_mfma_f32_32x32x16_bf16 v[176:191], a[24:27], a[184:187], v[176:191]
ds_read_b64_tr_b16 a[160:161], v84 offset:0
ds_read_b64_tr_b16 a[162:163], v84 offset:1280
v_max_f32 v97, s85, v97
v_max_f32 v98, s85, v98
v_max_f32 v99, s85, v99
v_max_f32 v100, s85, v100
v_mfma_f32_32x32x16_bf16 v[192:207], a[24:27], a[188:191], v[192:207]
ds_read_b64_tr_b16 a[164:165], v84 offset:32
ds_read_b64_tr_b16 a[166:167], v84 offset:1312
s_add_u32 s74, s55, 983040
s_add_u32 m0, s80, 49408
s_nop 0
buffer_load_dwordx4 v7, s[16:19], s74 offen lds
v_mfma_f32_32x32x16_bf16 v[208:223], a[24:27], a[192:195], v[208:223]
ds_read_b64_tr_b16 a[168:169], v84 offset:64
ds_read_b64_tr_b16 a[170:171], v84 offset:1344
v_max_f32 v101, s85, v101
v_max_f32 v102, s85, v102
v_max_f32 v103, s85, v103
v_add_f32 v96, v96, v68
v_mfma_f32_32x32x16_bf16 v[224:239], a[24:27], a[196:199], v[224:239]
ds_read_b64_tr_b16 a[172:173], v84 offset:96
ds_read_b64_tr_b16 a[174:175], v84 offset:1376
buffer_load_dwordx4 v8, s[16:19], s74 offen offset:1024 lds
v_add_f32 v97, v97, v69
v_add_f32 v98, v98, v70
v_add_f32 v99, v99, v71
v_mfma_f32_32x32x16_bf16 v[240:255], a[24:27], a[200:203], v[240:255]
ds_read_b64_tr_b16 a[176:177], v84 offset:128
ds_read_b64_tr_b16 a[178:179], v84 offset:1408
v_add_f32 v100, v100, v72
v_add_f32 v101, v101, v73
v_add_f32 v102, v102, v74
v_add_f32 v103, v103, v75
s_waitcnt lgkmcnt(10)
v_mfma_f32_32x32x16_bf16 v[176:191], a[28:31], a[208:211], v[176:191]
ds_read_b64_tr_b16 a[184:185], v84 offset:5120
ds_read_b64_tr_b16 a[186:187], v84 offset:6400
buffer_load_dwordx4 v9, s[16:19], s74 offen offset:2048 lds
v_cvt_pk_bf16_f32 v96, v96, v97
v_cvt_pk_bf16_f32 v97, v98, v99
v_cvt_pk_bf16_f32 v98, v100, v101
v_mfma_f32_32x32x16_bf16 v[192:207], a[28:31], a[212:215], v[192:207]
ds_read_b64_tr_b16 a[188:189], v84 offset:5152
ds_read_b64_tr_b16 a[190:191], v84 offset:6432
v_cvt_pk_bf16_f32 v99, v102, v103
v_fma_f32 v68, v104, s84, v64
v_fma_f32 v69, v105, s84, v64
v_fma_f32 v70, v106, s84, v64
v_mfma_f32_32x32x16_bf16 v[208:223], a[28:31], a[216:219], v[208:223]
ds_read_b64_tr_b16 a[192:193], v84 offset:5184
ds_read_b64_tr_b16 a[194:195], v84 offset:6464
buffer_load_dwordx4 v10, s[16:19], s74 offen offset:3072 lds
v_fma_f32 v71, v107, s84, v64
v_fma_f32 v72, v108, s84, v64
v_fma_f32 v73, v109, s84, v64
v_mfma_f32_32x32x16_bf16 v[224:239], a[28:31], a[220:223], v[224:239]
ds_read_b64_tr_b16 a[196:197], v84 offset:5216
ds_read_b64_tr_b16 a[198:199], v84 offset:6496
v_fma_f32 v74, v110, s84, v64
v_fma_f32 v75, v111, s84, v64
v_exp_f32_e64 v68, v68 clamp
v_exp_f32_e64 v69, v69 clamp
v_mfma_f32_32x32x16_bf16 v[240:255], a[28:31], a[224:227], v[240:255]
ds_read_b64_tr_b16 a[200:201], v84 offset:5248
ds_read_b64_tr_b16 a[202:203], v84 offset:6528
s_add_u32 m0, s80, 53504
s_nop 0
buffer_load_dwordx4 v11, s[16:19], s74 offen lds
v_exp_f32_e64 v70, v70 clamp
s_waitcnt lgkmcnt(10)
v_mfma_f32_32x32x16_bf16 v[176:191], a[32:35], a[160:163], v[176:191]
ds_read_b64_tr_b16 a[208:209], v84 offset:10240
ds_read_b64_tr_b16 a[210:211], v84 offset:11520
v_exp_f32_e64 v71, v71 clamp
v_exp_f32_e64 v72, v72 clamp
v_exp_f32_e64 v73, v73 clamp
v_exp_f32_e64 v74, v74 clamp
v_mfma_f32_32x32x16_bf16 v[192:207], a[32:35], a[164:167], v[192:207]
ds_read_b64_tr_b16 a[212:213], v84 offset:10272
ds_read_b64_tr_b16 a[214:215], v84 offset:11552
v_exp_f32_e64 v75, v75 clamp
v_max_f32 v104, s85, v104
v_max_f32 v105, s85, v105
v_max_f32 v106, s85, v106
v_mfma_f32_32x32x16_bf16 v[208:223], a[32:35], a[168:171], v[208:223]
ds_read_b64_tr_b16 a[216:217], v84 offset:10304
ds_read_b64_tr_b16 a[218:219], v84 offset:11584
v_max_f32 v107, s85, v107
v_max_f32 v108, s85, v108
v_max_f32 v109, s85, v109
v_max_f32 v110, s85, v110
v_mfma_f32_32x32x16_bf16 v[224:239], a[32:35], a[172:175], v[224:239]
ds_read_b64_tr_b16 a[220:221], v84 offset:10336
ds_read_b64_tr_b16 a[222:223], v84 offset:11616
v_max_f32 v111, s85, v111
v_add_f32 v104, v104, v68
v_add_f32 v105, v105, v69
v_add_f32 v106, v106, v70
v_mfma_f32_32x32x16_bf16 v[240:255], a[32:35], a[176:179], v[240:255]
ds_read_b64_tr_b16 a[224:225], v84 offset:10368
ds_read_b64_tr_b16 a[226:227], v84 offset:11648
v_add_f32 v107, v107, v71
v_add_f32 v108, v108, v72
v_add_f32 v109, v109, v73
v_add_f32 v110, v110, v74
s_waitcnt lgkmcnt(10)
v_mfma_f32_32x32x16_bf16 v[176:191], a[36:39], a[184:187], v[176:191]
ds_read_b64_tr_b16 a[160:161], v84 offset:15360
ds_read_b64_tr_b16 a[162:163], v84 offset:16640
v_add_f32 v111, v111, v75
v_cvt_pk_bf16_f32 v104, v104, v105
v_cvt_pk_bf16_f32 v105, v106, v107
v_cvt_pk_bf16_f32 v106, v108, v109
v_mfma_f32_32x32x16_bf16 v[192:207], a[36:39], a[188:191], v[192:207]
ds_read_b64_tr_b16 a[164:165], v84 offset:15392
ds_read_b64_tr_b16 a[166:167], v84 offset:16672
v_cvt_pk_bf16_f32 v107, v110, v111
ds_write_b128 v78, v[96:99] offset:0
ds_write_b128 v79, v[104:107] offset:0
v_fma_f32 v112, v112, v48, s85
v_mfma_f32_32x32x16_bf16 v[208:223], a[36:39], a[192:195], v[208:223]
ds_read_b64_tr_b16 a[168:169], v84 offset:15424
ds_read_b64_tr_b16 a[170:171], v84 offset:16704
v_fma_f32 v113, v113, v49, s85
v_fma_f32 v114, v114, v50, s85
v_fma_f32 v115, v115, v51, s85
v_fma_f32 v116, v116, v52, s85
v_mfma_f32_32x32x16_bf16 v[224:239], a[36:39], a[196:199], v[224:239]
ds_read_b64_tr_b16 a[172:173], v84 offset:15456
ds_read_b64_tr_b16 a[174:175], v84 offset:16736
v_fma_f32 v117, v117, v53, s85
v_fma_f32 v118, v118, v54, s85
v_fma_f32 v119, v119, v55, s85
v_fma_f32 v120, v120, v56, s85
v_mfma_f32_32x32x16_bf16 v[240:255], a[36:39], a[200:203], v[240:255]
ds_read_b64_tr_b16 a[176:177], v84 offset:15488
ds_read_b64_tr_b16 a[178:179], v84 offset:16768
v_fma_f32 v121, v121, v57, s85
v_fma_f32 v122, v122, v58, s85
v_fma_f32 v123, v123, v59, s85
v_fma_f32 v124, v124, v60, s85
s_waitcnt vmcnt(5)
s_barrier
s_waitcnt lgkmcnt(12)
v_mfma_f32_32x32x16_bf16 v[176:191], a[40:43], a[208:211], v[176:191]
ds_read_b64_tr_b16 a[184:185], v84 offset:24704
ds_read_b64_tr_b16 a[186:187], v84 offset:25984
v_fma_f32 v125, v125, v61, s85
v_fma_f32 v126, v126, v62, s85
v_fma_f32 v127, v127, v63, s85
v_fma_f32 v68, v112, s84, v64
v_mfma_f32_32x32x16_bf16 v[192:207], a[40:43], a[212:215], v[192:207]
ds_read_b64_tr_b16 a[188:189], v84 offset:24736
ds_read_b64_tr_b16 a[190:191], v84 offset:26016
s_add_u32 s74, s55, 1228800
s_add_u32 m0, s80, 74112
s_nop 0
buffer_load_dwordx4 v7, s[16:19], s74 offen lds
v_mfma_f32_32x32x16_bf16 v[208:223], a[40:43], a[216:219], v[208:223]
ds_read_b64_tr_b16 a[192:193], v84 offset:24768
ds_read_b64_tr_b16 a[194:195], v84 offset:26048
v_fma_f32 v69, v113, s84, v64
v_fma_f32 v70, v114, s84, v64
v_fma_f32 v71, v115, s84, v64
v_fma_f32 v72, v116, s84, v64
v_mfma_f32_32x32x16_bf16 v[224:239], a[40:43], a[220:223], v[224:239]
ds_read_b64_tr_b16 a[196:197], v84 offset:24800
ds_read_b64_tr_b16 a[198:199], v84 offset:26080
buffer_load_dwordx4 v8, s[16:19], s74 offen offset:1024 lds
v_fma_f32 v73, v117, s84, v64
v_fma_f32 v74, v118, s84, v64
v_fma_f32 v75, v119, s84, v64
v_mfma_f32_32x32x16_bf16 v[240:255], a[40:43], a[224:227], v[240:255]
ds_read_b64_tr_b16 a[200:201], v84 offset:24832
ds_read_b64_tr_b16 a[202:203], v84 offset:26112
v_exp_f32_e64 v68, v68 clamp
v_exp_f32_e64 v69, v69 clamp
v_exp_f32_e64 v70, v70 clamp
v_exp_f32_e64 v71, v71 clamp
s_waitcnt lgkmcnt(10)
v_mfma_f32_32x32x16_bf16 v[176:191], a[44:47], a[160:163], v[176:191]
ds_read_b64_tr_b16 a[208:209], v84 offset:29824
ds_read_b64_tr_b16 a[210:211], v84 offset:31104
buffer_load_dwordx4 v9, s[16:19], s74 offen offset:2048 lds
v_exp_f32_e64 v72, v72 clamp
v_exp_f32_e64 v73, v73 clamp
v_exp_f32_e64 v74, v74 clamp
v_mfma_f32_32x32x16_bf16 v[192:207], a[44:47], a[164:167], v[192:207]
ds_read_b64_tr_b16 a[212:213], v84 offset:29856
ds_read_b64_tr_b16 a[214:215], v84 offset:31136
v_exp_f32_e64 v75, v75 clamp
v_max_f32 v112, s85, v112
v_max_f32 v113, s85, v113
v_max_f32 v114, s85, v114
v_mfma_f32_32x32x16_bf16 v[208:223], a[44:47], a[168:171], v[208:223]
ds_read_b64_tr_b16 a[216:217], v84 offset:29888
ds_read_b64_tr_b16 a[218:219], v84 offset:31168
buffer_load_dwordx4 v10, s[16:19], s74 offen offset:3072 lds
v_max_f32 v115, s85, v115
v_max_f32 v116, s85, v116
v_max_f32 v117, s85, v117
v_mfma_f32_32x32x16_bf16 v[224:239], a[44:47], a[172:175], v[224:239]
ds_read_b64_tr_b16 a[220:221], v84 offset:29920
ds_read_b64_tr_b16 a[222:223], v84 offset:31200
v_max_f32 v118, s85, v118
v_max_f32 v119, s85, v119
v_add_f32 v112, v112, v68
v_add_f32 v113, v113, v69
v_mfma_f32_32x32x16_bf16 v[240:255], a[44:47], a[176:179], v[240:255]
ds_read_b64_tr_b16 a[224:225], v84 offset:29952
ds_read_b64_tr_b16 a[226:227], v84 offset:31232
s_add_u32 m0, s80, 78208
s_nop 0
buffer_load_dwordx4 v11, s[16:19], s74 offen lds
v_add_f32 v114, v114, v70
s_waitcnt lgkmcnt(10)
v_mfma_f32_32x32x16_bf16 v[176:191], a[48:51], a[184:187], v[176:191]
ds_read_b64_tr_b16 a[160:161], v84 offset:34944
ds_read_b64_tr_b16 a[162:163], v84 offset:36224
v_add_f32 v115, v115, v71
v_add_f32 v116, v116, v72
v_add_f32 v117, v117, v73
v_add_f32 v118, v118, v74
v_mfma_f32_32x32x16_bf16 v[192:207], a[48:51], a[188:191], v[192:207]
ds_read_b64_tr_b16 a[164:165], v84 offset:34976
ds_read_b64_tr_b16 a[166:167], v84 offset:36256
v_add_f32 v119, v119, v75
v_cvt_pk_bf16_f32 v112, v112, v113
v_cvt_pk_bf16_f32 v113, v114, v115
v_cvt_pk_bf16_f32 v114, v116, v117
v_mfma_f32_32x32x16_bf16 v[208:223], a[48:51], a[192:195], v[208:223]
ds_read_b64_tr_b16 a[168:169], v84 offset:35008
ds_read_b64_tr_b16 a[170:171], v84 offset:36288
v_cvt_pk_bf16_f32 v115, v118, v119
v_fma_f32 v68, v120, s84, v64
v_fma_f32 v69, v121, s84, v64
v_fma_f32 v70, v122, s84, v64
v_mfma_f32_32x32x16_bf16 v[224:239], a[48:51], a[196:199], v[224:239]
ds_read_b64_tr_b16 a[172:173], v84 offset:35040
ds_read_b64_tr_b16 a[174:175], v84 offset:36320
v_fma_f32 v71, v123, s84, v64
v_fma_f32 v72, v124, s84, v64
v_fma_f32 v73, v125, s84, v64
v_fma_f32 v74, v126, s84, v64
v_mfma_f32_32x32x16_bf16 v[240:255], a[48:51], a[200:203], v[240:255]
ds_read_b64_tr_b16 a[176:177], v84 offset:35072
ds_read_b64_tr_b16 a[178:179], v84 offset:36352
v_fma_f32 v75, v127, s84, v64
v_exp_f32_e64 v68, v68 clamp
v_exp_f32_e64 v69, v69 clamp
v_exp_f32_e64 v70, v70 clamp
s_waitcnt lgkmcnt(10)
v_mfma_f32_32x32x16_bf16 v[176:191], a[52:55], a[208:211], v[176:191]
ds_read_b64_tr_b16 a[184:185], v84 offset:40064
ds_read_b64_tr_b16 a[186:187], v84 offset:41344
v_exp_f32_e64 v71, v71 clamp
v_exp_f32_e64 v72, v72 clamp
v_exp_f32_e64 v73, v73 clamp
v_exp_f32_e64 v74, v74 clamp
v_mfma_f32_32x32x16_bf16 v[192:207], a[52:55], a[212:215], v[192:207]
ds_read_b64_tr_b16 a[188:189], v84 offset:40096
ds_read_b64_tr_b16 a[190:191], v84 offset:41376
v_exp_f32_e64 v75, v75 clamp
v_max_f32 v120, s85, v120
v_max_f32 v121, s85, v121
v_max_f32 v122, s85, v122
v_mfma_f32_32x32x16_bf16 v[208:223], a[52:55], a[216:219], v[208:223]
ds_read_b64_tr_b16 a[192:193], v84 offset:40128
ds_read_b64_tr_b16 a[194:195], v84 offset:41408
v_max_f32 v123, s85, v123
v_max_f32 v124, s85, v124
v_max_f32 v125, s85, v125
v_max_f32 v126, s85, v126
v_mfma_f32_32x32x16_bf16 v[224:239], a[52:55], a[220:223], v[224:239]
ds_read_b64_tr_b16 a[196:197], v84 offset:40160
ds_read_b64_tr_b16 a[198:199], v84 offset:41440
v_max_f32 v127, s85, v127
v_add_f32 v120, v120, v68
v_add_f32 v121, v121, v69
v_add_f32 v122, v122, v70
v_mfma_f32_32x32x16_bf16 v[240:255], a[52:55], a[224:227], v[240:255]
ds_read_b64_tr_b16 a[200:201], v84 offset:40192
ds_read_b64_tr_b16 a[202:203], v84 offset:41472
v_add_f32 v123, v123, v71
v_add_f32 v124, v124, v72
v_add_f32 v125, v125, v73
v_add_f32 v126, v126, v74
s_waitcnt vmcnt(5)
s_barrier
s_waitcnt lgkmcnt(10)
v_mfma_f32_32x32x16_bf16 v[176:191], a[56:59], a[160:163], v[176:191]
ds_read_b64_tr_b16 a[208:209], v85 offset:0
ds_read_b64_tr_b16 a[210:211], v85 offset:1280
v_add_f32 v127, v127, v75
v_cvt_pk_bf16_f32 v120, v120, v121
v_cvt_pk_bf16_f32 v121, v122, v123
v_cvt_pk_bf16_f32 v122, v124, v125
v_mfma_f32_32x32x16_bf16 v[192:207], a[56:59], a[164:167], v[192:207]
ds_read_b64_tr_b16 a[212:213], v85 offset:32
ds_read_b64_tr_b16 a[214:215], v85 offset:1312
s_add_u32 s74, s55, 1474560
s_add_u32 m0, s80, 0
s_nop 0
buffer_load_dwordx4 v7, s[16:19], s74 offen lds
v_mfma_f32_32x32x16_bf16 v[208:223], a[56:59], a[168:171], v[208:223]
ds_read_b64_tr_b16 a[216:217], v85 offset:64
ds_read_b64_tr_b16 a[218:219], v85 offset:1344
v_cvt_pk_bf16_f32 v123, v126, v127
ds_write_b128 v78, v[112:115] offset:4096
ds_write_b128 v79, v[120:123] offset:4096
v_fma_f32 v128, v128, v48, s85
v_mfma_f32_32x32x16_bf16 v[224:239], a[56:59], a[172:175], v[224:239]
ds_read_b64_tr_b16 a[220:221], v85 offset:96
ds_read_b64_tr_b16 a[222:223], v85 offset:1376
buffer_load_dwordx4 v8, s[16:19], s74 offen offset:1024 lds
v_fma_f32 v129, v129, v49, s85
v_fma_f32 v130, v130, v50, s85
v_fma_f32 v131, v131, v51, s85
v_mfma_f32_32x32x16_bf16 v[240:255], a[56:59], a[176:179], v[240:255]
ds_read_b64_tr_b16 a[224:225], v85 offset:128
ds_read_b64_tr_b16 a[226:227], v85 offset:1408
v_fma_f32 v132, v132, v52, s85
v_fma_f32 v133, v133, v53, s85
v_fma_f32 v134, v134, v54, s85
v_fma_f32 v135, v135, v55, s85
s_waitcnt lgkmcnt(12)
v_mfma_f32_32x32x16_bf16 v[176:191], a[60:63], a[184:187], v[176:191]
ds_read_b64_tr_b16 a[160:161], v85 offset:5120
ds_read_b64_tr_b16 a[162:163], v85 offset:6400
buffer_load_dwordx4 v9, s[16:19], s74 offen offset:2048 lds
v_fma_f32 v136, v136, v56, s85
v_fma_f32 v137, v137, v57, s85
v_fma_f32 v138, v138, v58, s85
v_mfma_f32_32x32x16_bf16 v[192:207], a[60:63], a[188:191], v[192:207]
ds_read_b64_tr_b16 a[164:165], v85 offset:5152
ds_read_b64_tr_b16 a[166:167], v85 offset:6432
v_fma_f32 v139, v139, v59, s85
v_fma_f32 v140, v140, v60, s85
v_fma_f32 v141, v141, v61, s85
v_fma_f32 v142, v142, v62, s85
v_mfma_f32_32x32x16_bf16 v[208:223], a[60:63], a[192:195], v[208:223]
ds_read_b64_tr_b16 a[168:169], v85 offset:5184
ds_read_b64_tr_b16 a[170:171], v85 offset:6464
buffer_load_dwordx4 v10, s[16:19], s74 offen offset:3072 lds
v_fma_f32 v143, v143, v63, s85
v_fma_f32 v68, v128, s84, v64
v_fma_f32 v69, v129, s84, v64
v_mfma_f32_32x32x16_bf16 v[224:239], a[60:63], a[196:199], v[224:239]
ds_read_b64_tr_b16 a[172:173], v85 offset:5216
ds_read_b64_tr_b16 a[174:175], v85 offset:6496
v_fma_f32 v70, v130, s84, v64
v_fma_f32 v71, v131, s84, v64
v_fma_f32 v72, v132, s84, v64
v_fma_f32 v73, v133, s84, v64
v_mfma_f32_32x32x16_bf16 v[240:255], a[60:63], a[200:203], v[240:255]
ds_read_b64_tr_b16 a[176:177], v85 offset:5248
ds_read_b64_tr_b16 a[178:179], v85 offset:6528
s_add_u32 m0, s80, 4096
s_nop 0
buffer_load_dwordx4 v11, s[16:19], s74 offen lds
v_fma_f32 v74, v134, s84, v64
s_waitcnt lgkmcnt(10)
v_mfma_f32_32x32x16_bf16 v[176:191], a[64:67], a[208:211], v[176:191]
ds_read_b64_tr_b16 a[184:185], v85 offset:10240
ds_read_b64_tr_b16 a[186:187], v85 offset:11520
v_fma_f32 v75, v135, s84, v64
v_exp_f32_e64 v68, v68 clamp
v_exp_f32_e64 v69, v69 clamp
v_exp_f32_e64 v70, v70 clamp
v_mfma_f32_32x32x16_bf16 v[192:207], a[64:67], a[212:215], v[192:207]
ds_read_b64_tr_b16 a[188:189], v85 offset:10272
ds_read_b64_tr_b16 a[190:191], v85 offset:11552
v_exp_f32_e64 v71, v71 clamp
v_exp_f32_e64 v72, v72 clamp
v_exp_f32_e64 v73, v73 clamp
v_exp_f32_e64 v74, v74 clamp
v_mfma_f32_32x32x16_bf16 v[208:223], a[64:67], a[216:219], v[208:223]
ds_read_b64_tr_b16 a[192:193], v85 offset:10304
ds_read_b64_tr_b16 a[194:195], v85 offset:11584
v_exp_f32_e64 v75, v75 clamp
v_max_f32 v128, s85, v128
v_max_f32 v129, s85, v129
v_max_f32 v130, s85, v130
v_mfma_f32_32x32x16_bf16 v[224:239], a[64:67], a[220:223], v[224:239]
ds_read_b64_tr_b16 a[196:197], v85 offset:10336
ds_read_b64_tr_b16 a[198:199], v85 offset:11616
v_max_f32 v131, s85, v131
v_max_f32 v132, s85, v132
v_max_f32 v133, s85, v133
v_max_f32 v134, s85, v134
v_mfma_f32_32x32x16_bf16 v[240:255], a[64:67], a[224:227], v[240:255]
ds_read_b64_tr_b16 a[200:201], v85 offset:10368
ds_read_b64_tr_b16 a[202:203], v85 offset:11648
v_max_f32 v135, s85, v135
v_add_f32 v128, v128, v68
v_add_f32 v129, v129, v69
v_add_f32 v130, v130, v70
s_waitcnt lgkmcnt(10)
v_mfma_f32_32x32x16_bf16 v[176:191], a[68:71], a[160:163], v[176:191]
ds_read_b64_tr_b16 a[208:209], v85 offset:15360
ds_read_b64_tr_b16 a[210:211], v85 offset:16640
v_add_f32 v131, v131, v71
v_add_f32 v132, v132, v72
v_add_f32 v133, v133, v73
v_add_f32 v134, v134, v74
v_mfma_f32_32x32x16_bf16 v[192:207], a[68:71], a[164:167], v[192:207]
ds_read_b64_tr_b16 a[212:213], v85 offset:15392
ds_read_b64_tr_b16 a[214:215], v85 offset:16672
v_add_f32 v135, v135, v75
v_cvt_pk_bf16_f32 v128, v128, v129
v_cvt_pk_bf16_f32 v129, v130, v131
v_cvt_pk_bf16_f32 v130, v132, v133
v_mfma_f32_32x32x16_bf16 v[208:223], a[68:71], a[168:171], v[208:223]
ds_read_b64_tr_b16 a[216:217], v85 offset:15424
ds_read_b64_tr_b16 a[218:219], v85 offset:16704
v_cvt_pk_bf16_f32 v131, v134, v135
v_fma_f32 v68, v136, s84, v64
v_fma_f32 v69, v137, s84, v64
v_fma_f32 v70, v138, s84, v64
v_mfma_f32_32x32x16_bf16 v[224:239], a[68:71], a[172:175], v[224:239]
ds_read_b64_tr_b16 a[220:221], v85 offset:15456
ds_read_b64_tr_b16 a[222:223], v85 offset:16736
v_fma_f32 v71, v139, s84, v64
v_fma_f32 v72, v140, s84, v64
v_fma_f32 v73, v141, s84, v64
v_fma_f32 v74, v142, s84, v64
v_mfma_f32_32x32x16_bf16 v[240:255], a[68:71], a[176:179], v[240:255]
ds_read_b64_tr_b16 a[224:225], v85 offset:15488
ds_read_b64_tr_b16 a[226:227], v85 offset:16768
v_fma_f32 v75, v143, s84, v64
v_exp_f32_e64 v68, v68 clamp
v_exp_f32_e64 v69, v69 clamp
v_exp_f32_e64 v70, v70 clamp
s_waitcnt vmcnt(5)
s_barrier
s_waitcnt lgkmcnt(10)
v_mfma_f32_32x32x16_bf16 v[176:191], a[72:75], a[184:187], v[176:191]
ds_read_b64_tr_b16 a[160:161], v85 offset:24704
ds_read_b64_tr_b16 a[162:163], v85 offset:25984
v_exp_f32_e64 v71, v71 clamp
v_mov_b32 v13, v13
s_cmp_lg_u32 s48, 0
s_cbranch_scc1 POKEBKV
v_cmp_ne_u32 vcc, v13, v30
s_nop 3
s_and_b32 vcc_lo, vcc_lo, 16777215
s_and_b32 vcc_hi, vcc_hi, 0
s_or_b32 s76, vcc_lo, vcc_hi
s_cbranch_scc0 POKEBKV
s_mov_b32 s77, 4000
s_mov_b32 s75, 12550144
PSPEBKV:
s_sleep 3
buffer_load_dword v13, v12, s[24:27], s75 offen sc1
s_waitcnt vmcnt(0)
v_cmp_ne_u32 vcc, v13, v30
s_nop 3
s_and_b32 vcc_lo, vcc_lo, 16777215
s_and_b32 vcc_hi, vcc_hi, 0
s_or_b32 s76, vcc_lo, vcc_hi
s_cbranch_scc0 POKEBKV
s_sub_u32 s77, s77, 1
s_cmp_lg_u32 s77, 0
s_cbranch_scc1 PSPEBKV
POKEBKV:
s_barrier
v_mfma_f32_32x32x16_bf16 v[192:207], a[72:75], a[188:191], v[192:207]
ds_read_b64_tr_b16 a[164:165], v85 offset:24736
ds_read_b64_tr_b16 a[166:167], v85 offset:26016
s_add_u32 s74, s55, 1720320
s_add_u32 m0, s80, 24704
s_nop 0
buffer_load_dwordx4 v7, s[16:19], s74 offen lds
buffer_load_dwordx4 a[0:3], v4, s[12:15], s43 offen offset:0 sc1
v_mfma_f32_32x32x16_bf16 v[208:223], a[72:75], a[192:195], v[208:223]
ds_read_b64_tr_b16 a[168:169], v85 offset:24768
ds_read_b64_tr_b16 a[170:171], v85 offset:26048
v_exp_f32_e64 v72, v72 clamp
v_exp_f32_e64 v73, v73 clamp
v_exp_f32_e64 v74, v74 clamp
v_exp_f32_e64 v75, v75 clamp
v_mfma_f32_32x32x16_bf16 v[224:239], a[72:75], a[196:199], v[224:239]
ds_read_b64_tr_b16 a[172:173], v85 offset:24800
ds_read_b64_tr_b16 a[174:175], v85 offset:26080
buffer_load_dwordx4 v8, s[16:19], s74 offen offset:1024 lds
buffer_load_dwordx4 a[4:7], v4, s[12:15], s43 offen offset:1024 sc1
v_max_f32 v136, s85, v136
v_max_f32 v137, s85, v137
v_mfma_f32_32x32x16_bf16 v[240:255], a[72:75], a[200:203], v[240:255]
ds_read_b64_tr_b16 a[176:177], v85 offset:24832
ds_read_b64_tr_b16 a[178:179], v85 offset:26112
v_max_f32 v138, s85, v138
v_max_f32 v139, s85, v139
v_max_f32 v140, s85, v140
v_max_f32 v141, s85, v141
s_waitcnt lgkmcnt(10)
v_mfma_f32_32x32x16_bf16 v[176:191], a[76:79], a[208:211], v[176:191]
ds_read_b64_tr_b16 a[184:185], v85 offset:29824
ds_read_b64_tr_b16 a[186:187], v85 offset:31104
buffer_load_dwordx4 v9, s[16:19], s74 offen offset:2048 lds
buffer_load_dwordx4 a[8:11], v4, s[12:15], s43 offen offset:2048 sc1
v_max_f32 v142, s85, v142
v_max_f32 v143, s85, v143
v_mfma_f32_32x32x16_bf16 v[192:207], a[76:79], a[212:215], v[192:207]
ds_read_b64_tr_b16 a[188:189], v85 offset:29856
ds_read_b64_tr_b16 a[190:191], v85 offset:31136
v_add_f32 v136, v136, v68
v_add_f32 v137, v137, v69
v_add_f32 v138, v138, v70
v_add_f32 v139, v139, v71
v_mfma_f32_32x32x16_bf16 v[208:223], a[76:79], a[216:219], v[208:223]
ds_read_b64_tr_b16 a[192:193], v85 offset:29888
ds_read_b64_tr_b16 a[194:195], v85 offset:31168
buffer_load_dwordx4 v10, s[16:19], s74 offen offset:3072 lds
buffer_load_dwordx4 a[12:15], v4, s[12:15], s43 offen offset:3072 sc1
v_add_f32 v140, v140, v72
v_add_f32 v141, v141, v73
v_mfma_f32_32x32x16_bf16 v[224:239], a[76:79], a[220:223], v[224:239]
ds_read_b64_tr_b16 a[196:197], v85 offset:29920
ds_read_b64_tr_b16 a[198:199], v85 offset:31200
v_add_f32 v142, v142, v74
v_add_f32 v143, v143, v75
v_cvt_pk_bf16_f32 v136, v136, v137
v_cvt_pk_bf16_f32 v137, v138, v139
v_mfma_f32_32x32x16_bf16 v[240:255], a[76:79], a[224:227], v[240:255]
ds_read_b64_tr_b16 a[200:201], v85 offset:29952
ds_read_b64_tr_b16 a[202:203], v85 offset:31232
s_add_u32 m0, s80, 28800
s_nop 0
buffer_load_dwordx4 v11, s[16:19], s74 offen lds
buffer_load_dwordx4 a[16:19], v5, s[12:15], s43 offen sc1
s_waitcnt lgkmcnt(10)
v_mfma_f32_32x32x16_bf16 v[176:191], a[80:83], a[160:163], v[176:191]
ds_read_b64_tr_b16 a[208:209], v85 offset:34944
ds_read_b64_tr_b16 a[210:211], v85 offset:36224
v_cvt_pk_bf16_f32 v138, v140, v141
v_cvt_pk_bf16_f32 v139, v142, v143
ds_write_b128 v78, v[128:131] offset:8192
ds_write_b128 v79, v[136:139] offset:8192
v_mfma_f32_32x32x16_bf16 v[192:207], a[80:83], a[164:167], v[192:207]
ds_read_b64_tr_b16 a[212:213], v85 offset:34976
ds_read_b64_tr_b16 a[214:215], v85 offset:36256
s_add_u32 s43, s43, 20480
v_fma_f32 v144, v144, v48, s85
v_fma_f32 v145, v145, v49, s85
v_fma_f32 v146, v146, v50, s85
v_mfma_f32_32x32x16_bf16 v[208:223], a[80:83], a[168:171], v[208:223]
ds_read_b64_tr_b16 a[216:217], v85 offset:35008
ds_read_b64_tr_b16 a[218:219], v85 offset:36288
v_fma_f32 v147, v147, v51, s85
v_fma_f32 v148, v148, v52, s85
v_fma_f32 v149, v149, v53, s85
v_fma_f32 v150, v150, v54, s85
v_mfma_f32_32x32x16_bf16 v[224:239], a[80:83], a[172:175], v[224:239]
ds_read_b64_tr_b16 a[220:221], v85 offset:35040
ds_read_b64_tr_b16 a[222:223], v85 offset:36320
buffer_load_dwordx4 a[20:23], v4, s[12:15], s43 offen offset:0 sc1
v_fma_f32 v151, v151, v55, s85
v_fma_f32 v152, v152, v56, s85
v_fma_f32 v153, v153, v57, s85
v_mfma_f32_32x32x16_bf16 v[240:255], a[80:83], a[176:179], v[240:255]
ds_read_b64_tr_b16 a[224:225], v85 offset:35072
ds_read_b64_tr_b16 a[226:227], v85 offset:36352
v_fma_f32 v154, v154, v58, s85
v_fma_f32 v155, v155, v59, s85
v_fma_f32 v156, v156, v60, s85
v_fma_f32 v157, v157, v61, s85
s_waitcnt lgkmcnt(12)
v_mfma_f32_32x32x16_bf16 v[176:191], a[84:87], a[184:187], v[176:191]
ds_read_b64_tr_b16 a[160:161], v85 offset:40064
ds_read_b64_tr_b16 a[162:163], v85 offset:41344
buffer_load_dwordx4 a[24:27], v4, s[12:15], s43 offen offset:1024 sc1
v_fma_f32 v158, v158, v62, s85
v_fma_f32 v159, v159, v63, s85
v_fma_f32 v68, v144, s84, v64
v_mfma_f32_32x32x16_bf16 v[192:207], a[84:87], a[188:191], v[192:207]
ds_read_b64_tr_b16 a[164:165], v85 offset:40096
ds_read_b64_tr_b16 a[166:167], v85 offset:41376
v_fma_f32 v69, v145, s84, v64
v_fma_f32 v70, v146, s84, v64
v_fma_f32 v71, v147, s84, v64
v_fma_f32 v72, v148, s84, v64
v_mfma_f32_32x32x16_bf16 v[208:223], a[84:87], a[192:195], v[208:223]
ds_read_b64_tr_b16 a[168:169], v85 offset:40128
ds_read_b64_tr_b16 a[170:171], v85 offset:41408
buffer_load_dwordx4 a[28:31], v4, s[12:15], s43 offen offset:2048 sc1
v_fma_f32 v73, v149, s84, v64
v_fma_f32 v74, v150, s84, v64
v_fma_f32 v75, v151, s84, v64
v_mfma_f32_32x32x16_bf16 v[224:239], a[84:87], a[196:199], v[224:239]
ds_read_b64_tr_b16 a[172:173], v85 offset:40160
ds_read_b64_tr_b16 a[174:175], v85 offset:41440
v_exp_f32_e64 v68, v68 clamp
v_exp_f32_e64 v69, v69 clamp
v_exp_f32_e64 v70, v70 clamp
v_exp_f32_e64 v71, v71 clamp
v_mfma_f32_32x32x16_bf16 v[240:255], a[84:87], a[200:203], v[240:255]
ds_read_b64_tr_b16 a[176:177], v85 offset:40192
ds_read_b64_tr_b16 a[178:179], v85 offset:41472
buffer_load_dwordx4 a[32:35], v4, s[12:15], s43 offen offset:3072 sc1
v_exp_f32_e64 v72, v72 clamp
v_exp_f32_e64 v73, v73 clamp
v_exp_f32_e64 v74, v74 clamp
s_waitcnt vmcnt(14)
s_barrier
s_waitcnt lgkmcnt(10)
v_mfma_f32_32x32x16_bf16 v[176:191], a[88:91], a[208:211], v[176:191]
ds_read_b64_tr_b16 a[184:185], v84 offset:0
ds_read_b64_tr_b16 a[186:187], v84 offset:1280
v_exp_f32_e64 v75, v75 clamp
v_max_f32 v144, s85, v144
v_max_f32 v145, s85, v145
v_max_f32 v146, s85, v146
v_mfma_f32_32x32x16_bf16 v[192:207], a[88:91], a[212:215], v[192:207]
ds_read_b64_tr_b16 a[188:189], v84 offset:32
ds_read_b64_tr_b16 a[190:191], v84 offset:1312
s_add_u32 s74, s55, 1966080
s_add_u32 m0, s80, 49408
s_nop 0
buffer_load_dwordx4 v7, s[16:19], s74 offen lds
buffer_load_dwordx4 a[36:39], v5, s[12:15], s43 offen sc1
v_mfma_f32_32x32x16_bf16 v[208:223], a[88:91], a[216:219], v[208:223]
ds_read_b64_tr_b16 a[192:193], v84 offset:64
ds_read_b64_tr_b16 a[194:195], v84 offset:1344
v_max_f32 v147, s85, v147
v_max_f32 v148, s85, v148
v_max_f32 v149, s85, v149
v_max_f32 v150, s85, v150
v_mfma_f32_32x32x16_bf16 v[224:239], a[88:91], a[220:223], v[224:239]
ds_read_b64_tr_b16 a[196:197], v84 offset:96
ds_read_b64_tr_b16 a[198:199], v84 offset:1376
buffer_load_dwordx4 v8, s[16:19], s74 offen offset:1024 lds
s_add_u32 s43, s43, 20480
v_max_f32 v151, s85, v151
v_add_f32 v144, v144, v68
v_mfma_f32_32x32x16_bf16 v[240:255], a[88:91], a[224:227], v[240:255]
ds_read_b64_tr_b16 a[200:201], v84 offset:128
ds_read_b64_tr_b16 a[202:203], v84 offset:1408
v_add_f32 v145, v145, v69
v_add_f32 v146, v146, v70
v_add_f32 v147, v147, v71
v_add_f32 v148, v148, v72
s_waitcnt lgkmcnt(10)
v_mfma_f32_32x32x16_bf16 v[176:191], a[92:95], a[160:163], v[176:191]
ds_read_b64_tr_b16 a[208:209], v84 offset:5120
ds_read_b64_tr_b16 a[210:211], v84 offset:6400
buffer_load_dwordx4 v9, s[16:19], s74 offen offset:2048 lds
buffer_load_dwordx4 a[40:43], v4, s[12:15], s43 offen offset:0 sc1
v_add_f32 v149, v149, v73
v_add_f32 v150, v150, v74
v_mfma_f32_32x32x16_bf16 v[192:207], a[92:95], a[164:167], v[192:207]
ds_read_b64_tr_b16 a[212:213], v84 offset:5152
ds_read_b64_tr_b16 a[214:215], v84 offset:6432
v_add_f32 v151, v151, v75
v_cvt_pk_bf16_f32 v144, v144, v145
v_cvt_pk_bf16_f32 v145, v146, v147
v_cvt_pk_bf16_f32 v146, v148, v149
v_mfma_f32_32x32x16_bf16 v[208:223], a[92:95], a[168:171], v[208:223]
ds_read_b64_tr_b16 a[216:217], v84 offset:5184
ds_read_b64_tr_b16 a[218:219], v84 offset:6464
buffer_load_dwordx4 v10, s[16:19], s74 offen offset:3072 lds
buffer_load_dwordx4 a[44:47], v4, s[12:15], s43 offen offset:1024 sc1
v_cvt_pk_bf16_f32 v147, v150, v151
v_fma_f32 v68, v152, s84, v64
v_mfma_f32_32x32x16_bf16 v[224:239], a[92:95], a[172:175], v[224:239]
ds_read_b64_tr_b16 a[220:221], v84 offset:5216
ds_read_b64_tr_b16 a[222:223], v84 offset:6496
v_fma_f32 v69, v153, s84, v64
v_fma_f32 v70, v154, s84, v64
v_fma_f32 v71, v155, s84, v64
v_fma_f32 v72, v156, s84, v64
v_mfma_f32_32x32x16_bf16 v[240:255], a[92:95], a[176:179], v[240:255]
ds_read_b64_tr_b16 a[224:225], v84 offset:5248
ds_read_b64_tr_b16 a[226:227], v84 offset:6528
s_add_u32 m0, s80, 53504
s_nop 0
buffer_load_dwordx4 v11, s[16:19], s74 offen lds
buffer_load_dwordx4 a[48:51], v4, s[12:15], s43 offen offset:2048 sc1
s_waitcnt lgkmcnt(10)
v_mfma_f32_32x32x16_bf16 v[176:191], a[96:99], a[184:187], v[176:191]
ds_read_b64_tr_b16 a[160:161], v84 offset:10240
ds_read_b64_tr_b16 a[162:163], v84 offset:11520
v_fma_f32 v73, v157, s84, v64
v_fma_f32 v74, v158, s84, v64
v_fma_f32 v75, v159, s84, v64
v_exp_f32_e64 v68, v68 clamp
v_mfma_f32_32x32x16_bf16 v[192:207], a[96:99], a[188:191], v[192:207]
ds_read_b64_tr_b16 a[164:165], v84 offset:10272
ds_read_b64_tr_b16 a[166:167], v84 offset:11552
buffer_load_dwordx4 a[52:55], v4, s[12:15], s43 offen offset:3072 sc1
v_exp_f32_e64 v69, v69 clamp
v_exp_f32_e64 v70, v70 clamp
v_exp_f32_e64 v71, v71 clamp
v_mfma_f32_32x32x16_bf16 v[208:223], a[96:99], a[192:195], v[208:223]
ds_read_b64_tr_b16 a[168:169], v84 offset:10304
ds_read_b64_tr_b16 a[170:171], v84 offset:11584
v_exp_f32_e64 v72, v72 clamp
v_exp_f32_e64 v73, v73 clamp
v_exp_f32_e64 v74, v74 clamp
v_exp_f32_e64 v75, v75 clamp
v_mfma_f32_32x32x16_bf16 v[224:239], a[96:99], a[196:199], v[224:239]
ds_read_b64_tr_b16 a[172:173], v84 offset:10336
ds_read_b64_tr_b16 a[174:175], v84 offset:11616
buffer_load_dwordx4 a[56:59], v5, s[12:15], s43 offen sc1
v_max_f32 v152, s85, v152
v_max_f32 v153, s85, v153
v_max_f32 v154, s85, v154
v_mfma_f32_32x32x16_bf16 v[240:255], a[96:99], a[200:203], v[240:255]
ds_read_b64_tr_b16 a[176:177], v84 offset:10368
ds_read_b64_tr_b16 a[178:179], v84 offset:11648
v_max_f32 v155, s85, v155
v_max_f32 v156, s85, v156
v_max_f32 v157, s85, v157
v_max_f32 v158, s85, v158
s_waitcnt lgkmcnt(10)
v_mfma_f32_32x32x16_bf16 v[176:191], a[100:103], a[208:211], v[176:191]
ds_read_b64_tr_b16 a[184:185], v84 offset:15360
ds_read_b64_tr_b16 a[186:187], v84 offset:16640
s_add_u32 s43, s43, 20480
v_max_f32 v159, s85, v159
v_add_f32 v152, v152, v68
v_add_f32 v153, v153, v69
v_mfma_f32_32x32x16_bf16 v[192:207], a[100:103], a[212:215], v[192:207]
ds_read_b64_tr_b16 a[188:189], v84 offset:15392
ds_read_b64_tr_b16 a[190:191], v84 offset:16672
v_add_f32 v154, v154, v70
v_add_f32 v155, v155, v71
v_add_f32 v156, v156, v72
v_add_f32 v157, v157, v73
v_mfma_f32_32x32x16_bf16 v[208:223], a[100:103], a[216:219], v[208:223]
ds_read_b64_tr_b16 a[192:193], v84 offset:15424
ds_read_b64_tr_b16 a[194:195], v84 offset:16704
buffer_load_dwordx4 a[60:63], v4, s[12:15], s43 offen offset:0 sc1
v_add_f32 v158, v158, v74
v_add_f32 v159, v159, v75
v_cvt_pk_bf16_f32 v152, v152, v153
v_mfma_f32_32x32x16_bf16 v[224:239], a[100:103], a[220:223], v[224:239]
ds_read_b64_tr_b16 a[196:197], v84 offset:15456
ds_read_b64_tr_b16 a[198:199], v84 offset:16736
v_cvt_pk_bf16_f32 v153, v154, v155
v_cvt_pk_bf16_f32 v154, v156, v157
v_cvt_pk_bf16_f32 v155, v158, v159
ds_write_b128 v78, v[144:147] offset:12288
ds_write_b128 v79, v[152:155] offset:12288
v_mfma_f32_32x32x16_bf16 v[240:255], a[100:103], a[224:227], v[240:255]
ds_read_b64_tr_b16 a[200:201], v84 offset:15488
ds_read_b64_tr_b16 a[202:203], v84 offset:16768
buffer_load_dwordx4 a[64:67], v4, s[12:15], s43 offen offset:1024 sc1
v_fma_f32 v160, v160, v48, s85
v_fma_f32 v161, v161, v49, s85
v_fma_f32 v162, v162, v50, s85
s_waitcnt vmcnt(18)
s_barrier
s_waitcnt lgkmcnt(12)
v_mfma_f32_32x32x16_bf16 v[176:191], a[104:107], a[160:163], v[176:191]
ds_read_b64_tr_b16 a[208:209], v84 offset:24704
ds_read_b64_tr_b16 a[210:211], v84 offset:25984
v_fma_f32 v163, v163, v51, s85
v_fma_f32 v164, v164, v52, s85
v_fma_f32 v165, v165, v53, s85
v_fma_f32 v166, v166, v54, s85
v_mfma_f32_32x32x16_bf16 v[192:207], a[104:107], a[164:167], v[192:207]
ds_read_b64_tr_b16 a[212:213], v84 offset:24736
ds_read_b64_tr_b16 a[214:215], v84 offset:26016
s_add_u32 s74, s55, 2211840
s_add_u32 m0, s80, 74112
s_nop 0
buffer_load_dwordx4 v7, s[16:19], s74 offen lds
buffer_load_dwordx4 a[68:71], v4, s[12:15], s43 offen offset:2048 sc1
v_mfma_f32_32x32x16_bf16 v[208:223], a[104:107], a[168:171], v[208:223]
ds_read_b64_tr_b16 a[216:217], v84 offset:24768
ds_read_b64_tr_b16 a[218:219], v84 offset:26048
v_fma_f32 v167, v167, v55, s85
v_fma_f32 v168, v168, v56, s85
v_fma_f32 v169, v169, v57, s85
v_fma_f32 v170, v170, v58, s85
v_mfma_f32_32x32x16_bf16 v[224:239], a[104:107], a[172:175], v[224:239]
ds_read_b64_tr_b16 a[220:221], v84 offset:24800
ds_read_b64_tr_b16 a[222:223], v84 offset:26080
buffer_load_dwordx4 v8, s[16:19], s74 offen offset:1024 lds
buffer_load_dwordx4 a[72:75], v4, s[12:15], s43 offen offset:3072 sc1
v_fma_f32 v171, v171, v59, s85
v_fma_f32 v172, v172, v60, s85
v_mfma_f32_32x32x16_bf16 v[240:255], a[104:107], a[176:179], v[240:255]
ds_read_b64_tr_b16 a[224:225], v84 offset:24832
ds_read_b64_tr_b16 a[226:227], v84 offset:26112
v_fma_f32 v173, v173, v61, s85
v_fma_f32 v174, v174, v62, s85
v_fma_f32 v175, v175, v63, s85
v_fma_f32 v68, v160, s84, v64
s_waitcnt lgkmcnt(10)
v_mfma_f32_32x32x16_bf16 v[176:191], a[108:111], a[184:187], v[176:191]
ds_read_b64_tr_b16 a[160:161], v84 offset:29824
ds_read_b64_tr_b16 a[162:163], v84 offset:31104
buffer_load_dwordx4 v9, s[16:19], s74 offen offset:2048 lds
buffer_load_dwordx4 a[76:79], v5, s[12:15], s43 offen sc1
v_fma_f32 v69, v161, s84, v64
v_fma_f32 v70, v162, s84, v64
v_mfma_f32_32x32x16_bf16 v[192:207], a[108:111], a[188:191], v[192:207]
ds_read_b64_tr_b16 a[164:165], v84 offset:29856
ds_read_b64_tr_b16 a[166:167], v84 offset:31136
v_fma_f32 v71, v163, s84, v64
v_fma_f32 v72, v164, s84, v64
v_fma_f32 v73, v165, s84, v64
v_fma_f32 v74, v166, s84, v64
v_mfma_f32_32x32x16_bf16 v[208:223], a[108:111], a[192:195], v[208:223]
ds_read_b64_tr_b16 a[168:169], v84 offset:29888
ds_read_b64_tr_b16 a[170:171], v84 offset:31168
buffer_load_dwordx4 v10, s[16:19], s74 offen offset:3072 lds
s_add_u32 s43, s43, 20480
v_fma_f32 v75, v167, s84, v64
v_exp_f32_e64 v68, v68 clamp
v_mfma_f32_32x32x16_bf16 v[224:239], a[108:111], a[196:199], v[224:239]
ds_read_b64_tr_b16 a[172:173], v84 offset:29920
ds_read_b64_tr_b16 a[174:175], v84 offset:31200
v_exp_f32_e64 v69, v69 clamp
v_exp_f32_e64 v70, v70 clamp
v_exp_f32_e64 v71, v71 clamp
v_exp_f32_e64 v72, v72 clamp
v_mfma_f32_32x32x16_bf16 v[240:255], a[108:111], a[200:203], v[240:255]
ds_read_b64_tr_b16 a[176:177], v84 offset:29952
ds_read_b64_tr_b16 a[178:179], v84 offset:31232
s_add_u32 m0, s80, 78208
s_nop 0
buffer_load_dwordx4 v11, s[16:19], s74 offen lds
buffer_load_dwordx4 a[80:83], v4, s[12:15], s43 offen offset:0 sc1
s_waitcnt lgkmcnt(10)
v_mfma_f32_32x32x16_bf16 v[176:191], a[112:115], a[208:211], v[176:191]
ds_read_b64_tr_b16 a[184:185], v84 offset:34944
ds_read_b64_tr_b16 a[186:187], v84 offset:36224
v_exp_f32_e64 v73, v73 clamp
v_exp_f32_e64 v74, v74 clamp
v_exp_f32_e64 v75, v75 clamp
v_max_f32 v160, s85, v160
v_mfma_f32_32x32x16_bf16 v[192:207], a[112:115], a[212:215], v[192:207]
ds_read_b64_tr_b16 a[188:189], v84 offset:34976
ds_read_b64_tr_b16 a[190:191], v84 offset:36256
buffer_load_dwordx4 a[84:87], v4, s[12:15], s43 offen offset:1024 sc1
v_max_f32 v161, s85, v161
v_max_f32 v162, s85, v162
v_max_f32 v163, s85, v163
v_mfma_f32_32x32x16_bf16 v[208:223], a[112:115], a[216:219], v[208:223]
ds_read_b64_tr_b16 a[192:193], v84 offset:35008
ds_read_b64_tr_b16 a[194:195], v84 offset:36288
v_max_f32 v164, s85, v164
v_max_f32 v165, s85, v165
v_max_f32 v166, s85, v166
v_max_f32 v167, s85, v167
v_mfma_f32_32x32x16_bf16 v[224:239], a[112:115], a[220:223], v[224:239]
ds_read_b64_tr_b16 a[196:197], v84 offset:35040
ds_read_b64_tr_b16 a[198:199], v84 offset:36320
buffer_load_dwordx4 a[88:91], v4, s[12:15], s43 offen offset:2048 sc1
v_add_f32 v160, v160, v68
v_add_f32 v161, v161, v69
v_add_f32 v162, v162, v70
v_mfma_f32_32x32x16_bf16 v[240:255], a[112:115], a[224:227], v[240:255]
ds_read_b64_tr_b16 a[200:201], v84 offset:35072
ds_read_b64_tr_b16 a[202:203], v84 offset:36352
v_add_f32 v163, v163, v71
v_add_f32 v164, v164, v72
v_add_f32 v165, v165, v73
v_add_f32 v166, v166, v74
s_waitcnt lgkmcnt(10)
v_mfma_f32_32x32x16_bf16 v[176:191], a[116:119], a[160:163], v[176:191]
ds_read_b64_tr_b16 a[208:209], v84 offset:40064
ds_read_b64_tr_b16 a[210:211], v84 offset:41344
buffer_load_dwordx4 a[92:95], v4, s[12:15], s43 offen offset:3072 sc1
v_add_f32 v167, v167, v75
v_cvt_pk_bf16_f32 v160, v160, v161
v_cvt_pk_bf16_f32 v161, v162, v163
v_mfma_f32_32x32x16_bf16 v[192:207], a[116:119], a[164:167], v[192:207]
ds_read_b64_tr_b16 a[212:213], v84 offset:40096
ds_read_b64_tr_b16 a[214:215], v84 offset:41376
v_cvt_pk_bf16_f32 v162, v164, v165
v_cvt_pk_bf16_f32 v163, v166, v167
v_fma_f32 v68, v168, s84, v64
v_fma_f32 v69, v169, s84, v64
v_mfma_f32_32x32x16_bf16 v[208:223], a[116:119], a[168:171], v[208:223]
ds_read_b64_tr_b16 a[216:217], v84 offset:40128
ds_read_b64_tr_b16 a[218:219], v84 offset:41408
buffer_load_dwordx4 a[96:99], v5, s[12:15], s43 offen sc1
v_fma_f32 v70, v170, s84, v64
v_fma_f32 v71, v171, s84, v64
v_fma_f32 v72, v172, s84, v64
v_mfma_f32_32x32x16_bf16 v[224:239], a[116:119], a[172:175], v[224:239]
ds_read_b64_tr_b16 a[220:221], v84 offset:40160
ds_read_b64_tr_b16 a[222:223], v84 offset:41440
v_fma_f32 v73, v173, s84, v64
v_fma_f32 v74, v174, s84, v64
v_fma_f32 v75, v175, s84, v64
v_exp_f32_e64 v68, v68 clamp
v_mfma_f32_32x32x16_bf16 v[240:255], a[116:119], a[176:179], v[240:255]
ds_read_b64_tr_b16 a[224:225], v84 offset:40192
ds_read_b64_tr_b16 a[226:227], v84 offset:41472
s_add_u32 s43, s43, 20480
v_exp_f32_e64 v69, v69 clamp
v_exp_f32_e64 v70, v70 clamp
v_exp_f32_e64 v71, v71 clamp
s_waitcnt vmcnt(18)
s_barrier
s_waitcnt lgkmcnt(10)
v_mfma_f32_32x32x16_bf16 v[176:191], a[120:123], a[184:187], v[176:191]
ds_read_b64_tr_b16 a[160:161], v85 offset:0
ds_read_b64_tr_b16 a[162:163], v85 offset:1280
v_exp_f32_e64 v72, v72 clamp
v_exp_f32_e64 v73, v73 clamp
v_exp_f32_e64 v74, v74 clamp
v_exp_f32_e64 v75, v75 clamp
v_mfma_f32_32x32x16_bf16 v[192:207], a[120:123], a[188:191], v[192:207]
ds_read_b64_tr_b16 a[164:165], v85 offset:32
ds_read_b64_tr_b16 a[166:167], v85 offset:1312
v_max_f32 v168, s85, v168
v_max_f32 v169, s85, v169
v_max_f32 v170, s85, v170
v_max_f32 v171, s85, v171
v_mfma_f32_32x32x16_bf16 v[208:223], a[120:123], a[192:195], v[208:223]
ds_read_b64_tr_b16 a[168:169], v85 offset:64
ds_read_b64_tr_b16 a[170:171], v85 offset:1344
v_max_f32 v172, s85, v172
v_max_f32 v173, s85, v173
v_max_f32 v174, s85, v174
v_max_f32 v175, s85, v175
v_mfma_f32_32x32x16_bf16 v[224:239], a[120:123], a[196:199], v[224:239]
ds_read_b64_tr_b16 a[172:173], v85 offset:96
ds_read_b64_tr_b16 a[174:175], v85 offset:1376
v_add_f32 v168, v168, v68
v_add_f32 v169, v169, v69
v_add_f32 v170, v170, v70
v_add_f32 v171, v171, v71
v_mfma_f32_32x32x16_bf16 v[240:255], a[120:123], a[200:203], v[240:255]
ds_read_b64_tr_b16 a[176:177], v85 offset:128
ds_read_b64_tr_b16 a[178:179], v85 offset:1408
v_add_f32 v172, v172, v72
v_add_f32 v173, v173, v73
v_add_f32 v174, v174, v74
v_add_f32 v175, v175, v75
s_waitcnt lgkmcnt(10)
v_mfma_f32_32x32x16_bf16 v[176:191], a[124:127], a[208:211], v[176:191]
ds_read_b64_tr_b16 a[184:185], v85 offset:5120
ds_read_b64_tr_b16 a[186:187], v85 offset:6400
v_cvt_pk_bf16_f32 v168, v168, v169
v_cvt_pk_bf16_f32 v169, v170, v171
v_cvt_pk_bf16_f32 v170, v172, v173
v_cvt_pk_bf16_f32 v171, v174, v175
v_mfma_f32_32x32x16_bf16 v[192:207], a[124:127], a[212:215], v[192:207]
ds_read_b64_tr_b16 a[188:189], v85 offset:5152
ds_read_b64_tr_b16 a[190:191], v85 offset:6432
ds_write_b128 v78, v[160:163] offset:16384
ds_write_b128 v79, v[168:171] offset:16384
v_and_b32 v80, 31, v1
v_lshrrev_b32 v81, 5, v1
s_lshl_b32 s60, s48, 1
s_add_u32 s60, s60, 0
s_mul_i32 s60, s60, 20
v_add_u32 v82, s60, v80
v_and_b32 v83, 15, v82
v_xor_b32 v83, v83, v81
v_lshlrev_b32 v83, 4, v83
v_lshl_add_u32 v83, v82, 8, v83
v_add_u32 v87, 98816, v83
v_add_u32 v86, 0, v83
v_mov_b32 v83, 161024
v_cmp_gt_u32 vcc, 20, v80
s_nop 1
v_cndmask_b32 v86, v83, v86, vcc
v_cndmask_b32 v87, v83, v87, vcc
v_mfma_f32_32x32x16_bf16 v[208:223], a[124:127], a[216:219], v[208:223]
ds_read_b64_tr_b16 a[192:193], v85 offset:5184
ds_read_b64_tr_b16 a[194:195], v85 offset:6464
v_and_b32 v80, 31, v1
v_lshrrev_b32 v81, 5, v1
s_lshl_b32 s60, s48, 1
s_add_u32 s60, s60, 1
s_mul_i32 s60, s60, 20
v_add_u32 v82, s60, v80
v_and_b32 v83, 15, v82
v_xor_b32 v83, v83, v81
v_lshlrev_b32 v83, 4, v83
v_lshl_add_u32 v83, v82, 8, v83
v_add_u32 v89, 98816, v83
v_add_u32 v88, 0, v83
v_mov_b32 v83, 161024
v_cmp_gt_u32 vcc, 20, v80
s_nop 1
v_cndmask_b32 v88, v83, v88, vcc
v_cndmask_b32 v89, v83, v89, vcc
v_mfma_f32_32x32x16_bf16 v[224:239], a[124:127], a[220:223], v[224:239]
ds_read_b64_tr_b16 a[196:197], v85 offset:5216
ds_read_b64_tr_b16 a[198:199], v85 offset:6496
s_mul_i32 s60, s48, 6144
s_add_u32 s60, s60, 40960
v_and_b32 v80, 31, v1
v_min_u32 v80, 20, v80
v_mul_u32_u24 v80, 144, v80
v_lshrrev_b32 v81, 5, v1
v_lshl_add_u32 v80, v81, 6, v80
v_add_u32 v90, s60, v80
v_lshrrev_b32 v80, 3, v1
v_mul_u32_u24 v80, 144, v80
v_and_b32 v81, 7, v1
v_lshl_add_u32 v80, v81, 4, v80
v_add_u32 v91, s60, v80
v_cmp_gt_u32 vcc, 32, v1
v_add_u32 v80, 2048, v22
s_nop 0
v_cndmask_b32 v93, v31, v80, vcc
v_mfma_f32_32x32x16_bf16 v[240:255], a[124:127], a[224:227], v[240:255]
ds_read_b64_tr_b16 a[200:201], v85 offset:5248
ds_read_b64_tr_b16 a[202:203], v85 offset:6528
buffer_load_dwordx4 a[100:103], v4, s[12:15], s43 offen offset:0 sc1
s_waitcnt lgkmcnt(6)
s_barrier
v_xor_b32 v80, 0, v87
ds_read_b128 v[96:99], v80
v_mfma_f32_32x32x16_bf16 v[176:191], a[128:131], a[160:163], v[176:191]
ds_read_b64_tr_b16 a[208:209], v85 offset:10240
ds_read_b64_tr_b16 a[210:211], v85 offset:11520
v_xor_b32 v81, 32, v87
ds_read_b128 v[100:103], v81
v_xor_b32 v80, 64, v87
ds_read_b128 v[104:107], v80
v_mfma_f32_32x32x16_bf16 v[192:207], a[128:131], a[164:167], v[192:207]
ds_read_b64_tr_b16 a[212:213], v85 offset:10272
ds_read_b64_tr_b16 a[214:215], v85 offset:11552
buffer_load_dwordx4 a[104:107], v4, s[12:15], s43 offen offset:1024 sc1
v_xor_b32 v81, 96, v87
ds_read_b128 v[108:111], v81
v_xor_b32 v80, 128, v87
ds_read_b128 v[112:115], v80
v_mfma_f32_32x32x16_bf16 v[208:223], a[128:131], a[168:171], v[208:223]
ds_read_b64_tr_b16 a[216:217], v85 offset:10304
ds_read_b64_tr_b16 a[218:219], v85 offset:11584
v_xor_b32 v81, 160, v87
ds_read_b128 v[116:119], v81
v_xor_b32 v80, 192, v87
ds_read_b128 v[120:123], v80
v_mfma_f32_32x32x16_bf16 v[224:239], a[128:131], a[172:175], v[224:239]
ds_read_b64_tr_b16 a[220:221], v85 offset:10336
ds_read_b64_tr_b16 a[222:223], v85 offset:11616
buffer_load_dwordx4 a[108:111], v4, s[12:15], s43 offen offset:2048 sc1
v_xor_b32 v81, 224, v87
ds_read_b128 v[124:127], v81
v_xor_b32 v80, 0, v89
ds_read_b128 v[128:131], v80
v_mfma_f32_32x32x16_bf16 v[240:255], a[128:131], a[176:179], v[240:255]
ds_read_b64_tr_b16 a[224:225], v85 offset:10368
ds_read_b64_tr_b16 a[226:227], v85 offset:11648
v_xor_b32 v81, 32, v89
ds_read_b128 v[132:135], v81
v_xor_b32 v80, 64, v89
ds_read_b128 v[136:139], v80
s_waitcnt lgkmcnt(15)
v_mfma_f32_32x32x16_bf16 v[176:191], a[132:135], a[184:187], v[176:191]
ds_read_b64_tr_b16 a[160:161], v85 offset:15360
ds_read_b64_tr_b16 a[162:163], v85 offset:16640
buffer_load_dwordx4 a[112:115], v4, s[12:15], s43 offen offset:3072 sc1
v_xor_b32 v81, 96, v89
ds_read_b128 v[140:143], v81
v_xor_b32 v80, 128, v89
ds_read_b128 v[144:147], v80
v_mfma_f32_32x32x16_bf16 v[192:207], a[132:135], a[188:191], v[192:207]
ds_read_b64_tr_b16 a[164:165], v85 offset:15392
ds_read_b64_tr_b16 a[166:167], v85 offset:16672
v_xor_b32 v81, 160, v89
ds_read_b128 v[148:151], v81
v_xor_b32 v80, 192, v89
ds_read_b128 v[152:155], v80
v_mfma_f32_32x32x16_bf16 v[208:223], a[132:135], a[192:195], v[208:223]
ds_read_b64_tr_b16 a[168:169], v85 offset:15424
ds_read_b64_tr_b16 a[170:171], v85 offset:16704
buffer_load_dwordx4 a[116:119], v5, s[12:15], s43 offen sc1
v_xor_b32 v81, 224, v89
ds_read_b128 v[156:159], v81
v_mfma_f32_32x32x16_bf16 v[224:239], a[132:135], a[196:199], v[224:239]
ds_read_b64_tr_b16 a[172:173], v85 offset:15456
ds_read_b64_tr_b16 a[174:175], v85 offset:16736
v_mfma_f32_32x32x16_bf16 v[240:255], a[132:135], a[200:203], v[240:255]
ds_read_b64_tr_b16 a[176:177], v85 offset:15488
ds_read_b64_tr_b16 a[178:179], v85 offset:16768
s_add_u32 s43, s43, 20480
s_waitcnt vmcnt(10)
s_barrier
s_waitcnt lgkmcnt(15)
v_mfma_f32_32x32x16_bf16 v[176:191], a[136:139], a[208:211], v[176:191]
ds_read_b64_tr_b16 a[184:185], v85 offset:24704
ds_read_b64_tr_b16 a[186:187], v85 offset:25984
v_mfma_f32_32x32x16_bf16 v[192:207], a[136:139], a[212:215], v[192:207]
ds_read_b64_tr_b16 a[188:189], v85 offset:24736
ds_read_b64_tr_b16 a[190:191], v85 offset:26016
v_mfma_f32_32x32x16_bf16 v[208:223], a[136:139], a[216:219], v[208:223]
ds_read_b64_tr_b16 a[192:193], v85 offset:24768
ds_read_b64_tr_b16 a[194:195], v85 offset:26048
v_mfma_f32_32x32x16_bf16 v[224:239], a[136:139], a[220:223], v[224:239]
ds_read_b64_tr_b16 a[196:197], v85 offset:24800
ds_read_b64_tr_b16 a[198:199], v85 offset:26080
v_mfma_f32_32x32x16_bf16 v[240:255], a[136:139], a[224:227], v[240:255]
ds_read_b64_tr_b16 a[200:201], v85 offset:24832
ds_read_b64_tr_b16 a[202:203], v85 offset:26112
s_waitcnt lgkmcnt(10)
v_mfma_f32_32x32x16_bf16 v[176:191], a[140:143], a[160:163], v[176:191]
ds_read_b64_tr_b16 a[208:209], v85 offset:29824
ds_read_b64_tr_b16 a[210:211], v85 offset:31104
v_mfma_f32_32x32x16_bf16 v[192:207], a[140:143], a[164:167], v[192:207]
ds_read_b64_tr_b16 a[212:213], v85 offset:29856
ds_read_b64_tr_b16 a[214:215], v85 offset:31136
v_mfma_f32_32x32x16_bf16 v[208:223], a[140:143], a[168:171], v[208:223]
ds_read_b64_tr_b16 a[216:217], v85 offset:29888
ds_read_b64_tr_b16 a[218:219], v85 offset:31168
v_mfma_f32_32x32x16_bf16 v[224:239], a[140:143], a[172:175], v[224:239]
ds_read_b64_tr_b16 a[220:221], v85 offset:29920
ds_read_b64_tr_b16 a[222:223], v85 offset:31200
v_mfma_f32_32x32x16_bf16 v[240:255], a[140:143], a[176:179], v[240:255]
ds_read_b64_tr_b16 a[224:225], v85 offset:29952
ds_read_b64_tr_b16 a[226:227], v85 offset:31232
s_waitcnt lgkmcnt(10)
v_mfma_f32_32x32x16_bf16 v[176:191], a[144:147], a[184:187], v[176:191]
ds_read_b64_tr_b16 a[160:161], v85 offset:34944
ds_read_b64_tr_b16 a[162:163], v85 offset:36224
v_mfma_f32_32x32x16_bf16 v[192:207], a[144:147], a[188:191], v[192:207]
ds_read_b64_tr_b16 a[164:165], v85 offset:34976
ds_read_b64_tr_b16 a[166:167], v85 offset:36256
v_mfma_f32_32x32x16_bf16 v[208:223], a[144:147], a[192:195], v[208:223]
ds_read_b64_tr_b16 a[168:169], v85 offset:35008
ds_read_b64_tr_b16 a[170:171], v85 offset:36288
v_mfma_f32_32x32x16_bf16 v[224:239], a[144:147], a[196:199], v[224:239]
ds_read_b64_tr_b16 a[172:173], v85 offset:35040
ds_read_b64_tr_b16 a[174:175], v85 offset:36320
v_mfma_f32_32x32x16_bf16 v[240:255], a[144:147], a[200:203], v[240:255]
ds_read_b64_tr_b16 a[176:177], v85 offset:35072
ds_read_b64_tr_b16 a[178:179], v85 offset:36352
s_waitcnt lgkmcnt(10)
v_mfma_f32_32x32x16_bf16 v[176:191], a[148:151], a[208:211], v[176:191]
ds_read_b64_tr_b16 a[184:185], v85 offset:40064
ds_read_b64_tr_b16 a[186:187], v85 offset:41344
v_mfma_f32_32x32x16_bf16 v[192:207], a[148:151], a[212:215], v[192:207]
ds_read_b64_tr_b16 a[188:189], v85 offset:40096
ds_read_b64_tr_b16 a[190:191], v85 offset:41376
v_mfma_f32_32x32x16_bf16 v[208:223], a[148:151], a[216:219], v[208:223]
ds_read_b64_tr_b16 a[192:193], v85 offset:40128
ds_read_b64_tr_b16 a[194:195], v85 offset:41408
v_mfma_f32_32x32x16_bf16 v[224:239], a[148:151], a[220:223], v[224:239]
ds_read_b64_tr_b16 a[196:197], v85 offset:40160
ds_read_b64_tr_b16 a[198:199], v85 offset:41440
v_mfma_f32_32x32x16_bf16 v[240:255], a[148:151], a[224:227], v[240:255]
ds_read_b64_tr_b16 a[200:201], v85 offset:40192
ds_read_b64_tr_b16 a[202:203], v85 offset:41472
s_waitcnt lgkmcnt(10)
v_mfma_f32_32x32x16_bf16 v[176:191], a[152:155], a[160:163], v[176:191]
v_mfma_f32_32x32x16_bf16 v[192:207], a[152:155], a[164:167], v[192:207]
v_mfma_f32_32x32x16_bf16 v[208:223], a[152:155], a[168:171], v[208:223]
v_mfma_f32_32x32x16_bf16 v[224:239], a[152:155], a[172:175], v[224:239]
v_mfma_f32_32x32x16_bf16 v[240:255], a[152:155], a[176:179], v[240:255]
s_waitcnt lgkmcnt(0)
v_mfma_f32_32x32x16_bf16 v[176:191], a[156:159], a[184:187], v[176:191]
v_mfma_f32_32x32x16_bf16 v[192:207], a[156:159], a[188:191], v[192:207]
v_mfma_f32_32x32x16_bf16 v[208:223], a[156:159], a[192:195], v[208:223]
v_mfma_f32_32x32x16_bf16 v[224:239], a[156:159], a[196:199], v[224:239]
v_mfma_f32_32x32x16_bf16 v[240:255], a[156:159], a[200:203], v[240:255]
s_barrier
v_mov_b32 v34, 0
v_mov_b32 v35, 0
v_mov_b32 v38, 0
v_mov_b32 v39, 0
ds_read_b32 v40, v23 offset:27936
ds_read_b32 v41, v23 offset:28000
ds_read_b32 v42, v23 offset:28064
ds_read_b32 v43, v23 offset:28128
ds_read_b32 v44, v23 offset:28192
s_waitcnt lgkmcnt(4)
v_cvt_pk_bf16_f32 v32, v40, v40
v_lshlrev_b32 v46, 16, v32
v_sub_f32 v46, v40, v46
v_cvt_pk_bf16_f32 v33, v46, v46
s_nop 1
v_mfma_f32_32x32x16_bf16 v[176:191], a[244:247], v[32:35], v[176:191]
s_waitcnt lgkmcnt(3)
v_cvt_pk_bf16_f32 v36, v41, v41
v_lshlrev_b32 v47, 16, v36
v_sub_f32 v47, v41, v47
v_cvt_pk_bf16_f32 v37, v47, v47
s_nop 1
v_mfma_f32_32x32x16_bf16 v[192:207], a[244:247], v[36:39], v[192:207]
s_waitcnt lgkmcnt(2)
v_cvt_pk_bf16_f32 v32, v42, v42
v_lshlrev_b32 v46, 16, v32
v_sub_f32 v46, v42, v46
v_cvt_pk_bf16_f32 v33, v46, v46
s_nop 1
v_mfma_f32_32x32x16_bf16 v[208:223], a[244:247], v[32:35], v[208:223]
s_waitcnt lgkmcnt(1)
v_cvt_pk_bf16_f32 v36, v43, v43
v_lshlrev_b32 v47, 16, v36
v_sub_f32 v47, v43, v47
v_cvt_pk_bf16_f32 v37, v47, v47
s_nop 1
v_mfma_f32_32x32x16_bf16 v[224:239], a[244:247], v[36:39], v[224:239]
s_waitcnt lgkmcnt(0)
v_cvt_pk_bf16_f32 v32, v44, v44
v_lshlrev_b32 v46, 16, v32
v_sub_f32 v46, v44, v46
v_cvt_pk_bf16_f32 v33, v46, v46
s_nop 1
v_mfma_f32_32x32x16_bf16 v[240:255], a[244:247], v[32:35], v[240:255]
v_add_u32 v78, 0, v76
v_xor_b32 v79, 16, v78
v_mul_f32 v176, v176, v48
v_mul_f32 v177, v177, v49
v_mul_f32 v178, v178, v50
v_mul_f32 v179, v179, v51
v_mul_f32 v180, v180, v52
v_mul_f32 v181, v181, v53
v_mul_f32 v182, v182, v54
v_mul_f32 v183, v183, v55
v_mul_f32 v184, v184, v56
v_mul_f32 v185, v185, v57
v_mul_f32 v186, v186, v58
v_mul_f32 v187, v187, v59
v_mul_f32 v188, v188, v60
v_mul_f32 v189, v189, v61
v_mul_f32 v190, v190, v62
v_mul_f32 v191, v191, v63
v_cvt_pk_bf16_f32 v176, v176, v177
v_cvt_pk_bf16_f32 v177, v178, v179
v_cvt_pk_bf16_f32 v178, v180, v181
v_cvt_pk_bf16_f32 v179, v182, v183
v_cvt_pk_bf16_f32 v184, v184, v185
v_cvt_pk_bf16_f32 v185, v186, v187
v_cvt_pk_bf16_f32 v186, v188, v189
v_cvt_pk_bf16_f32 v187, v190, v191
ds_write_b128 v78, v[176:179] offset:0
ds_write_b128 v79, v[184:187] offset:0
v_mul_f32 v192, v192, v48
v_mul_f32 v193, v193, v49
v_mul_f32 v194, v194, v50
v_mul_f32 v195, v195, v51
v_mul_f32 v196, v196, v52
v_mul_f32 v197, v197, v53
v_mul_f32 v198, v198, v54
v_mul_f32 v199, v199, v55
v_mul_f32 v200, v200, v56
v_mul_f32 v201, v201, v57
v_mul_f32 v202, v202, v58
v_mul_f32 v203, v203, v59
v_mul_f32 v204, v204, v60
v_mul_f32 v205, v205, v61
v_mul_f32 v206, v206, v62
v_mul_f32 v207, v207, v63
v_cvt_pk_bf16_f32 v192, v192, v193
v_cvt_pk_bf16_f32 v193, v194, v195
v_cvt_pk_bf16_f32 v194, v196, v197
v_cvt_pk_bf16_f32 v195, v198, v199
v_cvt_pk_bf16_f32 v200, v200, v201
v_cvt_pk_bf16_f32 v201, v202, v203
v_cvt_pk_bf16_f32 v202, v204, v205
v_cvt_pk_bf16_f32 v203, v206, v207
ds_write_b128 v78, v[192:195] offset:4096
ds_write_b128 v79, v[200:203] offset:4096
v_mul_f32 v208, v208, v48
v_mul_f32 v209, v209, v49
v_mul_f32 v210, v210, v50
v_mul_f32 v211, v211, v51
v_mul_f32 v212, v212, v52
v_mul_f32 v213, v213, v53
v_mul_f32 v214, v214, v54
v_mul_f32 v215, v215, v55
v_mul_f32 v216, v216, v56
v_mul_f32 v217, v217, v57
v_mul_f32 v218, v218, v58
v_mul_f32 v219, v219, v59
v_mul_f32 v220, v220, v60
v_mul_f32 v221, v221, v61
v_mul_f32 v222, v222, v62
v_mul_f32 v223, v223, v63
v_cvt_pk_bf16_f32 v208, v208, v209
v_cvt_pk_bf16_f32 v209, v210, v211
v_cvt_pk_bf16_f32 v210, v212, v213
v_cvt_pk_bf16_f32 v211, v214, v215
v_cvt_pk_bf16_f32 v216, v216, v217
v_cvt_pk_bf16_f32 v217, v218, v219
v_cvt_pk_bf16_f32 v218, v220, v221
v_cvt_pk_bf16_f32 v219, v222, v223
ds_write_b128 v78, v[208:211] offset:8192
ds_write_b128 v79, v[216:219] offset:8192
v_mul_f32 v224, v224, v48
v_mul_f32 v225, v225, v49
v_mul_f32 v226, v226, v50
v_mul_f32 v227, v227, v51
v_mul_f32 v228, v228, v52
v_mul_f32 v229, v229, v53
v_mul_f32 v230, v230, v54
v_mul_f32 v231, v231, v55
v_mul_f32 v232, v232, v56
v_mul_f32 v233, v233, v57
v_mul_f32 v234, v234, v58
v_mul_f32 v235, v235, v59
v_mul_f32 v236, v236, v60
v_mul_f32 v237, v237, v61
v_mul_f32 v238, v238, v62
v_mul_f32 v239, v239, v63
v_cvt_pk_bf16_f32 v224, v224, v225
v_cvt_pk_bf16_f32 v225, v226, v227
v_cvt_pk_bf16_f32 v226, v228, v229
v_cvt_pk_bf16_f32 v227, v230, v231
v_cvt_pk_bf16_f32 v232, v232, v233
v_cvt_pk_bf16_f32 v233, v234, v235
v_cvt_pk_bf16_f32 v234, v236, v237
v_cvt_pk_bf16_f32 v235, v238, v239
ds_write_b128 v78, v[224:227] offset:12288
ds_write_b128 v79, v[232:235] offset:12288
v_mul_f32 v240, v240, v48
v_mul_f32 v241, v241, v49
v_mul_f32 v242, v242, v50
v_mul_f32 v243, v243, v51
v_mul_f32 v244, v244, v52
v_mul_f32 v245, v245, v53
v_mul_f32 v246, v246, v54
v_mul_f32 v247, v247, v55
v_mul_f32 v248, v248, v56
v_mul_f32 v249, v249, v57
v_mul_f32 v250, v250, v58
v_mul_f32 v251, v251, v59
v_mul_f32 v252, v252, v60
v_mul_f32 v253, v253, v61
v_mul_f32 v254, v254, v62
v_mul_f32 v255, v255, v63
v_cvt_pk_bf16_f32 v240, v240, v241
v_cvt_pk_bf16_f32 v241, v242, v243
v_cvt_pk_bf16_f32 v242, v244, v245
v_cvt_pk_bf16_f32 v243, v246, v247
v_cvt_pk_bf16_f32 v248, v248, v249
v_cvt_pk_bf16_f32 v249, v250, v251
v_cvt_pk_bf16_f32 v250, v252, v253
v_cvt_pk_bf16_f32 v251, v254, v255
ds_write_b128 v78, v[240:243] offset:16384
ds_write_b128 v79, v[248:251] offset:16384
s_waitcnt lgkmcnt(0)
s_barrier
v_xor_b32 v80, 0, v86
ds_read_b128 v[176:179], v80
v_xor_b32 v81, 32, v86
ds_read_b128 v[180:183], v81
v_xor_b32 v80, 64, v86
ds_read_b128 v[184:187], v80
v_xor_b32 v81, 96, v86
ds_read_b128 v[188:191], v81
v_xor_b32 v80, 128, v86
ds_read_b128 v[192:195], v80
v_xor_b32 v81, 160, v86
ds_read_b128 v[196:199], v81
v_xor_b32 v80, 192, v86
ds_read_b128 v[200:203], v80
v_xor_b32 v81, 224, v86
ds_read_b128 v[204:207], v81
v_xor_b32 v80, 0, v88
ds_read_b128 v[208:211], v80
v_xor_b32 v81, 32, v88
ds_read_b128 v[212:215], v81
v_xor_b32 v80, 64, v88
ds_read_b128 v[216:219], v80
v_xor_b32 v81, 96, v88
ds_read_b128 v[220:223], v81
v_xor_b32 v80, 128, v88
ds_read_b128 v[224:227], v80
v_xor_b32 v81, 160, v88
ds_read_b128 v[228:231], v81
v_xor_b32 v80, 192, v88
ds_read_b128 v[232:235], v80
v_xor_b32 v81, 224, v88
ds_read_b128 v[236:239], v81
s_lshl_b32 s60, s51, 3
s_lshl_b32 s61, s48, 1
s_add_u32 s60, s60, s61
s_lshl_b32 s60, s60, 4
s_add_u32 s60, s60, s49
s_mul_i32 s46, s60, 4096
s_add_u32 s46, s46, 12582912
s_add_u32 s81, s46, 65536
s_waitcnt lgkmcnt(15)
v_mfma_f32_32x32x16_bf16 v[32:47], v[176:179], v[96:99], 0
s_waitcnt lgkmcnt(7)
v_mfma_f32_32x32x16_bf16 v[48:63], v[208:211], v[128:131], 0
v_mfma_f32_32x32x16_bf16 v[32:47], v[180:183], v[100:103], v[32:47]
s_waitcnt lgkmcnt(6)
v_mfma_f32_32x32x16_bf16 v[48:63], v[212:215], v[132:135], v[48:63]
v_mfma_f32_32x32x16_bf16 v[32:47], v[184:187], v[104:107], v[32:47]
s_waitcnt lgkmcnt(5)
v_mfma_f32_32x32x16_bf16 v[48:63], v[216:219], v[136:139], v[48:63]
v_mfma_f32_32x32x16_bf16 v[32:47], v[188:191], v[108:111], v[32:47]
s_waitcnt lgkmcnt(4)
v_mfma_f32_32x32x16_bf16 v[48:63], v[220:223], v[140:143], v[48:63]
v_mfma_f32_32x32x16_bf16 v[32:47], v[192:195], v[112:115], v[32:47]
s_waitcnt lgkmcnt(3)
v_mfma_f32_32x32x16_bf16 v[48:63], v[224:227], v[144:147], v[48:63]
v_mfma_f32_32x32x16_bf16 v[32:47], v[196:199], v[116:119], v[32:47]
s_waitcnt lgkmcnt(2)
v_mfma_f32_32x32x16_bf16 v[48:63], v[228:231], v[148:151], v[48:63]
v_mfma_f32_32x32x16_bf16 v[32:47], v[200:203], v[120:123], v[32:47]
s_waitcnt lgkmcnt(1)
v_mfma_f32_32x32x16_bf16 v[48:63], v[232:235], v[152:155], v[48:63]
v_mfma_f32_32x32x16_bf16 v[32:47], v[204:207], v[124:127], v[32:47]
s_waitcnt lgkmcnt(0)
v_mfma_f32_32x32x16_bf16 v[48:63], v[236:239], v[156:159], v[48:63]
s_nop 9
v_mov_b32 v176, v32
v_mov_b32 v177, v33
v_mov_b32 v178, v34
v_mov_b32 v179, v30
v_mov_b32 v180, v35
v_mov_b32 v181, v36
v_mov_b32 v182, v37
v_mov_b32 v183, v30
v_mov_b32 v184, v38
v_mov_b32 v185, v39
v_mov_b32 v186, v40
v_mov_b32 v187, v30
v_mov_b32 v188, v41
v_mov_b32 v189, v42
v_mov_b32 v190, v43
v_mov_b32 v191, v30
v_mov_b32 v192, v48
v_mov_b32 v193, v49
v_mov_b32 v194, v50
v_mov_b32 v195, v30
v_mov_b32 v196, v51
v_mov_b32 v197, v52
v_mov_b32 v198, v53
v_mov_b32 v199, v30
v_mov_b32 v200, v54
v_mov_b32 v201, v55
v_mov_b32 v202, v56
v_mov_b32 v203, v30
v_mov_b32 v204, v57
v_mov_b32 v205, v58
v_mov_b32 v206, v59
v_mov_b32 v207, v30
ds_write_b128 v90, v[176:179] offset:0
ds_write_b128 v90, v[180:183] offset:16
ds_write_b128 v90, v[184:187] offset:32
ds_write_b128 v90, v[188:191] offset:48
ds_write_b128 v90, v[192:195] offset:3072
ds_write_b128 v90, v[196:199] offset:3088
ds_write_b128 v90, v[200:203] offset:3104
ds_write_b128 v90, v[204:207] offset:3120
s_waitcnt lgkmcnt(0)
ds_read_b128 v[96:99], v91 offset:0
ds_read_b128 v[100:103], v91 offset:1152
ds_read_b128 v[104:107], v91 offset:2304
ds_read_b128 v[108:111], v91 offset:3072
ds_read_b128 v[112:115], v91 offset:4224
ds_read_b128 v[116:119], v91 offset:5376
s_waitcnt lgkmcnt(5)
buffer_store_dwordx4 v[96:99], v22, s[24:27], s46 offen sc1
s_waitcnt lgkmcnt(4)
buffer_store_dwordx4 v[100:103], v22, s[24:27], s46 offen offset:1024 sc1
s_waitcnt lgkmcnt(3)
buffer_store_dwordx4 v[104:107], v93, s[24:27], s46 offen sc1
s_waitcnt lgkmcnt(2)
buffer_store_dwordx4 v[108:111], v22, s[24:27], s81 offen sc1
s_waitcnt lgkmcnt(1)
buffer_store_dwordx4 v[112:115], v22, s[24:27], s81 offen offset:1024 sc1
s_waitcnt lgkmcnt(0)
buffer_store_dwordx4 v[116:119], v93, s[24:27], s81 offen sc1
s_mul_i32 s51, s40, 278528
s_add_u32 s8, s24, s51
s_addc_u32 s9, s25, 0
s_mov_b32 s10, 278528
s_mov_b32 s11, 0x20000
s_mov_b32 s16, s4
s_mov_b32 s17, s5
s_mov_b32 s18, 2621440
s_mov_b32 s19, 0x20000
s_mov_b32 s20, s86
s_mov_b32 s21, s87
s_mov_b32 s22, 2621440
s_mov_b32 s23, 0x20000
s_mov_b32 s63, 0x358637bd
s_mul_i32 s62, s41, 3200
s_add_u32 s62, s62, 11534336
s_mul_i32 s46, s40, 81920
s_mul_i32 s51, s41, 160
s_add_u32 s46, s46, s51
v_and_b32 v52, 15, v1
v_lshrrev_b32 v53, 4, v1
v_lshrrev_b32 v54, 1, v53
v_lshlrev_b32 v56, 10, v54
v_and_b32 v55, 1, v53
v_lshl_add_u32 v56, v55, 9, v56
v_lshl_add_u32 v2, v52, 4, v56
v_add_u32 v3, 139264, v2
s_mul_i32 s51, s48, 20480
v_add_u32 v6, s51, v4
v_lshl_add_u32 v54, v54, 2, v55
s_mul_i32 s51, s48, 2048
s_add_u32 s51, s51, 96512
v_lshlrev_b32 v59, 5, v52
v_add_u32 v59, s51, v59
s_mul_i32 s52, s48, 204800
v_lshlrev_b32 v58, 3, v52
v_add_u32 v58, s52, v58
s_mov_b32 s53, 25600
s_mov_b32 s54, 52429
s_mov_b32 s55, -20
v_add_u32 v55, 0, v54
v_mul_u32_u24 v56, s54, v55
v_lshrrev_b32 v56, 18, v56
v_mad_i32_i24 v57, v56, -5, v55
v_lshl_add_u32 v42, v56, 2, v59
v_mad_u32_u24 v56, v56, s53, v58
v_lshl_add_u32 v32, v57, 7, v56
v_add_u32 v55, 2, v54
v_mul_u32_u24 v56, s54, v55
v_lshrrev_b32 v56, 18, v56
v_mad_i32_i24 v57, v56, -5, v55
v_lshl_add_u32 v43, v56, 2, v59
v_mad_u32_u24 v56, v56, s53, v58
v_lshl_add_u32 v33, v57, 7, v56
v_add_u32 v55, 8, v54
v_mul_u32_u24 v56, s54, v55
v_lshrrev_b32 v56, 18, v56
v_mad_i32_i24 v57, v56, -5, v55
v_lshl_add_u32 v44, v56, 2, v59
v_mad_u32_u24 v56, v56, s53, v58
v_lshl_add_u32 v34, v57, 7, v56
v_add_u32 v55, 10, v54
v_mul_u32_u24 v56, s54, v55
v_lshrrev_b32 v56, 18, v56
v_mad_i32_i24 v57, v56, -5, v55
v_lshl_add_u32 v45, v56, 2, v59
v_mad_u32_u24 v56, v56, s53, v58
v_lshl_add_u32 v35, v57, 7, v56
v_add_u32 v55, 16, v54
v_mul_u32_u24 v56, s54, v55
v_lshrrev_b32 v56, 18, v56
v_mad_i32_i24 v57, v56, -5, v55
v_lshl_add_u32 v46, v56, 2, v59
v_mad_u32_u24 v56, v56, s53, v58
v_lshl_add_u32 v36, v57, 7, v56
v_add_u32 v55, 18, v54
v_mul_u32_u24 v56, s54, v55
v_lshrrev_b32 v56, 18, v56
v_mad_i32_i24 v57, v56, -5, v55
v_lshl_add_u32 v47, v56, 2, v59
v_mad_u32_u24 v56, v56, s53, v58
v_lshl_add_u32 v37, v57, 7, v56
v_add_u32 v55, 24, v54
v_mul_u32_u24 v56, s54, v55
v_lshrrev_b32 v56, 18, v56
v_mad_i32_i24 v57, v56, -5, v55
v_lshl_add_u32 v48, v56, 2, v59
v_mad_u32_u24 v56, v56, s53, v58
v_lshl_add_u32 v38, v57, 7, v56
v_add_u32 v55, 26, v54
v_mul_u32_u24 v56, s54, v55
v_lshrrev_b32 v56, 18, v56
v_mad_i32_i24 v57, v56, -5, v55
v_lshl_add_u32 v49, v56, 2, v59
v_mad_u32_u24 v56, v56, s53, v58
v_lshl_add_u32 v39, v57, 7, v56
v_add_u32 v55, 32, v54
v_mul_u32_u24 v56, s54, v55
v_lshrrev_b32 v56, 18, v56
v_mad_i32_i24 v57, v56, -5, v55
v_lshl_add_u32 v50, v56, 2, v59
v_mad_u32_u24 v56, v56, s53, v58
v_lshl_add_u32 v40, v57, 7, v56
v_add_u32 v55, 34, v54
v_mul_u32_u24 v56, s54, v55
v_lshrrev_b32 v56, 18, v56
v_mad_i32_i24 v57, v56, -5, v55
v_lshl_add_u32 v51, v56, 2, v59
v_mad_u32_u24 v56, v56, s53, v58
v_lshl_add_u32 v41, v57, 7, v56
s_mul_i32 s51, s48, 5120
v_add_u32 v7, s51, v4
v_add_u32 v8, 40960, v7
s_lshl_b32 s51, s48, 4
v_add_u32 v12, s51, v52
v_mul_u32_u24 v12, 1280, v12
v_lshl_add_u32 v12, v53, 3, v12
s_mul_i32 s51, s48, 3072
s_add_u32 s51, s51, 110848
v_lshrrev_b32 v55, 3, v1
v_mul_u32_u24 v55, 360, v55
v_and_b32 v56, 7, v1
v_mul_u32_u24 v56, 6, v56
v_add3_u32 v17, v55, v56, s51
v_min_u32 v55, 8, v52
v_mul_u32_u24 v55, 320, v55
v_lshl_add_u32 v55, v54, 3, v55
v_add_u32 v28, s51, v55
v_add_u32 v55, s51, v4
v_mov_b32 v60, 0
v_mov_b32 v61, 0
v_mov_b32 v62, 0
v_mov_b32 v63, 0
ds_write_b128 v55, v[60:63]
ds_write_b128 v55, v[60:63] offset:1024
ds_write_b128 v55, v[60:63] offset:2048
s_lshr_b32 s51, s40, 1
s_lshl_b32 s51, s51, 4
v_add_u32 v84, s51, v1
v_lshlrev_b32 v84, 7, v84
v_cmp_gt_u32 vcc, 16, v1
s_nop 1
v_cndmask_b32 v84, v31, v84, vcc
buffer_load_dwordx4 a[120:123], v4, s[12:15], s43 offen offset:0 sc1
buffer_load_dwordx4 a[124:127], v4, s[12:15], s43 offen offset:1024 sc1
buffer_load_dwordx4 a[128:131], v4, s[12:15], s43 offen offset:2048 sc1
buffer_load_dwordx4 a[132:135], v4, s[12:15], s43 offen offset:3072 sc1
buffer_load_dwordx4 a[136:139], v5, s[12:15], s43 offen sc1
s_add_u32 s43, s43, 20480
buffer_load_dwordx4 a[140:143], v4, s[12:15], s43 offen offset:0 sc1
buffer_load_dwordx4 a[144:147], v4, s[12:15], s43 offen offset:1024 sc1
buffer_load_dwordx4 a[148:151], v4, s[12:15], s43 offen offset:2048 sc1
buffer_load_dwordx4 a[152:155], v4, s[12:15], s43 offen offset:3072 sc1
buffer_load_dwordx4 a[156:159], v5, s[12:15], s43 offen sc1
s_add_u32 s43, s43, 20480
buffer_load_dwordx2 v[18:19], v12, s[16:19], s46 offen
buffer_load_dwordx2 v[20:21], v12, s[16:19], s46 offen offset:32
buffer_load_dwordx2 v[22:23], v12, s[16:19], s46 offen offset:64
buffer_load_dwordx2 v[24:25], v12, s[16:19], s46 offen offset:96
buffer_load_dwordx2 v[26:27], v12, s[16:19], s46 offen offset:128
s_mov_b32 s75, 12517376
s_cmp_eq_u32 s48, 0
s_cselect_b32 s75, s75, 17825792
buffer_load_dword v86, v84, s[24:27], s75 offen sc1
s_waitcnt vmcnt(0)
v_mov_b32 v86, v86
s_cmp_lg_u32 s48, 0
s_cbranch_scc1 POKLBKV
v_cmp_ne_u32 vcc, v86, v30
s_nop 3
s_and_b32 vcc_lo, vcc_lo, 61166
s_and_b32 vcc_hi, vcc_hi, 0
s_or_b32 s76, vcc_lo, vcc_hi
s_cbranch_scc0 POKLBKV
s_mov_b32 s77, 4000
s_mov_b32 s75, 12517376
PSPLBKV:
s_sleep 3
buffer_load_dword v86, v84, s[24:27], s75 offen sc1
s_waitcnt vmcnt(0)
v_cmp_ne_u32 vcc, v86, v30
s_nop 3
s_and_b32 vcc_lo, vcc_lo, 61166
s_and_b32 vcc_hi, vcc_hi, 0
s_or_b32 s76, vcc_lo, vcc_hi
s_cbranch_scc0 POKLBKV
s_sub_u32 s77, s77, 1
s_cmp_lg_u32 s77, 0
s_cbranch_scc1 PSPLBKV
POKLBKV:
s_barrier
buffer_load_dwordx4 a[160:163], v2, s[8:11], s42 offen offset:0 sc1
buffer_load_dwordx4 a[164:167], v2, s[8:11], s42 offen offset:256 sc1
buffer_load_dwordx4 a[168:171], v3, s[8:11], s42 offen offset:0 sc1
buffer_load_dwordx4 a[172:175], v3, s[8:11], s42 offen offset:256 sc1
s_add_u32 s42, s42, 8192
buffer_load_dwordx4 a[176:179], v2, s[8:11], s42 offen offset:0 sc1
buffer_load_dwordx4 a[180:183], v2, s[8:11], s42 offen offset:256 sc1
buffer_load_dwordx4 a[184:187], v3, s[8:11], s42 offen offset:0 sc1
buffer_load_dwordx4 a[188:191], v3, s[8:11], s42 offen offset:256 sc1
s_add_u32 s42, s42, 8192
buffer_load_dwordx4 a[192:195], v2, s[8:11], s42 offen offset:0 sc1
buffer_load_dwordx4 a[196:199], v2, s[8:11], s42 offen offset:256 sc1
buffer_load_dwordx4 a[200:203], v3, s[8:11], s42 offen offset:0 sc1
buffer_load_dwordx4 a[204:207], v3, s[8:11], s42 offen offset:256 sc1
s_add_u32 s42, s42, 8192
s_waitcnt vmcnt(11)
v_mfma_f32_16x16x32_bf16 v[176:179], a[0:3], a[160:163], 0
buffer_load_dwordx4 a[208:211], v2, s[8:11], s42 offen offset:0 sc1
v_mfma_f32_16x16x32_bf16 v[180:183], a[4:7], a[160:163], 0
buffer_load_dwordx4 a[212:215], v2, s[8:11], s42 offen offset:256 sc1
v_mfma_f32_16x16x32_bf16 v[184:187], a[8:11], a[160:163], 0
buffer_load_dwordx4 a[216:219], v3, s[8:11], s42 offen offset:0 sc1
v_mfma_f32_16x16x32_bf16 v[188:191], a[12:15], a[160:163], 0
buffer_load_dwordx4 a[220:223], v3, s[8:11], s42 offen offset:256 sc1
v_mfma_f32_16x16x32_bf16 v[192:195], a[16:19], a[160:163], 0
s_add_u32 s42, s42, 8192
s_waitcnt vmcnt(14)
v_mfma_f32_16x16x32_bf16 v[196:199], a[0:3], a[164:167], 0
v_mfma_f32_16x16x32_bf16 v[200:203], a[4:7], a[164:167], 0
v_mfma_f32_16x16x32_bf16 v[204:207], a[8:11], a[164:167], 0
v_mfma_f32_16x16x32_bf16 v[208:211], a[12:15], a[164:167], 0
v_mfma_f32_16x16x32_bf16 v[212:215], a[16:19], a[164:167], 0
s_waitcnt vmcnt(13)
v_mfma_f32_16x16x32_bf16 v[216:219], a[0:3], a[168:171], 0
v_mfma_f32_16x16x32_bf16 v[220:223], a[4:7], a[168:171], 0
v_mfma_f32_16x16x32_bf16 v[224:227], a[8:11], a[168:171], 0
v_mfma_f32_16x16x32_bf16 v[228:231], a[12:15], a[168:171], 0
v_mfma_f32_16x16x32_bf16 v[232:235], a[16:19], a[168:171], 0
s_waitcnt vmcnt(12)
v_mfma_f32_16x16x32_bf16 v[236:239], a[0:3], a[172:175], 0
v_mfma_f32_16x16x32_bf16 v[240:243], a[4:7], a[172:175], 0
v_mfma_f32_16x16x32_bf16 v[244:247], a[8:11], a[172:175], 0
v_mfma_f32_16x16x32_bf16 v[248:251], a[12:15], a[172:175], 0
v_mfma_f32_16x16x32_bf16 v[252:255], a[16:19], a[172:175], 0
s_waitcnt vmcnt(11)
v_mfma_f32_16x16x32_bf16 v[176:179], a[20:23], a[176:179], v[176:179]
buffer_load_dwordx4 a[160:163], v2, s[8:11], s42 offen offset:0 sc1
v_mfma_f32_16x16x32_bf16 v[180:183], a[24:27], a[176:179], v[180:183]
buffer_load_dwordx4 a[164:167], v2, s[8:11], s42 offen offset:256 sc1
v_mfma_f32_16x16x32_bf16 v[184:187], a[28:31], a[176:179], v[184:187]
buffer_load_dwordx4 a[168:171], v3, s[8:11], s42 offen offset:0 sc1
v_mfma_f32_16x16x32_bf16 v[188:191], a[32:35], a[176:179], v[188:191]
buffer_load_dwordx4 a[172:175], v3, s[8:11], s42 offen offset:256 sc1
v_mfma_f32_16x16x32_bf16 v[192:195], a[36:39], a[176:179], v[192:195]
s_add_u32 s42, s42, 8192
s_waitcnt vmcnt(14)
v_mfma_f32_16x16x32_bf16 v[196:199], a[20:23], a[180:183], v[196:199]
v_mfma_f32_16x16x32_bf16 v[200:203], a[24:27], a[180:183], v[200:203]
v_mfma_f32_16x16x32_bf16 v[204:207], a[28:31], a[180:183], v[204:207]
v_mfma_f32_16x16x32_bf16 v[208:211], a[32:35], a[180:183], v[208:211]
v_mfma_f32_16x16x32_bf16 v[212:215], a[36:39], a[180:183], v[212:215]
s_waitcnt vmcnt(13)
v_mfma_f32_16x16x32_bf16 v[216:219], a[20:23], a[184:187], v[216:219]
v_mfma_f32_16x16x32_bf16 v[220:223], a[24:27], a[184:187], v[220:223]
v_mfma_f32_16x16x32_bf16 v[224:227], a[28:31], a[184:187], v[224:227]
v_mfma_f32_16x16x32_bf16 v[228:231], a[32:35], a[184:187], v[228:231]
v_mfma_f32_16x16x32_bf16 v[232:235], a[36:39], a[184:187], v[232:235]
s_waitcnt vmcnt(12)
v_mfma_f32_16x16x32_bf16 v[236:239], a[20:23], a[188:191], v[236:239]
v_mfma_f32_16x16x32_bf16 v[240:243], a[24:27], a[188:191], v[240:243]
v_mfma_f32_16x16x32_bf16 v[244:247], a[28:31], a[188:191], v[244:247]
v_mfma_f32_16x16x32_bf16 v[248:251], a[32:35], a[188:191], v[248:251]
v_mfma_f32_16x16x32_bf16 v[252:255], a[36:39], a[188:191], v[252:255]
s_waitcnt vmcnt(11)
v_mfma_f32_16x16x32_bf16 v[176:179], a[40:43], a[192:195], v[176:179]
buffer_load_dwordx4 a[176:179], v2, s[8:11], s42 offen offset:0 sc1
v_mfma_f32_16x16x32_bf16 v[180:183], a[44:47], a[192:195], v[180:183]
buffer_load_dwordx4 a[180:183], v2, s[8:11], s42 offen offset:256 sc1
v_mfma_f32_16x16x32_bf16 v[184:187], a[48:51], a[192:195], v[184:187]
buffer_load_dwordx4 a[184:187], v3, s[8:11], s42 offen offset:0 sc1
v_mfma_f32_16x16x32_bf16 v[188:191], a[52:55], a[192:195], v[188:191]
buffer_load_dwordx4 a[188:191], v3, s[8:11], s42 offen offset:256 sc1
v_mfma_f32_16x16x32_bf16 v[192:195], a[56:59], a[192:195], v[192:195]
s_add_u32 s42, s42, 8192
s_waitcnt vmcnt(14)
v_mfma_f32_16x16x32_bf16 v[196:199], a[40:43], a[196:199], v[196:199]
v_mfma_f32_16x16x32_bf16 v[200:203], a[44:47], a[196:199], v[200:203]
v_mfma_f32_16x16x32_bf16 v[204:207], a[48:51], a[196:199], v[204:207]
v_mfma_f32_16x16x32_bf16 v[208:211], a[52:55], a[196:199], v[208:211]
v_mfma_f32_16x16x32_bf16 v[212:215], a[56:59], a[196:199], v[212:215]
s_waitcnt vmcnt(13)
v_mfma_f32_16x16x32_bf16 v[216:219], a[40:43], a[200:203], v[216:219]
v_mfma_f32_16x16x32_bf16 v[220:223], a[44:47], a[200:203], v[220:223]
v_mfma_f32_16x16x32_bf16 v[224:227], a[48:51], a[200:203], v[224:227]
v_mfma_f32_16x16x32_bf16 v[228:231], a[52:55], a[200:203], v[228:231]
v_mfma_f32_16x16x32_bf16 v[232:235], a[56:59], a[200:203], v[232:235]
s_waitcnt vmcnt(12)
v_mfma_f32_16x16x32_bf16 v[236:239], a[40:43], a[204:207], v[236:239]
v_mfma_f32_16x16x32_bf16 v[240:243], a[44:47], a[204:207], v[240:243]
v_mfma_f32_16x16x32_bf16 v[244:247], a[48:51], a[204:207], v[244:247]
v_mfma_f32_16x16x32_bf16 v[248:251], a[52:55], a[204:207], v[248:251]
v_mfma_f32_16x16x32_bf16 v[252:255], a[56:59], a[204:207], v[252:255]
s_waitcnt vmcnt(11)
v_mfma_f32_16x16x32_bf16 v[176:179], a[60:63], a[208:211], v[176:179]
buffer_load_dwordx4 a[192:195], v2, s[8:11], s42 offen offset:0 sc1
v_mfma_f32_16x16x32_bf16 v[180:183], a[64:67], a[208:211], v[180:183]
buffer_load_dwordx4 a[196:199], v2, s[8:11], s42 offen offset:256 sc1
v_mfma_f32_16x16x32_bf16 v[184:187], a[68:71], a[208:211], v[184:187]
buffer_load_dwordx4 a[200:203], v3, s[8:11], s42 offen offset:0 sc1
v_mfma_f32_16x16x32_bf16 v[188:191], a[72:75], a[208:211], v[188:191]
buffer_load_dwordx4 a[204:207], v3, s[8:11], s42 offen offset:256 sc1
v_mfma_f32_16x16x32_bf16 v[192:195], a[76:79], a[208:211], v[192:195]
s_add_u32 s42, s42, 8192
s_mul_i32 s64, s48, 10240
s_add_u32 s64, s64, 98304
buffer_load_dwordx4 v[96:99], v2, s[8:11], s64 offen offset:0 sc1
buffer_load_dwordx4 v[100:103], v2, s[8:11], s64 offen offset:256 sc1
s_waitcnt vmcnt(16)
v_mfma_f32_16x16x32_bf16 v[196:199], a[60:63], a[212:215], v[196:199]
buffer_load_dwordx4 v[104:107], v3, s[8:11], s64 offen offset:0 sc1
buffer_load_dwordx4 v[108:111], v3, s[8:11], s64 offen offset:256 sc1
s_add_u32 s64, s64, 2048
buffer_load_dwordx4 v[112:115], v2, s[8:11], s64 offen offset:0 sc1
buffer_load_dwordx4 v[116:119], v2, s[8:11], s64 offen offset:256 sc1
v_mfma_f32_16x16x32_bf16 v[200:203], a[64:67], a[212:215], v[200:203]
buffer_load_dwordx4 v[120:123], v3, s[8:11], s64 offen offset:0 sc1
buffer_load_dwordx4 v[124:127], v3, s[8:11], s64 offen offset:256 sc1
s_add_u32 s64, s64, 2048
buffer_load_dwordx4 v[128:131], v2, s[8:11], s64 offen offset:0 sc1
buffer_load_dwordx4 v[132:135], v2, s[8:11], s64 offen offset:256 sc1
v_mfma_f32_16x16x32_bf16 v[204:207], a[68:71], a[212:215], v[204:207]
buffer_load_dwordx4 v[136:139], v3, s[8:11], s64 offen offset:0 sc1
buffer_load_dwordx4 v[140:143], v3, s[8:11], s64 offen offset:256 sc1
s_add_u32 s64, s64, 2048
buffer_load_dwordx4 v[144:147], v2, s[8:11], s64 offen offset:0 sc1
buffer_load_dwordx4 v[148:151], v2, s[8:11], s64 offen offset:256 sc1
v_mfma_f32_16x16x32_bf16 v[208:211], a[72:75], a[212:215], v[208:211]
buffer_load_dwordx4 v[152:155], v3, s[8:11], s64 offen offset:0 sc1
buffer_load_dwordx4 v[156:159], v3, s[8:11], s64 offen offset:256 sc1
s_add_u32 s64, s64, 2048
buffer_load_dwordx4 v[160:163], v2, s[8:11], s64 offen offset:0 sc1
buffer_load_dwordx4 v[164:167], v2, s[8:11], s64 offen offset:256 sc1
v_mfma_f32_16x16x32_bf16 v[212:215], a[76:79], a[212:215], v[212:215]
buffer_load_dwordx4 v[168:171], v3, s[8:11], s64 offen offset:0 sc1
buffer_load_dwordx4 v[172:175], v3, s[8:11], s64 offen offset:256 sc1
s_add_u32 s64, s64, 2048
s_waitcnt vmcnt(33)
v_mfma_f32_16x16x32_bf16 v[216:219], a[60:63], a[216:219], v[216:219]
v_mfma_f32_16x16x32_bf16 v[220:223], a[64:67], a[216:219], v[220:223]
v_mfma_f32_16x16x32_bf16 v[224:227], a[68:71], a[216:219], v[224:227]
v_mfma_f32_16x16x32_bf16 v[228:231], a[72:75], a[216:219], v[228:231]
v_mfma_f32_16x16x32_bf16 v[232:235], a[76:79], a[216:219], v[232:235]
s_waitcnt vmcnt(32)
v_mfma_f32_16x16x32_bf16 v[236:239], a[60:63], a[220:223], v[236:239]
v_mfma_f32_16x16x32_bf16 v[240:243], a[64:67], a[220:223], v[240:243]
v_mfma_f32_16x16x32_bf16 v[244:247], a[68:71], a[220:223], v[244:247]
v_mfma_f32_16x16x32_bf16 v[248:251], a[72:75], a[220:223], v[248:251]
v_mfma_f32_16x16x32_bf16 v[252:255], a[76:79], a[220:223], v[252:255]
s_waitcnt vmcnt(31)
v_mfma_f32_16x16x32_bf16 v[176:179], a[80:83], a[160:163], v[176:179]
buffer_load_dwordx4 a[208:211], v2, s[8:11], s42 offen offset:0 sc1
v_mfma_f32_16x16x32_bf16 v[180:183], a[84:87], a[160:163], v[180:183]
buffer_load_dwordx4 a[212:215], v2, s[8:11], s42 offen offset:256 sc1
v_mfma_f32_16x16x32_bf16 v[184:187], a[88:91], a[160:163], v[184:187]
buffer_load_dwordx4 a[216:219], v3, s[8:11], s42 offen offset:0 sc1
v_mfma_f32_16x16x32_bf16 v[188:191], a[92:95], a[160:163], v[188:191]
buffer_load_dwordx4 a[220:223], v3, s[8:11], s42 offen offset:256 sc1
v_mfma_f32_16x16x32_bf16 v[192:195], a[96:99], a[160:163], v[192:195]
s_add_u32 s42, s42, 8192
s_waitcnt vmcnt(34)
v_mfma_f32_16x16x32_bf16 v[196:199], a[80:83], a[164:167], v[196:199]
buffer_load_dwordx4 a[0:3], v4, s[12:15], s43 offen offset:0 sc1
v_mfma_f32_16x16x32_bf16 v[200:203], a[84:87], a[164:167], v[200:203]
buffer_load_dwordx4 a[4:7], v4, s[12:15], s43 offen offset:1024 sc1
v_mfma_f32_16x16x32_bf16 v[204:207], a[88:91], a[164:167], v[204:207]
buffer_load_dwordx4 a[8:11], v4, s[12:15], s43 offen offset:2048 sc1
v_mfma_f32_16x16x32_bf16 v[208:211], a[92:95], a[164:167], v[208:211]
buffer_load_dwordx4 a[12:15], v4, s[12:15], s43 offen offset:3072 sc1
v_mfma_f32_16x16x32_bf16 v[212:215], a[96:99], a[164:167], v[212:215]
buffer_load_dwordx4 a[16:19], v5, s[12:15], s43 offen sc1
s_waitcnt vmcnt(38)
v_mfma_f32_16x16x32_bf16 v[216:219], a[80:83], a[168:171], v[216:219]
s_add_u32 s43, s43, 20480
v_mfma_f32_16x16x32_bf16 v[220:223], a[84:87], a[168:171], v[220:223]
v_mfma_f32_16x16x32_bf16 v[224:227], a[88:91], a[168:171], v[224:227]
v_mfma_f32_16x16x32_bf16 v[228:231], a[92:95], a[168:171], v[228:231]
v_mfma_f32_16x16x32_bf16 v[232:235], a[96:99], a[168:171], v[232:235]
s_waitcnt vmcnt(37)
v_mfma_f32_16x16x32_bf16 v[236:239], a[80:83], a[172:175], v[236:239]
v_mfma_f32_16x16x32_bf16 v[240:243], a[84:87], a[172:175], v[240:243]
v_mfma_f32_16x16x32_bf16 v[244:247], a[88:91], a[172:175], v[244:247]
v_mfma_f32_16x16x32_bf16 v[248:251], a[92:95], a[172:175], v[248:251]
v_mfma_f32_16x16x32_bf16 v[252:255], a[96:99], a[172:175], v[252:255]
s_waitcnt vmcnt(36)
v_mfma_f32_16x16x32_bf16 v[176:179], a[100:103], a[176:179], v[176:179]
buffer_load_dwordx4 a[160:163], v2, s[8:11], s42 offen offset:0 sc1
v_mfma_f32_16x16x32_bf16 v[180:183], a[104:107], a[176:179], v[180:183]
buffer_load_dwordx4 a[164:167], v2, s[8:11], s42 offen offset:256 sc1
v_mfma_f32_16x16x32_bf16 v[184:187], a[108:111], a[176:179], v[184:187]
buffer_load_dwordx4 a[168:171], v3, s[8:11], s42 offen offset:0 sc1
v_mfma_f32_16x16x32_bf16 v[188:191], a[112:115], a[176:179], v[188:191]
buffer_load_dwordx4 a[172:175], v3, s[8:11], s42 offen offset:256 sc1
v_mfma_f32_16x16x32_bf16 v[192:195], a[116:119], a[176:179], v[192:195]
s_add_u32 s42, s42, 8192
s_waitcnt vmcnt(39)
v_mfma_f32_16x16x32_bf16 v[196:199], a[100:103], a[180:183], v[196:199]
buffer_load_dwordx4 a[20:23], v4, s[12:15], s43 offen offset:0 sc1
v_mfma_f32_16x16x32_bf16 v[200:203], a[104:107], a[180:183], v[200:203]
buffer_load_dwordx4 a[24:27], v4, s[12:15], s43 offen offset:1024 sc1
v_mfma_f32_16x16x32_bf16 v[204:207], a[108:111], a[180:183], v[204:207]
buffer_load_dwordx4 a[28:31], v4, s[12:15], s43 offen offset:2048 sc1
v_mfma_f32_16x16x32_bf16 v[208:211], a[112:115], a[180:183], v[208:211]
buffer_load_dwordx4 a[32:35], v4, s[12:15], s43 offen offset:3072 sc1
v_mfma_f32_16x16x32_bf16 v[212:215], a[116:119], a[180:183], v[212:215]
buffer_load_dwordx4 a[36:39], v5, s[12:15], s43 offen sc1
s_waitcnt vmcnt(43)
v_mfma_f32_16x16x32_bf16 v[216:219], a[100:103], a[184:187], v[216:219]
s_add_u32 s43, s43, 20480
v_mfma_f32_16x16x32_bf16 v[220:223], a[104:107], a[184:187], v[220:223]
v_mfma_f32_16x16x32_bf16 v[224:227], a[108:111], a[184:187], v[224:227]
v_mfma_f32_16x16x32_bf16 v[228:231], a[112:115], a[184:187], v[228:231]
v_mfma_f32_16x16x32_bf16 v[232:235], a[116:119], a[184:187], v[232:235]
s_waitcnt vmcnt(42)
v_mfma_f32_16x16x32_bf16 v[236:239], a[100:103], a[188:191], v[236:239]
v_mfma_f32_16x16x32_bf16 v[240:243], a[104:107], a[188:191], v[240:243]
v_mfma_f32_16x16x32_bf16 v[244:247], a[108:111], a[188:191], v[244:247]
v_mfma_f32_16x16x32_bf16 v[248:251], a[112:115], a[188:191], v[248:251]
v_mfma_f32_16x16x32_bf16 v[252:255], a[116:119], a[188:191], v[252:255]
s_waitcnt vmcnt(41)
v_mfma_f32_16x16x32_bf16 v[176:179], a[120:123], a[192:195], v[176:179]
buffer_load_dwordx4 a[176:179], v2, s[8:11], s42 offen offset:0 sc1
v_mfma_f32_16x16x32_bf16 v[180:183], a[124:127], a[192:195], v[180:183]
buffer_load_dwordx4 a[180:183], v2, s[8:11], s42 offen offset:256 sc1
v_mfma_f32_16x16x32_bf16 v[184:187], a[128:131], a[192:195], v[184:187]
buffer_load_dwordx4 a[184:187], v3, s[8:11], s42 offen offset:0 sc1
v_mfma_f32_16x16x32_bf16 v[188:191], a[132:135], a[192:195], v[188:191]
buffer_load_dwordx4 a[188:191], v3, s[8:11], s42 offen offset:256 sc1
v_mfma_f32_16x16x32_bf16 v[192:195], a[136:139], a[192:195], v[192:195]
s_add_u32 s42, s42, 8192
s_waitcnt vmcnt(44)
v_mfma_f32_16x16x32_bf16 v[196:199], a[120:123], a[196:199], v[196:199]
buffer_load_dwordx4 a[40:43], v4, s[12:15], s43 offen offset:0 sc1
v_mfma_f32_16x16x32_bf16 v[200:203], a[124:127], a[196:199], v[200:203]
buffer_load_dwordx4 a[44:47], v4, s[12:15], s43 offen offset:1024 sc1
v_mfma_f32_16x16x32_bf16 v[204:207], a[128:131], a[196:199], v[204:207]
buffer_load_dwordx4 a[48:51], v4, s[12:15], s43 offen offset:2048 sc1
v_mfma_f32_16x16x32_bf16 v[208:211], a[132:135], a[196:199], v[208:211]
buffer_load_dwordx4 a[52:55], v4, s[12:15], s43 offen offset:3072 sc1
v_mfma_f32_16x16x32_bf16 v[212:215], a[136:139], a[196:199], v[212:215]
buffer_load_dwordx4 a[56:59], v5, s[12:15], s43 offen sc1
s_waitcnt vmcnt(48)
v_mfma_f32_16x16x32_bf16 v[216:219], a[120:123], a[200:203], v[216:219]
s_add_u32 s43, s43, 20480
v_mfma_f32_16x16x32_bf16 v[220:223], a[124:127], a[200:203], v[220:223]
v_mfma_f32_16x16x32_bf16 v[224:227], a[128:131], a[200:203], v[224:227]
v_mfma_f32_16x16x32_bf16 v[228:231], a[132:135], a[200:203], v[228:231]
v_mfma_f32_16x16x32_bf16 v[232:235], a[136:139], a[200:203], v[232:235]
s_waitcnt vmcnt(47)
v_mfma_f32_16x16x32_bf16 v[236:239], a[120:123], a[204:207], v[236:239]
v_mfma_f32_16x16x32_bf16 v[240:243], a[124:127], a[204:207], v[240:243]
v_mfma_f32_16x16x32_bf16 v[244:247], a[128:131], a[204:207], v[244:247]
v_mfma_f32_16x16x32_bf16 v[248:251], a[132:135], a[204:207], v[248:251]
v_mfma_f32_16x16x32_bf16 v[252:255], a[136:139], a[204:207], v[252:255]
v_lshrrev_b32 v54, 3, v1
v_lshlrev_b32 v54, 10, v54
v_and_b32 v55, 7, v1
v_lshl_add_u32 v54, v55, 4, v54
s_lshl_b32 s65, s48, 6
s_add_u32 s65, s65, s41
s_lshl_b32 s65, s65, 7
s_add_u32 s65, s65, 12386304
buffer_load_dwordx4 v[64:67], v54, s[24:27], s65 offen sc1
s_waitcnt vmcnt(27)
v_mfma_f32_16x16x32_bf16 v[176:179], a[140:143], a[208:211], v[176:179]
buffer_load_dwordx4 a[192:195], v2, s[8:11], s42 offen offset:0 sc1
v_mfma_f32_16x16x32_bf16 v[180:183], a[144:147], a[208:211], v[180:183]
buffer_load_dwordx4 a[196:199], v2, s[8:11], s42 offen offset:256 sc1
v_mfma_f32_16x16x32_bf16 v[184:187], a[148:151], a[208:211], v[184:187]
buffer_load_dwordx4 a[200:203], v3, s[8:11], s42 offen offset:0 sc1
v_mfma_f32_16x16x32_bf16 v[188:191], a[152:155], a[208:211], v[188:191]
buffer_load_dwordx4 a[204:207], v3, s[8:11], s42 offen offset:256 sc1
v_mfma_f32_16x16x32_bf16 v[192:195], a[156:159], a[208:211], v[192:195]
s_add_u32 s42, s42, 8192
s_waitcnt vmcnt(30)
v_mfma_f32_16x16x32_bf16 v[196:199], a[140:143], a[212:215], v[196:199]
buffer_load_dwordx4 a[60:63], v4, s[12:15], s43 offen offset:0 sc1
v_mfma_f32_16x16x32_bf16 v[200:203], a[144:147], a[212:215], v[200:203]
buffer_load_dwordx4 a[64:67], v4, s[12:15], s43 offen offset:1024 sc1
v_mfma_f32_16x16x32_bf16 v[204:207], a[148:151], a[212:215], v[204:207]
buffer_load_dwordx4 a[68:71], v4, s[12:15], s43 offen offset:2048 sc1
v_mfma_f32_16x16x32_bf16 v[208:211], a[152:155], a[212:215], v[208:211]
buffer_load_dwordx4 a[72:75], v4, s[12:15], s43 offen offset:3072 sc1
v_mfma_f32_16x16x32_bf16 v[212:215], a[156:159], a[212:215], v[212:215]
buffer_load_dwordx4 a[76:79], v5, s[12:15], s43 offen sc1
s_waitcnt vmcnt(34)
v_mfma_f32_16x16x32_bf16 v[216:219], a[140:143], a[216:219], v[216:219]
s_add_u32 s43, s43, 20480
v_mfma_f32_16x16x32_bf16 v[220:223], a[144:147], a[216:219], v[220:223]
v_mfma_f32_16x16x32_bf16 v[224:227], a[148:151], a[216:219], v[224:227]
v_mfma_f32_16x16x32_bf16 v[228:231], a[152:155], a[216:219], v[228:231]
v_mfma_f32_16x16x32_bf16 v[232:235], a[156:159], a[216:219], v[232:235]
s_waitcnt vmcnt(33)
v_mfma_f32_16x16x32_bf16 v[236:239], a[140:143], a[220:223], v[236:239]
v_mfma_f32_16x16x32_bf16 v[240:243], a[144:147], a[220:223], v[240:243]
v_mfma_f32_16x16x32_bf16 v[244:247], a[148:151], a[220:223], v[244:247]
v_mfma_f32_16x16x32_bf16 v[248:251], a[152:155], a[220:223], v[248:251]
v_mfma_f32_16x16x32_bf16 v[252:255], a[156:159], a[220:223], v[252:255]
s_waitcnt vmcnt(27)
v_mfma_f32_16x16x32_bf16 v[176:179], a[0:3], a[160:163], v[176:179]
buffer_load_dwordx4 a[208:211], v2, s[8:11], s42 offen offset:0 sc1
v_mfma_f32_16x16x32_bf16 v[180:183], a[4:7], a[160:163], v[180:183]
buffer_load_dwordx4 a[212:215], v2, s[8:11], s42 offen offset:256 sc1
v_mfma_f32_16x16x32_bf16 v[184:187], a[8:11], a[160:163], v[184:187]
buffer_load_dwordx4 a[216:219], v3, s[8:11], s42 offen offset:0 sc1
v_mfma_f32_16x16x32_bf16 v[188:191], a[12:15], a[160:163], v[188:191]
buffer_load_dwordx4 a[220:223], v3, s[8:11], s42 offen offset:256 sc1
v_mfma_f32_16x16x32_bf16 v[192:195], a[16:19], a[160:163], v[192:195]
s_add_u32 s42, s42, 8192
s_waitcnt vmcnt(30)
v_mfma_f32_16x16x32_bf16 v[196:199], a[0:3], a[164:167], v[196:199]
v_mfma_f32_16x16x32_bf16 v[200:203], a[4:7], a[164:167], v[200:203]
v_mfma_f32_16x16x32_bf16 v[204:207], a[8:11], a[164:167], v[204:207]
v_mfma_f32_16x16x32_bf16 v[208:211], a[12:15], a[164:167], v[208:211]
v_mfma_f32_16x16x32_bf16 v[212:215], a[16:19], a[164:167], v[212:215]
s_waitcnt vmcnt(13)
v_cmp_ne_u32 vcc, v67, v30
s_nop 3
s_cbranch_vccz K2COKBKV
s_mov_b32 s77, 4000
K2CSPBKV:
s_sleep 3
buffer_load_dwordx4 v[64:67], v54, s[24:27], s65 offen sc1
s_waitcnt vmcnt(0)
v_cmp_ne_u32 vcc, v67, v30
s_sub_u32 s77, s77, 1
s_nop 2
s_cbranch_vccz K2COKBKV
s_cmp_lg_u32 s77, 0
s_cbranch_scc1 K2CSPBKV
K2COKBKV:
v_mfma_f32_16x16x32_bf16 v[216:219], a[0:3], a[168:171], v[216:219]
v_cvt_pk_bf16_f32 v64, v64, v65
v_cvt_pk_bf16_f32 v66, v66, v66
s_mov_b64 s[60:61], exec
s_mov_b32 exec_lo, 0x7f7f7f7f
s_mov_b32 exec_hi, 0x7f7f7f7f
ds_write_b16 v17, v64
ds_write_b16_d16_hi v17, v64 offset:2
s_mov_b32 exec_lo, 0x3f3f3f3f
s_mov_b32 exec_hi, 0x3f3f3f3f
ds_write_b16 v17, v66 offset:4
s_mov_b64 exec, s[60:61]
v_mfma_f32_16x16x32_bf16 v[220:223], a[4:7], a[168:171], v[220:223]
s_waitcnt lgkmcnt(0)
ds_read_b64 v[72:73], v28 offset:0
ds_read_b64 v[74:75], v28 offset:16
ds_read_b64 v[76:77], v28 offset:64
ds_read_b64 v[78:79], v28 offset:80
ds_read_b64 v[80:81], v28 offset:128
ds_read_b64 v[82:83], v28 offset:144
ds_read_b64 v[84:85], v28 offset:192
ds_read_b64 v[86:87], v28 offset:208
ds_read_b64 v[88:89], v28 offset:256
ds_read_b64 v[90:91], v28 offset:272
v_mfma_f32_16x16x32_bf16 v[224:227], a[8:11], a[168:171], v[224:227]
s_waitcnt lgkmcnt(8)
v_mfma_f32_16x16x32_bf16 v[54:57], v[72:75], v[96:99], 0
v_mfma_f32_16x16x32_bf16 v[58:61], v[72:75], v[100:103], 0
v_mfma_f32_16x16x32_bf16 v[62:65], v[72:75], v[104:107], 0
v_mfma_f32_16x16x32_bf16 v[66:69], v[72:75], v[108:111], 0
s_waitcnt lgkmcnt(6)
v_mfma_f32_16x16x32_bf16 v[54:57], v[76:79], v[112:115], v[54:57]
v_mfma_f32_16x16x32_bf16 v[228:231], a[12:15], a[168:171], v[228:231]
v_mfma_f32_16x16x32_bf16 v[58:61], v[76:79], v[116:119], v[58:61]
v_mfma_f32_16x16x32_bf16 v[62:65], v[76:79], v[120:123], v[62:65]
v_mfma_f32_16x16x32_bf16 v[66:69], v[76:79], v[124:127], v[66:69]
s_waitcnt lgkmcnt(4)
v_mfma_f32_16x16x32_bf16 v[54:57], v[80:83], v[128:131], v[54:57]
v_mfma_f32_16x16x32_bf16 v[58:61], v[80:83], v[132:135], v[58:61]
v_mfma_f32_16x16x32_bf16 v[232:235], a[16:19], a[168:171], v[232:235]
v_mfma_f32_16x16x32_bf16 v[62:65], v[80:83], v[136:139], v[62:65]
v_mfma_f32_16x16x32_bf16 v[66:69], v[80:83], v[140:143], v[66:69]
s_waitcnt lgkmcnt(2)
v_mfma_f32_16x16x32_bf16 v[54:57], v[84:87], v[144:147], v[54:57]
v_mfma_f32_16x16x32_bf16 v[58:61], v[84:87], v[148:151], v[58:61]
v_mfma_f32_16x16x32_bf16 v[62:65], v[84:87], v[152:155], v[62:65]
v_mfma_f32_16x16x32_bf16 v[236:239], a[0:3], a[172:175], v[236:239]
v_mfma_f32_16x16x32_bf16 v[66:69], v[84:87], v[156:159], v[66:69]
s_waitcnt lgkmcnt(0)
v_mfma_f32_16x16x32_bf16 v[54:57], v[88:91], v[160:163], v[54:57]
v_mfma_f32_16x16x32_bf16 v[58:61], v[88:91], v[164:167], v[58:61]
v_mfma_f32_16x16x32_bf16 v[62:65], v[88:91], v[168:171], v[62:65]
v_mfma_f32_16x16x32_bf16 v[66:69], v[88:91], v[172:175], v[66:69]
v_mfma_f32_16x16x32_bf16 v[240:243], a[4:7], a[172:175], v[240:243]
v_and_b32 v70, 15, v1
v_lshlrev_b32 v70, 5, v70
v_lshrrev_b32 v71, 4, v1
v_lshl_add_u32 v70, v71, 4, v70
s_lshl_b32 s51, s48, 11
v_mfma_f32_16x16x32_bf16 v[244:247], a[8:11], a[172:175], v[244:247]
s_add_u32 s64, s51, 96512
v_add_u32 v70, s64, v70
v_add_f32 v54, s63, v54
v_add_f32 v55, s63, v55
v_add_f32 v56, s63, v56
v_mfma_f32_16x16x32_bf16 v[248:251], a[12:15], a[172:175], v[248:251]
v_add_f32 v57, s63, v57
v_add_f32 v58, s63, v58
v_add_f32 v59, s63, v59
v_add_f32 v60, s63, v60
v_add_f32 v61, s63, v61
v_mfma_f32_16x16x32_bf16 v[252:255], a[16:19], a[172:175], v[252:255]
v_add_f32 v62, s63, v62
v_add_f32 v63, s63, v63
v_add_f32 v64, s63, v64
v_add_f32 v65, s63, v65
v_add_f32 v66, s63, v66
v_mfma_f32_16x16x32_bf16 v[176:179], a[20:23], a[176:179], v[176:179]
buffer_load_dwordx2 a[80:81], v32, s[24:27], s62 offen offset:0 sc1
v_add_f32 v67, s63, v67
v_add_f32 v68, s63, v68
v_add_f32 v69, s63, v69
v_rcp_f32 v54, v54
v_mfma_f32_16x16x32_bf16 v[180:183], a[24:27], a[176:179], v[180:183]
buffer_load_dwordx2 a[82:83], v33, s[24:27], s62 offen offset:0 sc1
v_rcp_f32 v55, v55
v_rcp_f32 v56, v56
v_rcp_f32 v57, v57
v_rcp_f32 v58, v58
v_mfma_f32_16x16x32_bf16 v[184:187], a[28:31], a[176:179], v[184:187]
buffer_load_dwordx2 a[84:85], v32, s[24:27], s62 offen offset:640 sc1
v_rcp_f32 v59, v59
v_rcp_f32 v60, v60
v_rcp_f32 v61, v61
v_rcp_f32 v62, v62
v_mfma_f32_16x16x32_bf16 v[188:191], a[32:35], a[176:179], v[188:191]
buffer_load_dwordx2 a[86:87], v33, s[24:27], s62 offen offset:640 sc1
v_rcp_f32 v63, v63
v_rcp_f32 v64, v64
v_rcp_f32 v65, v65
v_rcp_f32 v66, v66
v_mfma_f32_16x16x32_bf16 v[192:195], a[36:39], a[176:179], v[192:195]
buffer_load_dwordx2 a[88:89], v32, s[24:27], s62 offen offset:1280 sc1
v_rcp_f32 v67, v67
v_rcp_f32 v68, v68
v_rcp_f32 v69, v69
s_mov_b64 s[60:61], exec
s_mov_b64 exec, 0xffffffff
ds_write_b128 v70, v[54:57] offset:0
ds_write_b128 v70, v[58:61] offset:512
ds_write_b128 v70, v[62:65] offset:1024
ds_write_b128 v70, v[66:69] offset:1536
s_mov_b64 exec, s[60:61]
v_mfma_f32_16x16x32_bf16 v[196:199], a[20:23], a[180:183], v[196:199]
buffer_load_dwordx2 a[90:91], v33, s[24:27], s62 offen offset:1280 sc1
s_waitcnt lgkmcnt(0)
ds_read_b32 v72, v42 offset:0
ds_read_b32 v73, v43 offset:0
ds_read_b32 v74, v42 offset:512
ds_read_b32 v75, v43 offset:512
ds_read_b32 v76, v42 offset:1024
ds_read_b32 v77, v43 offset:1024
ds_read_b32 v78, v42 offset:1536
ds_read_b32 v79, v43 offset:1536
v_mfma_f32_16x16x32_bf16 v[200:203], a[24:27], a[180:183], v[200:203]
buffer_load_dwordx2 a[92:93], v32, s[24:27], s62 offen offset:1920 sc1
v_lshlrev_b32 v88, 16, v96
v_and_b32 v89, 0xffff0000, v96
v_lshlrev_b32 v90, 16, v97
v_and_b32 v91, 0xffff0000, v97
v_mfma_f32_16x16x32_bf16 v[204:207], a[28:31], a[180:183], v[204:207]
buffer_load_dwordx2 a[94:95], v33, s[24:27], s62 offen offset:1920 sc1
v_lshlrev_b32 v92, 16, v98
v_and_b32 v93, 0xffff0000, v98
v_lshlrev_b32 v94, 16, v99
v_and_b32 v95, 0xffff0000, v99
v_mfma_f32_16x16x32_bf16 v[208:211], a[32:35], a[180:183], v[208:211]
buffer_load_dwordx2 a[96:97], v32, s[24:27], s62 offen offset:2560 sc1
s_waitcnt lgkmcnt(7)
v_mul_f32 v88, v88, v72
v_mul_f32 v89, v89, v72
v_mul_f32 v90, v90, v72
v_mul_f32 v91, v91, v72
v_mfma_f32_16x16x32_bf16 v[212:215], a[36:39], a[180:183], v[212:215]
buffer_load_dwordx2 a[98:99], v33, s[24:27], s62 offen offset:2560 sc1
s_waitcnt lgkmcnt(6)
v_mul_f32 v92, v92, v73
v_mul_f32 v93, v93, v73
v_mul_f32 v94, v94, v73
v_mul_f32 v95, v95, v73
v_mfma_f32_16x16x32_bf16 v[216:219], a[20:23], a[184:187], v[216:219]
buffer_load_dwordx2 a[100:101], v34, s[24:27], s62 offen offset:0 sc1
v_cvt_pk_bf16_f32 v96, v88, v89
v_cvt_pk_bf16_f32 v97, v90, v91
v_cvt_pk_bf16_f32 v98, v92, v93
v_cvt_pk_bf16_f32 v99, v94, v95
v_mfma_f32_16x16x32_bf16 v[220:223], a[24:27], a[184:187], v[220:223]
buffer_load_dwordx2 a[102:103], v35, s[24:27], s62 offen offset:0 sc1
v_lshlrev_b32 v88, 16, v100
v_and_b32 v89, 0xffff0000, v100
v_lshlrev_b32 v90, 16, v101
v_and_b32 v91, 0xffff0000, v101
v_mfma_f32_16x16x32_bf16 v[224:227], a[28:31], a[184:187], v[224:227]
buffer_load_dwordx2 a[104:105], v34, s[24:27], s62 offen offset:640 sc1
v_lshlrev_b32 v92, 16, v102
v_and_b32 v93, 0xffff0000, v102
v_lshlrev_b32 v94, 16, v103
v_and_b32 v95, 0xffff0000, v103
v_mfma_f32_16x16x32_bf16 v[228:231], a[32:35], a[184:187], v[228:231]
buffer_load_dwordx2 a[106:107], v35, s[24:27], s62 offen offset:640 sc1
s_waitcnt lgkmcnt(5)
v_mul_f32 v88, v88, v74
v_mul_f32 v89, v89, v74
v_mul_f32 v90, v90, v74
v_mul_f32 v91, v91, v74
v_mfma_f32_16x16x32_bf16 v[232:235], a[36:39], a[184:187], v[232:235]
buffer_load_dwordx2 a[108:109], v34, s[24:27], s62 offen offset:1280 sc1
s_waitcnt lgkmcnt(4)
v_mul_f32 v92, v92, v75
v_mul_f32 v93, v93, v75
v_mul_f32 v94, v94, v75
v_mul_f32 v95, v95, v75
v_mfma_f32_16x16x32_bf16 v[236:239], a[20:23], a[188:191], v[236:239]
buffer_load_dwordx2 a[110:111], v35, s[24:27], s62 offen offset:1280 sc1
v_cvt_pk_bf16_f32 v100, v88, v89
v_cvt_pk_bf16_f32 v101, v90, v91
v_cvt_pk_bf16_f32 v102, v92, v93
v_cvt_pk_bf16_f32 v103, v94, v95
v_mfma_f32_16x16x32_bf16 v[240:243], a[24:27], a[188:191], v[240:243]
buffer_load_dwordx2 a[112:113], v34, s[24:27], s62 offen offset:1920 sc1
v_lshlrev_b32 v88, 16, v104
v_and_b32 v89, 0xffff0000, v104
v_lshlrev_b32 v90, 16, v105
v_and_b32 v91, 0xffff0000, v105
v_mfma_f32_16x16x32_bf16 v[244:247], a[28:31], a[188:191], v[244:247]
buffer_load_dwordx2 a[114:115], v35, s[24:27], s62 offen offset:1920 sc1
v_lshlrev_b32 v92, 16, v106
v_and_b32 v93, 0xffff0000, v106
v_lshlrev_b32 v94, 16, v107
v_and_b32 v95, 0xffff0000, v107
v_mfma_f32_16x16x32_bf16 v[248:251], a[32:35], a[188:191], v[248:251]
buffer_load_dwordx2 a[116:117], v34, s[24:27], s62 offen offset:2560 sc1
s_waitcnt lgkmcnt(3)
v_mul_f32 v88, v88, v76
v_mul_f32 v89, v89, v76
v_mul_f32 v90, v90, v76
v_mul_f32 v91, v91, v76
v_mfma_f32_16x16x32_bf16 v[252:255], a[36:39], a[188:191], v[252:255]
buffer_load_dwordx2 a[118:119], v35, s[24:27], s62 offen offset:2560 sc1
s_waitcnt lgkmcnt(2)
v_mul_f32 v92, v92, v77
v_mul_f32 v93, v93, v77
v_mul_f32 v94, v94, v77
v_mul_f32 v95, v95, v77
s_waitcnt vmcnt(32)
v_mfma_f32_16x16x32_bf16 v[176:179], a[40:43], a[192:195], v[176:179]
buffer_load_dwordx2 a[120:121], v36, s[24:27], s62 offen offset:0 sc1
v_cvt_pk_bf16_f32 v104, v88, v89
v_cvt_pk_bf16_f32 v105, v90, v91
v_cvt_pk_bf16_f32 v106, v92, v93
v_cvt_pk_bf16_f32 v107, v94, v95
v_mfma_f32_16x16x32_bf16 v[180:183], a[44:47], a[192:195], v[180:183]
buffer_load_dwordx2 a[122:123], v37, s[24:27], s62 offen offset:0 sc1
v_lshlrev_b32 v88, 16, v108
v_and_b32 v89, 0xffff0000, v108
v_lshlrev_b32 v90, 16, v109
v_and_b32 v91, 0xffff0000, v109
v_mfma_f32_16x16x32_bf16 v[184:187], a[48:51], a[192:195], v[184:187]
buffer_load_dwordx2 a[124:125], v36, s[24:27], s62 offen offset:640 sc1
v_lshlrev_b32 v92, 16, v110
v_and_b32 v93, 0xffff0000, v110
v_lshlrev_b32 v94, 16, v111
v_and_b32 v95, 0xffff0000, v111
v_mfma_f32_16x16x32_bf16 v[188:191], a[52:55], a[192:195], v[188:191]
buffer_load_dwordx2 a[126:127], v37, s[24:27], s62 offen offset:640 sc1
s_waitcnt lgkmcnt(1)
v_mul_f32 v88, v88, v78
v_mul_f32 v89, v89, v78
v_mul_f32 v90, v90, v78
v_mul_f32 v91, v91, v78
v_mfma_f32_16x16x32_bf16 v[192:195], a[56:59], a[192:195], v[192:195]
buffer_load_dwordx2 a[128:129], v36, s[24:27], s62 offen offset:1280 sc1
s_waitcnt lgkmcnt(0)
v_mul_f32 v92, v92, v79
v_mul_f32 v93, v93, v79
v_mul_f32 v94, v94, v79
v_mul_f32 v95, v95, v79
s_waitcnt vmcnt(36)
v_mfma_f32_16x16x32_bf16 v[196:199], a[40:43], a[196:199], v[196:199]
buffer_load_dwordx2 a[130:131], v37, s[24:27], s62 offen offset:1280 sc1
v_cvt_pk_bf16_f32 v108, v88, v89
v_cvt_pk_bf16_f32 v109, v90, v91
v_cvt_pk_bf16_f32 v110, v92, v93
v_cvt_pk_bf16_f32 v111, v94, v95
v_mfma_f32_16x16x32_bf16 v[200:203], a[44:47], a[196:199], v[200:203]
buffer_load_dwordx2 a[132:133], v36, s[24:27], s62 offen offset:1920 sc1
ds_read_b32 v80, v44 offset:0
ds_read_b32 v81, v45 offset:0
ds_read_b32 v82, v44 offset:512
ds_read_b32 v83, v45 offset:512
ds_read_b32 v84, v44 offset:1024
ds_read_b32 v85, v45 offset:1024
ds_read_b32 v86, v44 offset:1536
ds_read_b32 v87, v45 offset:1536
v_mfma_f32_16x16x32_bf16 v[204:207], a[48:51], a[196:199], v[204:207]
buffer_load_dwordx2 a[134:135], v37, s[24:27], s62 offen offset:1920 sc1
v_lshlrev_b32 v88, 16, v112
v_and_b32 v89, 0xffff0000, v112
v_lshlrev_b32 v90, 16, v113
v_and_b32 v91, 0xffff0000, v113
v_mfma_f32_16x16x32_bf16 v[208:211], a[52:55], a[196:199], v[208:211]
buffer_load_dwordx2 a[136:137], v36, s[24:27], s62 offen offset:2560 sc1
v_lshlrev_b32 v92, 16, v114
v_and_b32 v93, 0xffff0000, v114
v_lshlrev_b32 v94, 16, v115
v_and_b32 v95, 0xffff0000, v115
v_mfma_f32_16x16x32_bf16 v[212:215], a[56:59], a[196:199], v[212:215]
buffer_load_dwordx2 a[138:139], v37, s[24:27], s62 offen offset:2560 sc1
s_waitcnt lgkmcnt(7)
v_mul_f32 v88, v88, v80
v_mul_f32 v89, v89, v80
v_mul_f32 v90, v90, v80
v_mul_f32 v91, v91, v80
s_waitcnt vmcnt(40)
v_mfma_f32_16x16x32_bf16 v[216:219], a[40:43], a[200:203], v[216:219]
s_waitcnt lgkmcnt(6)
v_mul_f32 v92, v92, v81
v_mul_f32 v93, v93, v81
v_mul_f32 v94, v94, v81
v_mul_f32 v95, v95, v81
v_cvt_pk_bf16_f32 v112, v88, v89
v_mfma_f32_16x16x32_bf16 v[220:223], a[44:47], a[200:203], v[220:223]
v_cvt_pk_bf16_f32 v113, v90, v91
v_cvt_pk_bf16_f32 v114, v92, v93
v_cvt_pk_bf16_f32 v115, v94, v95
v_lshlrev_b32 v88, 16, v116
v_and_b32 v89, 0xffff0000, v116
v_mfma_f32_16x16x32_bf16 v[224:227], a[48:51], a[200:203], v[224:227]
v_lshlrev_b32 v90, 16, v117
v_and_b32 v91, 0xffff0000, v117
v_lshlrev_b32 v92, 16, v118
v_and_b32 v93, 0xffff0000, v118
v_lshlrev_b32 v94, 16, v119
v_mfma_f32_16x16x32_bf16 v[228:231], a[52:55], a[200:203], v[228:231]
v_and_b32 v95, 0xffff0000, v119
s_waitcnt lgkmcnt(5)
v_mul_f32 v88, v88, v82
v_mul_f32 v89, v89, v82
v_mul_f32 v90, v90, v82
v_mul_f32 v91, v91, v82
v_mfma_f32_16x16x32_bf16 v[232:235], a[56:59], a[200:203], v[232:235]
s_waitcnt lgkmcnt(4)
v_mul_f32 v92, v92, v83
v_mul_f32 v93, v93, v83
v_mul_f32 v94, v94, v83
v_mul_f32 v95, v95, v83
v_cvt_pk_bf16_f32 v116, v88, v89
s_waitcnt vmcnt(39)
v_mfma_f32_16x16x32_bf16 v[236:239], a[40:43], a[204:207], v[236:239]
v_cvt_pk_bf16_f32 v117, v90, v91
v_cvt_pk_bf16_f32 v118, v92, v93
v_cvt_pk_bf16_f32 v119, v94, v95
v_lshlrev_b32 v88, 16, v120
v_and_b32 v89, 0xffff0000, v120
v_mfma_f32_16x16x32_bf16 v[240:243], a[44:47], a[204:207], v[240:243]
v_lshlrev_b32 v90, 16, v121
v_and_b32 v91, 0xffff0000, v121
v_lshlrev_b32 v92, 16, v122
v_and_b32 v93, 0xffff0000, v122
v_lshlrev_b32 v94, 16, v123
v_mfma_f32_16x16x32_bf16 v[244:247], a[48:51], a[204:207], v[244:247]
v_and_b32 v95, 0xffff0000, v123
s_waitcnt lgkmcnt(3)
v_mul_f32 v88, v88, v84
v_mul_f32 v89, v89, v84
v_mul_f32 v90, v90, v84
v_mul_f32 v91, v91, v84
v_mfma_f32_16x16x32_bf16 v[248:251], a[52:55], a[204:207], v[248:251]
s_waitcnt lgkmcnt(2)
v_mul_f32 v92, v92, v85
v_mul_f32 v93, v93, v85
v_mul_f32 v94, v94, v85
v_mul_f32 v95, v95, v85
v_cvt_pk_bf16_f32 v120, v88, v89
v_mfma_f32_16x16x32_bf16 v[252:255], a[56:59], a[204:207], v[252:255]
v_cvt_pk_bf16_f32 v121, v90, v91
v_cvt_pk_bf16_f32 v122, v92, v93
v_cvt_pk_bf16_f32 v123, v94, v95
v_lshlrev_b32 v88, 16, v124
v_and_b32 v89, 0xffff0000, v124
s_waitcnt vmcnt(33)
v_mfma_f32_16x16x32_bf16 v[176:179], a[60:63], a[208:211], v[176:179]
buffer_load_dwordx2 a[140:141], v38, s[24:27], s62 offen offset:0 sc1
v_lshlrev_b32 v90, 16, v125
v_and_b32 v91, 0xffff0000, v125
v_lshlrev_b32 v92, 16, v126
v_and_b32 v93, 0xffff0000, v126
v_mfma_f32_16x16x32_bf16 v[180:183], a[64:67], a[208:211], v[180:183]
buffer_load_dwordx2 a[142:143], v39, s[24:27], s62 offen offset:0 sc1
v_lshlrev_b32 v94, 16, v127
v_and_b32 v95, 0xffff0000, v127
s_waitcnt lgkmcnt(1)
v_mul_f32 v88, v88, v86
v_mul_f32 v89, v89, v86
v_mfma_f32_16x16x32_bf16 v[184:187], a[68:71], a[208:211], v[184:187]
buffer_load_dwordx2 a[144:145], v38, s[24:27], s62 offen offset:640 sc1
v_mul_f32 v90, v90, v86
v_mul_f32 v91, v91, v86
s_waitcnt lgkmcnt(0)
v_mul_f32 v92, v92, v87
v_mul_f32 v93, v93, v87
v_mfma_f32_16x16x32_bf16 v[188:191], a[72:75], a[208:211], v[188:191]
buffer_load_dwordx2 a[146:147], v39, s[24:27], s62 offen offset:640 sc1
v_mul_f32 v94, v94, v87
v_mul_f32 v95, v95, v87
v_cvt_pk_bf16_f32 v124, v88, v89
v_cvt_pk_bf16_f32 v125, v90, v91
v_mfma_f32_16x16x32_bf16 v[192:195], a[76:79], a[208:211], v[192:195]
buffer_load_dwordx2 a[148:149], v38, s[24:27], s62 offen offset:1280 sc1
v_cvt_pk_bf16_f32 v126, v92, v93
v_cvt_pk_bf16_f32 v127, v94, v95
ds_read_b32 v72, v46 offset:0
ds_read_b32 v73, v47 offset:0
ds_read_b32 v74, v46 offset:512
ds_read_b32 v75, v47 offset:512
ds_read_b32 v76, v46 offset:1024
ds_read_b32 v77, v47 offset:1024
ds_read_b32 v78, v46 offset:1536
ds_read_b32 v79, v47 offset:1536
s_waitcnt vmcnt(37)
v_mfma_f32_16x16x32_bf16 v[196:199], a[60:63], a[212:215], v[196:199]
buffer_load_dwordx2 a[150:151], v39, s[24:27], s62 offen offset:1280 sc1
v_lshlrev_b32 v88, 16, v128
v_and_b32 v89, 0xffff0000, v128
v_lshlrev_b32 v90, 16, v129
v_and_b32 v91, 0xffff0000, v129
v_mfma_f32_16x16x32_bf16 v[200:203], a[64:67], a[212:215], v[200:203]
buffer_load_dwordx2 a[152:153], v38, s[24:27], s62 offen offset:1920 sc1
v_lshlrev_b32 v92, 16, v130
v_and_b32 v93, 0xffff0000, v130
v_lshlrev_b32 v94, 16, v131
v_and_b32 v95, 0xffff0000, v131
v_mfma_f32_16x16x32_bf16 v[204:207], a[68:71], a[212:215], v[204:207]
buffer_load_dwordx2 a[154:155], v39, s[24:27], s62 offen offset:1920 sc1
s_waitcnt lgkmcnt(7)
v_mul_f32 v88, v88, v72
v_mul_f32 v89, v89, v72
v_mul_f32 v90, v90, v72
v_mul_f32 v91, v91, v72
v_mfma_f32_16x16x32_bf16 v[208:211], a[72:75], a[212:215], v[208:211]
buffer_load_dwordx2 a[156:157], v38, s[24:27], s62 offen offset:2560 sc1
s_waitcnt lgkmcnt(6)
v_mul_f32 v92, v92, v73
v_mul_f32 v93, v93, v73
v_mul_f32 v94, v94, v73
v_mul_f32 v95, v95, v73
v_mfma_f32_16x16x32_bf16 v[212:215], a[76:79], a[212:215], v[212:215]
buffer_load_dwordx2 a[158:159], v39, s[24:27], s62 offen offset:2560 sc1
v_cvt_pk_bf16_f32 v128, v88, v89
v_cvt_pk_bf16_f32 v129, v90, v91
v_cvt_pk_bf16_f32 v130, v92, v93
v_cvt_pk_bf16_f32 v131, v94, v95
s_waitcnt vmcnt(41)
v_mfma_f32_16x16x32_bf16 v[216:219], a[60:63], a[216:219], v[216:219]
v_lshlrev_b32 v88, 16, v132
v_and_b32 v89, 0xffff0000, v132
v_lshlrev_b32 v90, 16, v133
v_and_b32 v91, 0xffff0000, v133
v_lshlrev_b32 v92, 16, v134
v_mfma_f32_16x16x32_bf16 v[220:223], a[64:67], a[216:219], v[220:223]
v_and_b32 v93, 0xffff0000, v134
v_lshlrev_b32 v94, 16, v135
v_and_b32 v95, 0xffff0000, v135
s_waitcnt lgkmcnt(5)
v_mul_f32 v88, v88, v74
v_mul_f32 v89, v89, v74
v_mfma_f32_16x16x32_bf16 v[224:227], a[68:71], a[216:219], v[224:227]
v_mul_f32 v90, v90, v74
v_mul_f32 v91, v91, v74
s_waitcnt lgkmcnt(4)
v_mul_f32 v92, v92, v75
v_mul_f32 v93, v93, v75
v_mul_f32 v94, v94, v75
v_mfma_f32_16x16x32_bf16 v[228:231], a[72:75], a[216:219], v[228:231]
v_mul_f32 v95, v95, v75
v_cvt_pk_bf16_f32 v132, v88, v89
v_cvt_pk_bf16_f32 v133, v90, v91
v_cvt_pk_bf16_f32 v134, v92, v93
v_cvt_pk_bf16_f32 v135, v94, v95
v_mfma_f32_16x16x32_bf16 v[232:235], a[76:79], a[216:219], v[232:235]
v_lshlrev_b32 v88, 16, v136
v_and_b32 v89, 0xffff0000, v136
v_lshlrev_b32 v90, 16, v137
v_and_b32 v91, 0xffff0000, v137
v_lshlrev_b32 v92, 16, v138
s_waitcnt vmcnt(40)
v_mfma_f32_16x16x32_bf16 v[236:239], a[60:63], a[220:223], v[236:239]
v_and_b32 v93, 0xffff0000, v138
v_lshlrev_b32 v94, 16, v139
v_and_b32 v95, 0xffff0000, v139
s_waitcnt lgkmcnt(3)
v_mul_f32 v88, v88, v76
v_mul_f32 v89, v89, v76
v_mfma_f32_16x16x32_bf16 v[240:243], a[64:67], a[220:223], v[240:243]
v_mul_f32 v90, v90, v76
v_mul_f32 v91, v91, v76
s_waitcnt lgkmcnt(2)
v_mul_f32 v92, v92, v77
v_mul_f32 v93, v93, v77
v_mul_f32 v94, v94, v77
v_mfma_f32_16x16x32_bf16 v[244:247], a[68:71], a[220:223], v[244:247]
v_mul_f32 v95, v95, v77
v_cvt_pk_bf16_f32 v136, v88, v89
v_cvt_pk_bf16_f32 v137, v90, v91
v_cvt_pk_bf16_f32 v138, v92, v93
v_cvt_pk_bf16_f32 v139, v94, v95
v_mfma_f32_16x16x32_bf16 v[248:251], a[72:75], a[220:223], v[248:251]
v_lshlrev_b32 v88, 16, v140
v_and_b32 v89, 0xffff0000, v140
v_lshlrev_b32 v90, 16, v141
v_and_b32 v91, 0xffff0000, v141
v_lshlrev_b32 v92, 16, v142
v_mfma_f32_16x16x32_bf16 v[252:255], a[76:79], a[220:223], v[252:255]
v_and_b32 v93, 0xffff0000, v142
v_lshlrev_b32 v94, 16, v143
v_and_b32 v95, 0xffff0000, v143
s_waitcnt lgkmcnt(1)
v_mul_f32 v88, v88, v78
v_mul_f32 v89, v89, v78
s_waitcnt vmcnt(38)
v_mfma_f32_16x16x32_bf16 v[176:179], a[80:83], v[96:99], v[176:179]
buffer_load_dwordx2 a[0:1], v40, s[24:27], s62 offen offset:0 sc1
v_mul_f32 v90, v90, v78
v_mul_f32 v91, v91, v78
s_waitcnt lgkmcnt(0)
v_mul_f32 v92, v92, v79
v_mul_f32 v93, v93, v79
s_waitcnt vmcnt(37)
v_mfma_f32_16x16x32_bf16 v[180:183], a[84:87], v[96:99], v[180:183]
buffer_load_dwordx2 a[2:3], v41, s[24:27], s62 offen offset:0 sc1
v_mul_f32 v94, v94, v79
v_mul_f32 v95, v95, v79
v_cvt_pk_bf16_f32 v140, v88, v89
v_cvt_pk_bf16_f32 v141, v90, v91
s_waitcnt vmcnt(36)
v_mfma_f32_16x16x32_bf16 v[184:187], a[88:91], v[96:99], v[184:187]
buffer_load_dwordx2 a[4:5], v40, s[24:27], s62 offen offset:640 sc1
v_cvt_pk_bf16_f32 v142, v92, v93
v_cvt_pk_bf16_f32 v143, v94, v95
ds_read_b32 v80, v48 offset:0
ds_read_b32 v81, v49 offset:0
ds_read_b32 v82, v48 offset:512
ds_read_b32 v83, v49 offset:512
ds_read_b32 v84, v48 offset:1024
ds_read_b32 v85, v49 offset:1024
ds_read_b32 v86, v48 offset:1536
ds_read_b32 v87, v49 offset:1536
s_waitcnt vmcnt(35)
v_mfma_f32_16x16x32_bf16 v[188:191], a[92:95], v[96:99], v[188:191]
buffer_load_dwordx2 a[6:7], v41, s[24:27], s62 offen offset:640 sc1
v_lshlrev_b32 v88, 16, v144
v_and_b32 v89, 0xffff0000, v144
v_lshlrev_b32 v90, 16, v145
v_and_b32 v91, 0xffff0000, v145
s_waitcnt vmcnt(34)
v_mfma_f32_16x16x32_bf16 v[192:195], a[96:99], v[96:99], v[192:195]
buffer_load_dwordx2 a[8:9], v40, s[24:27], s62 offen offset:1280 sc1
v_lshlrev_b32 v92, 16, v146
v_and_b32 v93, 0xffff0000, v146
v_lshlrev_b32 v94, 16, v147
v_and_b32 v95, 0xffff0000, v147
v_mfma_f32_16x16x32_bf16 v[196:199], a[80:83], v[100:103], v[196:199]
buffer_load_dwordx2 a[10:11], v41, s[24:27], s62 offen offset:1280 sc1
s_waitcnt lgkmcnt(7)
v_mul_f32 v88, v88, v80
v_mul_f32 v89, v89, v80
v_mul_f32 v90, v90, v80
v_mul_f32 v91, v91, v80
v_mfma_f32_16x16x32_bf16 v[200:203], a[84:87], v[100:103], v[200:203]
buffer_load_dwordx2 a[12:13], v40, s[24:27], s62 offen offset:1920 sc1
s_waitcnt lgkmcnt(6)
v_mul_f32 v92, v92, v81
v_mul_f32 v93, v93, v81
v_mul_f32 v94, v94, v81
v_mul_f32 v95, v95, v81
v_mfma_f32_16x16x32_bf16 v[204:207], a[88:91], v[100:103], v[204:207]
buffer_load_dwordx2 a[14:15], v41, s[24:27], s62 offen offset:1920 sc1
v_cvt_pk_bf16_f32 v144, v88, v89
v_cvt_pk_bf16_f32 v145, v90, v91
v_cvt_pk_bf16_f32 v146, v92, v93
v_cvt_pk_bf16_f32 v147, v94, v95
v_mfma_f32_16x16x32_bf16 v[208:211], a[92:95], v[100:103], v[208:211]
buffer_load_dwordx2 a[16:17], v40, s[24:27], s62 offen offset:2560 sc1
v_lshlrev_b32 v88, 16, v148
v_and_b32 v89, 0xffff0000, v148
v_lshlrev_b32 v90, 16, v149
v_and_b32 v91, 0xffff0000, v149
v_mfma_f32_16x16x32_bf16 v[212:215], a[96:99], v[100:103], v[212:215]
buffer_load_dwordx2 a[18:19], v41, s[24:27], s62 offen offset:2560 sc1
v_lshlrev_b32 v92, 16, v150
v_and_b32 v93, 0xffff0000, v150
v_lshlrev_b32 v94, 16, v151
v_and_b32 v95, 0xffff0000, v151
v_mfma_f32_16x16x32_bf16 v[216:219], a[80:83], v[104:107], v[216:219]
s_waitcnt lgkmcnt(5)
v_mul_f32 v88, v88, v82
v_mul_f32 v89, v89, v82
v_mul_f32 v90, v90, v82
v_mul_f32 v91, v91, v82
s_waitcnt lgkmcnt(4)
v_mul_f32 v92, v92, v83
v_mfma_f32_16x16x32_bf16 v[220:223], a[84:87], v[104:107], v[220:223]
v_mul_f32 v93, v93, v83
v_mul_f32 v94, v94, v83
v_mul_f32 v95, v95, v83
v_cvt_pk_bf16_f32 v148, v88, v89
v_cvt_pk_bf16_f32 v149, v90, v91
v_mfma_f32_16x16x32_bf16 v[224:227], a[88:91], v[104:107], v[224:227]
v_cvt_pk_bf16_f32 v150, v92, v93
v_cvt_pk_bf16_f32 v151, v94, v95
v_lshlrev_b32 v88, 16, v152
v_and_b32 v89, 0xffff0000, v152
v_lshlrev_b32 v90, 16, v153
v_mfma_f32_16x16x32_bf16 v[228:231], a[92:95], v[104:107], v[228:231]
v_and_b32 v91, 0xffff0000, v153
v_lshlrev_b32 v92, 16, v154
v_and_b32 v93, 0xffff0000, v154
v_lshlrev_b32 v94, 16, v155
v_and_b32 v95, 0xffff0000, v155
v_mfma_f32_16x16x32_bf16 v[232:235], a[96:99], v[104:107], v[232:235]
s_waitcnt lgkmcnt(3)
v_mul_f32 v88, v88, v84
v_mul_f32 v89, v89, v84
v_mul_f32 v90, v90, v84
v_mul_f32 v91, v91, v84
s_waitcnt lgkmcnt(2)
v_mul_f32 v92, v92, v85
v_mfma_f32_16x16x32_bf16 v[236:239], a[80:83], v[108:111], v[236:239]
v_mul_f32 v93, v93, v85
v_mul_f32 v94, v94, v85
v_mul_f32 v95, v95, v85
v_cvt_pk_bf16_f32 v152, v88, v89
v_cvt_pk_bf16_f32 v153, v90, v91
v_mfma_f32_16x16x32_bf16 v[240:243], a[84:87], v[108:111], v[240:243]
v_cvt_pk_bf16_f32 v154, v92, v93
v_cvt_pk_bf16_f32 v155, v94, v95
v_lshlrev_b32 v88, 16, v156
v_and_b32 v89, 0xffff0000, v156
v_lshlrev_b32 v90, 16, v157
v_mfma_f32_16x16x32_bf16 v[244:247], a[88:91], v[108:111], v[244:247]
v_and_b32 v91, 0xffff0000, v157
v_lshlrev_b32 v92, 16, v158
v_and_b32 v93, 0xffff0000, v158
v_lshlrev_b32 v94, 16, v159
v_and_b32 v95, 0xffff0000, v159
v_mfma_f32_16x16x32_bf16 v[248:251], a[92:95], v[108:111], v[248:251]
s_waitcnt lgkmcnt(1)
v_mul_f32 v88, v88, v86
v_mul_f32 v89, v89, v86
v_mul_f32 v90, v90, v86
v_mul_f32 v91, v91, v86
s_waitcnt lgkmcnt(0)
v_mul_f32 v92, v92, v87
v_mfma_f32_16x16x32_bf16 v[252:255], a[96:99], v[108:111], v[252:255]
v_mul_f32 v93, v93, v87
v_mul_f32 v94, v94, v87
v_mul_f32 v95, v95, v87
v_cvt_pk_bf16_f32 v156, v88, v89
v_cvt_pk_bf16_f32 v157, v90, v91
s_waitcnt vmcnt(38)
v_mfma_f32_16x16x32_bf16 v[176:179], a[100:103], v[112:115], v[176:179]
v_cvt_pk_bf16_f32 v158, v92, v93
v_cvt_pk_bf16_f32 v159, v94, v95
ds_read_b32 v72, v50 offset:0
ds_read_b32 v73, v51 offset:0
ds_read_b32 v74, v50 offset:512
ds_read_b32 v75, v51 offset:512
ds_read_b32 v76, v50 offset:1024
ds_read_b32 v77, v51 offset:1024
ds_read_b32 v78, v50 offset:1536
ds_read_b32 v79, v51 offset:1536
s_waitcnt vmcnt(36)
v_mfma_f32_16x16x32_bf16 v[180:183], a[104:107], v[112:115], v[180:183]
v_lshlrev_b32 v88, 16, v160
v_and_b32 v89, 0xffff0000, v160
v_lshlrev_b32 v90, 16, v161
v_and_b32 v91, 0xffff0000, v161
v_lshlrev_b32 v92, 16, v162
s_waitcnt vmcnt(34)
v_mfma_f32_16x16x32_bf16 v[184:187], a[108:111], v[112:115], v[184:187]
v_and_b32 v93, 0xffff0000, v162
v_lshlrev_b32 v94, 16, v163
v_and_b32 v95, 0xffff0000, v163
s_waitcnt lgkmcnt(7)
v_mul_f32 v88, v88, v72
v_mul_f32 v89, v89, v72
s_waitcnt vmcnt(32)
v_mfma_f32_16x16x32_bf16 v[188:191], a[112:115], v[112:115], v[188:191]
v_mul_f32 v90, v90, v72
v_mul_f32 v91, v91, v72
s_waitcnt lgkmcnt(6)
v_mul_f32 v92, v92, v73
v_mul_f32 v93, v93, v73
v_mul_f32 v94, v94, v73
s_waitcnt vmcnt(30)
v_mfma_f32_16x16x32_bf16 v[192:195], a[116:119], v[112:115], v[192:195]
v_mul_f32 v95, v95, v73
v_cvt_pk_bf16_f32 v160, v88, v89
v_cvt_pk_bf16_f32 v161, v90, v91
v_cvt_pk_bf16_f32 v162, v92, v93
v_cvt_pk_bf16_f32 v163, v94, v95
v_mfma_f32_16x16x32_bf16 v[196:199], a[100:103], v[116:119], v[196:199]
v_lshlrev_b32 v88, 16, v164
v_and_b32 v89, 0xffff0000, v164
v_lshlrev_b32 v90, 16, v165
v_and_b32 v91, 0xffff0000, v165
v_lshlrev_b32 v92, 16, v166
v_mfma_f32_16x16x32_bf16 v[200:203], a[104:107], v[116:119], v[200:203]
v_and_b32 v93, 0xffff0000, v166
v_lshlrev_b32 v94, 16, v167
v_and_b32 v95, 0xffff0000, v167
s_waitcnt lgkmcnt(5)
v_mul_f32 v88, v88, v74
v_mul_f32 v89, v89, v74
v_mfma_f32_16x16x32_bf16 v[204:207], a[108:111], v[116:119], v[204:207]
v_mul_f32 v90, v90, v74
v_mul_f32 v91, v91, v74
s_waitcnt lgkmcnt(4)
v_mul_f32 v92, v92, v75
v_mul_f32 v93, v93, v75
v_mul_f32 v94, v94, v75
v_mfma_f32_16x16x32_bf16 v[208:211], a[112:115], v[116:119], v[208:211]
v_mul_f32 v95, v95, v75
v_cvt_pk_bf16_f32 v164, v88, v89
v_cvt_pk_bf16_f32 v165, v90, v91
v_cvt_pk_bf16_f32 v166, v92, v93
v_cvt_pk_bf16_f32 v167, v94, v95
v_mfma_f32_16x16x32_bf16 v[212:215], a[116:119], v[116:119], v[212:215]
v_lshlrev_b32 v88, 16, v168
v_and_b32 v89, 0xffff0000, v168
v_lshlrev_b32 v90, 16, v169
v_and_b32 v91, 0xffff0000, v169
v_lshlrev_b32 v92, 16, v170
v_mfma_f32_16x16x32_bf16 v[216:219], a[100:103], v[120:123], v[216:219]
v_and_b32 v93, 0xffff0000, v170
v_lshlrev_b32 v94, 16, v171
v_and_b32 v95, 0xffff0000, v171
s_waitcnt lgkmcnt(3)
v_mul_f32 v88, v88, v76
v_mul_f32 v89, v89, v76
v_mfma_f32_16x16x32_bf16 v[220:223], a[104:107], v[120:123], v[220:223]
v_mul_f32 v90, v90, v76
v_mul_f32 v91, v91, v76
s_waitcnt lgkmcnt(2)
v_mul_f32 v92, v92, v77
v_mul_f32 v93, v93, v77
v_mul_f32 v94, v94, v77
v_mfma_f32_16x16x32_bf16 v[224:227], a[108:111], v[120:123], v[224:227]
v_mul_f32 v95, v95, v77
v_cvt_pk_bf16_f32 v168, v88, v89
v_cvt_pk_bf16_f32 v169, v90, v91
v_cvt_pk_bf16_f32 v170, v92, v93
v_cvt_pk_bf16_f32 v171, v94, v95
v_mfma_f32_16x16x32_bf16 v[228:231], a[112:115], v[120:123], v[228:231]
v_lshlrev_b32 v88, 16, v172
v_and_b32 v89, 0xffff0000, v172
v_lshlrev_b32 v90, 16, v173
v_and_b32 v91, 0xffff0000, v173
v_lshlrev_b32 v92, 16, v174
v_mfma_f32_16x16x32_bf16 v[232:235], a[116:119], v[120:123], v[232:235]
v_and_b32 v93, 0xffff0000, v174
v_lshlrev_b32 v94, 16, v175
v_and_b32 v95, 0xffff0000, v175
s_waitcnt lgkmcnt(1)
v_mul_f32 v88, v88, v78
v_mul_f32 v89, v89, v78
v_mfma_f32_16x16x32_bf16 v[236:239], a[100:103], v[124:127], v[236:239]
v_mul_f32 v90, v90, v78
v_mul_f32 v91, v91, v78
s_waitcnt lgkmcnt(0)
v_mul_f32 v92, v92, v79
v_mul_f32 v93, v93, v79
v_mul_f32 v94, v94, v79
v_mfma_f32_16x16x32_bf16 v[240:243], a[104:107], v[124:127], v[240:243]
v_mul_f32 v95, v95, v79
v_cvt_pk_bf16_f32 v172, v88, v89
v_cvt_pk_bf16_f32 v173, v90, v91
v_cvt_pk_bf16_f32 v174, v92, v93
v_cvt_pk_bf16_f32 v175, v94, v95
v_mfma_f32_16x16x32_bf16 v[244:247], a[108:111], v[124:127], v[244:247]
v_mfma_f32_16x16x32_bf16 v[248:251], a[112:115], v[124:127], v[248:251]
v_mfma_f32_16x16x32_bf16 v[252:255], a[116:119], v[124:127], v[252:255]
s_waitcnt vmcnt(28)
v_mfma_f32_16x16x32_bf16 v[176:179], a[120:123], v[128:131], v[176:179]
s_waitcnt vmcnt(26)
v_mfma_f32_16x16x32_bf16 v[180:183], a[124:127], v[128:131], v[180:183]
s_waitcnt vmcnt(24)
v_mfma_f32_16x16x32_bf16 v[184:187], a[128:131], v[128:131], v[184:187]
s_waitcnt vmcnt(22)
v_mfma_f32_16x16x32_bf16 v[188:191], a[132:135], v[128:131], v[188:191]
s_waitcnt vmcnt(20)
v_mfma_f32_16x16x32_bf16 v[192:195], a[136:139], v[128:131], v[192:195]
v_mfma_f32_16x16x32_bf16 v[196:199], a[120:123], v[132:135], v[196:199]
v_mfma_f32_16x16x32_bf16 v[200:203], a[124:127], v[132:135], v[200:203]
v_mfma_f32_16x16x32_bf16 v[204:207], a[128:131], v[132:135], v[204:207]
v_mfma_f32_16x16x32_bf16 v[208:211], a[132:135], v[132:135], v[208:211]
v_mfma_f32_16x16x32_bf16 v[212:215], a[136:139], v[132:135], v[212:215]
v_mfma_f32_16x16x32_bf16 v[216:219], a[120:123], v[136:139], v[216:219]
v_mfma_f32_16x16x32_bf16 v[220:223], a[124:127], v[136:139], v[220:223]
v_mfma_f32_16x16x32_bf16 v[224:227], a[128:131], v[136:139], v[224:227]
v_mfma_f32_16x16x32_bf16 v[228:231], a[132:135], v[136:139], v[228:231]
v_mfma_f32_16x16x32_bf16 v[232:235], a[136:139], v[136:139], v[232:235]
v_mfma_f32_16x16x32_bf16 v[236:239], a[120:123], v[140:143], v[236:239]
v_mfma_f32_16x16x32_bf16 v[240:243], a[124:127], v[140:143], v[240:243]
v_mfma_f32_16x16x32_bf16 v[244:247], a[128:131], v[140:143], v[244:247]
v_mfma_f32_16x16x32_bf16 v[248:251], a[132:135], v[140:143], v[248:251]
v_mfma_f32_16x16x32_bf16 v[252:255], a[136:139], v[140:143], v[252:255]
s_waitcnt vmcnt(18)
v_mfma_f32_16x16x32_bf16 v[176:179], a[140:143], v[144:147], v[176:179]
s_waitcnt vmcnt(16)
v_mfma_f32_16x16x32_bf16 v[180:183], a[144:147], v[144:147], v[180:183]
s_waitcnt vmcnt(14)
v_mfma_f32_16x16x32_bf16 v[184:187], a[148:151], v[144:147], v[184:187]
s_waitcnt vmcnt(12)
v_mfma_f32_16x16x32_bf16 v[188:191], a[152:155], v[144:147], v[188:191]
s_waitcnt vmcnt(10)
v_mfma_f32_16x16x32_bf16 v[192:195], a[156:159], v[144:147], v[192:195]
v_mfma_f32_16x16x32_bf16 v[196:199], a[140:143], v[148:151], v[196:199]
v_mfma_f32_16x16x32_bf16 v[200:203], a[144:147], v[148:151], v[200:203]
v_mfma_f32_16x16x32_bf16 v[204:207], a[148:151], v[148:151], v[204:207]
v_mfma_f32_16x16x32_bf16 v[208:211], a[152:155], v[148:151], v[208:211]
v_mfma_f32_16x16x32_bf16 v[212:215], a[156:159], v[148:151], v[212:215]
v_mfma_f32_16x16x32_bf16 v[216:219], a[140:143], v[152:155], v[216:219]
v_mfma_f32_16x16x32_bf16 v[220:223], a[144:147], v[152:155], v[220:223]
v_mfma_f32_16x16x32_bf16 v[224:227], a[148:151], v[152:155], v[224:227]
v_mfma_f32_16x16x32_bf16 v[228:231], a[152:155], v[152:155], v[228:231]
v_mfma_f32_16x16x32_bf16 v[232:235], a[156:159], v[152:155], v[232:235]
v_mfma_f32_16x16x32_bf16 v[236:239], a[140:143], v[156:159], v[236:239]
v_mfma_f32_16x16x32_bf16 v[240:243], a[144:147], v[156:159], v[240:243]
v_mfma_f32_16x16x32_bf16 v[244:247], a[148:151], v[156:159], v[244:247]
v_mfma_f32_16x16x32_bf16 v[248:251], a[152:155], v[156:159], v[248:251]
v_mfma_f32_16x16x32_bf16 v[252:255], a[156:159], v[156:159], v[252:255]
s_waitcnt vmcnt(8)
v_mfma_f32_16x16x32_bf16 v[176:179], a[0:3], v[160:163], v[176:179]
s_waitcnt vmcnt(6)
v_mfma_f32_16x16x32_bf16 v[180:183], a[4:7], v[160:163], v[180:183]
s_waitcnt vmcnt(4)
v_mfma_f32_16x16x32_bf16 v[184:187], a[8:11], v[160:163], v[184:187]
s_waitcnt vmcnt(2)
v_mfma_f32_16x16x32_bf16 v[188:191], a[12:15], v[160:163], v[188:191]
s_waitcnt vmcnt(0)
v_mfma_f32_16x16x32_bf16 v[192:195], a[16:19], v[160:163], v[192:195]
v_mfma_f32_16x16x32_bf16 v[196:199], a[0:3], v[164:167], v[196:199]
v_mfma_f32_16x16x32_bf16 v[200:203], a[4:7], v[164:167], v[200:203]
v_mfma_f32_16x16x32_bf16 v[204:207], a[8:11], v[164:167], v[204:207]
v_mfma_f32_16x16x32_bf16 v[208:211], a[12:15], v[164:167], v[208:211]
v_mfma_f32_16x16x32_bf16 v[212:215], a[16:19], v[164:167], v[212:215]
ds_write_b128 v6, v[176:179] offset:0
v_mfma_f32_16x16x32_bf16 v[216:219], a[0:3], v[168:171], v[216:219]
ds_write_b128 v6, v[180:183] offset:1024
v_mfma_f32_16x16x32_bf16 v[220:223], a[4:7], v[168:171], v[220:223]
ds_write_b128 v6, v[184:187] offset:2048
v_mfma_f32_16x16x32_bf16 v[224:227], a[8:11], v[168:171], v[224:227]
ds_write_b128 v6, v[188:191] offset:3072
v_mfma_f32_16x16x32_bf16 v[228:231], a[12:15], v[168:171], v[228:231]
ds_write_b128 v6, v[192:195] offset:4096
v_mfma_f32_16x16x32_bf16 v[232:235], a[16:19], v[168:171], v[232:235]
ds_write_b128 v6, v[196:199] offset:5120
v_mfma_f32_16x16x32_bf16 v[236:239], a[0:3], v[172:175], v[236:239]
ds_write_b128 v6, v[200:203] offset:6144
v_mfma_f32_16x16x32_bf16 v[240:243], a[4:7], v[172:175], v[240:243]
ds_write_b128 v6, v[204:207] offset:7168
v_mfma_f32_16x16x32_bf16 v[244:247], a[8:11], v[172:175], v[244:247]
ds_write_b128 v6, v[208:211] offset:8192
v_mfma_f32_16x16x32_bf16 v[248:251], a[12:15], v[172:175], v[248:251]
ds_write_b128 v6, v[212:215] offset:9216
v_mfma_f32_16x16x32_bf16 v[252:255], a[16:19], v[172:175], v[252:255]
ds_write_b128 v6, v[216:219] offset:10240
ds_write_b128 v6, v[220:223] offset:11264
ds_write_b128 v6, v[224:227] offset:12288
ds_write_b128 v6, v[228:231] offset:13312
ds_write_b128 v6, v[232:235] offset:14336
ds_write_b128 v6, v[236:239] offset:15360
ds_write_b128 v6, v[240:243] offset:16384
ds_write_b128 v6, v[244:247] offset:17408
ds_write_b128 v6, v[248:251] offset:18432
ds_write_b128 v6, v[252:255] offset:19456
s_waitcnt lgkmcnt(0)
s_barrier
ds_read_b128 v[96:99], v7 offset:0
ds_read_b128 v[100:103], v7 offset:20480
ds_read_b128 v[104:107], v8 offset:0
ds_read_b128 v[108:111], v8 offset:20480
ds_read_b128 v[112:115], v7 offset:1024
ds_read_b128 v[116:119], v7 offset:21504
ds_read_b128 v[120:123], v8 offset:1024
ds_read_b128 v[124:127], v8 offset:21504
ds_read_b128 v[128:131], v7 offset:2048
ds_read_b128 v[132:135], v7 offset:22528
ds_read_b128 v[136:139], v8 offset:2048
ds_read_b128 v[140:143], v8 offset:22528
ds_read_b128 v[144:147], v7 offset:3072
ds_read_b128 v[148:151], v7 offset:23552
ds_read_b128 v[152:155], v8 offset:3072
ds_read_b128 v[156:159], v8 offset:23552
ds_read_b128 v[160:163], v7 offset:4096
ds_read_b128 v[164:167], v7 offset:24576
ds_read_b128 v[168:171], v8 offset:4096
ds_read_b128 v[172:175], v8 offset:24576
v_lshlrev_b32 v176, 16, v18
v_and_b32 v177, 0xffff0000, v18
v_lshlrev_b32 v178, 16, v19
v_and_b32 v179, 0xffff0000, v19
s_waitcnt lgkmcnt(15)
v_add_f32 v96, v96, v100
v_add_f32 v97, v97, v101
v_add_f32 v98, v98, v102
v_add_f32 v99, v99, v103
v_add_f32 v104, v104, v108
v_add_f32 v105, v105, v109
v_add_f32 v106, v106, v110
v_add_f32 v107, v107, v111
v_add_f32 v176, v176, v96
v_add_f32 v177, v177, v97
v_add_f32 v178, v178, v98
v_add_f32 v179, v179, v99
v_add_f32 v176, v176, v104
v_add_f32 v177, v177, v105
v_add_f32 v178, v178, v106
v_add_f32 v179, v179, v107
v_cvt_pk_bf16_f32 v180, v176, v177
v_cvt_pk_bf16_f32 v181, v178, v179
buffer_store_dwordx2 v[180:181], v12, s[20:23], s46 offen
v_lshlrev_b32 v182, 16, v20
v_and_b32 v183, 0xffff0000, v20
v_lshlrev_b32 v184, 16, v21
v_and_b32 v185, 0xffff0000, v21
s_waitcnt lgkmcnt(14)
v_add_f32 v112, v112, v116
v_add_f32 v113, v113, v117
v_add_f32 v114, v114, v118
v_add_f32 v115, v115, v119
s_waitcnt lgkmcnt(12)
v_add_f32 v120, v120, v124
v_add_f32 v121, v121, v125
v_add_f32 v122, v122, v126
v_add_f32 v123, v123, v127
v_add_f32 v182, v182, v112
v_add_f32 v183, v183, v113
v_add_f32 v184, v184, v114
v_add_f32 v185, v185, v115
v_add_f32 v182, v182, v120
v_add_f32 v183, v183, v121
v_add_f32 v184, v184, v122
v_add_f32 v185, v185, v123
v_cvt_pk_bf16_f32 v186, v182, v183
v_cvt_pk_bf16_f32 v187, v184, v185
buffer_store_dwordx2 v[186:187], v12, s[20:23], s46 offen offset:32
v_lshlrev_b32 v188, 16, v22
v_and_b32 v189, 0xffff0000, v22
v_lshlrev_b32 v190, 16, v23
v_and_b32 v191, 0xffff0000, v23
s_waitcnt lgkmcnt(10)
v_add_f32 v128, v128, v132
v_add_f32 v129, v129, v133
v_add_f32 v130, v130, v134
v_add_f32 v131, v131, v135
s_waitcnt lgkmcnt(8)
v_add_f32 v136, v136, v140
v_add_f32 v137, v137, v141
v_add_f32 v138, v138, v142
v_add_f32 v139, v139, v143
v_add_f32 v188, v188, v128
v_add_f32 v189, v189, v129
v_add_f32 v190, v190, v130
v_add_f32 v191, v191, v131
v_add_f32 v188, v188, v136
v_add_f32 v189, v189, v137
v_add_f32 v190, v190, v138
v_add_f32 v191, v191, v139
v_cvt_pk_bf16_f32 v192, v188, v189
v_cvt_pk_bf16_f32 v193, v190, v191
buffer_store_dwordx2 v[192:193], v12, s[20:23], s46 offen offset:64
v_lshlrev_b32 v194, 16, v24
v_and_b32 v195, 0xffff0000, v24
v_lshlrev_b32 v196, 16, v25
v_and_b32 v197, 0xffff0000, v25
s_waitcnt lgkmcnt(6)
v_add_f32 v144, v144, v148
v_add_f32 v145, v145, v149
v_add_f32 v146, v146, v150
v_add_f32 v147, v147, v151
s_waitcnt lgkmcnt(4)
v_add_f32 v152, v152, v156
v_add_f32 v153, v153, v157
v_add_f32 v154, v154, v158
v_add_f32 v155, v155, v159
v_add_f32 v194, v194, v144
v_add_f32 v195, v195, v145
v_add_f32 v196, v196, v146
v_add_f32 v197, v197, v147
v_add_f32 v194, v194, v152
v_add_f32 v195, v195, v153
v_add_f32 v196, v196, v154
v_add_f32 v197, v197, v155
v_cvt_pk_bf16_f32 v198, v194, v195
v_cvt_pk_bf16_f32 v199, v196, v197
buffer_store_dwordx2 v[198:199], v12, s[20:23], s46 offen offset:96
v_lshlrev_b32 v200, 16, v26
v_and_b32 v201, 0xffff0000, v26
v_lshlrev_b32 v202, 16, v27
v_and_b32 v203, 0xffff0000, v27
s_waitcnt lgkmcnt(2)
v_add_f32 v160, v160, v164
v_add_f32 v161, v161, v165
v_add_f32 v162, v162, v166
v_add_f32 v163, v163, v167
s_waitcnt lgkmcnt(0)
v_add_f32 v168, v168, v172
v_add_f32 v169, v169, v173
v_add_f32 v170, v170, v174
v_add_f32 v171, v171, v175
v_add_f32 v200, v200, v160
v_add_f32 v201, v201, v161
v_add_f32 v202, v202, v162
v_add_f32 v203, v203, v163
v_add_f32 v200, v200, v168
v_add_f32 v201, v201, v169
v_add_f32 v202, v202, v170
v_add_f32 v203, v203, v171
v_cvt_pk_bf16_f32 v204, v200, v201
v_cvt_pk_bf16_f32 v205, v202, v203
buffer_store_dwordx2 v[204:205], v12, s[20:23], s46 offen offset:128
s_endpgm
K1_Q:
s_getpc_b64 s[90:91]
v_and_b32 v1, 63, v0
v_lshrrev_b32 v32, 6, v0
s_nop 0
v_readfirstlane_b32 s48, v32
v_lshrrev_b32 v32, 3, v1
v_lshrrev_b32 v33, 1, v32
v_and_b32 v34, 7, v1
v_xor_b32 v34, v34, v33
v_mul_u32_u24 v32, 1280, v32
v_lshl_add_u32 v12, v34, 4, v32
v_xor_b32 v32, 64, v12
v_add_u32 v13, 9216, v32
v_add_u32 v14, 18432, v12
v_add_u32 v15, 27648, v32
s_and_b32 s60, s2, 7
s_lshr_b32 s61, s2, 3
s_and_b32 s49, s60, 1
s_lshl_b32 s49, s49, 3
s_and_b32 s62, s61, 7
s_add_u32 s49, s49, s62
s_lshr_b32 s50, s60, 1
s_lshl_b32 s50, s50, 2
s_lshr_b32 s63, s61, 3
s_add_u32 s50, s50, s63
s_mul_i32 s53, s48, 12288
s_add_u32 s53, s53, 98816
s_mul_i32 s56, s48, 40960
s_mul_i32 s52, s48, 5120
s_mul_i32 s54, s48, 61440
s_lshr_b32 s51, s50, 2
s_mul_i32 s64, s51, 320
s_add_u32 s65, s64, 160
s_lshl_b32 s66, s51, 7
s_add_u32 s66, s66, 2560
s_mov_b32 s67, s66
s_mul_i32 s58, s51, 10240
s_add_u32 s58, s58, 98304
s_lshl_b32 s59, s51, 12
s_add_u32 s59, s59, 81920
v_add_u32 v32, 0, v1
v_mul_u32_u24 v33, 3277, v32
v_lshrrev_b32 v33, 16, v33
v_mul_u32_u24 v34, 20, v33
v_sub_u32 v34, v32, v34
v_mul_u32_u24 v33, 3840, v33
v_lshl_add_u32 v2, v34, 4, v33
v_add_u32 v32, 64, v1
v_mul_u32_u24 v33, 3277, v32
v_lshrrev_b32 v33, 16, v33
v_mul_u32_u24 v34, 20, v33
v_sub_u32 v34, v32, v34
v_mul_u32_u24 v33, 3840, v33
v_lshl_add_u32 v3, v34, 4, v33
v_subrev_u32 v3, 1024, v3
v_add_u32 v32, 128, v1
v_mul_u32_u24 v33, 3277, v32
v_lshrrev_b32 v33, 16, v33
v_mul_u32_u24 v34, 20, v33
v_sub_u32 v34, v32, v34
v_mul_u32_u24 v33, 3840, v33
v_lshl_add_u32 v4, v34, 4, v33
v_subrev_u32 v4, 2048, v4
v_add_u32 v32, 192, v1
v_mul_u32_u24 v33, 3277, v32
v_lshrrev_b32 v33, 16, v33
v_mul_u32_u24 v34, 20, v33
v_sub_u32 v34, v32, v34
v_mul_u32_u24 v33, 3840, v33
v_lshl_add_u32 v5, v34, 4, v33
v_subrev_u32 v5, 3072, v5
v_add_u32 v32, 256, v1
v_mul_u32_u24 v33, 3277, v32
v_lshrrev_b32 v33, 16, v33
v_mul_u32_u24 v34, 20, v33
v_sub_u32 v34, v32, v34
v_mul_u32_u24 v33, 3840, v33
v_lshl_add_u32 v6, v34, 4, v33
s_waitcnt lgkmcnt(0)
s_mul_i32 s60, s49, 163840
s_add_u32 s8, s4, s60
s_addc_u32 s9, s5, 0
s_mov_b32 s10, 163840
s_mov_b32 s11, 0x20000
s_add_u32 m0, s53, 0
s_add_u32 s75, s56, 0
buffer_load_dwordx4 v12, s[8:11], s75 offen lds
buffer_load_dwordx4 v13, s[8:11], s75 offen offset:1024 lds
buffer_load_dwordx4 v14, s[8:11], s75 offen offset:2048 lds
buffer_load_dwordx4 v15, s[8:11], s75 offen offset:3072 lds
s_add_u32 s12, s6, s64
s_addc_u32 s13, s7, 0
s_sub_u32 s14, 2457600, s64
s_mov_b32 s15, 0x20000
s_add_u32 s74, s54, 0
s_add_u32 m0, s52, 0
s_nop 0
buffer_load_dwordx4 v2, s[12:15], s74 offen lds
buffer_load_dwordx4 v3, s[12:15], s74 offen offset:1024 lds
buffer_load_dwordx4 v4, s[12:15], s74 offen offset:2048 lds
buffer_load_dwordx4 v5, s[12:15], s74 offen offset:3072 lds
s_add_u32 m0, s52, 4096
s_nop 0
buffer_load_dwordx4 v6, s[12:15], s74 offen lds
s_mov_b32 s28, s46
s_mov_b32 s29, s47
s_mov_b32 s30, 256
s_mov_b32 s31, 0x20000
s_memrealtime s[98:99]
s_or_b32 s60, s2, s48
s_cmp_eq_u32 s60, 0
s_cselect_b32 s60, 0, 2147483647
v_mov_b32 v32, s60
v_mov_b32 v31, 2147483647
v_cmp_eq_u32 vcc, 0, v1
s_nop 1
v_cndmask_b32 v32, v31, v32, vcc
s_waitcnt lgkmcnt(0)
s_waitcnt lgkmcnt(0)
s_or_b32 s98, s98, 1
s_sub_u32 s92, s98, 2048
v_mov_b32 v33, s98
buffer_store_dword v33, v32, s[28:31], 0 offen sc1
s_lshr_b32 s60, s2, 3
s_and_b32 s60, s60, 7
s_lshl_b32 s60, s60, 2
s_add_u32 s60, s60, s48
s_and_b32 s60, s60, 7
s_lshl_b32 s60, s60, 12
s_add_u32 s60, s90, s60
s_addc_u32 s61, s91, 0
v_lshlrev_b32 v32, 6, v1
v_mov_b32 v33, s61
v_add_co_u32 v32, vcc, s60, v32
s_nop 1
v_addc_co_u32 v33, vcc, 0, v33, vcc
global_load_dword a255, v[32:33], off
s_cmp_lt_u32 s48, 2
s_cselect_b32 s60, s40, s42
s_cselect_b32 s61, s41, s43
s_add_u32 s16, s60, s66
s_addc_u32 s17, s61, 0
s_sub_u32 s18, 1966080, s66
s_mov_b32 s19, 0x20000
s_lshr_b32 s60, s48, 1
s_mul_i32 s80, s60, 8192
s_and_b32 s61, s48, 1
s_mul_i32 s62, s61, 4096
s_add_u32 s80, s80, s62
s_mul_i32 s55, s61, 98304
s_mov_b32 s24, s44
s_mov_b32 s25, s45
s_mov_b32 s26, 17825792
s_mov_b32 s27, 0x20000
s_mov_b32 s32, s76
s_mov_b32 s33, s77
s_mov_b32 s34, 1966080
s_mov_b32 s35, 0x20000
s_mov_b32 s36, s78
s_mov_b32 s37, s79
s_mov_b32 s38, 819200
s_mov_b32 s39, 0x20000
s_mov_b32 s84, 1069066811
s_mov_b32 s85, 0x358637bd
s_lshl_b32 s57, s49, 2
s_add_u32 s57, s57, s48
s_mul_i32 s57, s57, 139264
v_lshrrev_b32 v32, 3, v1
v_bfe_u32 v33, v1, 4, 1
s_lshr_b32 s60, s48, 1
s_lshl_b32 s60, s60, 1
v_add_u32 v33, s60, v33
v_lshlrev_b32 v33, 1, v33
v_and_b32 v34, 7, v1
v_xor_b32 v34, v34, v33
v_mul_u32_u24 v32, 3072, v32
v_lshl_add_u32 v7, v34, 4, v32
v_add_u32 v8, 23552, v7
v_add_u32 v9, 47104, v7
v_add_u32 v10, 70656, v7
v_and_b32 v32, 31, v1
v_lshrrev_b32 v33, 5, v1
v_bfe_u32 v34, v32, 1, 3
v_xor_b32 v34, v34, v33
v_lshlrev_b32 v34, 4, v34
v_lshl_add_u32 v35, v32, 7, v34
v_add_u32 v16, s53, v35
v_xor_b32 v17, 32, v16
v_xor_b32 v18, 64, v16
v_xor_b32 v19, 96, v16
v_lshlrev_b32 v22, 4, v1
v_lshlrev_b32 v29, 4, v33
v_add_u32 v29, 131072, v29
v_mov_b32 v32, 0x3f803f80
v_lshlrev_b32 v33, 2, v1
v_add_u32 v33, 131072, v33
ds_write_b32 v33, v32 offset:29952
v_bfe_u32 v32, v1, 2, 2
v_lshrrev_b32 v33, 5, v1
v_lshl_add_u32 v32, v33, 3, v32
v_bfe_u32 v34, v1, 4, 1
v_and_b32 v35, 3, v1
v_lshlrev_b32 v35, 3, v35
v_mul_u32_u24 v32, 320, v32
v_mul_u32_u24 v34, 160, v34
v_add3_u32 v20, v32, v34, v35
v_add_u32 v21, 49408, v20
v_bfe_u32 v32, v1, 2, 2
v_lshrrev_b32 v33, 5, v1
v_lshl_add_u32 v32, v33, 3, v32
v_bfe_u32 v34, v1, 4, 1
v_and_b32 v35, 3, v1
v_lshlrev_b32 v35, 3, v35
v_bfe_u32 v36, v1, 3, 1
v_lshl_add_u32 v36, v34, 1, v36
v_lshlrev_b32 v36, 5, v36
v_lshlrev_b32 v32, 7, v32
v_lshlrev_b32 v34, 13, v34
v_add3_u32 v32, v32, v34, v35
v_add_u32 v32, v32, v36
v_xor_b32 v84, 0, v32
v_add_u32 v85, 49408, v84
v_xor_b32 v86, 32, v32
v_add_u32 v87, 49408, v86
v_xor_b32 v88, 64, v32
v_add_u32 v89, 49408, v88
v_xor_b32 v90, 96, v32
v_add_u32 v91, 49408, v90
s_add_u32 m0, s53, 4096
s_add_u32 s75, s56, 128
buffer_load_dwordx4 v12, s[8:11], s75 offen lds
buffer_load_dwordx4 v13, s[8:11], s75 offen offset:1024 lds
buffer_load_dwordx4 v14, s[8:11], s75 offen offset:2048 lds
buffer_load_dwordx4 v15, s[8:11], s75 offen offset:3072 lds
s_add_u32 s74, s54, 245760
s_add_u32 m0, s52, 24704
s_nop 0
buffer_load_dwordx4 v2, s[12:15], s74 offen lds
buffer_load_dwordx4 v3, s[12:15], s74 offen offset:1024 lds
buffer_load_dwordx4 v4, s[12:15], s74 offen offset:2048 lds
buffer_load_dwordx4 v5, s[12:15], s74 offen offset:3072 lds
s_add_u32 m0, s52, 28800
s_nop 0
buffer_load_dwordx4 v6, s[12:15], s74 offen lds
s_cmp_eq_u32 s48, 0
s_cselect_b32 s60, 0, 2147483647
v_mov_b32 v32, 0
buffer_load_dword v30, v32, s[28:31], s60 offen sc1
s_waitcnt vmcnt(12)
s_barrier
ds_read_b128 a[0:3], v16 offset:0
ds_read_b128 a[4:7], v17 offset:0
ds_read_b128 a[8:11], v18 offset:0
ds_read_b128 a[12:15], v19 offset:0
ds_read_b64_tr_b16 a[160:161], v20 offset:0
ds_read_b64_tr_b16 a[162:163], v20 offset:1280
ds_read_b64_tr_b16 a[164:165], v20 offset:32
ds_read_b64_tr_b16 a[166:167], v20 offset:1312
ds_read_b64_tr_b16 a[168:169], v20 offset:64
ds_read_b64_tr_b16 a[170:171], v20 offset:1344
ds_read_b64_tr_b16 a[172:173], v20 offset:96
ds_read_b64_tr_b16 a[174:175], v20 offset:1376
ds_read_b64_tr_b16 a[176:177], v20 offset:128
ds_read_b64_tr_b16 a[178:179], v20 offset:1408
ds_read_b64_tr_b16 a[184:185], v20 offset:5120
ds_read_b64_tr_b16 a[186:187], v20 offset:6400
ds_read_b64_tr_b16 a[188:189], v20 offset:5152
ds_read_b64_tr_b16 a[190:191], v20 offset:6432
ds_read_b64_tr_b16 a[192:193], v20 offset:5184
ds_read_b64_tr_b16 a[194:195], v20 offset:6464
ds_read_b64_tr_b16 a[196:197], v20 offset:5216
ds_read_b64_tr_b16 a[198:199], v20 offset:6496
ds_read_b64_tr_b16 a[200:201], v20 offset:5248
ds_read_b64_tr_b16 a[202:203], v20 offset:6528
s_waitcnt lgkmcnt(10)
v_mfma_f32_32x32x16_bf16 v[96:111], a[160:163], a[0:3], 0
ds_read_b64_tr_b16 a[208:209], v20 offset:10240
ds_read_b64_tr_b16 a[210:211], v20 offset:11520
s_add_u32 m0, s53, 8192
s_add_u32 s75, s56, 256
buffer_load_dwordx4 v12, s[8:11], s75 offen lds
v_mfma_f32_32x32x16_bf16 v[112:127], a[164:167], a[0:3], 0
ds_read_b64_tr_b16 a[212:213], v20 offset:10272
ds_read_b64_tr_b16 a[214:215], v20 offset:11552
buffer_load_dwordx4 v13, s[8:11], s75 offen offset:1024 lds
v_mfma_f32_32x32x16_bf16 v[128:143], a[168:171], a[0:3], 0
ds_read_b64_tr_b16 a[216:217], v20 offset:10304
ds_read_b64_tr_b16 a[218:219], v20 offset:11584
buffer_load_dwordx4 v14, s[8:11], s75 offen offset:2048 lds
v_mfma_f32_32x32x16_bf16 v[144:159], a[172:175], a[0:3], 0
ds_read_b64_tr_b16 a[220:221], v20 offset:10336
ds_read_b64_tr_b16 a[222:223], v20 offset:11616
buffer_load_dwordx4 v15, s[8:11], s75 offen offset:3072 lds
v_mfma_f32_32x32x16_bf16 v[160:175], a[176:179], a[0:3], 0
ds_read_b64_tr_b16 a[224:225], v20 offset:10368
ds_read_b64_tr_b16 a[226:227], v20 offset:11648
s_waitcnt lgkmcnt(10)
v_mfma_f32_32x32x16_bf16 v[96:111], a[184:187], a[4:7], v[96:111]
ds_read_b64_tr_b16 a[160:161], v20 offset:15360
ds_read_b64_tr_b16 a[162:163], v20 offset:16640
s_add_u32 s74, s54, 491520
s_add_u32 m0, s52, 49408
s_nop 0
buffer_load_dwordx4 v2, s[12:15], s74 offen lds
v_mfma_f32_32x32x16_bf16 v[112:127], a[188:191], a[4:7], v[112:127]
ds_read_b64_tr_b16 a[164:165], v20 offset:15392
ds_read_b64_tr_b16 a[166:167], v20 offset:16672
v_mfma_f32_32x32x16_bf16 v[128:143], a[192:195], a[4:7], v[128:143]
ds_read_b64_tr_b16 a[168:169], v20 offset:15424
ds_read_b64_tr_b16 a[170:171], v20 offset:16704
buffer_load_dwordx4 v3, s[12:15], s74 offen offset:1024 lds
v_mfma_f32_32x32x16_bf16 v[144:159], a[196:199], a[4:7], v[144:159]
ds_read_b64_tr_b16 a[172:173], v20 offset:15456
ds_read_b64_tr_b16 a[174:175], v20 offset:16736
v_mfma_f32_32x32x16_bf16 v[160:175], a[200:203], a[4:7], v[160:175]
ds_read_b64_tr_b16 a[176:177], v20 offset:15488
ds_read_b64_tr_b16 a[178:179], v20 offset:16768
buffer_load_dwordx4 v4, s[12:15], s74 offen offset:2048 lds
v_lshrrev_b32 v32, 5, v1
s_lshl_b32 s60, s50, 3
s_lshl_b32 s61, s48, 1
s_add_u32 s60, s60, s61
v_add_u32 v32, s60, v32
v_mul_u32_u24 v33, 1280, v32
v_and_b32 v34, 31, v1
v_lshl_add_u32 v33, v34, 3, v33
buffer_load_dwordx2 v[192:193], v33, s[8:11], 0 offen
s_waitcnt vmcnt(9)
s_barrier
s_waitcnt lgkmcnt(10)
v_mfma_f32_32x32x16_bf16 v[96:111], a[208:211], a[8:11], v[96:111]
ds_read_b64_tr_b16 a[184:185], v20 offset:24704
ds_read_b64_tr_b16 a[186:187], v20 offset:25984
ds_read_b128 a[16:19], v16 offset:4096
buffer_load_dwordx4 v5, s[12:15], s74 offen offset:3072 lds
buffer_load_dwordx2 v[194:195], v33, s[8:11], 0 offen offset:256
buffer_load_dwordx2 v[196:197], v33, s[8:11], 0 offen offset:512
buffer_load_dwordx2 v[198:199], v33, s[8:11], 0 offen offset:768
buffer_load_dwordx2 v[200:201], v33, s[8:11], 0 offen offset:1024
s_and_b32 s63, s48, 1
s_cmp_eq_u32 s63, 0
s_cselect_b32 s68, s6, s6
s_cselect_b32 s69, s7, s7
s_cselect_b32 s70, s64, s65
s_cselect_b32 s71, s40, s42
s_cselect_b32 s72, s41, s43
s_cselect_b32 s73, s66, s67
s_cmp_lt_u32 s48, 2
s_cselect_b32 s68, s68, s71
s_cselect_b32 s69, s69, s72
s_cselect_b32 s70, s70, s73
s_mov_b32 s73, 1966080
s_cselect_b32 s71, 2457600, s73
s_mov_b32 s73, 3072
s_cselect_b32 s72, 3840, s73
s_cselect_b32 s73, 10, 8
s_add_u32 s20, s68, s70
s_addc_u32 s21, s69, 0
s_sub_u32 s22, s71, s70
s_mov_b32 s23, 0x20000
v_and_b32 v36, 15, v1
v_lshrrev_b32 v37, 4, v1
s_mul_i32 s60, s72, 10
v_mul_lo_u32 v37, s60, v37
v_lshl_add_u32 v37, v36, 4, v37
v_cmp_gt_u32 vcc, s73, v36
s_nop 1
v_cndmask_b32 v37, v31, v37, vcc
s_mul_i32 s96, s49, 40
s_mul_i32 s96, s96, s72
buffer_load_dwordx4 v[204:207], v37, s[20:23], s96 offen
v_mfma_f32_32x32x16_bf16 v[112:127], a[212:215], a[8:11], v[112:127]
ds_read_b64_tr_b16 a[188:189], v20 offset:24736
ds_read_b64_tr_b16 a[190:191], v20 offset:26016
ds_read_b128 a[20:23], v17 offset:4096
s_add_u32 m0, s52, 53504
s_nop 0
buffer_load_dwordx4 v6, s[12:15], s74 offen lds
s_add_u32 s96, s96, s72
buffer_load_dwordx4 v[208:211], v37, s[20:23], s96 offen
s_add_u32 s96, s96, s72
buffer_load_dwordx4 v[212:215], v37, s[20:23], s96 offen
v_mfma_f32_32x32x16_bf16 v[128:143], a[216:219], a[8:11], v[128:143]
ds_read_b64_tr_b16 a[192:193], v20 offset:24768
ds_read_b64_tr_b16 a[194:195], v20 offset:26048
ds_read_b128 a[24:27], v18 offset:4096
s_add_u32 s96, s96, s72
buffer_load_dwordx4 v[216:219], v37, s[20:23], s96 offen
s_add_u32 s96, s96, s72
buffer_load_dwordx4 v[220:223], v37, s[20:23], s96 offen
s_add_u32 s96, s96, s72
buffer_load_dwordx4 v[224:227], v37, s[20:23], s96 offen
v_mfma_f32_32x32x16_bf16 v[144:159], a[220:223], a[8:11], v[144:159]
ds_read_b64_tr_b16 a[196:197], v20 offset:24800
ds_read_b64_tr_b16 a[198:199], v20 offset:26080
ds_read_b128 a[28:31], v19 offset:4096
s_add_u32 m0, s53, 0
s_add_u32 s75, s56, 384
buffer_load_dwordx4 v12, s[8:11], s75 offen lds
s_add_u32 s96, s96, s72
buffer_load_dwordx4 v[228:231], v37, s[20:23], s96 offen
s_add_u32 s96, s96, s72
buffer_load_dwordx4 v[232:235], v37, s[20:23], s96 offen
v_mfma_f32_32x32x16_bf16 v[160:175], a[224:227], a[8:11], v[160:175]
ds_read_b64_tr_b16 a[200:201], v20 offset:24832
ds_read_b64_tr_b16 a[202:203], v20 offset:26112
s_add_u32 s96, s96, s72
buffer_load_dwordx4 v[236:239], v37, s[20:23], s96 offen
s_add_u32 s96, s96, s72
buffer_load_dwordx4 v[240:243], v37, s[20:23], s96 offen
s_lshl_b32 s60, s49, 4
s_add_u32 s60, s60, s50
s_lshl_b32 s60, s60, 2
s_add_u32 s60, s60, s48
s_lshl_b32 s60, s60, 7
s_add_u32 s60, s60, 14680064
v_add_u32 v32, s60, v22
v_cmp_gt_u32 vcc, 8, v1
s_nop 1
v_cndmask_b32 v95, v31, v32, vcc
s_lshl_b32 s60, s50, 4
s_add_u32 s60, s60, s49
s_lshl_b32 s60, s60, 2
s_add_u32 s60, s60, s48
s_lshl_b32 s60, s60, 9
s_add_u32 s60, s60, 15728640
v_add_u32 v34, s60, v22
v_cmp_gt_u32 vcc, 32, v1
s_nop 1
v_cndmask_b32 v94, v31, v34, vcc
s_waitcnt lgkmcnt(14)
v_mfma_f32_32x32x16_bf16 v[96:111], a[160:163], a[12:15], v[96:111]
ds_read_b64_tr_b16 a[208:209], v20 offset:29824
ds_read_b64_tr_b16 a[210:211], v20 offset:31104
buffer_load_dwordx4 v13, s[8:11], s75 offen offset:1024 lds
s_sub_u32 s97, s2, 64
s_and_b32 s60, s97, 7
s_lshr_b32 s61, s97, 3
s_mul_i32 s98, s61, 81920
s_mul_i32 s62, s60, 160
s_add_u32 s98, s98, s62
s_mul_i32 s60, s60, 48
s_lshl_b32 s61, s61, 1
s_add_u32 s60, s60, s61
s_mul_i32 s99, s60, 5120
s_add_u32 s99, s99, 9437184
v_mfma_f32_32x32x16_bf16 v[112:127], a[164:167], a[12:15], v[112:127]
ds_read_b64_tr_b16 a[212:213], v20 offset:29856
ds_read_b64_tr_b16 a[214:215], v20 offset:31136
s_lshl_b32 s60, s48, 6
v_add_u32 v80, s60, v1
v_mul_u32_u24 v81, 6554, v80
v_lshrrev_b32 v81, 16, v81
v_mul_u32_u24 v93, 10, v81
v_sub_u32 v93, v80, v93
v_mul_u32_u24 v81, 1280, v81
v_lshl_add_u32 v82, v93, 4, v81
v_mfma_f32_32x32x16_bf16 v[128:143], a[168:171], a[12:15], v[128:143]
ds_read_b64_tr_b16 a[216:217], v20 offset:29888
ds_read_b64_tr_b16 a[218:219], v20 offset:31168
buffer_load_dwordx4 v14, s[8:11], s75 offen offset:2048 lds
v_add_u32 v80, 256, v1
v_mul_u32_u24 v81, 6554, v80
v_lshrrev_b32 v81, 16, v81
v_mul_u32_u24 v93, 10, v81
v_sub_u32 v93, v80, v93
v_mul_u32_u24 v81, 1280, v81
v_lshl_add_u32 v83, v93, 4, v81
v_mfma_f32_32x32x16_bf16 v[144:159], a[172:175], a[12:15], v[144:159]
ds_read_b64_tr_b16 a[220:221], v20 offset:29920
ds_read_b64_tr_b16 a[222:223], v20 offset:31200
v_lshrrev_b32 v80, 5, v1
v_lshlrev_b32 v80, 4, v80
v_bfe_u32 v81, v1, 4, 1
v_lshl_add_u32 v80, v81, 2, v80
v_bfe_u32 v81, v1, 2, 2
v_add_u32 v80, v80, v81
v_mul_u32_u24 v80, 160, v80
v_mfma_f32_32x32x16_bf16 v[160:175], a[176:179], a[12:15], v[160:175]
ds_read_b64_tr_b16 a[224:225], v20 offset:29952
ds_read_b64_tr_b16 a[226:227], v20 offset:31232
buffer_load_dwordx4 v15, s[8:11], s75 offen offset:3072 lds
v_and_b32 v81, 3, v1
v_lshl_add_u32 v80, v81, 3, v80
v_add_u32 v81, 147968, v80
s_add_u32 s61, s98, 0
s_lshl_b32 s62, s48, 10
s_add_u32 m0, s62, 147968
s_cmp_eq_u32 s48, 0
buffer_load_dwordx4 v82, s[32:35], s61 offen lds
s_cselect_b32 s61, s61, 2147483647
s_cselect_b32 s62, 0, 1024
s_add_u32 m0, s62, 152064
s_nop 0
buffer_load_dwordx4 v83, s[32:35], s61 offen lds
s_waitcnt lgkmcnt(10)
v_mfma_f32_32x32x16_bf16 v[96:111], a[184:187], a[16:19], v[96:111]
ds_read_b64_tr_b16 a[160:161], v20 offset:34944
ds_read_b64_tr_b16 a[162:163], v20 offset:36224
v_mfma_f32_32x32x16_bf16 v[112:127], a[188:191], a[16:19], v[112:127]
ds_read_b64_tr_b16 a[164:165], v20 offset:34976
ds_read_b64_tr_b16 a[166:167], v20 offset:36256
s_add_u32 s74, s54, 737280
s_add_u32 m0, s52, 74112
s_nop 0
buffer_load_dwordx4 v2, s[12:15], s74 offen lds
v_mfma_f32_32x32x16_bf16 v[128:143], a[192:195], a[16:19], v[128:143]
ds_read_b64_tr_b16 a[168:169], v20 offset:35008
ds_read_b64_tr_b16 a[170:171], v20 offset:36288
v_mfma_f32_32x32x16_bf16 v[144:159], a[196:199], a[16:19], v[144:159]
ds_read_b64_tr_b16 a[172:173], v20 offset:35040
ds_read_b64_tr_b16 a[174:175], v20 offset:36320
buffer_load_dwordx4 v3, s[12:15], s74 offen offset:1024 lds
v_mfma_f32_32x32x16_bf16 v[160:175], a[200:203], a[16:19], v[160:175]
ds_read_b64_tr_b16 a[176:177], v20 offset:35072
ds_read_b64_tr_b16 a[178:179], v20 offset:36352
s_waitcnt lgkmcnt(10)
v_mfma_f32_32x32x16_bf16 v[96:111], a[208:211], a[20:23], v[96:111]
ds_read_b64_tr_b16 a[184:185], v20 offset:40064
ds_read_b64_tr_b16 a[186:187], v20 offset:41344
buffer_load_dwordx4 v4, s[12:15], s74 offen offset:2048 lds
v_mfma_f32_32x32x16_bf16 v[112:127], a[212:215], a[20:23], v[112:127]
ds_read_b64_tr_b16 a[188:189], v20 offset:40096
ds_read_b64_tr_b16 a[190:191], v20 offset:41376
v_mfma_f32_32x32x16_bf16 v[128:143], a[216:219], a[20:23], v[128:143]
ds_read_b64_tr_b16 a[192:193], v20 offset:40128
ds_read_b64_tr_b16 a[194:195], v20 offset:41408
buffer_load_dwordx4 v5, s[12:15], s74 offen offset:3072 lds
v_mfma_f32_32x32x16_bf16 v[144:159], a[220:223], a[20:23], v[144:159]
ds_read_b64_tr_b16 a[196:197], v20 offset:40160
ds_read_b64_tr_b16 a[198:199], v20 offset:41440
v_mfma_f32_32x32x16_bf16 v[160:175], a[224:227], a[20:23], v[160:175]
ds_read_b64_tr_b16 a[200:201], v20 offset:40192
ds_read_b64_tr_b16 a[202:203], v20 offset:41472
s_add_u32 m0, s52, 78208
s_nop 0
buffer_load_dwordx4 v6, s[12:15], s74 offen lds
s_waitcnt vmcnt(20)
s_barrier
s_waitcnt lgkmcnt(10)
v_mfma_f32_32x32x16_bf16 v[96:111], a[160:163], a[24:27], v[96:111]
ds_read_b64_tr_b16 a[208:209], v21 offset:0
ds_read_b64_tr_b16 a[210:211], v21 offset:1280
ds_read_b128 a[32:35], v16 offset:8192
v_mfma_f32_32x32x16_bf16 v[112:127], a[164:167], a[24:27], v[112:127]
ds_read_b64_tr_b16 a[212:213], v21 offset:32
ds_read_b64_tr_b16 a[214:215], v21 offset:1312
ds_read_b128 a[36:39], v17 offset:8192
s_add_u32 m0, s53, 4096
s_add_u32 s75, s56, 512
buffer_load_dwordx4 v12, s[8:11], s75 offen lds
v_mfma_f32_32x32x16_bf16 v[128:143], a[168:171], a[24:27], v[128:143]
ds_read_b64_tr_b16 a[216:217], v21 offset:64
ds_read_b64_tr_b16 a[218:219], v21 offset:1344
ds_read_b128 a[40:43], v18 offset:8192
v_mfma_f32_32x32x16_bf16 v[144:159], a[172:175], a[24:27], v[144:159]
ds_read_b64_tr_b16 a[220:221], v21 offset:96
ds_read_b64_tr_b16 a[222:223], v21 offset:1376
ds_read_b128 a[44:47], v19 offset:8192
buffer_load_dwordx4 v13, s[8:11], s75 offen offset:1024 lds
v_mfma_f32_32x32x16_bf16 v[160:175], a[176:179], a[24:27], v[160:175]
ds_read_b64_tr_b16 a[224:225], v21 offset:128
ds_read_b64_tr_b16 a[226:227], v21 offset:1408
s_waitcnt lgkmcnt(14)
v_mfma_f32_32x32x16_bf16 v[96:111], a[184:187], a[28:31], v[96:111]
ds_read_b64_tr_b16 a[160:161], v21 offset:5120
ds_read_b64_tr_b16 a[162:163], v21 offset:6400
buffer_load_dwordx4 v14, s[8:11], s75 offen offset:2048 lds
v_mfma_f32_32x32x16_bf16 v[112:127], a[188:191], a[28:31], v[112:127]
ds_read_b64_tr_b16 a[164:165], v21 offset:5152
ds_read_b64_tr_b16 a[166:167], v21 offset:6432
v_mfma_f32_32x32x16_bf16 v[128:143], a[192:195], a[28:31], v[128:143]
ds_read_b64_tr_b16 a[168:169], v21 offset:5184
ds_read_b64_tr_b16 a[170:171], v21 offset:6464
buffer_load_dwordx4 v15, s[8:11], s75 offen offset:3072 lds
v_mfma_f32_32x32x16_bf16 v[144:159], a[196:199], a[28:31], v[144:159]
ds_read_b64_tr_b16 a[172:173], v21 offset:5216
ds_read_b64_tr_b16 a[174:175], v21 offset:6496
v_mfma_f32_32x32x16_bf16 v[160:175], a[200:203], a[28:31], v[160:175]
ds_read_b64_tr_b16 a[176:177], v21 offset:5248
ds_read_b64_tr_b16 a[178:179], v21 offset:6528
s_add_u32 s74, s54, 983040
s_add_u32 m0, s52, 0
s_nop 0
buffer_load_dwordx4 v2, s[12:15], s74 offen lds
v_mov_b32 v32, 0
v_mov_b32 v33, 0
v_mov_b32 v34, 0
s_waitcnt lgkmcnt(10)
v_mfma_f32_32x32x16_bf16 v[96:111], a[208:211], a[32:35], v[96:111]
ds_read_b64_tr_b16 a[184:185], v21 offset:10240
ds_read_b64_tr_b16 a[186:187], v21 offset:11520
v_mov_b32 v35, 0
v_lshlrev_b32 v36, 16, v192
v_and_b32 v37, 0xffff0000, v192
v_add_f32 v32, v32, v36
v_add_f32 v33, v33, v37
v_fmac_f32 v34, v36, v36
v_fmac_f32 v35, v37, v37
v_mfma_f32_32x32x16_bf16 v[112:127], a[212:215], a[32:35], v[112:127]
ds_read_b64_tr_b16 a[188:189], v21 offset:10272
ds_read_b64_tr_b16 a[190:191], v21 offset:11552
buffer_load_dwordx4 v3, s[12:15], s74 offen offset:1024 lds
v_lshlrev_b32 v36, 16, v193
v_and_b32 v37, 0xffff0000, v193
v_add_f32 v32, v32, v36
v_add_f32 v33, v33, v37
v_fmac_f32 v34, v36, v36
v_fmac_f32 v35, v37, v37
v_mfma_f32_32x32x16_bf16 v[128:143], a[216:219], a[32:35], v[128:143]
ds_read_b64_tr_b16 a[192:193], v21 offset:10304
ds_read_b64_tr_b16 a[194:195], v21 offset:11584
v_lshlrev_b32 v36, 16, v194
v_and_b32 v37, 0xffff0000, v194
v_add_f32 v32, v32, v36
v_add_f32 v33, v33, v37
v_fmac_f32 v34, v36, v36
v_fmac_f32 v35, v37, v37
v_lshlrev_b32 v36, 16, v195
v_mfma_f32_32x32x16_bf16 v[144:159], a[220:223], a[32:35], v[144:159]
ds_read_b64_tr_b16 a[196:197], v21 offset:10336
ds_read_b64_tr_b16 a[198:199], v21 offset:11616
buffer_load_dwordx4 v4, s[12:15], s74 offen offset:2048 lds
v_and_b32 v37, 0xffff0000, v195
v_add_f32 v32, v32, v36
v_add_f32 v33, v33, v37
v_fmac_f32 v34, v36, v36
v_fmac_f32 v35, v37, v37
v_lshlrev_b32 v36, 16, v196
v_mfma_f32_32x32x16_bf16 v[160:175], a[224:227], a[32:35], v[160:175]
ds_read_b64_tr_b16 a[200:201], v21 offset:10368
ds_read_b64_tr_b16 a[202:203], v21 offset:11648
v_and_b32 v37, 0xffff0000, v196
v_add_f32 v32, v32, v36
v_add_f32 v33, v33, v37
v_fmac_f32 v34, v36, v36
v_fmac_f32 v35, v37, v37
v_lshlrev_b32 v36, 16, v197
v_and_b32 v37, 0xffff0000, v197
s_waitcnt lgkmcnt(10)
v_mfma_f32_32x32x16_bf16 v[96:111], a[160:163], a[36:39], v[96:111]
ds_read_b64_tr_b16 a[208:209], v21 offset:15360
ds_read_b64_tr_b16 a[210:211], v21 offset:16640
buffer_load_dwordx4 v5, s[12:15], s74 offen offset:3072 lds
v_add_f32 v32, v32, v36
v_add_f32 v33, v33, v37
v_fmac_f32 v34, v36, v36
v_fmac_f32 v35, v37, v37
v_lshlrev_b32 v36, 16, v198
v_and_b32 v37, 0xffff0000, v198
v_mfma_f32_32x32x16_bf16 v[112:127], a[164:167], a[36:39], v[112:127]
ds_read_b64_tr_b16 a[212:213], v21 offset:15392
ds_read_b64_tr_b16 a[214:215], v21 offset:16672
v_add_f32 v32, v32, v36
v_add_f32 v33, v33, v37
v_fmac_f32 v34, v36, v36
v_fmac_f32 v35, v37, v37
v_lshlrev_b32 v36, 16, v199
v_and_b32 v37, 0xffff0000, v199
v_add_f32 v32, v32, v36
v_mfma_f32_32x32x16_bf16 v[128:143], a[168:171], a[36:39], v[128:143]
ds_read_b64_tr_b16 a[216:217], v21 offset:15424
ds_read_b64_tr_b16 a[218:219], v21 offset:16704
s_add_u32 m0, s52, 4096
s_nop 0
buffer_load_dwordx4 v6, s[12:15], s74 offen lds
v_add_f32 v33, v33, v37
v_fmac_f32 v34, v36, v36
v_fmac_f32 v35, v37, v37
v_lshlrev_b32 v36, 16, v200
v_mfma_f32_32x32x16_bf16 v[144:159], a[172:175], a[36:39], v[144:159]
ds_read_b64_tr_b16 a[220:221], v21 offset:15456
ds_read_b64_tr_b16 a[222:223], v21 offset:16736
v_and_b32 v37, 0xffff0000, v200
v_add_f32 v32, v32, v36
v_add_f32 v33, v33, v37
v_fmac_f32 v34, v36, v36
v_fmac_f32 v35, v37, v37
v_lshlrev_b32 v36, 16, v201
v_and_b32 v37, 0xffff0000, v201
v_mfma_f32_32x32x16_bf16 v[160:175], a[176:179], a[36:39], v[160:175]
ds_read_b64_tr_b16 a[224:225], v21 offset:15488
ds_read_b64_tr_b16 a[226:227], v21 offset:16768
s_add_u32 m0, s53, 8192
s_add_u32 s75, s56, 640
buffer_load_dwordx4 v12, s[8:11], s75 offen lds
v_add_f32 v32, v32, v36
v_add_f32 v33, v33, v37
v_fmac_f32 v34, v36, v36
v_fmac_f32 v35, v37, v37
s_waitcnt vmcnt(10)
s_barrier
s_waitcnt lgkmcnt(10)
v_mfma_f32_32x32x16_bf16 v[96:111], a[184:187], a[40:43], v[96:111]
ds_read_b64_tr_b16 a[160:161], v21 offset:24704
ds_read_b64_tr_b16 a[162:163], v21 offset:25984
ds_read_b128 a[48:51], v16 offset:0
v_add_f32 v32, v32, v33
v_add_f32 v34, v34, v35
s_nop 0
v_add_f32_dpp v33, v32, v32 row_ror:8 row_mask:0xf bank_mask:0xf
v_add_f32_dpp v35, v34, v34 row_ror:8 row_mask:0xf bank_mask:0xf
s_nop 0
v_add_f32_dpp v32, v33, v33 row_ror:4 row_mask:0xf bank_mask:0xf
v_add_f32_dpp v34, v35, v35 row_ror:4 row_mask:0xf bank_mask:0xf
v_mfma_f32_32x32x16_bf16 v[112:127], a[188:191], a[40:43], v[112:127]
ds_read_b64_tr_b16 a[164:165], v21 offset:24736
ds_read_b64_tr_b16 a[166:167], v21 offset:26016
ds_read_b128 a[52:55], v17 offset:0
buffer_load_dwordx4 v13, s[8:11], s75 offen offset:1024 lds
v_add_f32_dpp v33, v32, v32 row_ror:2 row_mask:0xf bank_mask:0xf
v_add_f32_dpp v35, v34, v34 row_ror:2 row_mask:0xf bank_mask:0xf
s_nop 0
v_add_f32_dpp v32, v33, v33 row_ror:1 row_mask:0xf bank_mask:0xf
v_add_f32_dpp v34, v35, v35 row_ror:1 row_mask:0xf bank_mask:0xf
v_mov_b32 v33, v32
v_mfma_f32_32x32x16_bf16 v[128:143], a[192:195], a[40:43], v[128:143]
ds_read_b64_tr_b16 a[168:169], v21 offset:24768
ds_read_b64_tr_b16 a[170:171], v21 offset:26048
ds_read_b128 a[56:59], v18 offset:0
v_mov_b32 v35, v34
v_permlane16_swap_b32 v32, v33
s_nop 0
v_permlane16_swap_b32 v34, v35
v_add_f32 v32, v32, v33
v_add_f32 v34, v34, v35
v_mul_f32 v32, 0x3acccccd, v32
v_mfma_f32_32x32x16_bf16 v[144:159], a[196:199], a[40:43], v[144:159]
ds_read_b64_tr_b16 a[172:173], v21 offset:24800
ds_read_b64_tr_b16 a[174:175], v21 offset:26080
ds_read_b128 a[60:63], v19 offset:0
buffer_load_dwordx4 v14, s[8:11], s75 offen offset:2048 lds
v_mul_f32 v34, 0x3acccccd, v34
v_fma_f32 v34, -v32, v32, v34
v_max_f32 v34, 0, v34
v_add_f32 v34, 0x3727c5ac, v34
v_rsq_f32 v33, v34
v_mfma_f32_32x32x16_bf16 v[160:175], a[200:203], a[40:43], v[160:175]
ds_read_b64_tr_b16 a[176:177], v21 offset:24832
ds_read_b64_tr_b16 a[178:179], v21 offset:26112
v_mov_b32 v34, v32
v_mov_b32 v36, v32
v_and_b32 v38, 1, v1
v_mov_b32 v35, v33
v_mov_b32 v37, v33
v_permlane32_swap_b32 v36, v34
s_nop 0
v_permlane32_swap_b32 v37, v35
s_waitcnt lgkmcnt(14)
v_mfma_f32_32x32x16_bf16 v[96:111], a[208:211], a[44:47], v[96:111]
ds_read_b64_tr_b16 a[184:185], v21 offset:29824
ds_read_b64_tr_b16 a[186:187], v21 offset:31104
buffer_load_dwordx4 v15, s[8:11], s75 offen offset:3072 lds
v_cmp_eq_u32 vcc, 1, v38
s_nop 1
v_cndmask_b32 v32, v32, v34, vcc
v_cndmask_b32 v33, v33, v35, vcc
v_mov_b32 v30, v30
s_cmp_lg_u32 s48, 0
s_cbranch_scc1 NOKQ
v_subrev_u32 v39, s92, v30
v_and_b32 v40, 1, v30
v_cmp_lt_u32 vcc, 0x40000000, v39
v_cmp_eq_u32 s[82:83], 0, v40
s_nop 3
s_or_b64 vcc, vcc, s[82:83]
s_cbranch_vccz NWRQ
s_mov_b32 s68, 4000
v_mov_b32 v38, 0
NSPQ:
s_sleep 8
buffer_load_dword v30, v38, s[28:31], 0 offen sc1
s_waitcnt vmcnt(0)
v_subrev_u32 v39, s92, v30
v_and_b32 v40, 1, v30
v_cmp_lt_u32 vcc, 0x40000000, v39
v_cmp_eq_u32 s[82:83], 0, v40
s_nop 3
s_or_b64 vcc, vcc, s[82:83]
s_sub_u32 s68, s68, 1
s_cbranch_vccz NWRQ
s_cmp_lg_u32 s68, 0
s_cbranch_scc1 NSPQ
NWRQ:
v_mov_b32 v38, 131072
ds_write_b32 v38, v30 offset:30208
s_waitcnt lgkmcnt(0)
NOKQ:
s_barrier
v_mov_b32 v38, 131072
ds_read_b32 v30, v38 offset:30208
v_mfma_f32_32x32x16_bf16 v[112:127], a[212:215], a[44:47], v[112:127]
ds_read_b64_tr_b16 a[188:189], v21 offset:29856
ds_read_b64_tr_b16 a[190:191], v21 offset:31136
s_waitcnt lgkmcnt(2)
v_mov_b32 v34, v30
v_mov_b32 v35, v30
buffer_store_dwordx4 v[32:35], v95, s[24:27], 0 offen sc1
s_barrier
s_lshl_b32 s60, s48, 5
v_add_u32 v80, s60, v81
ds_read_b64_tr_b16 a[232:233], v80
ds_read_b64_tr_b16 a[234:235], v80 offset:1280
ds_read_b64_tr_b16 a[236:237], v81 offset:128
ds_read_b64_tr_b16 a[238:239], v81 offset:1408
v_mfma_f32_32x32x16_bf16 v[128:143], a[216:219], a[44:47], v[128:143]
ds_read_b64_tr_b16 a[192:193], v21 offset:29888
ds_read_b64_tr_b16 a[194:195], v21 offset:31168
s_add_u32 s74, s54, 1228800
s_add_u32 m0, s52, 24704
s_nop 0
buffer_load_dwordx4 v2, s[12:15], s74 offen lds
s_lshl_b32 s60, s48, 10
s_add_u32 s60, s60, s99
s_add_u32 s60, s60, 0
s_waitcnt lgkmcnt(4)
buffer_store_dwordx4 a[232:235], v22, s[24:27], s60 offen sc1
s_add_u32 s60, s99, 4096
s_cmp_eq_u32 s48, 0
s_cselect_b32 s60, s60, 17825792
s_waitcnt lgkmcnt(2)
buffer_store_dwordx4 a[236:239], v22, s[24:27], s60 offen sc1
v_mfma_f32_32x32x16_bf16 v[144:159], a[220:223], a[44:47], v[144:159]
ds_read_b64_tr_b16 a[196:197], v21 offset:29920
ds_read_b64_tr_b16 a[198:199], v21 offset:31200
s_barrier
v_mfma_f32_32x32x16_bf16 v[160:175], a[224:227], a[44:47], v[160:175]
ds_read_b64_tr_b16 a[200:201], v21 offset:29952
ds_read_b64_tr_b16 a[202:203], v21 offset:31232
buffer_load_dwordx4 v3, s[12:15], s74 offen offset:1024 lds
v_mfma_f32_32x32x16_bf16 v[96:111], a[160:163], a[48:51], v[96:111]
ds_read_b64_tr_b16 a[208:209], v21 offset:34944
ds_read_b64_tr_b16 a[210:211], v21 offset:36224
v_mfma_f32_32x32x16_bf16 v[112:127], a[164:167], a[48:51], v[112:127]
ds_read_b64_tr_b16 a[212:213], v21 offset:34976
ds_read_b64_tr_b16 a[214:215], v21 offset:36256
buffer_load_dwordx4 v4, s[12:15], s74 offen offset:2048 lds
v_mfma_f32_32x32x16_bf16 v[128:143], a[168:171], a[48:51], v[128:143]
ds_read_b64_tr_b16 a[216:217], v21 offset:35008
ds_read_b64_tr_b16 a[218:219], v21 offset:36288
v_mfma_f32_32x32x16_bf16 v[144:159], a[172:175], a[48:51], v[144:159]
ds_read_b64_tr_b16 a[220:221], v21 offset:35040
ds_read_b64_tr_b16 a[222:223], v21 offset:36320
buffer_load_dwordx4 v5, s[12:15], s74 offen offset:3072 lds
s_add_u32 s61, s98, 40960
s_lshl_b32 s62, s48, 10
s_add_u32 m0, s62, 147968
s_cmp_eq_u32 s48, 0
buffer_load_dwordx4 v82, s[32:35], s61 offen lds
s_cselect_b32 s61, s61, 2147483647
s_cselect_b32 s62, 0, 1024
s_add_u32 m0, s62, 152064
s_nop 0
buffer_load_dwordx4 v83, s[32:35], s61 offen lds
v_mfma_f32_32x32x16_bf16 v[160:175], a[176:179], a[48:51], v[160:175]
ds_read_b64_tr_b16 a[224:225], v21 offset:35072
ds_read_b64_tr_b16 a[226:227], v21 offset:36352
v_lshlrev_b32 v244, 16, v204
v_and_b32 v245, 0xffff0000, v204
v_lshlrev_b32 v246, 16, v205
v_and_b32 v247, 0xffff0000, v205
v_lshlrev_b32 v248, 16, v206
v_and_b32 v249, 0xffff0000, v206
v_lshlrev_b32 v250, 16, v207
s_waitcnt lgkmcnt(10)
v_mfma_f32_32x32x16_bf16 v[96:111], a[184:187], a[52:55], v[96:111]
ds_read_b64_tr_b16 a[160:161], v21 offset:40064
ds_read_b64_tr_b16 a[162:163], v21 offset:41344
s_add_u32 m0, s52, 28800
s_nop 0
buffer_load_dwordx4 v6, s[12:15], s74 offen lds
v_and_b32 v251, 0xffff0000, v207
v_lshlrev_b32 v192, 16, v208
v_and_b32 v193, 0xffff0000, v208
v_add_f32 v244, v244, v192
v_mfma_f32_32x32x16_bf16 v[112:127], a[188:191], a[52:55], v[112:127]
ds_read_b64_tr_b16 a[164:165], v21 offset:40096
ds_read_b64_tr_b16 a[166:167], v21 offset:41376
v_add_f32 v245, v245, v193
v_lshlrev_b32 v194, 16, v209
v_and_b32 v195, 0xffff0000, v209
v_add_f32 v246, v246, v194
v_add_f32 v247, v247, v195
v_lshlrev_b32 v196, 16, v210
v_and_b32 v197, 0xffff0000, v210
v_mfma_f32_32x32x16_bf16 v[128:143], a[192:195], a[52:55], v[128:143]
ds_read_b64_tr_b16 a[168:169], v21 offset:40128
ds_read_b64_tr_b16 a[170:171], v21 offset:41408
s_add_u32 m0, s53, 0
s_add_u32 s75, s56, 768
buffer_load_dwordx4 v12, s[8:11], s75 offen lds
v_add_f32 v248, v248, v196
v_add_f32 v249, v249, v197
v_lshlrev_b32 v198, 16, v211
v_and_b32 v199, 0xffff0000, v211
v_mfma_f32_32x32x16_bf16 v[144:159], a[196:199], a[52:55], v[144:159]
ds_read_b64_tr_b16 a[172:173], v21 offset:40160
ds_read_b64_tr_b16 a[174:175], v21 offset:41440
v_add_f32 v250, v250, v198
v_add_f32 v251, v251, v199
v_lshlrev_b32 v192, 16, v212
v_and_b32 v193, 0xffff0000, v212
v_add_f32 v244, v244, v192
v_add_f32 v245, v245, v193
v_lshlrev_b32 v194, 16, v213
v_mfma_f32_32x32x16_bf16 v[160:175], a[200:203], a[52:55], v[160:175]
ds_read_b64_tr_b16 a[176:177], v21 offset:40192
ds_read_b64_tr_b16 a[178:179], v21 offset:41472
buffer_load_dwordx4 v13, s[8:11], s75 offen offset:1024 lds
v_and_b32 v195, 0xffff0000, v213
v_add_f32 v246, v246, v194
v_add_f32 v247, v247, v195
v_lshlrev_b32 v196, 16, v214
v_and_b32 v197, 0xffff0000, v214
v_add_f32 v248, v248, v196
s_waitcnt vmcnt(16)
s_barrier
s_waitcnt lgkmcnt(10)
v_mfma_f32_32x32x16_bf16 v[96:111], a[208:211], a[56:59], v[96:111]
ds_read_b64_tr_b16 a[184:185], v20 offset:0
ds_read_b64_tr_b16 a[186:187], v20 offset:1280
ds_read_b128 a[64:67], v16 offset:4096
v_add_f32 v249, v249, v197
v_lshlrev_b32 v198, 16, v215
v_and_b32 v199, 0xffff0000, v215
v_add_f32 v250, v250, v198
v_add_f32 v251, v251, v199
v_lshlrev_b32 v192, 16, v216
v_mfma_f32_32x32x16_bf16 v[112:127], a[212:215], a[56:59], v[112:127]
ds_read_b64_tr_b16 a[188:189], v20 offset:32
ds_read_b64_tr_b16 a[190:191], v20 offset:1312
ds_read_b128 a[68:71], v17 offset:4096
buffer_load_dwordx4 v14, s[8:11], s75 offen offset:2048 lds
v_and_b32 v193, 0xffff0000, v216
v_add_f32 v244, v244, v192
v_add_f32 v245, v245, v193
v_lshlrev_b32 v194, 16, v217
v_and_b32 v195, 0xffff0000, v217
v_mfma_f32_32x32x16_bf16 v[128:143], a[216:219], a[56:59], v[128:143]
ds_read_b64_tr_b16 a[192:193], v20 offset:64
ds_read_b64_tr_b16 a[194:195], v20 offset:1344
ds_read_b128 a[72:75], v18 offset:4096
v_add_f32 v246, v246, v194
v_add_f32 v247, v247, v195
v_lshlrev_b32 v196, 16, v218
v_and_b32 v197, 0xffff0000, v218
v_add_f32 v248, v248, v196
v_add_f32 v249, v249, v197
v_mfma_f32_32x32x16_bf16 v[144:159], a[220:223], a[56:59], v[144:159]
ds_read_b64_tr_b16 a[196:197], v20 offset:96
ds_read_b64_tr_b16 a[198:199], v20 offset:1376
ds_read_b128 a[76:79], v19 offset:4096
buffer_load_dwordx4 v15, s[8:11], s75 offen offset:3072 lds
v_lshlrev_b32 v198, 16, v219
v_and_b32 v199, 0xffff0000, v219
v_add_f32 v250, v250, v198
v_add_f32 v251, v251, v199
v_lshlrev_b32 v192, 16, v220
v_mfma_f32_32x32x16_bf16 v[160:175], a[224:227], a[56:59], v[160:175]
ds_read_b64_tr_b16 a[200:201], v20 offset:128
ds_read_b64_tr_b16 a[202:203], v20 offset:1408
v_and_b32 v193, 0xffff0000, v220
v_add_f32 v244, v244, v192
v_add_f32 v245, v245, v193
v_lshlrev_b32 v194, 16, v221
v_and_b32 v195, 0xffff0000, v221
v_add_f32 v246, v246, v194
v_add_f32 v247, v247, v195
s_waitcnt lgkmcnt(14)
v_mfma_f32_32x32x16_bf16 v[96:111], a[160:163], a[60:63], v[96:111]
ds_read_b64_tr_b16 a[208:209], v20 offset:5120
ds_read_b64_tr_b16 a[210:211], v20 offset:6400
s_add_u32 s74, s54, 1474560
s_add_u32 m0, s52, 49408
s_nop 0
buffer_load_dwordx4 v2, s[12:15], s74 offen lds
v_lshlrev_b32 v196, 16, v222
v_and_b32 v197, 0xffff0000, v222
v_add_f32 v248, v248, v196
v_mfma_f32_32x32x16_bf16 v[112:127], a[164:167], a[60:63], v[112:127]
ds_read_b64_tr_b16 a[212:213], v20 offset:5152
ds_read_b64_tr_b16 a[214:215], v20 offset:6432
v_add_f32 v249, v249, v197
v_lshlrev_b32 v198, 16, v223
v_and_b32 v199, 0xffff0000, v223
v_add_f32 v250, v250, v198
v_add_f32 v251, v251, v199
v_lshlrev_b32 v192, 16, v224
v_and_b32 v193, 0xffff0000, v224
v_mfma_f32_32x32x16_bf16 v[128:143], a[168:171], a[60:63], v[128:143]
ds_read_b64_tr_b16 a[216:217], v20 offset:5184
ds_read_b64_tr_b16 a[218:219], v20 offset:6464
buffer_load_dwordx4 v3, s[12:15], s74 offen offset:1024 lds
v_add_f32 v244, v244, v192
v_add_f32 v245, v245, v193
v_lshlrev_b32 v194, 16, v225
v_and_b32 v195, 0xffff0000, v225
v_add_f32 v246, v246, v194
v_add_f32 v247, v247, v195
v_mfma_f32_32x32x16_bf16 v[144:159], a[172:175], a[60:63], v[144:159]
ds_read_b64_tr_b16 a[220:221], v20 offset:5216
ds_read_b64_tr_b16 a[222:223], v20 offset:6496
v_lshlrev_b32 v196, 16, v226
v_and_b32 v197, 0xffff0000, v226
v_add_f32 v248, v248, v196
v_add_f32 v249, v249, v197
v_lshlrev_b32 v198, 16, v227
v_and_b32 v199, 0xffff0000, v227
v_add_f32 v250, v250, v198
v_mfma_f32_32x32x16_bf16 v[160:175], a[176:179], a[60:63], v[160:175]
ds_read_b64_tr_b16 a[224:225], v20 offset:5248
ds_read_b64_tr_b16 a[226:227], v20 offset:6528
buffer_load_dwordx4 v4, s[12:15], s74 offen offset:2048 lds
v_add_f32 v251, v251, v199
v_lshlrev_b32 v192, 16, v228
v_and_b32 v193, 0xffff0000, v228
v_add_f32 v244, v244, v192
v_add_f32 v245, v245, v193
v_lshlrev_b32 v194, 16, v229
s_waitcnt lgkmcnt(10)
v_mfma_f32_32x32x16_bf16 v[96:111], a[184:187], a[64:67], v[96:111]
ds_read_b64_tr_b16 a[160:161], v20 offset:10240
ds_read_b64_tr_b16 a[162:163], v20 offset:11520
v_and_b32 v195, 0xffff0000, v229
v_add_f32 v246, v246, v194
v_add_f32 v247, v247, v195
v_lshlrev_b32 v196, 16, v230
v_and_b32 v197, 0xffff0000, v230
v_add_f32 v248, v248, v196
v_add_f32 v249, v249, v197
v_mfma_f32_32x32x16_bf16 v[112:127], a[188:191], a[64:67], v[112:127]
ds_read_b64_tr_b16 a[164:165], v20 offset:10272
ds_read_b64_tr_b16 a[166:167], v20 offset:11552
buffer_load_dwordx4 v5, s[12:15], s74 offen offset:3072 lds
v_lshlrev_b32 v198, 16, v231
v_and_b32 v199, 0xffff0000, v231
v_add_f32 v250, v250, v198
v_add_f32 v251, v251, v199
v_lshlrev_b32 v192, 16, v232
v_and_b32 v193, 0xffff0000, v232
v_mfma_f32_32x32x16_bf16 v[128:143], a[192:195], a[64:67], v[128:143]
ds_read_b64_tr_b16 a[168:169], v20 offset:10304
ds_read_b64_tr_b16 a[170:171], v20 offset:11584
v_add_f32 v244, v244, v192
v_add_f32 v245, v245, v193
v_lshlrev_b32 v194, 16, v233
v_and_b32 v195, 0xffff0000, v233
v_add_f32 v246, v246, v194
v_add_f32 v247, v247, v195
v_lshlrev_b32 v196, 16, v234
v_mfma_f32_32x32x16_bf16 v[144:159], a[196:199], a[64:67], v[144:159]
ds_read_b64_tr_b16 a[172:173], v20 offset:10336
ds_read_b64_tr_b16 a[174:175], v20 offset:11616
s_add_u32 m0, s52, 53504
s_nop 0
buffer_load_dwordx4 v6, s[12:15], s74 offen lds
v_and_b32 v197, 0xffff0000, v234
v_add_f32 v248, v248, v196
v_add_f32 v249, v249, v197
v_lshlrev_b32 v198, 16, v235
v_mfma_f32_32x32x16_bf16 v[160:175], a[200:203], a[64:67], v[160:175]
ds_read_b64_tr_b16 a[176:177], v20 offset:10368
ds_read_b64_tr_b16 a[178:179], v20 offset:11648
v_and_b32 v199, 0xffff0000, v235
v_add_f32 v250, v250, v198
v_add_f32 v251, v251, v199
v_lshlrev_b32 v192, 16, v236
v_and_b32 v193, 0xffff0000, v236
v_add_f32 v244, v244, v192
v_add_f32 v245, v245, v193
s_waitcnt lgkmcnt(10)
v_mfma_f32_32x32x16_bf16 v[96:111], a[208:211], a[68:71], v[96:111]
ds_read_b64_tr_b16 a[184:185], v20 offset:15360
ds_read_b64_tr_b16 a[186:187], v20 offset:16640
s_add_u32 m0, s53, 4096
s_add_u32 s75, s56, 896
buffer_load_dwordx4 v12, s[8:11], s75 offen lds
v_lshlrev_b32 v194, 16, v237
v_and_b32 v195, 0xffff0000, v237
v_add_f32 v246, v246, v194
v_add_f32 v247, v247, v195
v_mfma_f32_32x32x16_bf16 v[112:127], a[212:215], a[68:71], v[112:127]
ds_read_b64_tr_b16 a[188:189], v20 offset:15392
ds_read_b64_tr_b16 a[190:191], v20 offset:16672
v_lshlrev_b32 v196, 16, v238
v_and_b32 v197, 0xffff0000, v238
v_add_f32 v248, v248, v196
v_add_f32 v249, v249, v197
v_lshlrev_b32 v198, 16, v239
v_and_b32 v199, 0xffff0000, v239
v_add_f32 v250, v250, v198
v_mfma_f32_32x32x16_bf16 v[128:143], a[216:219], a[68:71], v[128:143]
ds_read_b64_tr_b16 a[192:193], v20 offset:15424
ds_read_b64_tr_b16 a[194:195], v20 offset:16704
buffer_load_dwordx4 v13, s[8:11], s75 offen offset:1024 lds
v_add_f32 v251, v251, v199
v_lshlrev_b32 v192, 16, v240
v_and_b32 v193, 0xffff0000, v240
v_add_f32 v244, v244, v192
v_add_f32 v245, v245, v193
v_lshlrev_b32 v194, 16, v241
v_mfma_f32_32x32x16_bf16 v[144:159], a[220:223], a[68:71], v[144:159]
ds_read_b64_tr_b16 a[196:197], v20 offset:15456
ds_read_b64_tr_b16 a[198:199], v20 offset:16736
v_and_b32 v195, 0xffff0000, v241
v_add_f32 v246, v246, v194
v_add_f32 v247, v247, v195
v_lshlrev_b32 v196, 16, v242
v_and_b32 v197, 0xffff0000, v242
v_add_f32 v248, v248, v196
v_add_f32 v249, v249, v197
v_mfma_f32_32x32x16_bf16 v[160:175], a[224:227], a[68:71], v[160:175]
ds_read_b64_tr_b16 a[200:201], v20 offset:15488
ds_read_b64_tr_b16 a[202:203], v20 offset:16768
buffer_load_dwordx4 v14, s[8:11], s75 offen offset:2048 lds
v_lshlrev_b32 v198, 16, v243
v_and_b32 v199, 0xffff0000, v243
v_add_f32 v250, v250, v198
v_add_f32 v251, v251, v199
v_mov_b32 v192, v244
v_mov_b32 v193, v245
s_waitcnt vmcnt(12)
s_barrier
s_waitcnt lgkmcnt(10)
v_mfma_f32_32x32x16_bf16 v[96:111], a[160:163], a[72:75], v[96:111]
ds_read_b64_tr_b16 a[208:209], v20 offset:24704
ds_read_b64_tr_b16 a[210:211], v20 offset:25984
ds_read_b128 a[80:83], v16 offset:8192
v_mov_b32 v194, v246
v_mov_b32 v195, v247
v_mov_b32 v196, v248
v_mov_b32 v197, v249
v_mov_b32 v198, v250
v_mov_b32 v199, v251
v_mfma_f32_32x32x16_bf16 v[112:127], a[164:167], a[72:75], v[112:127]
ds_read_b64_tr_b16 a[212:213], v20 offset:24736
ds_read_b64_tr_b16 a[214:215], v20 offset:26016
ds_read_b128 a[84:87], v17 offset:8192
buffer_load_dwordx4 v15, s[8:11], s75 offen offset:3072 lds
v_permlane16_swap_b32 v244, v192
v_permlane16_swap_b32 v245, v193
v_permlane16_swap_b32 v246, v194
v_permlane16_swap_b32 v247, v195
v_permlane16_swap_b32 v248, v196
v_mfma_f32_32x32x16_bf16 v[128:143], a[168:171], a[72:75], v[128:143]
ds_read_b64_tr_b16 a[216:217], v20 offset:24768
ds_read_b64_tr_b16 a[218:219], v20 offset:26048
ds_read_b128 a[88:91], v18 offset:8192
v_permlane16_swap_b32 v249, v197
v_permlane16_swap_b32 v250, v198
v_permlane16_swap_b32 v251, v199
v_add_f32 v244, v244, v192
v_add_f32 v245, v245, v193
v_add_f32 v246, v246, v194
v_mfma_f32_32x32x16_bf16 v[144:159], a[172:175], a[72:75], v[144:159]
ds_read_b64_tr_b16 a[220:221], v20 offset:24800
ds_read_b64_tr_b16 a[222:223], v20 offset:26080
ds_read_b128 a[92:95], v19 offset:8192
s_add_u32 s74, s54, 1720320
s_add_u32 m0, s52, 74112
s_nop 0
buffer_load_dwordx4 v2, s[12:15], s74 offen lds
v_add_f32 v247, v247, v195
v_add_f32 v248, v248, v196
v_mfma_f32_32x32x16_bf16 v[160:175], a[176:179], a[72:75], v[160:175]
ds_read_b64_tr_b16 a[224:225], v20 offset:24832
ds_read_b64_tr_b16 a[226:227], v20 offset:26112
v_add_f32 v249, v249, v197
v_add_f32 v250, v250, v198
v_add_f32 v251, v251, v199
v_mov_b32 v192, v244
v_mov_b32 v193, v245
v_mov_b32 v194, v246
v_mov_b32 v195, v247
s_waitcnt lgkmcnt(14)
v_mfma_f32_32x32x16_bf16 v[96:111], a[184:187], a[76:79], v[96:111]
ds_read_b64_tr_b16 a[160:161], v20 offset:29824
ds_read_b64_tr_b16 a[162:163], v20 offset:31104
buffer_load_dwordx4 v3, s[12:15], s74 offen offset:1024 lds
v_mov_b32 v196, v248
v_mov_b32 v197, v249
v_mov_b32 v198, v250
v_mov_b32 v199, v251
v_permlane32_swap_b32 v244, v192
v_permlane32_swap_b32 v245, v193
v_mfma_f32_32x32x16_bf16 v[112:127], a[188:191], a[76:79], v[112:127]
ds_read_b64_tr_b16 a[164:165], v20 offset:29856
ds_read_b64_tr_b16 a[166:167], v20 offset:31136
v_permlane32_swap_b32 v246, v194
v_permlane32_swap_b32 v247, v195
v_permlane32_swap_b32 v248, v196
v_permlane32_swap_b32 v249, v197
v_permlane32_swap_b32 v250, v198
v_permlane32_swap_b32 v251, v199
v_add_f32 v244, v244, v192
v_mfma_f32_32x32x16_bf16 v[128:143], a[192:195], a[76:79], v[128:143]
ds_read_b64_tr_b16 a[168:169], v20 offset:29888
ds_read_b64_tr_b16 a[170:171], v20 offset:31168
buffer_load_dwordx4 v4, s[12:15], s74 offen offset:2048 lds
v_add_f32 v245, v245, v193
v_add_f32 v246, v246, v194
v_add_f32 v247, v247, v195
v_add_f32 v248, v248, v196
v_add_f32 v249, v249, v197
v_add_f32 v250, v250, v198
v_mfma_f32_32x32x16_bf16 v[144:159], a[196:199], a[76:79], v[144:159]
ds_read_b64_tr_b16 a[172:173], v20 offset:29920
ds_read_b64_tr_b16 a[174:175], v20 offset:31200
v_add_f32 v251, v251, v199
s_lshl_b32 s60, s48, 10
s_add_u32 s60, s60, 154112
v_lshlrev_b32 v192, 5, v1
v_add_u32 v192, s60, v192
v_and_b32 v193, 31, v1
v_mul_u32_u24 v193, 12, v193
v_add_u32 v193, s60, v193
s_mov_b64 s[82:83], exec
s_mov_b64 exec, 0xffff
ds_write_b128 v192, v[244:247]
ds_write_b128 v192, v[248:251] offset:16
s_mov_b64 exec, s[82:83]
v_mfma_f32_32x32x16_bf16 v[160:175], a[200:203], a[76:79], v[160:175]
ds_read_b64_tr_b16 a[176:177], v20 offset:29952
ds_read_b64_tr_b16 a[178:179], v20 offset:31232
buffer_load_dwordx4 v5, s[12:15], s74 offen offset:3072 lds
s_waitcnt lgkmcnt(2)
ds_read_b32 v196, v193
ds_read_b32 v197, v193 offset:4
ds_read_b32 v198, v193 offset:8
v_mov_b32 v199, v30
s_waitcnt lgkmcnt(0)
buffer_store_dwordx4 v[196:199], v94, s[24:27], 0 offen sc1
s_barrier
v_mfma_f32_32x32x16_bf16 v[96:111], a[208:211], a[80:83], v[96:111]
ds_read_b64_tr_b16 a[184:185], v20 offset:34944
ds_read_b64_tr_b16 a[186:187], v20 offset:36224
s_lshl_b32 s60, s48, 5
v_add_u32 v80, s60, v81
ds_read_b64_tr_b16 a[232:233], v80
ds_read_b64_tr_b16 a[234:235], v80 offset:1280
ds_read_b64_tr_b16 a[236:237], v81 offset:128
ds_read_b64_tr_b16 a[238:239], v81 offset:1408
s_lshl_b32 s60, s48, 10
s_add_u32 s60, s60, s99
s_add_u32 s60, s60, 5120
s_waitcnt lgkmcnt(2)
buffer_store_dwordx4 a[232:235], v22, s[24:27], s60 offen sc1
s_add_u32 s60, s99, 9216
s_cmp_eq_u32 s48, 0
s_cselect_b32 s60, s60, 17825792
s_waitcnt lgkmcnt(0)
buffer_store_dwordx4 a[236:239], v22, s[24:27], s60 offen sc1
v_mfma_f32_32x32x16_bf16 v[112:127], a[212:215], a[80:83], v[112:127]
ds_read_b64_tr_b16 a[188:189], v20 offset:34976
ds_read_b64_tr_b16 a[190:191], v20 offset:36256
s_add_u32 m0, s52, 78208
s_nop 0
buffer_load_dwordx4 v6, s[12:15], s74 offen lds
s_barrier
v_mfma_f32_32x32x16_bf16 v[128:143], a[216:219], a[80:83], v[128:143]
ds_read_b64_tr_b16 a[192:193], v20 offset:35008
ds_read_b64_tr_b16 a[194:195], v20 offset:36288
v_mfma_f32_32x32x16_bf16 v[144:159], a[220:223], a[80:83], v[144:159]
ds_read_b64_tr_b16 a[196:197], v20 offset:35040
ds_read_b64_tr_b16 a[198:199], v20 offset:36320
s_add_u32 m0, s53, 8192
s_add_u32 s75, s56, 1024
buffer_load_dwordx4 v12, s[8:11], s75 offen lds
v_mfma_f32_32x32x16_bf16 v[160:175], a[224:227], a[80:83], v[160:175]
ds_read_b64_tr_b16 a[200:201], v20 offset:35072
ds_read_b64_tr_b16 a[202:203], v20 offset:36352
v_mfma_f32_32x32x16_bf16 v[96:111], a[160:163], a[84:87], v[96:111]
ds_read_b64_tr_b16 a[208:209], v20 offset:40064
ds_read_b64_tr_b16 a[210:211], v20 offset:41344
buffer_load_dwordx4 v13, s[8:11], s75 offen offset:1024 lds
v_mfma_f32_32x32x16_bf16 v[112:127], a[164:167], a[84:87], v[112:127]
ds_read_b64_tr_b16 a[212:213], v20 offset:40096
ds_read_b64_tr_b16 a[214:215], v20 offset:41376
v_mfma_f32_32x32x16_bf16 v[128:143], a[168:171], a[84:87], v[128:143]
ds_read_b64_tr_b16 a[216:217], v20 offset:40128
ds_read_b64_tr_b16 a[218:219], v20 offset:41408
buffer_load_dwordx4 v14, s[8:11], s75 offen offset:2048 lds
v_mfma_f32_32x32x16_bf16 v[144:159], a[172:175], a[84:87], v[144:159]
ds_read_b64_tr_b16 a[220:221], v20 offset:40160
ds_read_b64_tr_b16 a[222:223], v20 offset:41440
v_mfma_f32_32x32x16_bf16 v[160:175], a[176:179], a[84:87], v[160:175]
ds_read_b64_tr_b16 a[224:225], v20 offset:40192
ds_read_b64_tr_b16 a[226:227], v20 offset:41472
buffer_load_dwordx4 v15, s[8:11], s75 offen offset:3072 lds
s_waitcnt vmcnt(16)
s_barrier
s_waitcnt lgkmcnt(10)
v_mfma_f32_32x32x16_bf16 v[96:111], a[184:187], a[88:91], v[96:111]
ds_read_b64_tr_b16 a[160:161], v21 offset:0
ds_read_b64_tr_b16 a[162:163], v21 offset:1280
ds_read_b128 a[96:99], v16 offset:0
v_mfma_f32_32x32x16_bf16 v[112:127], a[188:191], a[88:91], v[112:127]
ds_read_b64_tr_b16 a[164:165], v21 offset:32
ds_read_b64_tr_b16 a[166:167], v21 offset:1312
ds_read_b128 a[100:103], v17 offset:0
s_add_u32 s74, s54, 1966080
s_add_u32 m0, s52, 0
s_nop 0
buffer_load_dwordx4 v2, s[12:15], s74 offen lds
v_mfma_f32_32x32x16_bf16 v[128:143], a[192:195], a[88:91], v[128:143]
ds_read_b64_tr_b16 a[168:169], v21 offset:64
ds_read_b64_tr_b16 a[170:171], v21 offset:1344
ds_read_b128 a[104:107], v18 offset:0
v_mfma_f32_32x32x16_bf16 v[144:159], a[196:199], a[88:91], v[144:159]
ds_read_b64_tr_b16 a[172:173], v21 offset:96
ds_read_b64_tr_b16 a[174:175], v21 offset:1376
ds_read_b128 a[108:111], v19 offset:0
buffer_load_dwordx4 v3, s[12:15], s74 offen offset:1024 lds
v_mfma_f32_32x32x16_bf16 v[160:175], a[200:203], a[88:91], v[160:175]
ds_read_b64_tr_b16 a[176:177], v21 offset:128
ds_read_b64_tr_b16 a[178:179], v21 offset:1408
s_waitcnt lgkmcnt(14)
v_mfma_f32_32x32x16_bf16 v[96:111], a[208:211], a[92:95], v[96:111]
ds_read_b64_tr_b16 a[184:185], v21 offset:5120
ds_read_b64_tr_b16 a[186:187], v21 offset:6400
buffer_load_dwordx4 v4, s[12:15], s74 offen offset:2048 lds
v_mfma_f32_32x32x16_bf16 v[112:127], a[212:215], a[92:95], v[112:127]
ds_read_b64_tr_b16 a[188:189], v21 offset:5152
ds_read_b64_tr_b16 a[190:191], v21 offset:6432
v_mfma_f32_32x32x16_bf16 v[128:143], a[216:219], a[92:95], v[128:143]
ds_read_b64_tr_b16 a[192:193], v21 offset:5184
ds_read_b64_tr_b16 a[194:195], v21 offset:6464
buffer_load_dwordx4 v5, s[12:15], s74 offen offset:3072 lds
v_mfma_f32_32x32x16_bf16 v[144:159], a[220:223], a[92:95], v[144:159]
ds_read_b64_tr_b16 a[196:197], v21 offset:5216
ds_read_b64_tr_b16 a[198:199], v21 offset:6496
v_mfma_f32_32x32x16_bf16 v[160:175], a[224:227], a[92:95], v[160:175]
ds_read_b64_tr_b16 a[200:201], v21 offset:5248
ds_read_b64_tr_b16 a[202:203], v21 offset:6528
s_add_u32 m0, s52, 4096
s_nop 0
buffer_load_dwordx4 v6, s[12:15], s74 offen lds
s_waitcnt lgkmcnt(10)
v_mfma_f32_32x32x16_bf16 v[96:111], a[160:163], a[96:99], v[96:111]
ds_read_b64_tr_b16 a[208:209], v21 offset:10240
ds_read_b64_tr_b16 a[210:211], v21 offset:11520
v_mfma_f32_32x32x16_bf16 v[112:127], a[164:167], a[96:99], v[112:127]
ds_read_b64_tr_b16 a[212:213], v21 offset:10272
ds_read_b64_tr_b16 a[214:215], v21 offset:11552
s_add_u32 m0, s53, 0
s_add_u32 s75, s56, 1152
buffer_load_dwordx4 v12, s[8:11], s75 offen lds
v_mfma_f32_32x32x16_bf16 v[128:143], a[168:171], a[96:99], v[128:143]
ds_read_b64_tr_b16 a[216:217], v21 offset:10304
ds_read_b64_tr_b16 a[218:219], v21 offset:11584
v_mfma_f32_32x32x16_bf16 v[144:159], a[172:175], a[96:99], v[144:159]
ds_read_b64_tr_b16 a[220:221], v21 offset:10336
ds_read_b64_tr_b16 a[222:223], v21 offset:11616
buffer_load_dwordx4 v13, s[8:11], s75 offen offset:1024 lds
v_mfma_f32_32x32x16_bf16 v[160:175], a[176:179], a[96:99], v[160:175]
ds_read_b64_tr_b16 a[224:225], v21 offset:10368
ds_read_b64_tr_b16 a[226:227], v21 offset:11648
s_waitcnt lgkmcnt(10)
v_mfma_f32_32x32x16_bf16 v[96:111], a[184:187], a[100:103], v[96:111]
ds_read_b64_tr_b16 a[160:161], v21 offset:15360
ds_read_b64_tr_b16 a[162:163], v21 offset:16640
buffer_load_dwordx4 v14, s[8:11], s75 offen offset:2048 lds
v_mfma_f32_32x32x16_bf16 v[112:127], a[188:191], a[100:103], v[112:127]
ds_read_b64_tr_b16 a[164:165], v21 offset:15392
ds_read_b64_tr_b16 a[166:167], v21 offset:16672
v_mfma_f32_32x32x16_bf16 v[128:143], a[192:195], a[100:103], v[128:143]
ds_read_b64_tr_b16 a[168:169], v21 offset:15424
ds_read_b64_tr_b16 a[170:171], v21 offset:16704
buffer_load_dwordx4 v15, s[8:11], s75 offen offset:3072 lds
v_mfma_f32_32x32x16_bf16 v[144:159], a[196:199], a[100:103], v[144:159]
ds_read_b64_tr_b16 a[172:173], v21 offset:15456
ds_read_b64_tr_b16 a[174:175], v21 offset:16736
v_mfma_f32_32x32x16_bf16 v[160:175], a[200:203], a[100:103], v[160:175]
ds_read_b64_tr_b16 a[176:177], v21 offset:15488
ds_read_b64_tr_b16 a[178:179], v21 offset:16768
s_waitcnt vmcnt(13)
s_barrier
s_waitcnt lgkmcnt(10)
v_mfma_f32_32x32x16_bf16 v[96:111], a[208:211], a[104:107], v[96:111]
ds_read_b64_tr_b16 a[184:185], v21 offset:24704
ds_read_b64_tr_b16 a[186:187], v21 offset:25984
ds_read_b128 a[112:115], v16 offset:4096
v_mfma_f32_32x32x16_bf16 v[112:127], a[212:215], a[104:107], v[112:127]
ds_read_b64_tr_b16 a[188:189], v21 offset:24736
ds_read_b64_tr_b16 a[190:191], v21 offset:26016
ds_read_b128 a[116:119], v17 offset:4096
s_add_u32 s74, s54, 2211840
s_add_u32 m0, s52, 24704
s_nop 0
buffer_load_dwordx4 v2, s[12:15], s74 offen lds
v_mfma_f32_32x32x16_bf16 v[128:143], a[216:219], a[104:107], v[128:143]
ds_read_b64_tr_b16 a[192:193], v21 offset:24768
ds_read_b64_tr_b16 a[194:195], v21 offset:26048
ds_read_b128 a[120:123], v18 offset:4096
v_mfma_f32_32x32x16_bf16 v[144:159], a[220:223], a[104:107], v[144:159]
ds_read_b64_tr_b16 a[196:197], v21 offset:24800
ds_read_b64_tr_b16 a[198:199], v21 offset:26080
ds_read_b128 a[124:127], v19 offset:4096
buffer_load_dwordx4 v3, s[12:15], s74 offen offset:1024 lds
v_mfma_f32_32x32x16_bf16 v[160:175], a[224:227], a[104:107], v[160:175]
ds_read_b64_tr_b16 a[200:201], v21 offset:24832
ds_read_b64_tr_b16 a[202:203], v21 offset:26112
s_waitcnt lgkmcnt(14)
v_mfma_f32_32x32x16_bf16 v[96:111], a[160:163], a[108:111], v[96:111]
ds_read_b64_tr_b16 a[208:209], v21 offset:29824
ds_read_b64_tr_b16 a[210:211], v21 offset:31104
buffer_load_dwordx4 v4, s[12:15], s74 offen offset:2048 lds
v_mfma_f32_32x32x16_bf16 v[112:127], a[164:167], a[108:111], v[112:127]
ds_read_b64_tr_b16 a[212:213], v21 offset:29856
ds_read_b64_tr_b16 a[214:215], v21 offset:31136
v_mfma_f32_32x32x16_bf16 v[128:143], a[168:171], a[108:111], v[128:143]
ds_read_b64_tr_b16 a[216:217], v21 offset:29888
ds_read_b64_tr_b16 a[218:219], v21 offset:31168
buffer_load_dwordx4 v5, s[12:15], s74 offen offset:3072 lds
v_mfma_f32_32x32x16_bf16 v[144:159], a[172:175], a[108:111], v[144:159]
ds_read_b64_tr_b16 a[220:221], v21 offset:29920
ds_read_b64_tr_b16 a[222:223], v21 offset:31200
v_mfma_f32_32x32x16_bf16 v[160:175], a[176:179], a[108:111], v[160:175]
ds_read_b64_tr_b16 a[224:225], v21 offset:29952
ds_read_b64_tr_b16 a[226:227], v21 offset:31232
s_add_u32 m0, s52, 28800
s_nop 0
buffer_load_dwordx4 v6, s[12:15], s74 offen lds
s_waitcnt lgkmcnt(10)
v_mfma_f32_32x32x16_bf16 v[96:111], a[184:187], a[112:115], v[96:111]
ds_read_b64_tr_b16 a[160:161], v21 offset:34944
ds_read_b64_tr_b16 a[162:163], v21 offset:36224
v_mfma_f32_32x32x16_bf16 v[112:127], a[188:191], a[112:115], v[112:127]
ds_read_b64_tr_b16 a[164:165], v21 offset:34976
ds_read_b64_tr_b16 a[166:167], v21 offset:36256
v_mfma_f32_32x32x16_bf16 v[128:143], a[192:195], a[112:115], v[128:143]
ds_read_b64_tr_b16 a[168:169], v21 offset:35008
ds_read_b64_tr_b16 a[170:171], v21 offset:36288
v_mfma_f32_32x32x16_bf16 v[144:159], a[196:199], a[112:115], v[144:159]
ds_read_b64_tr_b16 a[172:173], v21 offset:35040
ds_read_b64_tr_b16 a[174:175], v21 offset:36320
v_mfma_f32_32x32x16_bf16 v[160:175], a[200:203], a[112:115], v[160:175]
ds_read_b64_tr_b16 a[176:177], v21 offset:35072
ds_read_b64_tr_b16 a[178:179], v21 offset:36352
s_waitcnt lgkmcnt(10)
v_mfma_f32_32x32x16_bf16 v[96:111], a[208:211], a[116:119], v[96:111]
ds_read_b64_tr_b16 a[184:185], v21 offset:40064
ds_read_b64_tr_b16 a[186:187], v21 offset:41344
v_mfma_f32_32x32x16_bf16 v[112:127], a[212:215], a[116:119], v[112:127]
ds_read_b64_tr_b16 a[188:189], v21 offset:40096
ds_read_b64_tr_b16 a[190:191], v21 offset:41376
v_mfma_f32_32x32x16_bf16 v[128:143], a[216:219], a[116:119], v[128:143]
ds_read_b64_tr_b16 a[192:193], v21 offset:40128
ds_read_b64_tr_b16 a[194:195], v21 offset:41408
v_mfma_f32_32x32x16_bf16 v[144:159], a[220:223], a[116:119], v[144:159]
ds_read_b64_tr_b16 a[196:197], v21 offset:40160
ds_read_b64_tr_b16 a[198:199], v21 offset:41440
v_mfma_f32_32x32x16_bf16 v[160:175], a[224:227], a[116:119], v[160:175]
ds_read_b64_tr_b16 a[200:201], v21 offset:40192
ds_read_b64_tr_b16 a[202:203], v21 offset:41472
v_and_b32 v36, 31, v1
v_lshrrev_b32 v37, 1, v36
v_lshlrev_b32 v37, 7, v37
v_and_b32 v38, 1, v36
v_lshl_add_u32 v41, v38, 4, v37
s_lshl_b32 s47, s49, 2
s_add_u32 s47, s47, s48
s_lshl_b32 s47, s47, 11
s_add_u32 s47, s47, 14680064
s_lshl_b32 s46, s50, 15
s_lshl_b32 s60, s48, 9
s_add_u32 s46, s46, s60
s_add_u32 s46, s46, 15728640
s_waitcnt vmcnt(9)
s_barrier
s_waitcnt lgkmcnt(10)
v_mfma_f32_32x32x16_bf16 v[96:111], a[160:163], a[120:123], v[96:111]
ds_read_b64_tr_b16 a[208:209], v20 offset:0
ds_read_b64_tr_b16 a[210:211], v20 offset:1280
ds_read_b128 a[128:131], v16 offset:8192
v_lshrrev_b32 v37, 5, v1
v_lshlrev_b32 v37, 14, v37
v_lshl_add_u32 v37, v36, 4, v37
v_add_u32 v38, 4096, v37
v_add_u32 v39, 8192, v37
v_add_u32 v40, 12288, v37
v_mfma_f32_32x32x16_bf16 v[112:127], a[164:167], a[120:123], v[112:127]
ds_read_b64_tr_b16 a[212:213], v20 offset:32
ds_read_b64_tr_b16 a[214:215], v20 offset:1312
ds_read_b128 a[132:135], v17 offset:8192
s_add_u32 s74, s55, 0
s_add_u32 m0, s80, 49408
s_nop 0
buffer_load_dwordx4 v7, s[16:19], s74 offen lds
v_mov_b32 v36, v41
buffer_load_dwordx4 v[44:47], v36, s[24:27], s47 offen sc1
v_mfma_f32_32x32x16_bf16 v[128:143], a[168:171], a[120:123], v[128:143]
ds_read_b64_tr_b16 a[216:217], v20 offset:64
ds_read_b64_tr_b16 a[218:219], v20 offset:1344
ds_read_b128 a[136:139], v18 offset:8192
buffer_load_dwordx4 v[48:51], v37, s[24:27], s46 offen sc1
buffer_load_dwordx4 v[52:55], v37, s[24:27], s46 offen offset:2048 sc1
buffer_load_dwordx4 v[56:59], v38, s[24:27], s46 offen sc1
buffer_load_dwordx4 v[60:63], v38, s[24:27], s46 offen offset:2048 sc1
buffer_load_dwordx4 v[64:67], v39, s[24:27], s46 offen sc1
buffer_load_dwordx4 v[68:71], v39, s[24:27], s46 offen offset:2048 sc1
v_mfma_f32_32x32x16_bf16 v[144:159], a[172:175], a[120:123], v[144:159]
ds_read_b64_tr_b16 a[220:221], v20 offset:96
ds_read_b64_tr_b16 a[222:223], v20 offset:1376
ds_read_b128 a[140:143], v19 offset:8192
buffer_load_dwordx4 v8, s[16:19], s74 offen offset:1024 lds
buffer_load_dwordx4 v[72:75], v40, s[24:27], s46 offen sc1
buffer_load_dwordx4 v[76:79], v40, s[24:27], s46 offen offset:2048 sc1
v_mfma_f32_32x32x16_bf16 v[160:175], a[176:179], a[120:123], v[160:175]
ds_read_b64_tr_b16 a[224:225], v20 offset:128
ds_read_b64_tr_b16 a[226:227], v20 offset:1408
s_waitcnt lgkmcnt(14)
v_mfma_f32_32x32x16_bf16 v[96:111], a[184:187], a[124:127], v[96:111]
ds_read_b64_tr_b16 a[160:161], v20 offset:5120
ds_read_b64_tr_b16 a[162:163], v20 offset:6400
buffer_load_dwordx4 v9, s[16:19], s74 offen offset:2048 lds
v_mfma_f32_32x32x16_bf16 v[112:127], a[188:191], a[124:127], v[112:127]
ds_read_b64_tr_b16 a[164:165], v20 offset:5152
ds_read_b64_tr_b16 a[166:167], v20 offset:6432
v_mfma_f32_32x32x16_bf16 v[128:143], a[192:195], a[124:127], v[128:143]
ds_read_b64_tr_b16 a[168:169], v20 offset:5184
ds_read_b64_tr_b16 a[170:171], v20 offset:6464
buffer_load_dwordx4 v10, s[16:19], s74 offen offset:3072 lds
v_mfma_f32_32x32x16_bf16 v[144:159], a[196:199], a[124:127], v[144:159]
ds_read_b64_tr_b16 a[172:173], v20 offset:5216
ds_read_b64_tr_b16 a[174:175], v20 offset:6496
v_mfma_f32_32x32x16_bf16 v[160:175], a[200:203], a[124:127], v[160:175]
ds_read_b64_tr_b16 a[176:177], v20 offset:5248
ds_read_b64_tr_b16 a[178:179], v20 offset:6528
s_waitcnt lgkmcnt(10)
v_mfma_f32_32x32x16_bf16 v[96:111], a[208:211], a[128:131], v[96:111]
ds_read_b64_tr_b16 a[184:185], v20 offset:10240
ds_read_b64_tr_b16 a[186:187], v20 offset:11520
v_mfma_f32_32x32x16_bf16 v[112:127], a[212:215], a[128:131], v[112:127]
ds_read_b64_tr_b16 a[188:189], v20 offset:10272
ds_read_b64_tr_b16 a[190:191], v20 offset:11552
v_mfma_f32_32x32x16_bf16 v[128:143], a[216:219], a[128:131], v[128:143]
ds_read_b64_tr_b16 a[192:193], v20 offset:10304
ds_read_b64_tr_b16 a[194:195], v20 offset:11584
v_mfma_f32_32x32x16_bf16 v[144:159], a[220:223], a[128:131], v[144:159]
ds_read_b64_tr_b16 a[196:197], v20 offset:10336
ds_read_b64_tr_b16 a[198:199], v20 offset:11616
v_mfma_f32_32x32x16_bf16 v[160:175], a[224:227], a[128:131], v[160:175]
ds_read_b64_tr_b16 a[200:201], v20 offset:10368
ds_read_b64_tr_b16 a[202:203], v20 offset:11648
s_waitcnt lgkmcnt(10)
v_mfma_f32_32x32x16_bf16 v[96:111], a[160:163], a[132:135], v[96:111]
ds_read_b64_tr_b16 a[208:209], v20 offset:15360
ds_read_b64_tr_b16 a[210:211], v20 offset:16640
v_mfma_f32_32x32x16_bf16 v[112:127], a[164:167], a[132:135], v[112:127]
ds_read_b64_tr_b16 a[212:213], v20 offset:15392
ds_read_b64_tr_b16 a[214:215], v20 offset:16672
v_mfma_f32_32x32x16_bf16 v[128:143], a[168:171], a[132:135], v[128:143]
ds_read_b64_tr_b16 a[216:217], v20 offset:15424
ds_read_b64_tr_b16 a[218:219], v20 offset:16704
v_mfma_f32_32x32x16_bf16 v[144:159], a[172:175], a[132:135], v[144:159]
ds_read_b64_tr_b16 a[220:221], v20 offset:15456
ds_read_b64_tr_b16 a[222:223], v20 offset:16736
v_mfma_f32_32x32x16_bf16 v[160:175], a[176:179], a[132:135], v[160:175]
ds_read_b64_tr_b16 a[224:225], v20 offset:15488
ds_read_b64_tr_b16 a[226:227], v20 offset:16768
s_waitcnt vmcnt(13)
s_barrier
s_waitcnt lgkmcnt(10)
v_mfma_f32_32x32x16_bf16 v[96:111], a[184:187], a[136:139], v[96:111]
ds_read_b64_tr_b16 a[160:161], v20 offset:24704
ds_read_b64_tr_b16 a[162:163], v20 offset:25984
ds_read_b128 a[144:147], v16 offset:0
v_mfma_f32_32x32x16_bf16 v[112:127], a[188:191], a[136:139], v[112:127]
ds_read_b64_tr_b16 a[164:165], v20 offset:24736
ds_read_b64_tr_b16 a[166:167], v20 offset:26016
ds_read_b128 a[148:151], v17 offset:0
s_add_u32 s74, s55, 196608
s_add_u32 m0, s80, 74112
s_nop 0
buffer_load_dwordx4 v7, s[16:19], s74 offen lds
v_mfma_f32_32x32x16_bf16 v[128:143], a[192:195], a[136:139], v[128:143]
ds_read_b64_tr_b16 a[168:169], v20 offset:24768
ds_read_b64_tr_b16 a[170:171], v20 offset:26048
ds_read_b128 a[152:155], v18 offset:0
v_mfma_f32_32x32x16_bf16 v[144:159], a[196:199], a[136:139], v[144:159]
ds_read_b64_tr_b16 a[172:173], v20 offset:24800
ds_read_b64_tr_b16 a[174:175], v20 offset:26080
ds_read_b128 a[156:159], v19 offset:0
buffer_load_dwordx4 v8, s[16:19], s74 offen offset:1024 lds
v_mfma_f32_32x32x16_bf16 v[160:175], a[200:203], a[136:139], v[160:175]
ds_read_b64_tr_b16 a[176:177], v20 offset:24832
ds_read_b64_tr_b16 a[178:179], v20 offset:26112
s_waitcnt lgkmcnt(14)
v_mfma_f32_32x32x16_bf16 v[96:111], a[208:211], a[140:143], v[96:111]
ds_read_b64_tr_b16 a[184:185], v20 offset:29824
ds_read_b64_tr_b16 a[186:187], v20 offset:31104
buffer_load_dwordx4 v9, s[16:19], s74 offen offset:2048 lds
v_mfma_f32_32x32x16_bf16 v[112:127], a[212:215], a[140:143], v[112:127]
ds_read_b64_tr_b16 a[188:189], v20 offset:29856
ds_read_b64_tr_b16 a[190:191], v20 offset:31136
v_mfma_f32_32x32x16_bf16 v[128:143], a[216:219], a[140:143], v[128:143]
ds_read_b64_tr_b16 a[192:193], v20 offset:29888
ds_read_b64_tr_b16 a[194:195], v20 offset:31168
buffer_load_dwordx4 v10, s[16:19], s74 offen offset:3072 lds
v_mfma_f32_32x32x16_bf16 v[144:159], a[220:223], a[140:143], v[144:159]
ds_read_b64_tr_b16 a[196:197], v20 offset:29920
ds_read_b64_tr_b16 a[198:199], v20 offset:31200
v_mfma_f32_32x32x16_bf16 v[160:175], a[224:227], a[140:143], v[160:175]
ds_read_b64_tr_b16 a[200:201], v20 offset:29952
ds_read_b64_tr_b16 a[202:203], v20 offset:31232
s_waitcnt lgkmcnt(10)
v_mfma_f32_32x32x16_bf16 v[96:111], a[160:163], a[144:147], v[96:111]
ds_read_b64_tr_b16 a[208:209], v20 offset:34944
ds_read_b64_tr_b16 a[210:211], v20 offset:36224
v_mfma_f32_32x32x16_bf16 v[112:127], a[164:167], a[144:147], v[112:127]
ds_read_b64_tr_b16 a[212:213], v20 offset:34976
ds_read_b64_tr_b16 a[214:215], v20 offset:36256
v_mfma_f32_32x32x16_bf16 v[128:143], a[168:171], a[144:147], v[128:143]
ds_read_b64_tr_b16 a[216:217], v20 offset:35008
ds_read_b64_tr_b16 a[218:219], v20 offset:36288
v_mfma_f32_32x32x16_bf16 v[144:159], a[172:175], a[144:147], v[144:159]
ds_read_b64_tr_b16 a[220:221], v20 offset:35040
ds_read_b64_tr_b16 a[222:223], v20 offset:36320
v_mfma_f32_32x32x16_bf16 v[160:175], a[176:179], a[144:147], v[160:175]
ds_read_b64_tr_b16 a[224:225], v20 offset:35072
ds_read_b64_tr_b16 a[226:227], v20 offset:36352
s_waitcnt vmcnt(15)
v_xor_b32 v41, v46, v30
s_waitcnt vmcnt(14)
v_xor_b32 v42, v51, v30
v_or_b32 v41, v41, v42
s_waitcnt vmcnt(13)
v_xor_b32 v42, v55, v30
v_or_b32 v41, v41, v42
s_waitcnt vmcnt(12)
v_xor_b32 v42, v59, v30
v_or_b32 v41, v41, v42
s_waitcnt vmcnt(11)
v_xor_b32 v42, v63, v30
v_or_b32 v41, v41, v42
s_waitcnt vmcnt(10)
v_xor_b32 v42, v67, v30
v_or_b32 v41, v41, v42
s_waitcnt vmcnt(9)
v_xor_b32 v42, v71, v30
v_or_b32 v41, v41, v42
s_waitcnt vmcnt(7)
v_xor_b32 v42, v75, v30
v_or_b32 v41, v41, v42
s_waitcnt vmcnt(6)
v_xor_b32 v42, v79, v30
v_or_b32 v41, v41, v42
v_cmp_ne_u32 vcc, 0, v41
s_nop 3
s_cbranch_vccz COKQ
s_mov_b32 s68, 4000
CSPQ:
s_sleep 8
buffer_load_dwordx4 v[44:47], v36, s[24:27], s47 offen sc1
buffer_load_dwordx4 v[48:51], v37, s[24:27], s46 offen sc1
buffer_load_dwordx4 v[52:55], v37, s[24:27], s46 offen offset:2048 sc1
buffer_load_dwordx4 v[56:59], v38, s[24:27], s46 offen sc1
buffer_load_dwordx4 v[60:63], v38, s[24:27], s46 offen offset:2048 sc1
buffer_load_dwordx4 v[64:67], v39, s[24:27], s46 offen sc1
buffer_load_dwordx4 v[68:71], v39, s[24:27], s46 offen offset:2048 sc1
buffer_load_dwordx4 v[72:75], v40, s[24:27], s46 offen sc1
buffer_load_dwordx4 v[76:79], v40, s[24:27], s46 offen offset:2048 sc1
s_waitcnt vmcnt(0)
v_xor_b32 v41, v46, v30
v_xor_b32 v42, v51, v30
v_or_b32 v41, v41, v42
v_xor_b32 v42, v55, v30
v_or_b32 v41, v41, v42
v_xor_b32 v42, v59, v30
v_or_b32 v41, v41, v42
v_xor_b32 v42, v63, v30
v_or_b32 v41, v41, v42
v_xor_b32 v42, v67, v30
v_or_b32 v41, v41, v42
v_xor_b32 v42, v71, v30
v_or_b32 v41, v41, v42
v_xor_b32 v42, v75, v30
v_or_b32 v41, v41, v42
v_xor_b32 v42, v79, v30
v_or_b32 v41, v41, v42
v_cmp_ne_u32 vcc, 0, v41
s_sub_u32 s68, s68, 1
s_nop 2
s_cbranch_vccz COKQ
s_cmp_lg_u32 s68, 0
s_cbranch_scc1 CSPQ
COKQ:
s_waitcnt lgkmcnt(10)
v_mfma_f32_32x32x16_bf16 v[96:111], a[184:187], a[148:151], v[96:111]
ds_read_b64_tr_b16 a[160:161], v20 offset:40064
ds_read_b64_tr_b16 a[162:163], v20 offset:41344
v_add_f32 v48, v48, v64
v_add_f32 v49, v49, v65
v_add_f32 v50, v50, v66
v_add_f32 v52, v52, v68
v_add_f32 v53, v53, v69
v_add_f32 v54, v54, v70
v_add_f32 v56, v56, v72
v_mfma_f32_32x32x16_bf16 v[112:127], a[188:191], a[148:151], v[112:127]
ds_read_b64_tr_b16 a[164:165], v20 offset:40096
ds_read_b64_tr_b16 a[166:167], v20 offset:41376
v_add_f32 v57, v57, v73
v_add_f32 v58, v58, v74
v_add_f32 v60, v60, v76
v_add_f32 v61, v61, v77
v_add_f32 v62, v62, v78
v_add_f32 v48, v48, v56
v_add_f32 v49, v49, v57
v_mfma_f32_32x32x16_bf16 v[128:143], a[192:195], a[148:151], v[128:143]
ds_read_b64_tr_b16 a[168:169], v20 offset:40128
ds_read_b64_tr_b16 a[170:171], v20 offset:41408
v_add_f32 v50, v50, v58
v_add_f32 v52, v52, v60
v_add_f32 v53, v53, v61
v_add_f32 v54, v54, v62
v_add_f32 v48, v48, v52
v_add_f32 v49, v49, v53
v_add_f32 v50, v50, v54
v_mfma_f32_32x32x16_bf16 v[144:159], a[196:199], a[148:151], v[144:159]
ds_read_b64_tr_b16 a[172:173], v20 offset:40160
ds_read_b64_tr_b16 a[174:175], v20 offset:41440
v_mov_b32 v52, v48
v_mov_b32 v53, v49
v_mov_b32 v54, v50
v_permlane32_swap_b32 v48, v52
v_permlane32_swap_b32 v49, v53
v_permlane32_swap_b32 v50, v54
v_add_f32 v48, v48, v52
v_mfma_f32_32x32x16_bf16 v[160:175], a[200:203], a[148:151], v[160:175]
ds_read_b64_tr_b16 a[176:177], v20 offset:40192
ds_read_b64_tr_b16 a[178:179], v20 offset:41472
v_add_f32 v49, v49, v53
v_add_f32 v50, v50, v54
v_mov_b32 v24, v44
v_mov_b32 v25, v45
s_mul_i32 s60, s48, 400
s_add_u32 s60, s60, 158208
v_mul_u32_u24 v36, 12, v1
v_add_u32 v36, s60, v36
s_mov_b64 s[82:83], exec
s_mov_b64 exec, 0xffffffff
ds_write_b32 v36, v48 offset:0
ds_write_b32 v36, v49 offset:4
ds_write_b32 v36, v50 offset:8
s_mov_b64 exec, s[82:83]
s_waitcnt vmcnt(4)
s_barrier
s_waitcnt lgkmcnt(13)
v_mfma_f32_32x32x16_bf16 v[96:111], a[208:211], a[152:155], v[96:111]
ds_read_b64_tr_b16 a[184:185], v85 offset:0
ds_read_b64_tr_b16 a[186:187], v85 offset:512
v_and_b32 v36, 31, v1
v_lshlrev_b32 v36, 2, v36
s_lshl_b32 s60, s48, 7
s_add_u32 s60, s60, 159808
v_add_u32 v36, s60, v36
ds_write_b32 v36, v24
ds_write_b32 v36, v25 offset:512
v_mfma_f32_32x32x16_bf16 v[112:127], a[212:215], a[152:155], v[112:127]
ds_read_b64_tr_b16 a[188:189], v87 offset:0
ds_read_b64_tr_b16 a[190:191], v87 offset:512
s_add_u32 s74, s55, 393216
s_add_u32 m0, s80, 0
s_nop 0
buffer_load_dwordx4 v7, s[16:19], s74 offen lds
v_sub_f32 v24, 0, v24
v_mul_f32 v28, s84, v25
v_mul_f32 v27, v25, v25
v_mfma_f32_32x32x16_bf16 v[128:143], a[216:219], a[152:155], v[128:143]
ds_read_b64_tr_b16 a[192:193], v89 offset:0
ds_read_b64_tr_b16 a[194:195], v89 offset:512
v_sub_f32 v26, 0, v28
v_rcp_f32 v27, v27
v_cvt_pk_bf16_f32 v36, v24, v24
v_lshlrev_b32 v37, 16, v36
v_sub_f32 v37, v24, v37
v_cvt_pk_bf16_f32 v36, v24, v37
v_and_b32 v38, 15, v1
v_mfma_f32_32x32x16_bf16 v[144:159], a[220:223], a[152:155], v[144:159]
ds_read_b64_tr_b16 a[196:197], v91 offset:0
ds_read_b64_tr_b16 a[198:199], v91 offset:512
buffer_load_dwordx4 v8, s[16:19], s74 offen offset:1024 lds
v_bfe_u32 v39, v1, 4, 1
v_mul_u32_u24 v39, 100, v39
v_add_u32 v38, v38, v39
v_lshlrev_b32 v23, 2, v38
v_add_u32 v23, 131072, v23
v_cmp_gt_u32 vcc, 32, v1
s_nop 1
v_cndmask_b32 v36, 0, v36, vcc
v_mov_b32 v37, 0
v_accvgpr_write_b32 a244, v36
v_accvgpr_write_b32 a245, v36
v_accvgpr_write_b32 a246, v37
v_accvgpr_write_b32 a247, v37
v_mfma_f32_32x32x16_bf16 v[160:175], a[224:227], a[152:155], v[160:175]
s_waitcnt lgkmcnt(6)
s_barrier
s_barrier
s_lshl_b32 s60, s97, 7
s_add_u32 s60, s60, 12550144
s_cmp_eq_u32 s48, 0
s_cselect_b32 s60, s60, 17825792
v_mov_b32 v80, v30
v_mov_b32 v81, v30
v_mov_b32 v82, v30
v_mov_b32 v83, v30
v_cmp_gt_u32 vcc, 8, v1
s_nop 1
v_cndmask_b32 v93, v31, v22, vcc
buffer_store_dwordx4 v[80:83], v93, s[24:27], s60 offen sc1
v_mfma_f32_32x32x16_bf16 v[96:111], a[160:163], a[156:159], v[96:111]
ds_read_b64_tr_b16 a[208:209], v85 offset:2048
ds_read_b64_tr_b16 a[210:211], v85 offset:2560
buffer_load_dwordx4 v9, s[16:19], s74 offen offset:2048 lds
v_mfma_f32_32x32x16_bf16 v[112:127], a[164:167], a[156:159], v[112:127]
ds_read_b64_tr_b16 a[212:213], v87 offset:2048
ds_read_b64_tr_b16 a[214:215], v87 offset:2560
v_mfma_f32_32x32x16_bf16 v[128:143], a[168:171], a[156:159], v[128:143]
ds_read_b64_tr_b16 a[216:217], v89 offset:2048
ds_read_b64_tr_b16 a[218:219], v89 offset:2560
buffer_load_dwordx4 v10, s[16:19], s74 offen offset:3072 lds
v_mfma_f32_32x32x16_bf16 v[144:159], a[172:175], a[156:159], v[144:159]
ds_read_b64_tr_b16 a[220:221], v91 offset:2048
ds_read_b64_tr_b16 a[222:223], v91 offset:2560
v_mfma_f32_32x32x16_bf16 v[160:175], a[176:179], a[156:159], v[160:175]
s_waitcnt lgkmcnt(8)
v_mfma_f32_32x32x16_bf16 v[176:191], a[184:187], a[0:3], 0
ds_read_b64_tr_b16 a[160:161], v85 offset:4096
ds_read_b64_tr_b16 a[162:163], v85 offset:4608
v_mfma_f32_32x32x16_bf16 v[192:207], a[188:191], a[0:3], 0
ds_read_b64_tr_b16 a[164:165], v87 offset:4096
ds_read_b64_tr_b16 a[166:167], v87 offset:4608
v_mfma_f32_32x32x16_bf16 v[208:223], a[192:195], a[0:3], 0
ds_read_b64_tr_b16 a[168:169], v89 offset:4096
ds_read_b64_tr_b16 a[170:171], v89 offset:4608
v_mov_b32 v34, 0
v_mov_b32 v35, 0
v_mov_b32 v38, 0
v_mov_b32 v39, 0
v_mfma_f32_32x32x16_bf16 v[224:239], a[196:199], a[0:3], 0
ds_read_b64_tr_b16 a[172:173], v91 offset:4096
ds_read_b64_tr_b16 a[174:175], v91 offset:4608
ds_read_b32 v40, v23 offset:27136
ds_read_b32 v41, v23 offset:27200
ds_read_b32 v42, v23 offset:27264
ds_read_b32 v43, v23 offset:27328
s_waitcnt lgkmcnt(12)
v_mfma_f32_32x32x16_bf16 v[176:191], a[208:211], a[4:7], v[176:191]
ds_read_b64_tr_b16 a[184:185], v85 offset:6144
ds_read_b64_tr_b16 a[186:187], v85 offset:6656
ds_read_b32 v44, v23 offset:27392
s_waitcnt lgkmcnt(6)
v_cvt_pk_bf16_f32 v32, v40, v40
v_lshlrev_b32 v46, 16, v32
v_sub_f32 v46, v40, v46
v_mfma_f32_32x32x16_bf16 v[192:207], a[212:215], a[4:7], v[192:207]
ds_read_b64_tr_b16 a[188:189], v87 offset:6144
ds_read_b64_tr_b16 a[190:191], v87 offset:6656
v_cvt_pk_bf16_f32 v33, v46, v46
s_nop 1
v_mfma_f32_32x32x16_bf16 v[96:111], v[32:35], a[244:247], v[96:111]
s_waitcnt lgkmcnt(7)
v_cvt_pk_bf16_f32 v36, v41, v41
v_lshlrev_b32 v47, 16, v36
v_mfma_f32_32x32x16_bf16 v[208:223], a[216:219], a[4:7], v[208:223]
ds_read_b64_tr_b16 a[192:193], v89 offset:6144
ds_read_b64_tr_b16 a[194:195], v89 offset:6656
v_sub_f32 v47, v41, v47
v_cvt_pk_bf16_f32 v37, v47, v47
s_nop 1
v_mfma_f32_32x32x16_bf16 v[112:127], v[36:39], a[244:247], v[112:127]
s_waitcnt lgkmcnt(8)
v_cvt_pk_bf16_f32 v32, v42, v42
v_mfma_f32_32x32x16_bf16 v[224:239], a[220:223], a[4:7], v[224:239]
ds_read_b64_tr_b16 a[196:197], v91 offset:6144
ds_read_b64_tr_b16 a[198:199], v91 offset:6656
v_lshlrev_b32 v46, 16, v32
v_sub_f32 v46, v42, v46
v_cvt_pk_bf16_f32 v33, v46, v46
s_nop 1
v_mfma_f32_32x32x16_bf16 v[128:143], v[32:35], a[244:247], v[128:143]
s_waitcnt vmcnt(5)
s_barrier
v_mfma_f32_32x32x16_bf16 v[176:191], a[160:163], a[8:11], v[176:191]
ds_read_b64_tr_b16 a[208:209], v85 offset:24704
ds_read_b64_tr_b16 a[210:211], v85 offset:25216
s_waitcnt lgkmcnt(11)
v_cvt_pk_bf16_f32 v36, v43, v43
v_lshlrev_b32 v47, 16, v36
v_sub_f32 v47, v43, v47
v_cvt_pk_bf16_f32 v37, v47, v47
v_mfma_f32_32x32x16_bf16 v[192:207], a[164:167], a[8:11], v[192:207]
ds_read_b64_tr_b16 a[212:213], v87 offset:24704
ds_read_b64_tr_b16 a[214:215], v87 offset:25216
s_add_u32 s74, s55, 589824
s_add_u32 m0, s80, 24704
s_nop 0
buffer_load_dwordx4 v7, s[16:19], s74 offen lds
v_mfma_f32_32x32x16_bf16 v[208:223], a[168:171], a[8:11], v[208:223]
ds_read_b64_tr_b16 a[216:217], v89 offset:24704
ds_read_b64_tr_b16 a[218:219], v89 offset:25216
v_mfma_f32_32x32x16_bf16 v[144:159], v[36:39], a[244:247], v[144:159]
s_waitcnt lgkmcnt(12)
v_cvt_pk_bf16_f32 v32, v44, v44
v_lshlrev_b32 v46, 16, v32
v_sub_f32 v46, v44, v46
v_mfma_f32_32x32x16_bf16 v[224:239], a[172:175], a[8:11], v[224:239]
ds_read_b64_tr_b16 a[220:221], v91 offset:24704
ds_read_b64_tr_b16 a[222:223], v91 offset:25216
buffer_load_dwordx4 v8, s[16:19], s74 offen offset:1024 lds
v_cvt_pk_bf16_f32 v33, v46, v46
s_nop 1
v_mfma_f32_32x32x16_bf16 v[160:175], v[32:35], a[244:247], v[160:175]
v_mul_f32 v64, v28, v96
s_waitcnt lgkmcnt(8)
v_mfma_f32_32x32x16_bf16 v[176:191], a[184:187], a[12:15], v[176:191]
ds_read_b64_tr_b16 a[160:161], v85 offset:26752
ds_read_b64_tr_b16 a[162:163], v85 offset:27264
v_mul_f32 v65, v28, v97
v_mul_f32 v66, v28, v98
v_mul_f32 v67, v28, v99
v_mul_f32 v68, v28, v100
v_mfma_f32_32x32x16_bf16 v[192:207], a[188:191], a[12:15], v[192:207]
ds_read_b64_tr_b16 a[164:165], v87 offset:26752
ds_read_b64_tr_b16 a[166:167], v87 offset:27264
buffer_load_dwordx4 v9, s[16:19], s74 offen offset:2048 lds
v_mul_f32 v69, v28, v101
s_and_b32 s60, s2, 7
s_lshr_b32 s61, s2, 3
s_lshl_b32 s40, s60, 2
s_and_b32 s62, s61, 3
s_add_u32 s40, s40, s62
s_lshr_b32 s41, s61, 2
s_and_b32 s44, s2, 31
s_lshr_b32 s45, s2, 5
s_mul_i32 s60, s41, 245760
s_add_u32 s60, s60, 9437184
s_add_u32 s12, s24, s60
s_addc_u32 s13, s25, 0
s_mov_b32 s14, 245760
s_mov_b32 s15, 0x20000
s_lshl_b32 s42, s48, 11
s_mul_i32 s43, s48, 5120
v_mfma_f32_32x32x16_bf16 v[208:223], a[192:195], a[12:15], v[208:223]
ds_read_b64_tr_b16 a[168:169], v89 offset:26752
ds_read_b64_tr_b16 a[170:171], v89 offset:27264
v_lshlrev_b32 v4, 4, v1
v_add_u32 v5, 4096, v4
v_lshlrev_b32 v12, 3, v1
v_add_u32 v12, s41, v12
v_lshlrev_b32 v12, 7, v12
v_cmp_gt_u32 vcc, 24, v1
s_nop 1
v_cndmask_b32 v12, v31, v12, vcc
v_mfma_f32_32x32x16_bf16 v[224:239], a[196:199], a[12:15], v[224:239]
ds_read_b64_tr_b16 a[172:173], v91 offset:26752
ds_read_b64_tr_b16 a[174:175], v91 offset:27264
buffer_load_dwordx4 v10, s[16:19], s74 offen offset:3072 lds
s_mov_b32 s75, 12550144
s_cmp_eq_u32 s48, 0
s_cselect_b32 s75, s75, 17825792
buffer_load_dword v13, v12, s[24:27], s75 offen sc1
s_waitcnt lgkmcnt(8)
v_mfma_f32_32x32x16_bf16 v[176:191], a[208:211], a[16:19], v[176:191]
ds_read_b64_tr_b16 a[184:185], v85 offset:28800
ds_read_b64_tr_b16 a[186:187], v85 offset:29312
v_mul_f32 v70, v28, v102
v_mul_f32 v71, v28, v103
v_fma_f32 v96, v96, v25, s85
v_fma_f32 v97, v97, v25, s85
v_mfma_f32_32x32x16_bf16 v[192:207], a[212:215], a[16:19], v[192:207]
ds_read_b64_tr_b16 a[188:189], v87 offset:28800
ds_read_b64_tr_b16 a[190:191], v87 offset:29312
v_fma_f32 v98, v98, v25, s85
v_fma_f32 v99, v99, v25, s85
v_fma_f32 v100, v100, v25, s85
v_fma_f32 v101, v101, v25, s85
v_mfma_f32_32x32x16_bf16 v[208:223], a[216:219], a[16:19], v[208:223]
ds_read_b64_tr_b16 a[192:193], v89 offset:28800
ds_read_b64_tr_b16 a[194:195], v89 offset:29312
v_fma_f32 v102, v102, v25, s85
v_fma_f32 v103, v103, v25, s85
v_exp_f32_e64 v64, v64 clamp
v_exp_f32_e64 v65, v65 clamp
v_mfma_f32_32x32x16_bf16 v[224:239], a[220:223], a[16:19], v[224:239]
ds_read_b64_tr_b16 a[196:197], v91 offset:28800
ds_read_b64_tr_b16 a[198:199], v91 offset:29312
v_exp_f32_e64 v66, v66 clamp
v_exp_f32_e64 v67, v67 clamp
v_exp_f32_e64 v68, v68 clamp
v_exp_f32_e64 v69, v69 clamp
s_waitcnt lgkmcnt(8)
v_mfma_f32_32x32x16_bf16 v[176:191], a[160:163], a[20:23], v[176:191]
ds_read_b64_tr_b16 a[208:209], v85 offset:30848
ds_read_b64_tr_b16 a[210:211], v85 offset:31360
v_exp_f32_e64 v70, v70 clamp
v_exp_f32_e64 v71, v71 clamp
v_max_f32 v96, s85, v96
v_max_f32 v97, s85, v97
v_mfma_f32_32x32x16_bf16 v[192:207], a[164:167], a[20:23], v[192:207]
ds_read_b64_tr_b16 a[212:213], v87 offset:30848
ds_read_b64_tr_b16 a[214:215], v87 offset:31360
v_max_f32 v98, s85, v98
v_max_f32 v99, s85, v99
v_max_f32 v100, s85, v100
v_max_f32 v101, s85, v101
v_mfma_f32_32x32x16_bf16 v[208:223], a[168:171], a[20:23], v[208:223]
ds_read_b64_tr_b16 a[216:217], v89 offset:30848
ds_read_b64_tr_b16 a[218:219], v89 offset:31360
v_max_f32 v102, s85, v102
v_max_f32 v103, s85, v103
v_add_f32 v96, v96, v64
v_add_f32 v97, v97, v65
v_mfma_f32_32x32x16_bf16 v[224:239], a[172:175], a[20:23], v[224:239]
ds_read_b64_tr_b16 a[220:221], v91 offset:30848
ds_read_b64_tr_b16 a[222:223], v91 offset:31360
v_add_f32 v98, v98, v66
v_add_f32 v99, v99, v67
v_add_f32 v100, v100, v68
v_add_f32 v101, v101, v69
s_waitcnt vmcnt(5)
s_barrier
s_waitcnt lgkmcnt(8)
v_mfma_f32_32x32x16_bf16 v[176:191], a[184:187], a[24:27], v[176:191]
ds_read_b64_tr_b16 a[160:161], v84 offset:0
ds_read_b64_tr_b16 a[162:163], v84 offset:512
v_add_f32 v102, v102, v70
v_add_f32 v103, v103, v71
v_cvt_pk_bf16_f32 v96, v96, v97
v_cvt_pk_bf16_f32 v97, v98, v99
v_mfma_f32_32x32x16_bf16 v[192:207], a[188:191], a[24:27], v[192:207]
ds_read_b64_tr_b16 a[164:165], v86 offset:0
ds_read_b64_tr_b16 a[166:167], v86 offset:512
s_add_u32 s74, s55, 786432
s_add_u32 m0, s80, 49408
s_nop 0
buffer_load_dwordx4 v7, s[16:19], s74 offen lds
v_mfma_f32_32x32x16_bf16 v[208:223], a[192:195], a[24:27], v[208:223]
ds_read_b64_tr_b16 a[168:169], v88 offset:0
ds_read_b64_tr_b16 a[170:171], v88 offset:512
v_cvt_pk_bf16_f32 v98, v100, v101
v_cvt_pk_bf16_f32 v99, v102, v103
s_add_u32 s70, s57, s58
buffer_store_dwordx4 v[96:99], v22, s[24:27], s70 offen sc1
v_mfma_f32_32x32x16_bf16 v[224:239], a[196:199], a[24:27], v[224:239]
ds_read_b64_tr_b16 a[172:173], v90 offset:0
ds_read_b64_tr_b16 a[174:175], v90 offset:512
buffer_load_dwordx4 v8, s[16:19], s74 offen offset:1024 lds
v_mul_f32 v64, v28, v104
v_mul_f32 v65, v28, v105
v_mul_f32 v66, v28, v106
s_waitcnt lgkmcnt(8)
v_mfma_f32_32x32x16_bf16 v[176:191], a[208:211], a[28:31], v[176:191]
ds_read_b64_tr_b16 a[184:185], v84 offset:2048
ds_read_b64_tr_b16 a[186:187], v84 offset:2560
v_mul_f32 v67, v28, v107
v_mul_f32 v68, v28, v108
v_mul_f32 v69, v28, v109
v_mul_f32 v70, v28, v110
v_mfma_f32_32x32x16_bf16 v[192:207], a[212:215], a[28:31], v[192:207]
ds_read_b64_tr_b16 a[188:189], v86 offset:2048
ds_read_b64_tr_b16 a[190:191], v86 offset:2560
buffer_load_dwordx4 v9, s[16:19], s74 offen offset:2048 lds
v_mul_f32 v71, v28, v111
v_fma_f32 v104, v104, v25, s85
v_fma_f32 v105, v105, v25, s85
v_mfma_f32_32x32x16_bf16 v[208:223], a[216:219], a[28:31], v[208:223]
ds_read_b64_tr_b16 a[192:193], v88 offset:2048
ds_read_b64_tr_b16 a[194:195], v88 offset:2560
v_fma_f32 v106, v106, v25, s85
v_fma_f32 v107, v107, v25, s85
v_fma_f32 v108, v108, v25, s85
v_fma_f32 v109, v109, v25, s85
v_mfma_f32_32x32x16_bf16 v[224:239], a[220:223], a[28:31], v[224:239]
ds_read_b64_tr_b16 a[196:197], v90 offset:2048
ds_read_b64_tr_b16 a[198:199], v90 offset:2560
buffer_load_dwordx4 v10, s[16:19], s74 offen offset:3072 lds
v_fma_f32 v110, v110, v25, s85
v_fma_f32 v111, v111, v25, s85
v_exp_f32_e64 v64, v64 clamp
s_waitcnt lgkmcnt(8)
v_mfma_f32_32x32x16_bf16 v[176:191], a[160:163], a[32:35], v[176:191]
ds_read_b64_tr_b16 a[208:209], v84 offset:4096
ds_read_b64_tr_b16 a[210:211], v84 offset:4608
v_exp_f32_e64 v65, v65 clamp
v_exp_f32_e64 v66, v66 clamp
v_exp_f32_e64 v67, v67 clamp
v_exp_f32_e64 v68, v68 clamp
v_mfma_f32_32x32x16_bf16 v[192:207], a[164:167], a[32:35], v[192:207]
ds_read_b64_tr_b16 a[212:213], v86 offset:4096
ds_read_b64_tr_b16 a[214:215], v86 offset:4608
v_exp_f32_e64 v69, v69 clamp
v_exp_f32_e64 v70, v70 clamp
v_exp_f32_e64 v71, v71 clamp
v_max_f32 v104, s85, v104
v_mfma_f32_32x32x16_bf16 v[208:223], a[168:171], a[32:35], v[208:223]
ds_read_b64_tr_b16 a[216:217], v88 offset:4096
ds_read_b64_tr_b16 a[218:219], v88 offset:4608
v_max_f32 v105, s85, v105
v_max_f32 v106, s85, v106
v_max_f32 v107, s85, v107
v_max_f32 v108, s85, v108
v_mfma_f32_32x32x16_bf16 v[224:239], a[172:175], a[32:35], v[224:239]
ds_read_b64_tr_b16 a[220:221], v90 offset:4096
ds_read_b64_tr_b16 a[222:223], v90 offset:4608
v_max_f32 v109, s85, v109
v_max_f32 v110, s85, v110
v_max_f32 v111, s85, v111
v_add_f32 v104, v104, v64
s_waitcnt lgkmcnt(8)
v_mfma_f32_32x32x16_bf16 v[176:191], a[184:187], a[36:39], v[176:191]
ds_read_b64_tr_b16 a[160:161], v84 offset:6144
ds_read_b64_tr_b16 a[162:163], v84 offset:6656
v_add_f32 v105, v105, v65
v_add_f32 v106, v106, v66
v_add_f32 v107, v107, v67
v_add_f32 v108, v108, v68
v_mfma_f32_32x32x16_bf16 v[192:207], a[188:191], a[36:39], v[192:207]
ds_read_b64_tr_b16 a[164:165], v86 offset:6144
ds_read_b64_tr_b16 a[166:167], v86 offset:6656
v_add_f32 v109, v109, v69
v_add_f32 v110, v110, v70
v_add_f32 v111, v111, v71
v_cvt_pk_bf16_f32 v104, v104, v105
v_mfma_f32_32x32x16_bf16 v[208:223], a[192:195], a[36:39], v[208:223]
ds_read_b64_tr_b16 a[168:169], v88 offset:6144
ds_read_b64_tr_b16 a[170:171], v88 offset:6656
v_cvt_pk_bf16_f32 v105, v106, v107
v_cvt_pk_bf16_f32 v106, v108, v109
v_cvt_pk_bf16_f32 v107, v110, v111
s_add_u32 s70, s57, s58
s_add_u32 s70, s70, 5120
buffer_store_dwordx4 v[104:107], v22, s[24:27], s70 offen sc1
v_mfma_f32_32x32x16_bf16 v[224:239], a[196:199], a[36:39], v[224:239]
ds_read_b64_tr_b16 a[172:173], v90 offset:6144
ds_read_b64_tr_b16 a[174:175], v90 offset:6656
v_mul_f32 v64, v28, v112
v_mul_f32 v65, v28, v113
v_mul_f32 v66, v28, v114
v_mul_f32 v67, v28, v115
s_waitcnt vmcnt(7)
s_barrier
s_waitcnt lgkmcnt(8)
v_mfma_f32_32x32x16_bf16 v[176:191], a[208:211], a[40:43], v[176:191]
ds_read_b64_tr_b16 a[184:185], v84 offset:24704
ds_read_b64_tr_b16 a[186:187], v84 offset:25216
v_mul_f32 v68, v28, v116
v_mul_f32 v69, v28, v117
v_mul_f32 v70, v28, v118
v_mul_f32 v71, v28, v119
v_mfma_f32_32x32x16_bf16 v[192:207], a[212:215], a[40:43], v[192:207]
ds_read_b64_tr_b16 a[188:189], v86 offset:24704
ds_read_b64_tr_b16 a[190:191], v86 offset:25216
s_add_u32 s74, s55, 983040
s_add_u32 m0, s80, 74112
s_nop 0
buffer_load_dwordx4 v7, s[16:19], s74 offen lds
v_mfma_f32_32x32x16_bf16 v[208:223], a[216:219], a[40:43], v[208:223]
ds_read_b64_tr_b16 a[192:193], v88 offset:24704
ds_read_b64_tr_b16 a[194:195], v88 offset:25216
v_fma_f32 v112, v112, v25, s85
v_fma_f32 v113, v113, v25, s85
v_fma_f32 v114, v114, v25, s85
v_fma_f32 v115, v115, v25, s85
v_mfma_f32_32x32x16_bf16 v[224:239], a[220:223], a[40:43], v[224:239]
ds_read_b64_tr_b16 a[196:197], v90 offset:24704
ds_read_b64_tr_b16 a[198:199], v90 offset:25216
buffer_load_dwordx4 v8, s[16:19], s74 offen offset:1024 lds
v_fma_f32 v116, v116, v25, s85
v_fma_f32 v117, v117, v25, s85
v_fma_f32 v118, v118, v25, s85
s_waitcnt lgkmcnt(8)
v_mfma_f32_32x32x16_bf16 v[176:191], a[160:163], a[44:47], v[176:191]
ds_read_b64_tr_b16 a[208:209], v84 offset:26752
ds_read_b64_tr_b16 a[210:211], v84 offset:27264
v_fma_f32 v119, v119, v25, s85
v_exp_f32_e64 v64, v64 clamp
v_exp_f32_e64 v65, v65 clamp
v_exp_f32_e64 v66, v66 clamp
v_mfma_f32_32x32x16_bf16 v[192:207], a[164:167], a[44:47], v[192:207]
ds_read_b64_tr_b16 a[212:213], v86 offset:26752
ds_read_b64_tr_b16 a[214:215], v86 offset:27264
buffer_load_dwordx4 v9, s[16:19], s74 offen offset:2048 lds
v_exp_f32_e64 v67, v67 clamp
v_exp_f32_e64 v68, v68 clamp
v_exp_f32_e64 v69, v69 clamp
v_mfma_f32_32x32x16_bf16 v[208:223], a[168:171], a[44:47], v[208:223]
ds_read_b64_tr_b16 a[216:217], v88 offset:26752
ds_read_b64_tr_b16 a[218:219], v88 offset:27264
v_exp_f32_e64 v70, v70 clamp
v_exp_f32_e64 v71, v71 clamp
v_max_f32 v112, s85, v112
v_max_f32 v113, s85, v113
v_mfma_f32_32x32x16_bf16 v[224:239], a[172:175], a[44:47], v[224:239]
ds_read_b64_tr_b16 a[220:221], v90 offset:26752
ds_read_b64_tr_b16 a[222:223], v90 offset:27264
buffer_load_dwordx4 v10, s[16:19], s74 offen offset:3072 lds
v_max_f32 v114, s85, v114
v_max_f32 v115, s85, v115
v_max_f32 v116, s85, v116
s_waitcnt lgkmcnt(8)
v_mfma_f32_32x32x16_bf16 v[176:191], a[184:187], a[48:51], v[176:191]
ds_read_b64_tr_b16 a[160:161], v84 offset:28800
ds_read_b64_tr_b16 a[162:163], v84 offset:29312
v_max_f32 v117, s85, v117
v_max_f32 v118, s85, v118
v_max_f32 v119, s85, v119
v_add_f32 v112, v112, v64
v_mfma_f32_32x32x16_bf16 v[192:207], a[188:191], a[48:51], v[192:207]
ds_read_b64_tr_b16 a[164:165], v86 offset:28800
ds_read_b64_tr_b16 a[166:167], v86 offset:29312
v_add_f32 v113, v113, v65
v_add_f32 v114, v114, v66
v_add_f32 v115, v115, v67
v_add_f32 v116, v116, v68
v_mfma_f32_32x32x16_bf16 v[208:223], a[192:195], a[48:51], v[208:223]
ds_read_b64_tr_b16 a[168:169], v88 offset:28800
ds_read_b64_tr_b16 a[170:171], v88 offset:29312
v_add_f32 v117, v117, v69
v_add_f32 v118, v118, v70
v_add_f32 v119, v119, v71
v_cvt_pk_bf16_f32 v112, v112, v113
v_mfma_f32_32x32x16_bf16 v[224:239], a[196:199], a[48:51], v[224:239]
ds_read_b64_tr_b16 a[172:173], v90 offset:28800
ds_read_b64_tr_b16 a[174:175], v90 offset:29312
v_cvt_pk_bf16_f32 v113, v114, v115
v_cvt_pk_bf16_f32 v114, v116, v117
v_cvt_pk_bf16_f32 v115, v118, v119
s_add_u32 s70, s57, s58
buffer_store_dwordx4 v[112:115], v22, s[24:27], s70 offen offset:1024 sc1
s_waitcnt lgkmcnt(8)
v_mfma_f32_32x32x16_bf16 v[176:191], a[208:211], a[52:55], v[176:191]
ds_read_b64_tr_b16 a[184:185], v84 offset:30848
ds_read_b64_tr_b16 a[186:187], v84 offset:31360
v_mul_f32 v64, v28, v120
v_mul_f32 v65, v28, v121
v_mul_f32 v66, v28, v122
v_mul_f32 v67, v28, v123
v_mfma_f32_32x32x16_bf16 v[192:207], a[212:215], a[52:55], v[192:207]
ds_read_b64_tr_b16 a[188:189], v86 offset:30848
ds_read_b64_tr_b16 a[190:191], v86 offset:31360
v_mul_f32 v68, v28, v124
v_mul_f32 v69, v28, v125
v_mul_f32 v70, v28, v126
v_mul_f32 v71, v28, v127
v_mfma_f32_32x32x16_bf16 v[208:223], a[216:219], a[52:55], v[208:223]
ds_read_b64_tr_b16 a[192:193], v88 offset:30848
ds_read_b64_tr_b16 a[194:195], v88 offset:31360
v_fma_f32 v120, v120, v25, s85
v_fma_f32 v121, v121, v25, s85
v_fma_f32 v122, v122, v25, s85
v_fma_f32 v123, v123, v25, s85
v_mfma_f32_32x32x16_bf16 v[224:239], a[220:223], a[52:55], v[224:239]
ds_read_b64_tr_b16 a[196:197], v90 offset:30848
ds_read_b64_tr_b16 a[198:199], v90 offset:31360
v_fma_f32 v124, v124, v25, s85
v_fma_f32 v125, v125, v25, s85
v_fma_f32 v126, v126, v25, s85
v_fma_f32 v127, v127, v25, s85
s_waitcnt vmcnt(6)
s_barrier
s_waitcnt lgkmcnt(8)
v_mfma_f32_32x32x16_bf16 v[176:191], a[160:163], a[56:59], v[176:191]
ds_read_b64_tr_b16 a[208:209], v85 offset:0
ds_read_b64_tr_b16 a[210:211], v85 offset:512
v_exp_f32_e64 v64, v64 clamp
v_exp_f32_e64 v65, v65 clamp
v_exp_f32_e64 v66, v66 clamp
v_exp_f32_e64 v67, v67 clamp
v_mfma_f32_32x32x16_bf16 v[192:207], a[164:167], a[56:59], v[192:207]
ds_read_b64_tr_b16 a[212:213], v87 offset:0
ds_read_b64_tr_b16 a[214:215], v87 offset:512
s_add_u32 s74, s55, 1179648
s_add_u32 m0, s80, 0
s_nop 0
buffer_load_dwordx4 v7, s[16:19], s74 offen lds
v_mfma_f32_32x32x16_bf16 v[208:223], a[168:171], a[56:59], v[208:223]
ds_read_b64_tr_b16 a[216:217], v89 offset:0
ds_read_b64_tr_b16 a[218:219], v89 offset:512
v_exp_f32_e64 v68, v68 clamp
v_exp_f32_e64 v69, v69 clamp
v_exp_f32_e64 v70, v70 clamp
v_exp_f32_e64 v71, v71 clamp
v_mfma_f32_32x32x16_bf16 v[224:239], a[172:175], a[56:59], v[224:239]
ds_read_b64_tr_b16 a[220:221], v91 offset:0
ds_read_b64_tr_b16 a[222:223], v91 offset:512
buffer_load_dwordx4 v8, s[16:19], s74 offen offset:1024 lds
v_max_f32 v120, s85, v120
v_max_f32 v121, s85, v121
v_max_f32 v122, s85, v122
s_waitcnt lgkmcnt(8)
v_mfma_f32_32x32x16_bf16 v[176:191], a[184:187], a[60:63], v[176:191]
ds_read_b64_tr_b16 a[160:161], v85 offset:2048
ds_read_b64_tr_b16 a[162:163], v85 offset:2560
v_max_f32 v123, s85, v123
v_max_f32 v124, s85, v124
v_max_f32 v125, s85, v125
v_max_f32 v126, s85, v126
v_mfma_f32_32x32x16_bf16 v[192:207], a[188:191], a[60:63], v[192:207]
ds_read_b64_tr_b16 a[164:165], v87 offset:2048
ds_read_b64_tr_b16 a[166:167], v87 offset:2560
buffer_load_dwordx4 v9, s[16:19], s74 offen offset:2048 lds
v_max_f32 v127, s85, v127
v_add_f32 v120, v120, v64
v_add_f32 v121, v121, v65
v_mfma_f32_32x32x16_bf16 v[208:223], a[192:195], a[60:63], v[208:223]
ds_read_b64_tr_b16 a[168:169], v89 offset:2048
ds_read_b64_tr_b16 a[170:171], v89 offset:2560
v_add_f32 v122, v122, v66
v_add_f32 v123, v123, v67
v_add_f32 v124, v124, v68
v_add_f32 v125, v125, v69
v_mfma_f32_32x32x16_bf16 v[224:239], a[196:199], a[60:63], v[224:239]
ds_read_b64_tr_b16 a[172:173], v91 offset:2048
ds_read_b64_tr_b16 a[174:175], v91 offset:2560
buffer_load_dwordx4 v10, s[16:19], s74 offen offset:3072 lds
v_add_f32 v126, v126, v70
v_add_f32 v127, v127, v71
v_cvt_pk_bf16_f32 v120, v120, v121
s_waitcnt lgkmcnt(8)
v_mfma_f32_32x32x16_bf16 v[176:191], a[208:211], a[64:67], v[176:191]
ds_read_b64_tr_b16 a[184:185], v85 offset:4096
ds_read_b64_tr_b16 a[186:187], v85 offset:4608
v_cvt_pk_bf16_f32 v121, v122, v123
v_cvt_pk_bf16_f32 v122, v124, v125
v_cvt_pk_bf16_f32 v123, v126, v127
s_add_u32 s70, s57, s58
s_add_u32 s70, s70, 6144
buffer_store_dwordx4 v[120:123], v22, s[24:27], s70 offen sc1
v_mfma_f32_32x32x16_bf16 v[192:207], a[212:215], a[64:67], v[192:207]
ds_read_b64_tr_b16 a[188:189], v87 offset:4096
ds_read_b64_tr_b16 a[190:191], v87 offset:4608
v_mul_f32 v64, v28, v128
v_mul_f32 v65, v28, v129
v_mul_f32 v66, v28, v130
v_mul_f32 v67, v28, v131
v_mfma_f32_32x32x16_bf16 v[208:223], a[216:219], a[64:67], v[208:223]
ds_read_b64_tr_b16 a[192:193], v89 offset:4096
ds_read_b64_tr_b16 a[194:195], v89 offset:4608
v_mul_f32 v68, v28, v132
v_mul_f32 v69, v28, v133
v_mul_f32 v70, v28, v134
v_mul_f32 v71, v28, v135
v_mfma_f32_32x32x16_bf16 v[224:239], a[220:223], a[64:67], v[224:239]
ds_read_b64_tr_b16 a[196:197], v91 offset:4096
ds_read_b64_tr_b16 a[198:199], v91 offset:4608
v_fma_f32 v128, v128, v25, s85
v_fma_f32 v129, v129, v25, s85
v_fma_f32 v130, v130, v25, s85
v_fma_f32 v131, v131, v25, s85
s_waitcnt lgkmcnt(8)
v_mfma_f32_32x32x16_bf16 v[176:191], a[160:163], a[68:71], v[176:191]
ds_read_b64_tr_b16 a[208:209], v85 offset:6144
ds_read_b64_tr_b16 a[210:211], v85 offset:6656
v_fma_f32 v132, v132, v25, s85
v_fma_f32 v133, v133, v25, s85
v_fma_f32 v134, v134, v25, s85
v_fma_f32 v135, v135, v25, s85
v_mfma_f32_32x32x16_bf16 v[192:207], a[164:167], a[68:71], v[192:207]
ds_read_b64_tr_b16 a[212:213], v87 offset:6144
ds_read_b64_tr_b16 a[214:215], v87 offset:6656
v_exp_f32_e64 v64, v64 clamp
v_exp_f32_e64 v65, v65 clamp
v_exp_f32_e64 v66, v66 clamp
v_exp_f32_e64 v67, v67 clamp
v_mfma_f32_32x32x16_bf16 v[208:223], a[168:171], a[68:71], v[208:223]
ds_read_b64_tr_b16 a[216:217], v89 offset:6144
ds_read_b64_tr_b16 a[218:219], v89 offset:6656
v_exp_f32_e64 v68, v68 clamp
v_exp_f32_e64 v69, v69 clamp
v_exp_f32_e64 v70, v70 clamp
v_exp_f32_e64 v71, v71 clamp
v_mfma_f32_32x32x16_bf16 v[224:239], a[172:175], a[68:71], v[224:239]
ds_read_b64_tr_b16 a[220:221], v91 offset:6144
ds_read_b64_tr_b16 a[222:223], v91 offset:6656
v_max_f32 v128, s85, v128
v_max_f32 v129, s85, v129
v_max_f32 v130, s85, v130
v_max_f32 v131, s85, v131
s_waitcnt vmcnt(6)
s_barrier
s_waitcnt lgkmcnt(8)
v_mfma_f32_32x32x16_bf16 v[176:191], a[184:187], a[72:75], v[176:191]
ds_read_b64_tr_b16 a[160:161], v85 offset:24704
ds_read_b64_tr_b16 a[162:163], v85 offset:25216
v_max_f32 v132, s85, v132
v_max_f32 v133, s85, v133
v_max_f32 v134, s85, v134
v_max_f32 v135, s85, v135
v_mfma_f32_32x32x16_bf16 v[192:207], a[188:191], a[72:75], v[192:207]
ds_read_b64_tr_b16 a[164:165], v87 offset:24704
ds_read_b64_tr_b16 a[166:167], v87 offset:25216
s_add_u32 s74, s55, 1376256
s_add_u32 m0, s80, 24704
s_nop 0
buffer_load_dwordx4 v7, s[16:19], s74 offen lds
v_mfma_f32_32x32x16_bf16 v[208:223], a[192:195], a[72:75], v[208:223]
ds_read_b64_tr_b16 a[168:169], v89 offset:24704
ds_read_b64_tr_b16 a[170:171], v89 offset:25216
v_add_f32 v128, v128, v64
v_add_f32 v129, v129, v65
v_add_f32 v130, v130, v66
v_add_f32 v131, v131, v67
v_mfma_f32_32x32x16_bf16 v[224:239], a[196:199], a[72:75], v[224:239]
ds_read_b64_tr_b16 a[172:173], v91 offset:24704
ds_read_b64_tr_b16 a[174:175], v91 offset:25216
buffer_load_dwordx4 v8, s[16:19], s74 offen offset:1024 lds
v_add_f32 v132, v132, v68
v_add_f32 v133, v133, v69
v_add_f32 v134, v134, v70
s_waitcnt lgkmcnt(8)
v_mfma_f32_32x32x16_bf16 v[176:191], a[208:211], a[76:79], v[176:191]
ds_read_b64_tr_b16 a[184:185], v85 offset:26752
ds_read_b64_tr_b16 a[186:187], v85 offset:27264
v_add_f32 v135, v135, v71
v_cvt_pk_bf16_f32 v128, v128, v129
v_cvt_pk_bf16_f32 v129, v130, v131
v_cvt_pk_bf16_f32 v130, v132, v133
v_mfma_f32_32x32x16_bf16 v[192:207], a[212:215], a[76:79], v[192:207]
ds_read_b64_tr_b16 a[188:189], v87 offset:26752
ds_read_b64_tr_b16 a[190:191], v87 offset:27264
buffer_load_dwordx4 v9, s[16:19], s74 offen offset:2048 lds
v_cvt_pk_bf16_f32 v131, v134, v135
s_add_u32 s70, s57, s58
buffer_store_dwordx4 v[128:131], v22, s[24:27], s70 offen offset:2048 sc1
v_mfma_f32_32x32x16_bf16 v[208:223], a[216:219], a[76:79], v[208:223]
ds_read_b64_tr_b16 a[192:193], v89 offset:26752
ds_read_b64_tr_b16 a[194:195], v89 offset:27264
v_mul_f32 v64, v28, v136
v_mul_f32 v65, v28, v137
v_mul_f32 v66, v28, v138
v_mul_f32 v67, v28, v139
v_mfma_f32_32x32x16_bf16 v[224:239], a[220:223], a[76:79], v[224:239]
ds_read_b64_tr_b16 a[196:197], v91 offset:26752
ds_read_b64_tr_b16 a[198:199], v91 offset:27264
buffer_load_dwordx4 v10, s[16:19], s74 offen offset:3072 lds
v_mul_f32 v68, v28, v140
v_mul_f32 v69, v28, v141
v_mul_f32 v70, v28, v142
s_waitcnt lgkmcnt(8)
v_mfma_f32_32x32x16_bf16 v[176:191], a[160:163], a[80:83], v[176:191]
ds_read_b64_tr_b16 a[208:209], v85 offset:28800
ds_read_b64_tr_b16 a[210:211], v85 offset:29312
v_mul_f32 v71, v28, v143
v_fma_f32 v136, v136, v25, s85
v_fma_f32 v137, v137, v25, s85
v_fma_f32 v138, v138, v25, s85
v_mfma_f32_32x32x16_bf16 v[192:207], a[164:167], a[80:83], v[192:207]
ds_read_b64_tr_b16 a[212:213], v87 offset:28800
ds_read_b64_tr_b16 a[214:215], v87 offset:29312
v_fma_f32 v139, v139, v25, s85
v_fma_f32 v140, v140, v25, s85
v_fma_f32 v141, v141, v25, s85
v_fma_f32 v142, v142, v25, s85
v_mfma_f32_32x32x16_bf16 v[208:223], a[168:171], a[80:83], v[208:223]
ds_read_b64_tr_b16 a[216:217], v89 offset:28800
ds_read_b64_tr_b16 a[218:219], v89 offset:29312
v_fma_f32 v143, v143, v25, s85
v_exp_f32_e64 v64, v64 clamp
v_exp_f32_e64 v65, v65 clamp
v_exp_f32_e64 v66, v66 clamp
v_mfma_f32_32x32x16_bf16 v[224:239], a[172:175], a[80:83], v[224:239]
ds_read_b64_tr_b16 a[220:221], v91 offset:28800
ds_read_b64_tr_b16 a[222:223], v91 offset:29312
v_exp_f32_e64 v67, v67 clamp
v_exp_f32_e64 v68, v68 clamp
v_exp_f32_e64 v69, v69 clamp
v_exp_f32_e64 v70, v70 clamp
s_waitcnt lgkmcnt(8)
v_mfma_f32_32x32x16_bf16 v[176:191], a[184:187], a[84:87], v[176:191]
ds_read_b64_tr_b16 a[160:161], v85 offset:30848
ds_read_b64_tr_b16 a[162:163], v85 offset:31360
v_exp_f32_e64 v71, v71 clamp
v_max_f32 v136, s85, v136
v_max_f32 v137, s85, v137
v_max_f32 v138, s85, v138
v_mfma_f32_32x32x16_bf16 v[192:207], a[188:191], a[84:87], v[192:207]
ds_read_b64_tr_b16 a[164:165], v87 offset:30848
ds_read_b64_tr_b16 a[166:167], v87 offset:31360
v_max_f32 v139, s85, v139
v_max_f32 v140, s85, v140
v_max_f32 v141, s85, v141
v_max_f32 v142, s85, v142
v_mfma_f32_32x32x16_bf16 v[208:223], a[192:195], a[84:87], v[208:223]
ds_read_b64_tr_b16 a[168:169], v89 offset:30848
ds_read_b64_tr_b16 a[170:171], v89 offset:31360
v_max_f32 v143, s85, v143
v_add_f32 v136, v136, v64
v_add_f32 v137, v137, v65
v_add_f32 v138, v138, v66
v_mfma_f32_32x32x16_bf16 v[224:239], a[196:199], a[84:87], v[224:239]
ds_read_b64_tr_b16 a[172:173], v91 offset:30848
ds_read_b64_tr_b16 a[174:175], v91 offset:31360
v_add_f32 v139, v139, v67
v_add_f32 v140, v140, v68
v_add_f32 v141, v141, v69
v_add_f32 v142, v142, v70
s_waitcnt vmcnt(6)
s_barrier
s_waitcnt lgkmcnt(8)
v_mfma_f32_32x32x16_bf16 v[176:191], a[208:211], a[88:91], v[176:191]
ds_read_b64_tr_b16 a[184:185], v84 offset:0
ds_read_b64_tr_b16 a[186:187], v84 offset:512
v_add_f32 v143, v143, v71
v_cvt_pk_bf16_f32 v136, v136, v137
v_mov_b32 v13, v13
s_cmp_lg_u32 s48, 0
s_cbranch_scc1 POKEBQ
v_cmp_ne_u32 vcc, v13, v30
s_nop 3
s_and_b32 vcc_lo, vcc_lo, 16777215
s_and_b32 vcc_hi, vcc_hi, 0
s_or_b32 s76, vcc_lo, vcc_hi
s_cbranch_scc0 POKEBQ
s_mov_b32 s77, 4000
s_mov_b32 s75, 12550144
PSPEBQ:
s_sleep 3
buffer_load_dword v13, v12, s[24:27], s75 offen sc1
s_waitcnt vmcnt(0)
v_cmp_ne_u32 vcc, v13, v30
s_nop 3
s_and_b32 vcc_lo, vcc_lo, 16777215
s_and_b32 vcc_hi, vcc_hi, 0
s_or_b32 s76, vcc_lo, vcc_hi
s_cbranch_scc0 POKEBQ
s_sub_u32 s77, s77, 1
s_cmp_lg_u32 s77, 0
s_cbranch_scc1 PSPEBQ
POKEBQ:
s_barrier
v_mfma_f32_32x32x16_bf16 v[192:207], a[212:215], a[88:91], v[192:207]
ds_read_b64_tr_b16 a[188:189], v86 offset:0
ds_read_b64_tr_b16 a[190:191], v86 offset:512
s_add_u32 s74, s55, 1572864
s_add_u32 m0, s80, 49408
s_nop 0
buffer_load_dwordx4 v7, s[16:19], s74 offen lds
buffer_load_dwordx4 a[0:3], v4, s[12:15], s43 offen offset:0 sc1
v_mfma_f32_32x32x16_bf16 v[208:223], a[216:219], a[88:91], v[208:223]
ds_read_b64_tr_b16 a[192:193], v88 offset:0
ds_read_b64_tr_b16 a[194:195], v88 offset:512
v_cvt_pk_bf16_f32 v137, v138, v139
v_cvt_pk_bf16_f32 v138, v140, v141
v_cvt_pk_bf16_f32 v139, v142, v143
s_add_u32 s70, s57, s58
s_add_u32 s70, s70, 7168
buffer_store_dwordx4 v[136:139], v22, s[24:27], s70 offen sc1
v_mfma_f32_32x32x16_bf16 v[224:239], a[220:223], a[88:91], v[224:239]
ds_read_b64_tr_b16 a[196:197], v90 offset:0
ds_read_b64_tr_b16 a[198:199], v90 offset:512
buffer_load_dwordx4 v8, s[16:19], s74 offen offset:1024 lds
buffer_load_dwordx4 a[4:7], v4, s[12:15], s43 offen offset:1024 sc1
v_mul_f32 v64, v28, v144
v_mul_f32 v65, v28, v145
s_waitcnt lgkmcnt(8)
v_mfma_f32_32x32x16_bf16 v[176:191], a[160:163], a[92:95], v[176:191]
ds_read_b64_tr_b16 a[208:209], v84 offset:2048
ds_read_b64_tr_b16 a[210:211], v84 offset:2560
v_mul_f32 v66, v28, v146
v_mul_f32 v67, v28, v147
v_mul_f32 v68, v28, v148
v_mul_f32 v69, v28, v149
v_mfma_f32_32x32x16_bf16 v[192:207], a[164:167], a[92:95], v[192:207]
ds_read_b64_tr_b16 a[212:213], v86 offset:2048
ds_read_b64_tr_b16 a[214:215], v86 offset:2560
buffer_load_dwordx4 v9, s[16:19], s74 offen offset:2048 lds
buffer_load_dwordx4 a[8:11], v4, s[12:15], s43 offen offset:2048 sc1
v_mul_f32 v70, v28, v150
v_mul_f32 v71, v28, v151
v_mfma_f32_32x32x16_bf16 v[208:223], a[168:171], a[92:95], v[208:223]
ds_read_b64_tr_b16 a[216:217], v88 offset:2048
ds_read_b64_tr_b16 a[218:219], v88 offset:2560
v_fma_f32 v144, v144, v25, s85
v_fma_f32 v145, v145, v25, s85
v_fma_f32 v146, v146, v25, s85
v_fma_f32 v147, v147, v25, s85
v_mfma_f32_32x32x16_bf16 v[224:239], a[172:175], a[92:95], v[224:239]
ds_read_b64_tr_b16 a[220:221], v90 offset:2048
ds_read_b64_tr_b16 a[222:223], v90 offset:2560
buffer_load_dwordx4 v10, s[16:19], s74 offen offset:3072 lds
buffer_load_dwordx4 a[12:15], v4, s[12:15], s43 offen offset:3072 sc1
v_fma_f32 v148, v148, v25, s85
v_fma_f32 v149, v149, v25, s85
s_waitcnt lgkmcnt(8)
v_mfma_f32_32x32x16_bf16 v[176:191], a[184:187], a[96:99], v[176:191]
ds_read_b64_tr_b16 a[160:161], v84 offset:4096
ds_read_b64_tr_b16 a[162:163], v84 offset:4608
v_fma_f32 v150, v150, v25, s85
v_fma_f32 v151, v151, v25, s85
v_exp_f32_e64 v64, v64 clamp
v_exp_f32_e64 v65, v65 clamp
v_mfma_f32_32x32x16_bf16 v[192:207], a[188:191], a[96:99], v[192:207]
ds_read_b64_tr_b16 a[164:165], v86 offset:4096
ds_read_b64_tr_b16 a[166:167], v86 offset:4608
buffer_load_dwordx4 a[16:19], v5, s[12:15], s43 offen sc1
v_exp_f32_e64 v66, v66 clamp
v_exp_f32_e64 v67, v67 clamp
v_exp_f32_e64 v68, v68 clamp
v_mfma_f32_32x32x16_bf16 v[208:223], a[192:195], a[96:99], v[208:223]
ds_read_b64_tr_b16 a[168:169], v88 offset:4096
ds_read_b64_tr_b16 a[170:171], v88 offset:4608
v_exp_f32_e64 v69, v69 clamp
v_exp_f32_e64 v70, v70 clamp
v_exp_f32_e64 v71, v71 clamp
v_max_f32 v144, s85, v144
v_mfma_f32_32x32x16_bf16 v[224:239], a[196:199], a[96:99], v[224:239]
ds_read_b64_tr_b16 a[172:173], v90 offset:4096
ds_read_b64_tr_b16 a[174:175], v90 offset:4608
s_add_u32 s43, s43, 20480
v_max_f32 v145, s85, v145
v_max_f32 v146, s85, v146
v_max_f32 v147, s85, v147
s_waitcnt lgkmcnt(8)
v_mfma_f32_32x32x16_bf16 v[176:191], a[208:211], a[100:103], v[176:191]
ds_read_b64_tr_b16 a[184:185], v84 offset:6144
ds_read_b64_tr_b16 a[186:187], v84 offset:6656
v_max_f32 v148, s85, v148
v_max_f32 v149, s85, v149
v_max_f32 v150, s85, v150
v_max_f32 v151, s85, v151
v_mfma_f32_32x32x16_bf16 v[192:207], a[212:215], a[100:103], v[192:207]
ds_read_b64_tr_b16 a[188:189], v86 offset:6144
ds_read_b64_tr_b16 a[190:191], v86 offset:6656
buffer_load_dwordx4 a[20:23], v4, s[12:15], s43 offen offset:0 sc1
v_add_f32 v144, v144, v64
v_add_f32 v145, v145, v65
v_add_f32 v146, v146, v66
v_mfma_f32_32x32x16_bf16 v[208:223], a[216:219], a[100:103], v[208:223]
ds_read_b64_tr_b16 a[192:193], v88 offset:6144
ds_read_b64_tr_b16 a[194:195], v88 offset:6656
v_add_f32 v147, v147, v67
v_add_f32 v148, v148, v68
v_add_f32 v149, v149, v69
v_add_f32 v150, v150, v70
v_mfma_f32_32x32x16_bf16 v[224:239], a[220:223], a[100:103], v[224:239]
ds_read_b64_tr_b16 a[196:197], v90 offset:6144
ds_read_b64_tr_b16 a[198:199], v90 offset:6656
buffer_load_dwordx4 a[24:27], v4, s[12:15], s43 offen offset:1024 sc1
v_add_f32 v151, v151, v71
v_cvt_pk_bf16_f32 v144, v144, v145
v_cvt_pk_bf16_f32 v145, v146, v147
s_waitcnt vmcnt(12)
s_barrier
s_waitcnt lgkmcnt(8)
v_mfma_f32_32x32x16_bf16 v[176:191], a[160:163], a[104:107], v[176:191]
ds_read_b64_tr_b16 a[208:209], v84 offset:24704
ds_read_b64_tr_b16 a[210:211], v84 offset:25216
v_cvt_pk_bf16_f32 v146, v148, v149
v_cvt_pk_bf16_f32 v147, v150, v151
s_add_u32 s70, s57, s58
buffer_store_dwordx4 v[144:147], v22, s[24:27], s70 offen offset:3072 sc1
v_mfma_f32_32x32x16_bf16 v[192:207], a[164:167], a[104:107], v[192:207]
ds_read_b64_tr_b16 a[212:213], v86 offset:24704
ds_read_b64_tr_b16 a[214:215], v86 offset:25216
s_add_u32 s74, s55, 1769472
s_add_u32 m0, s80, 74112
s_nop 0
buffer_load_dwordx4 v7, s[16:19], s74 offen lds
buffer_load_dwordx4 a[28:31], v4, s[12:15], s43 offen offset:2048 sc1
v_mfma_f32_32x32x16_bf16 v[208:223], a[168:171], a[104:107], v[208:223]
ds_read_b64_tr_b16 a[216:217], v88 offset:24704
ds_read_b64_tr_b16 a[218:219], v88 offset:25216
v_mul_f32 v64, v28, v152
v_mul_f32 v65, v28, v153
v_mul_f32 v66, v28, v154
v_mul_f32 v67, v28, v155
v_mfma_f32_32x32x16_bf16 v[224:239], a[172:175], a[104:107], v[224:239]
ds_read_b64_tr_b16 a[220:221], v90 offset:24704
ds_read_b64_tr_b16 a[222:223], v90 offset:25216
buffer_load_dwordx4 v8, s[16:19], s74 offen offset:1024 lds
buffer_load_dwordx4 a[32:35], v4, s[12:15], s43 offen offset:3072 sc1
v_mul_f32 v68, v28, v156
v_mul_f32 v69, v28, v157
s_waitcnt lgkmcnt(8)
v_mfma_f32_32x32x16_bf16 v[176:191], a[184:187], a[108:111], v[176:191]
ds_read_b64_tr_b16 a[160:161], v84 offset:26752
ds_read_b64_tr_b16 a[162:163], v84 offset:27264
v_mul_f32 v70, v28, v158
v_mul_f32 v71, v28, v159
v_fma_f32 v152, v152, v25, s85
v_fma_f32 v153, v153, v25, s85
v_mfma_f32_32x32x16_bf16 v[192:207], a[188:191], a[108:111], v[192:207]
ds_read_b64_tr_b16 a[164:165], v86 offset:26752
ds_read_b64_tr_b16 a[166:167], v86 offset:27264
buffer_load_dwordx4 v9, s[16:19], s74 offen offset:2048 lds
buffer_load_dwordx4 a[36:39], v5, s[12:15], s43 offen sc1
v_fma_f32 v154, v154, v25, s85
v_fma_f32 v155, v155, v25, s85
v_mfma_f32_32x32x16_bf16 v[208:223], a[192:195], a[108:111], v[208:223]
ds_read_b64_tr_b16 a[168:169], v88 offset:26752
ds_read_b64_tr_b16 a[170:171], v88 offset:27264
v_fma_f32 v156, v156, v25, s85
v_fma_f32 v157, v157, v25, s85
v_fma_f32 v158, v158, v25, s85
v_fma_f32 v159, v159, v25, s85
v_mfma_f32_32x32x16_bf16 v[224:239], a[196:199], a[108:111], v[224:239]
ds_read_b64_tr_b16 a[172:173], v90 offset:26752
ds_read_b64_tr_b16 a[174:175], v90 offset:27264
buffer_load_dwordx4 v10, s[16:19], s74 offen offset:3072 lds
s_add_u32 s43, s43, 20480
v_exp_f32_e64 v64, v64 clamp
v_exp_f32_e64 v65, v65 clamp
s_waitcnt lgkmcnt(8)
v_mfma_f32_32x32x16_bf16 v[176:191], a[208:211], a[112:115], v[176:191]
ds_read_b64_tr_b16 a[184:185], v84 offset:28800
ds_read_b64_tr_b16 a[186:187], v84 offset:29312
v_exp_f32_e64 v66, v66 clamp
v_exp_f32_e64 v67, v67 clamp
v_exp_f32_e64 v68, v68 clamp
v_exp_f32_e64 v69, v69 clamp
v_mfma_f32_32x32x16_bf16 v[192:207], a[212:215], a[112:115], v[192:207]
ds_read_b64_tr_b16 a[188:189], v86 offset:28800
ds_read_b64_tr_b16 a[190:191], v86 offset:29312
buffer_load_dwordx4 a[40:43], v4, s[12:15], s43 offen offset:0 sc1
v_exp_f32_e64 v70, v70 clamp
v_exp_f32_e64 v71, v71 clamp
v_max_f32 v152, s85, v152
v_mfma_f32_32x32x16_bf16 v[208:223], a[216:219], a[112:115], v[208:223]
ds_read_b64_tr_b16 a[192:193], v88 offset:28800
ds_read_b64_tr_b16 a[194:195], v88 offset:29312
v_max_f32 v153, s85, v153
v_max_f32 v154, s85, v154
v_max_f32 v155, s85, v155
v_max_f32 v156, s85, v156
v_mfma_f32_32x32x16_bf16 v[224:239], a[220:223], a[112:115], v[224:239]
ds_read_b64_tr_b16 a[196:197], v90 offset:28800
ds_read_b64_tr_b16 a[198:199], v90 offset:29312
buffer_load_dwordx4 a[44:47], v4, s[12:15], s43 offen offset:1024 sc1
v_max_f32 v157, s85, v157
v_max_f32 v158, s85, v158
v_max_f32 v159, s85, v159
s_waitcnt lgkmcnt(8)
v_mfma_f32_32x32x16_bf16 v[176:191], a[160:163], a[116:119], v[176:191]
ds_read_b64_tr_b16 a[208:209], v84 offset:30848
ds_read_b64_tr_b16 a[210:211], v84 offset:31360
v_add_f32 v152, v152, v64
v_add_f32 v153, v153, v65
v_add_f32 v154, v154, v66
v_add_f32 v155, v155, v67
v_mfma_f32_32x32x16_bf16 v[192:207], a[164:167], a[116:119], v[192:207]
ds_read_b64_tr_b16 a[212:213], v86 offset:30848
ds_read_b64_tr_b16 a[214:215], v86 offset:31360
buffer_load_dwordx4 a[48:51], v4, s[12:15], s43 offen offset:2048 sc1
v_add_f32 v156, v156, v68
v_add_f32 v157, v157, v69
v_add_f32 v158, v158, v70
v_mfma_f32_32x32x16_bf16 v[208:223], a[168:171], a[116:119], v[208:223]
ds_read_b64_tr_b16 a[216:217], v88 offset:30848
ds_read_b64_tr_b16 a[218:219], v88 offset:31360
v_add_f32 v159, v159, v71
v_cvt_pk_bf16_f32 v152, v152, v153
v_cvt_pk_bf16_f32 v153, v154, v155
v_cvt_pk_bf16_f32 v154, v156, v157
v_mfma_f32_32x32x16_bf16 v[224:239], a[172:175], a[116:119], v[224:239]
ds_read_b64_tr_b16 a[220:221], v90 offset:30848
ds_read_b64_tr_b16 a[222:223], v90 offset:31360
buffer_load_dwordx4 a[52:55], v4, s[12:15], s43 offen offset:3072 sc1
v_cvt_pk_bf16_f32 v155, v158, v159
s_add_u32 s70, s57, s58
s_add_u32 s70, s70, 8192
buffer_store_dwordx4 v[152:155], v22, s[24:27], s70 offen sc1
s_waitcnt vmcnt(17)
s_barrier
s_waitcnt lgkmcnt(8)
v_mfma_f32_32x32x16_bf16 v[176:191], a[184:187], a[120:123], v[176:191]
ds_read_b64_tr_b16 a[160:161], v85 offset:0
ds_read_b64_tr_b16 a[162:163], v85 offset:512
v_mul_f32 v64, v28, v160
v_mul_f32 v65, v28, v161
v_mul_f32 v66, v28, v162
v_mul_f32 v67, v28, v163
v_mfma_f32_32x32x16_bf16 v[192:207], a[188:191], a[120:123], v[192:207]
ds_read_b64_tr_b16 a[164:165], v87 offset:0
ds_read_b64_tr_b16 a[166:167], v87 offset:512
buffer_load_dwordx4 a[56:59], v5, s[12:15], s43 offen sc1
v_mul_f32 v68, v28, v164
v_mul_f32 v69, v28, v165
v_mul_f32 v70, v28, v166
v_mfma_f32_32x32x16_bf16 v[208:223], a[192:195], a[120:123], v[208:223]
ds_read_b64_tr_b16 a[168:169], v89 offset:0
ds_read_b64_tr_b16 a[170:171], v89 offset:512
v_mul_f32 v71, v28, v167
v_fma_f32 v160, v160, v25, s85
v_fma_f32 v161, v161, v25, s85
v_fma_f32 v162, v162, v25, s85
v_mfma_f32_32x32x16_bf16 v[224:239], a[196:199], a[120:123], v[224:239]
ds_read_b64_tr_b16 a[172:173], v91 offset:0
ds_read_b64_tr_b16 a[174:175], v91 offset:512
s_add_u32 s43, s43, 20480
v_fma_f32 v163, v163, v25, s85
v_fma_f32 v164, v164, v25, s85
v_fma_f32 v165, v165, v25, s85
s_waitcnt lgkmcnt(8)
v_mfma_f32_32x32x16_bf16 v[176:191], a[208:211], a[124:127], v[176:191]
ds_read_b64_tr_b16 a[184:185], v85 offset:2048
ds_read_b64_tr_b16 a[186:187], v85 offset:2560
v_fma_f32 v166, v166, v25, s85
v_fma_f32 v167, v167, v25, s85
v_exp_f32_e64 v64, v64 clamp
v_exp_f32_e64 v65, v65 clamp
v_mfma_f32_32x32x16_bf16 v[192:207], a[212:215], a[124:127], v[192:207]
ds_read_b64_tr_b16 a[188:189], v87 offset:2048
ds_read_b64_tr_b16 a[190:191], v87 offset:2560
buffer_load_dwordx4 a[60:63], v4, s[12:15], s43 offen offset:0 sc1
v_exp_f32_e64 v66, v66 clamp
v_exp_f32_e64 v67, v67 clamp
v_exp_f32_e64 v68, v68 clamp
v_mfma_f32_32x32x16_bf16 v[208:223], a[216:219], a[124:127], v[208:223]
ds_read_b64_tr_b16 a[192:193], v89 offset:2048
ds_read_b64_tr_b16 a[194:195], v89 offset:2560
v_exp_f32_e64 v69, v69 clamp
v_exp_f32_e64 v70, v70 clamp
v_exp_f32_e64 v71, v71 clamp
v_max_f32 v160, s85, v160
v_mfma_f32_32x32x16_bf16 v[224:239], a[220:223], a[124:127], v[224:239]
ds_read_b64_tr_b16 a[196:197], v91 offset:2048
ds_read_b64_tr_b16 a[198:199], v91 offset:2560
buffer_load_dwordx4 a[64:67], v4, s[12:15], s43 offen offset:1024 sc1
v_max_f32 v161, s85, v161
v_max_f32 v162, s85, v162
v_max_f32 v163, s85, v163
s_waitcnt lgkmcnt(8)
v_mfma_f32_32x32x16_bf16 v[176:191], a[160:163], a[128:131], v[176:191]
ds_read_b64_tr_b16 a[208:209], v85 offset:4096
ds_read_b64_tr_b16 a[210:211], v85 offset:4608
v_max_f32 v164, s85, v164
v_max_f32 v165, s85, v165
v_max_f32 v166, s85, v166
v_max_f32 v167, s85, v167
v_mfma_f32_32x32x16_bf16 v[192:207], a[164:167], a[128:131], v[192:207]
ds_read_b64_tr_b16 a[212:213], v87 offset:4096
ds_read_b64_tr_b16 a[214:215], v87 offset:4608
buffer_load_dwordx4 a[68:71], v4, s[12:15], s43 offen offset:2048 sc1
v_add_f32 v160, v160, v64
v_add_f32 v161, v161, v65
v_add_f32 v162, v162, v66
v_mfma_f32_32x32x16_bf16 v[208:223], a[168:171], a[128:131], v[208:223]
ds_read_b64_tr_b16 a[216:217], v89 offset:4096
ds_read_b64_tr_b16 a[218:219], v89 offset:4608
v_add_f32 v163, v163, v67
v_add_f32 v164, v164, v68
v_add_f32 v165, v165, v69
v_add_f32 v166, v166, v70
v_mfma_f32_32x32x16_bf16 v[224:239], a[172:175], a[128:131], v[224:239]
ds_read_b64_tr_b16 a[220:221], v91 offset:4096
ds_read_b64_tr_b16 a[222:223], v91 offset:4608
buffer_load_dwordx4 a[72:75], v4, s[12:15], s43 offen offset:3072 sc1
v_add_f32 v167, v167, v71
v_cvt_pk_bf16_f32 v160, v160, v161
v_cvt_pk_bf16_f32 v161, v162, v163
s_waitcnt lgkmcnt(8)
v_mfma_f32_32x32x16_bf16 v[176:191], a[184:187], a[132:135], v[176:191]
ds_read_b64_tr_b16 a[160:161], v85 offset:6144
ds_read_b64_tr_b16 a[162:163], v85 offset:6656
v_cvt_pk_bf16_f32 v162, v164, v165
v_cvt_pk_bf16_f32 v163, v166, v167
s_add_u32 s70, s57, s58
s_add_u32 s70, s70, 4096
buffer_store_dwordx4 v[160:163], v22, s[24:27], s70 offen sc1
v_mfma_f32_32x32x16_bf16 v[192:207], a[188:191], a[132:135], v[192:207]
ds_read_b64_tr_b16 a[164:165], v87 offset:6144
ds_read_b64_tr_b16 a[166:167], v87 offset:6656
buffer_load_dwordx4 a[76:79], v5, s[12:15], s43 offen sc1
v_mul_f32 v64, v28, v168
v_mul_f32 v65, v28, v169
v_mul_f32 v66, v28, v170
v_mfma_f32_32x32x16_bf16 v[208:223], a[192:195], a[132:135], v[208:223]
ds_read_b64_tr_b16 a[168:169], v89 offset:6144
ds_read_b64_tr_b16 a[170:171], v89 offset:6656
v_mul_f32 v67, v28, v171
v_mul_f32 v68, v28, v172
v_mul_f32 v69, v28, v173
v_mul_f32 v70, v28, v174
v_mfma_f32_32x32x16_bf16 v[224:239], a[196:199], a[132:135], v[224:239]
ds_read_b64_tr_b16 a[172:173], v91 offset:6144
ds_read_b64_tr_b16 a[174:175], v91 offset:6656
s_add_u32 s43, s43, 20480
v_mul_f32 v71, v28, v175
v_fma_f32 v168, v168, v25, s85
v_fma_f32 v169, v169, v25, s85
s_waitcnt vmcnt(12)
s_barrier
s_waitcnt lgkmcnt(8)
v_mfma_f32_32x32x16_bf16 v[176:191], a[208:211], a[136:139], v[176:191]
ds_read_b64_tr_b16 a[184:185], v85 offset:24704
ds_read_b64_tr_b16 a[186:187], v85 offset:25216
v_fma_f32 v170, v170, v25, s85
v_fma_f32 v171, v171, v25, s85
v_fma_f32 v172, v172, v25, s85
v_fma_f32 v173, v173, v25, s85
v_mfma_f32_32x32x16_bf16 v[192:207], a[212:215], a[136:139], v[192:207]
ds_read_b64_tr_b16 a[188:189], v87 offset:24704
ds_read_b64_tr_b16 a[190:191], v87 offset:25216
buffer_load_dwordx4 a[80:83], v4, s[12:15], s43 offen offset:0 sc1
v_fma_f32 v174, v174, v25, s85
v_fma_f32 v175, v175, v25, s85
v_exp_f32_e64 v64, v64 clamp
v_mfma_f32_32x32x16_bf16 v[208:223], a[216:219], a[136:139], v[208:223]
ds_read_b64_tr_b16 a[192:193], v89 offset:24704
ds_read_b64_tr_b16 a[194:195], v89 offset:25216
v_exp_f32_e64 v65, v65 clamp
v_exp_f32_e64 v66, v66 clamp
v_exp_f32_e64 v67, v67 clamp
v_exp_f32_e64 v68, v68 clamp
v_mfma_f32_32x32x16_bf16 v[224:239], a[220:223], a[136:139], v[224:239]
ds_read_b64_tr_b16 a[196:197], v91 offset:24704
ds_read_b64_tr_b16 a[198:199], v91 offset:25216
buffer_load_dwordx4 a[84:87], v4, s[12:15], s43 offen offset:1024 sc1
v_exp_f32_e64 v69, v69 clamp
v_exp_f32_e64 v70, v70 clamp
v_exp_f32_e64 v71, v71 clamp
s_waitcnt lgkmcnt(8)
v_mfma_f32_32x32x16_bf16 v[176:191], a[160:163], a[140:143], v[176:191]
ds_read_b64_tr_b16 a[208:209], v85 offset:26752
ds_read_b64_tr_b16 a[210:211], v85 offset:27264
v_max_f32 v168, s85, v168
v_max_f32 v169, s85, v169
v_max_f32 v170, s85, v170
v_max_f32 v171, s85, v171
v_mfma_f32_32x32x16_bf16 v[192:207], a[164:167], a[140:143], v[192:207]
ds_read_b64_tr_b16 a[212:213], v87 offset:26752
ds_read_b64_tr_b16 a[214:215], v87 offset:27264
buffer_load_dwordx4 a[88:91], v4, s[12:15], s43 offen offset:2048 sc1
v_max_f32 v172, s85, v172
v_max_f32 v173, s85, v173
v_max_f32 v174, s85, v174
v_mfma_f32_32x32x16_bf16 v[208:223], a[168:171], a[140:143], v[208:223]
ds_read_b64_tr_b16 a[216:217], v89 offset:26752
ds_read_b64_tr_b16 a[218:219], v89 offset:27264
v_max_f32 v175, s85, v175
v_add_f32 v168, v168, v64
v_add_f32 v169, v169, v65
v_add_f32 v170, v170, v66
v_mfma_f32_32x32x16_bf16 v[224:239], a[172:175], a[140:143], v[224:239]
ds_read_b64_tr_b16 a[220:221], v91 offset:26752
ds_read_b64_tr_b16 a[222:223], v91 offset:27264
buffer_load_dwordx4 a[92:95], v4, s[12:15], s43 offen offset:3072 sc1
v_add_f32 v171, v171, v67
v_add_f32 v172, v172, v68
v_add_f32 v173, v173, v69
s_waitcnt lgkmcnt(8)
v_mfma_f32_32x32x16_bf16 v[176:191], a[184:187], a[144:147], v[176:191]
ds_read_b64_tr_b16 a[160:161], v85 offset:28800
ds_read_b64_tr_b16 a[162:163], v85 offset:29312
v_add_f32 v174, v174, v70
v_add_f32 v175, v175, v71
v_cvt_pk_bf16_f32 v168, v168, v169
v_cvt_pk_bf16_f32 v169, v170, v171
v_mfma_f32_32x32x16_bf16 v[192:207], a[188:191], a[144:147], v[192:207]
ds_read_b64_tr_b16 a[164:165], v87 offset:28800
ds_read_b64_tr_b16 a[166:167], v87 offset:29312
buffer_load_dwordx4 a[96:99], v5, s[12:15], s43 offen sc1
v_cvt_pk_bf16_f32 v170, v172, v173
v_cvt_pk_bf16_f32 v171, v174, v175
s_add_u32 s70, s57, s58
s_add_u32 s70, s70, 9216
buffer_store_dwordx4 v[168:171], v22, s[24:27], s70 offen sc1
v_mfma_f32_32x32x16_bf16 v[208:223], a[192:195], a[144:147], v[208:223]
ds_read_b64_tr_b16 a[168:169], v89 offset:28800
ds_read_b64_tr_b16 a[170:171], v89 offset:29312
v_mfma_f32_32x32x16_bf16 v[224:239], a[196:199], a[144:147], v[224:239]
ds_read_b64_tr_b16 a[172:173], v91 offset:28800
ds_read_b64_tr_b16 a[174:175], v91 offset:29312
s_add_u32 s43, s43, 20480
s_waitcnt lgkmcnt(8)
v_mfma_f32_32x32x16_bf16 v[176:191], a[208:211], a[148:151], v[176:191]
ds_read_b64_tr_b16 a[184:185], v85 offset:30848
ds_read_b64_tr_b16 a[186:187], v85 offset:31360
v_mfma_f32_32x32x16_bf16 v[192:207], a[212:215], a[148:151], v[192:207]
ds_read_b64_tr_b16 a[188:189], v87 offset:30848
ds_read_b64_tr_b16 a[190:191], v87 offset:31360
buffer_load_dwordx4 a[100:103], v4, s[12:15], s43 offen offset:0 sc1
v_mfma_f32_32x32x16_bf16 v[208:223], a[216:219], a[148:151], v[208:223]
ds_read_b64_tr_b16 a[192:193], v89 offset:30848
ds_read_b64_tr_b16 a[194:195], v89 offset:31360
v_mfma_f32_32x32x16_bf16 v[224:239], a[220:223], a[148:151], v[224:239]
ds_read_b64_tr_b16 a[196:197], v91 offset:30848
ds_read_b64_tr_b16 a[198:199], v91 offset:31360
buffer_load_dwordx4 a[104:107], v4, s[12:15], s43 offen offset:1024 sc1
s_waitcnt lgkmcnt(8)
v_mfma_f32_32x32x16_bf16 v[176:191], a[160:163], a[152:155], v[176:191]
v_mfma_f32_32x32x16_bf16 v[192:207], a[164:167], a[152:155], v[192:207]
buffer_load_dwordx4 a[108:111], v4, s[12:15], s43 offen offset:2048 sc1
v_mfma_f32_32x32x16_bf16 v[208:223], a[168:171], a[152:155], v[208:223]
v_mfma_f32_32x32x16_bf16 v[224:239], a[172:175], a[152:155], v[224:239]
buffer_load_dwordx4 a[112:115], v4, s[12:15], s43 offen offset:3072 sc1
s_waitcnt lgkmcnt(0)
v_mfma_f32_32x32x16_bf16 v[176:191], a[184:187], a[156:159], v[176:191]
v_mfma_f32_32x32x16_bf16 v[192:207], a[188:191], a[156:159], v[192:207]
buffer_load_dwordx4 a[116:119], v5, s[12:15], s43 offen sc1
v_mfma_f32_32x32x16_bf16 v[208:223], a[192:195], a[156:159], v[208:223]
v_mfma_f32_32x32x16_bf16 v[224:239], a[196:199], a[156:159], v[224:239]
s_add_u32 s43, s43, 20480
s_barrier
v_mov_b32 v34, 0
v_mov_b32 v35, 0
v_mov_b32 v38, 0
v_mov_b32 v39, 0
ds_read_b32 v40, v23 offset:27936
ds_read_b32 v41, v23 offset:28000
ds_read_b32 v42, v23 offset:28064
ds_read_b32 v43, v23 offset:28128
s_waitcnt lgkmcnt(3)
v_cvt_pk_bf16_f32 v32, v40, v40
v_lshlrev_b32 v46, 16, v32
v_sub_f32 v46, v40, v46
buffer_load_dwordx4 a[120:123], v4, s[12:15], s43 offen offset:0 sc1
v_cvt_pk_bf16_f32 v33, v46, v46
s_nop 1
v_mfma_f32_32x32x16_bf16 v[176:191], v[32:35], a[244:247], v[176:191]
s_waitcnt lgkmcnt(2)
v_cvt_pk_bf16_f32 v36, v41, v41
v_lshlrev_b32 v47, 16, v36
v_sub_f32 v47, v41, v47
v_cvt_pk_bf16_f32 v37, v47, v47
s_nop 1
v_mfma_f32_32x32x16_bf16 v[192:207], v[36:39], a[244:247], v[192:207]
s_waitcnt lgkmcnt(1)
v_cvt_pk_bf16_f32 v32, v42, v42
v_lshlrev_b32 v46, 16, v32
v_sub_f32 v46, v42, v46
v_cvt_pk_bf16_f32 v33, v46, v46
buffer_load_dwordx4 a[124:127], v4, s[12:15], s43 offen offset:1024 sc1
s_nop 0
v_mfma_f32_32x32x16_bf16 v[208:223], v[32:35], a[244:247], v[208:223]
s_waitcnt lgkmcnt(0)
v_cvt_pk_bf16_f32 v36, v43, v43
v_lshlrev_b32 v47, 16, v36
v_sub_f32 v47, v43, v47
v_cvt_pk_bf16_f32 v37, v47, v47
s_nop 1
v_mfma_f32_32x32x16_bf16 v[224:239], v[36:39], a[244:247], v[224:239]
v_mul_f32 v64, v26, v176
v_mul_f32 v65, v26, v177
v_mul_f32 v66, v26, v178
v_mul_f32 v67, v26, v179
v_mul_f32 v68, v26, v180
buffer_load_dwordx4 a[128:131], v4, s[12:15], s43 offen offset:2048 sc1
v_mul_f32 v69, v26, v181
v_mul_f32 v70, v26, v182
v_mul_f32 v71, v26, v183
v_exp_f32 v64, v64
v_exp_f32 v65, v65
v_exp_f32 v66, v66
v_exp_f32 v67, v67
v_exp_f32 v68, v68
v_exp_f32 v69, v69
v_exp_f32 v70, v70
v_exp_f32 v71, v71
buffer_load_dwordx4 a[132:135], v4, s[12:15], s43 offen offset:3072 sc1
v_mul_f32 v176, v176, v184
v_mul_f32 v177, v177, v185
v_mul_f32 v178, v178, v186
v_mul_f32 v179, v179, v187
v_mul_f32 v180, v180, v188
v_mul_f32 v181, v181, v189
v_mul_f32 v182, v182, v190
v_mul_f32 v183, v183, v191
v_fma_f32 v64, v64, v27, v27
v_fma_f32 v65, v65, v27, v27
v_fma_f32 v66, v66, v27, v27
buffer_load_dwordx4 a[136:139], v5, s[12:15], s43 offen sc1
v_fma_f32 v67, v67, v27, v27
v_fma_f32 v68, v68, v27, v27
v_fma_f32 v69, v69, v27, v27
v_fma_f32 v70, v70, v27, v27
v_fma_f32 v71, v71, v27, v27
v_rcp_f32 v64, v64
v_rcp_f32 v65, v65
v_rcp_f32 v66, v66
v_rcp_f32 v67, v67
v_rcp_f32 v68, v68
v_rcp_f32 v69, v69
s_add_u32 s43, s43, 20480
v_rcp_f32 v70, v70
v_rcp_f32 v71, v71
v_mul_f32 v176, v176, v64
v_mul_f32 v177, v177, v65
v_mul_f32 v178, v178, v66
v_mul_f32 v179, v179, v67
v_mul_f32 v180, v180, v68
v_mul_f32 v181, v181, v69
v_mul_f32 v182, v182, v70
v_mul_f32 v183, v183, v71
v_cvt_pk_bf16_f32 v184, v176, v177
buffer_load_dwordx4 a[140:143], v4, s[12:15], s43 offen offset:0 sc1
v_cvt_pk_bf16_f32 v185, v178, v179
v_cvt_pk_bf16_f32 v186, v180, v181
v_cvt_pk_bf16_f32 v187, v182, v183
s_add_u32 s70, s57, s59
buffer_store_dwordx4 v[184:187], v22, s[24:27], s70 offen sc1
v_mul_f32 v64, v26, v192
v_mul_f32 v65, v26, v193
v_mul_f32 v66, v26, v194
v_mul_f32 v67, v26, v195
v_mul_f32 v68, v26, v196
v_mul_f32 v69, v26, v197
v_mul_f32 v70, v26, v198
buffer_load_dwordx4 a[144:147], v4, s[12:15], s43 offen offset:1024 sc1
v_mul_f32 v71, v26, v199
v_exp_f32 v64, v64
v_exp_f32 v65, v65
v_exp_f32 v66, v66
v_exp_f32 v67, v67
v_exp_f32 v68, v68
v_exp_f32 v69, v69
v_exp_f32 v70, v70
v_exp_f32 v71, v71
v_mul_f32 v192, v192, v200
v_mul_f32 v193, v193, v201
buffer_load_dwordx4 a[148:151], v4, s[12:15], s43 offen offset:2048 sc1
v_mul_f32 v194, v194, v202
v_mul_f32 v195, v195, v203
v_mul_f32 v196, v196, v204
v_mul_f32 v197, v197, v205
v_mul_f32 v198, v198, v206
v_mul_f32 v199, v199, v207
v_fma_f32 v64, v64, v27, v27
v_fma_f32 v65, v65, v27, v27
v_fma_f32 v66, v66, v27, v27
v_fma_f32 v67, v67, v27, v27
v_fma_f32 v68, v68, v27, v27
buffer_load_dwordx4 a[152:155], v4, s[12:15], s43 offen offset:3072 sc1
v_fma_f32 v69, v69, v27, v27
v_fma_f32 v70, v70, v27, v27
v_fma_f32 v71, v71, v27, v27
v_rcp_f32 v64, v64
v_rcp_f32 v65, v65
v_rcp_f32 v66, v66
v_rcp_f32 v67, v67
v_rcp_f32 v68, v68
v_rcp_f32 v69, v69
v_rcp_f32 v70, v70
v_rcp_f32 v71, v71
buffer_load_dwordx4 a[156:159], v5, s[12:15], s43 offen sc1
v_mul_f32 v192, v192, v64
v_mul_f32 v193, v193, v65
v_mul_f32 v194, v194, v66
v_mul_f32 v195, v195, v67
v_mul_f32 v196, v196, v68
v_mul_f32 v197, v197, v69
v_mul_f32 v198, v198, v70
v_mul_f32 v199, v199, v71
v_cvt_pk_bf16_f32 v200, v192, v193
v_cvt_pk_bf16_f32 v201, v194, v195
v_cvt_pk_bf16_f32 v202, v196, v197
s_add_u32 s43, s43, 20480
v_cvt_pk_bf16_f32 v203, v198, v199
s_add_u32 s70, s57, s59
buffer_store_dwordx4 v[200:203], v22, s[24:27], s70 offen offset:1024 sc1
v_mul_f32 v64, v26, v208
v_mul_f32 v65, v26, v209
v_mul_f32 v66, v26, v210
v_mul_f32 v67, v26, v211
v_mul_f32 v68, v26, v212
v_mul_f32 v69, v26, v213
v_mul_f32 v70, v26, v214
v_mul_f32 v71, v26, v215
v_exp_f32 v64, v64
v_exp_f32 v65, v65
v_exp_f32 v66, v66
v_exp_f32 v67, v67
v_exp_f32 v68, v68
v_exp_f32 v69, v69
v_exp_f32 v70, v70
v_exp_f32 v71, v71
v_mul_f32 v208, v208, v216
v_mul_f32 v209, v209, v217
v_mul_f32 v210, v210, v218
v_mul_f32 v211, v211, v219
v_mul_f32 v212, v212, v220
v_mul_f32 v213, v213, v221
v_mul_f32 v214, v214, v222
v_mul_f32 v215, v215, v223
v_fma_f32 v64, v64, v27, v27
v_fma_f32 v65, v65, v27, v27
v_fma_f32 v66, v66, v27, v27
v_fma_f32 v67, v67, v27, v27
v_fma_f32 v68, v68, v27, v27
v_fma_f32 v69, v69, v27, v27
v_fma_f32 v70, v70, v27, v27
v_fma_f32 v71, v71, v27, v27
v_rcp_f32 v64, v64
v_rcp_f32 v65, v65
v_rcp_f32 v66, v66
v_rcp_f32 v67, v67
v_rcp_f32 v68, v68
v_rcp_f32 v69, v69
v_rcp_f32 v70, v70
v_rcp_f32 v71, v71
v_mul_f32 v208, v208, v64
v_mul_f32 v209, v209, v65
v_mul_f32 v210, v210, v66
v_mul_f32 v211, v211, v67
v_mul_f32 v212, v212, v68
v_mul_f32 v213, v213, v69
v_mul_f32 v214, v214, v70
v_mul_f32 v215, v215, v71
v_cvt_pk_bf16_f32 v216, v208, v209
v_cvt_pk_bf16_f32 v217, v210, v211
v_cvt_pk_bf16_f32 v218, v212, v213
v_cvt_pk_bf16_f32 v219, v214, v215
s_add_u32 s70, s57, s59
buffer_store_dwordx4 v[216:219], v22, s[24:27], s70 offen offset:2048 sc1
v_mul_f32 v64, v26, v224
v_mul_f32 v65, v26, v225
v_mul_f32 v66, v26, v226
v_mul_f32 v67, v26, v227
v_mul_f32 v68, v26, v228
v_mul_f32 v69, v26, v229
v_mul_f32 v70, v26, v230
v_mul_f32 v71, v26, v231
v_exp_f32 v64, v64
v_exp_f32 v65, v65
v_exp_f32 v66, v66
v_exp_f32 v67, v67
v_exp_f32 v68, v68
v_exp_f32 v69, v69
v_exp_f32 v70, v70
v_exp_f32 v71, v71
v_mul_f32 v224, v224, v232
v_mul_f32 v225, v225, v233
v_mul_f32 v226, v226, v234
v_mul_f32 v227, v227, v235
v_mul_f32 v228, v228, v236
v_mul_f32 v229, v229, v237
v_mul_f32 v230, v230, v238
v_mul_f32 v231, v231, v239
v_fma_f32 v64, v64, v27, v27
v_fma_f32 v65, v65, v27, v27
v_fma_f32 v66, v66, v27, v27
v_fma_f32 v67, v67, v27, v27
v_fma_f32 v68, v68, v27, v27
v_fma_f32 v69, v69, v27, v27
v_fma_f32 v70, v70, v27, v27
v_fma_f32 v71, v71, v27, v27
v_rcp_f32 v64, v64
v_rcp_f32 v65, v65
v_rcp_f32 v66, v66
v_rcp_f32 v67, v67
v_rcp_f32 v68, v68
v_rcp_f32 v69, v69
v_rcp_f32 v70, v70
v_rcp_f32 v71, v71
v_mul_f32 v224, v224, v64
v_mul_f32 v225, v225, v65
v_mul_f32 v226, v226, v66
v_mul_f32 v227, v227, v67
v_mul_f32 v228, v228, v68
v_mul_f32 v229, v229, v69
v_mul_f32 v230, v230, v70
v_mul_f32 v231, v231, v71
v_cvt_pk_bf16_f32 v232, v224, v225
v_cvt_pk_bf16_f32 v233, v226, v227
v_cvt_pk_bf16_f32 v234, v228, v229
v_cvt_pk_bf16_f32 v235, v230, v231
s_add_u32 s70, s57, s59
buffer_store_dwordx4 v[232:235], v22, s[24:27], s70 offen offset:3072 sc1
s_mul_i32 s51, s40, 278528
s_add_u32 s8, s24, s51
s_addc_u32 s9, s25, 0
s_mov_b32 s10, 278528
s_mov_b32 s11, 0x20000
s_mov_b32 s16, s4
s_mov_b32 s17, s5
s_mov_b32 s18, 2621440
s_mov_b32 s19, 0x20000
s_mov_b32 s20, s86
s_mov_b32 s21, s87
s_mov_b32 s22, 2621440
s_mov_b32 s23, 0x20000
s_mov_b32 s63, 0x358637bd
s_mul_i32 s62, s41, 3200
s_add_u32 s62, s62, 11534336
s_mul_i32 s46, s40, 81920
s_mul_i32 s51, s41, 160
s_add_u32 s46, s46, s51
v_and_b32 v52, 15, v1
v_lshrrev_b32 v53, 4, v1
v_lshrrev_b32 v54, 1, v53
v_lshlrev_b32 v56, 10, v54
v_and_b32 v55, 1, v53
v_lshl_add_u32 v56, v55, 9, v56
v_lshl_add_u32 v2, v52, 4, v56
v_add_u32 v3, 139264, v2
s_mul_i32 s51, s48, 20480
v_add_u32 v6, s51, v4
v_lshl_add_u32 v54, v54, 2, v55
s_mul_i32 s51, s48, 2048
s_add_u32 s51, s51, 96512
v_lshlrev_b32 v59, 5, v52
v_add_u32 v59, s51, v59
s_mul_i32 s52, s48, 204800
v_lshlrev_b32 v58, 3, v52
v_add_u32 v58, s52, v58
s_mov_b32 s53, 25600
s_mov_b32 s54, 52429
s_mov_b32 s55, -20
v_add_u32 v55, 0, v54
v_mul_u32_u24 v56, s54, v55
v_lshrrev_b32 v56, 18, v56
v_mad_i32_i24 v57, v56, -5, v55
v_lshl_add_u32 v42, v56, 2, v59
v_mad_u32_u24 v56, v56, s53, v58
v_lshl_add_u32 v32, v57, 7, v56
v_add_u32 v55, 2, v54
v_mul_u32_u24 v56, s54, v55
v_lshrrev_b32 v56, 18, v56
v_mad_i32_i24 v57, v56, -5, v55
v_lshl_add_u32 v43, v56, 2, v59
v_mad_u32_u24 v56, v56, s53, v58
v_lshl_add_u32 v33, v57, 7, v56
v_add_u32 v55, 8, v54
v_mul_u32_u24 v56, s54, v55
v_lshrrev_b32 v56, 18, v56
v_mad_i32_i24 v57, v56, -5, v55
v_lshl_add_u32 v44, v56, 2, v59
v_mad_u32_u24 v56, v56, s53, v58
v_lshl_add_u32 v34, v57, 7, v56
v_add_u32 v55, 10, v54
v_mul_u32_u24 v56, s54, v55
v_lshrrev_b32 v56, 18, v56
v_mad_i32_i24 v57, v56, -5, v55
v_lshl_add_u32 v45, v56, 2, v59
v_mad_u32_u24 v56, v56, s53, v58
v_lshl_add_u32 v35, v57, 7, v56
v_add_u32 v55, 16, v54
v_mul_u32_u24 v56, s54, v55
v_lshrrev_b32 v56, 18, v56
v_mad_i32_i24 v57, v56, -5, v55
v_lshl_add_u32 v46, v56, 2, v59
v_mad_u32_u24 v56, v56, s53, v58
v_lshl_add_u32 v36, v57, 7, v56
v_add_u32 v55, 18, v54
v_mul_u32_u24 v56, s54, v55
v_lshrrev_b32 v56, 18, v56
v_mad_i32_i24 v57, v56, -5, v55
v_lshl_add_u32 v47, v56, 2, v59
v_mad_u32_u24 v56, v56, s53, v58
v_lshl_add_u32 v37, v57, 7, v56
v_add_u32 v55, 24, v54
v_mul_u32_u24 v56, s54, v55
v_lshrrev_b32 v56, 18, v56
v_mad_i32_i24 v57, v56, -5, v55
v_lshl_add_u32 v48, v56, 2, v59
v_mad_u32_u24 v56, v56, s53, v58
v_lshl_add_u32 v38, v57, 7, v56
v_add_u32 v55, 26, v54
v_mul_u32_u24 v56, s54, v55
v_lshrrev_b32 v56, 18, v56
v_mad_i32_i24 v57, v56, -5, v55
v_lshl_add_u32 v49, v56, 2, v59
v_mad_u32_u24 v56, v56, s53, v58
v_lshl_add_u32 v39, v57, 7, v56
v_add_u32 v55, 32, v54
v_mul_u32_u24 v56, s54, v55
v_lshrrev_b32 v56, 18, v56
v_mad_i32_i24 v57, v56, -5, v55
v_lshl_add_u32 v50, v56, 2, v59
v_mad_u32_u24 v56, v56, s53, v58
v_lshl_add_u32 v40, v57, 7, v56
v_add_u32 v55, 34, v54
v_mul_u32_u24 v56, s54, v55
v_lshrrev_b32 v56, 18, v56
v_mad_i32_i24 v57, v56, -5, v55
v_lshl_add_u32 v51, v56, 2, v59
v_mad_u32_u24 v56, v56, s53, v58
v_lshl_add_u32 v41, v57, 7, v56
s_mul_i32 s51, s48, 5120
v_add_u32 v7, s51, v4
v_add_u32 v8, 40960, v7
s_lshl_b32 s51, s48, 4
v_add_u32 v12, s51, v52
v_mul_u32_u24 v12, 1280, v12
v_lshl_add_u32 v12, v53, 3, v12
s_mul_i32 s51, s48, 3072
s_add_u32 s51, s51, 110848
v_lshrrev_b32 v55, 3, v1
v_mul_u32_u24 v55, 360, v55
v_and_b32 v56, 7, v1
v_mul_u32_u24 v56, 6, v56
v_add3_u32 v17, v55, v56, s51
v_min_u32 v55, 8, v52
v_mul_u32_u24 v55, 320, v55
v_lshl_add_u32 v55, v54, 3, v55
v_add_u32 v28, s51, v55
v_add_u32 v55, s51, v4
v_mov_b32 v60, 0
v_mov_b32 v61, 0
v_mov_b32 v62, 0
v_mov_b32 v63, 0
ds_write_b128 v55, v[60:63]
ds_write_b128 v55, v[60:63] offset:1024
ds_write_b128 v55, v[60:63] offset:2048
s_waitcnt vmcnt(0)
s_barrier
s_lshl_b32 s51, s49, 4
s_add_u32 s51, s51, s50
s_lshl_b32 s51, s51, 7
s_add_u32 s51, s51, 12517376
s_cmp_eq_u32 s48, 0
s_cselect_b32 s51, s51, 17825792
v_mov_b32 v72, v30
v_mov_b32 v73, v30
v_mov_b32 v74, v30
v_mov_b32 v75, v30
v_cmp_gt_u32 vcc, 8, v1
s_nop 1
v_cndmask_b32 v76, v31, v4, vcc
buffer_store_dwordx4 v[72:75], v76, s[24:27], s51 offen sc1
s_lshr_b32 s51, s40, 1
s_lshl_b32 s51, s51, 4
v_add_u32 v84, s51, v1
v_lshlrev_b32 v84, 7, v84
v_cmp_gt_u32 vcc, 16, v1
s_nop 1
v_cndmask_b32 v84, v31, v84, vcc
buffer_load_dwordx2 v[18:19], v12, s[16:19], s46 offen
buffer_load_dwordx2 v[20:21], v12, s[16:19], s46 offen offset:32
buffer_load_dwordx2 v[22:23], v12, s[16:19], s46 offen offset:64
buffer_load_dwordx2 v[24:25], v12, s[16:19], s46 offen offset:96
buffer_load_dwordx2 v[26:27], v12, s[16:19], s46 offen offset:128
s_mul_i32 s51, s44, 25600
s_mul_i32 s52, s45, 160
s_add_u32 s65, s51, s52
s_lshl_b32 s51, s48, 6
v_add_u32 v55, s51, v1
v_mul_u32_u24 v56, 6554, v55
v_lshrrev_b32 v56, 16, v56
v_mad_i32_i24 v57, v56, -10, v55
v_mul_u32_u24 v56, 1280, v56
v_lshl_add_u32 v58, v57, 4, v56
v_add_u32 v55, 256, v1
v_mul_u32_u24 v56, 6554, v55
v_lshrrev_b32 v56, 16, v56
v_mad_i32_i24 v57, v56, -10, v55
v_mul_u32_u24 v56, 1280, v56
v_lshl_add_u32 v59, v57, 4, v56
s_lshl_b32 s51, s48, 10
s_add_u32 m0, s51, 88064
s_cmp_eq_u32 s48, 0
buffer_load_dwordx4 v58, s[36:39], s65 offen lds
s_cselect_b32 s51, s65, 2147483647
s_cselect_b32 s52, 0, 1024
s_add_u32 m0, s52, 92160
s_nop 0
buffer_load_dwordx4 v59, s[36:39], s51 offen lds
s_sub_u32 s65, s65, 320
s_lshl_b32 s51, s48, 10
s_add_u32 m0, s51, 104704
s_cmp_eq_u32 s48, 0
buffer_load_dwordx4 v58, s[36:39], s65 offen lds
s_cselect_b32 s51, s65, 2147483647
s_cselect_b32 s52, 0, 1024
s_add_u32 m0, s52, 108800
s_nop 0
buffer_load_dwordx4 v59, s[36:39], s51 offen lds
s_mov_b32 s75, 12517376
s_cmp_eq_u32 s48, 0
s_cselect_b32 s75, s75, 17825792
buffer_load_dword v86, v84, s[24:27], s75 offen sc1
s_waitcnt vmcnt(0)
v_mov_b32 v86, v86
s_cmp_lg_u32 s48, 0
s_cbranch_scc1 POKLBQ
v_cmp_ne_u32 vcc, v86, v30
s_nop 3
s_and_b32 vcc_lo, vcc_lo, 61166
s_and_b32 vcc_hi, vcc_hi, 0
s_or_b32 s76, vcc_lo, vcc_hi
s_cbranch_scc0 POKLBQ
s_mov_b32 s77, 4000
s_mov_b32 s75, 12517376
PSPLBQ:
s_sleep 3
buffer_load_dword v86, v84, s[24:27], s75 offen sc1
s_waitcnt vmcnt(0)
v_cmp_ne_u32 vcc, v86, v30
s_nop 3
s_and_b32 vcc_lo, vcc_lo, 61166
s_and_b32 vcc_hi, vcc_hi, 0
s_or_b32 s76, vcc_lo, vcc_hi
s_cbranch_scc0 POKLBQ
s_sub_u32 s77, s77, 1
s_cmp_lg_u32 s77, 0
s_cbranch_scc1 PSPLBQ
POKLBQ:
s_barrier
buffer_load_dwordx4 a[160:163], v2, s[8:11], s42 offen offset:0 sc1
buffer_load_dwordx4 a[164:167], v2, s[8:11], s42 offen offset:256 sc1
buffer_load_dwordx4 a[168:171], v3, s[8:11], s42 offen offset:0 sc1
buffer_load_dwordx4 a[172:175], v3, s[8:11], s42 offen offset:256 sc1
s_add_u32 s42, s42, 8192
buffer_load_dwordx4 a[176:179], v2, s[8:11], s42 offen offset:0 sc1
buffer_load_dwordx4 a[180:183], v2, s[8:11], s42 offen offset:256 sc1
buffer_load_dwordx4 a[184:187], v3, s[8:11], s42 offen offset:0 sc1
buffer_load_dwordx4 a[188:191], v3, s[8:11], s42 offen offset:256 sc1
s_add_u32 s42, s42, 8192
buffer_load_dwordx4 a[192:195], v2, s[8:11], s42 offen offset:0 sc1
buffer_load_dwordx4 a[196:199], v2, s[8:11], s42 offen offset:256 sc1
buffer_load_dwordx4 a[200:203], v3, s[8:11], s42 offen offset:0 sc1
buffer_load_dwordx4 a[204:207], v3, s[8:11], s42 offen offset:256 sc1
s_add_u32 s42, s42, 8192
s_waitcnt vmcnt(11)
v_mfma_f32_16x16x32_bf16 v[176:179], a[0:3], a[160:163], 0
buffer_load_dwordx4 a[208:211], v2, s[8:11], s42 offen offset:0 sc1
v_lshlrev_b32 v52, 4, v0
v_cmp_gt_u32 vcc, 160, v0
s_nop 1
v_cndmask_b32 v52, v31, v52, vcc
s_lshl_b32 s64, s44, 16
s_add_u32 s64, s64, 12582912
buffer_load_dwordx4 v[96:99], v52, s[24:27], s64 offen sc1
s_add_u32 s64, s64, 4096
buffer_load_dwordx4 v[100:103], v52, s[24:27], s64 offen sc1
s_add_u32 s64, s64, 4096
buffer_load_dwordx4 v[104:107], v52, s[24:27], s64 offen sc1
s_add_u32 s64, s64, 4096
buffer_load_dwordx4 v[108:111], v52, s[24:27], s64 offen sc1
s_add_u32 s64, s64, 4096
buffer_load_dwordx4 v[112:115], v52, s[24:27], s64 offen sc1
s_add_u32 s64, s64, 4096
buffer_load_dwordx4 v[116:119], v52, s[24:27], s64 offen sc1
s_add_u32 s64, s64, 4096
buffer_load_dwordx4 v[120:123], v52, s[24:27], s64 offen sc1
s_add_u32 s64, s64, 4096
buffer_load_dwordx4 v[124:127], v52, s[24:27], s64 offen sc1
s_add_u32 s64, s64, 4096
buffer_load_dwordx4 v[128:131], v52, s[24:27], s64 offen sc1
s_add_u32 s64, s64, 4096
buffer_load_dwordx4 v[132:135], v52, s[24:27], s64 offen sc1
s_add_u32 s64, s64, 4096
buffer_load_dwordx4 v[136:139], v52, s[24:27], s64 offen sc1
s_add_u32 s64, s64, 4096
buffer_load_dwordx4 v[140:143], v52, s[24:27], s64 offen sc1
s_add_u32 s64, s64, 4096
buffer_load_dwordx4 v[144:147], v52, s[24:27], s64 offen sc1
s_add_u32 s64, s64, 4096
buffer_load_dwordx4 v[148:151], v52, s[24:27], s64 offen sc1
s_add_u32 s64, s64, 4096
buffer_load_dwordx4 v[152:155], v52, s[24:27], s64 offen sc1
s_add_u32 s64, s64, 4096
buffer_load_dwordx4 v[156:159], v52, s[24:27], s64 offen sc1
v_mfma_f32_16x16x32_bf16 v[180:183], a[4:7], a[160:163], 0
buffer_load_dwordx4 a[212:215], v2, s[8:11], s42 offen offset:256 sc1
v_mfma_f32_16x16x32_bf16 v[184:187], a[8:11], a[160:163], 0
buffer_load_dwordx4 a[216:219], v3, s[8:11], s42 offen offset:0 sc1
v_mfma_f32_16x16x32_bf16 v[188:191], a[12:15], a[160:163], 0
buffer_load_dwordx4 a[220:223], v3, s[8:11], s42 offen offset:256 sc1
v_mfma_f32_16x16x32_bf16 v[192:195], a[16:19], a[160:163], 0
s_add_u32 s42, s42, 8192
s_waitcnt vmcnt(30)
v_mfma_f32_16x16x32_bf16 v[196:199], a[0:3], a[164:167], 0
v_mfma_f32_16x16x32_bf16 v[200:203], a[4:7], a[164:167], 0
v_mfma_f32_16x16x32_bf16 v[204:207], a[8:11], a[164:167], 0
v_mfma_f32_16x16x32_bf16 v[208:211], a[12:15], a[164:167], 0
v_mfma_f32_16x16x32_bf16 v[212:215], a[16:19], a[164:167], 0
s_waitcnt vmcnt(29)
v_mfma_f32_16x16x32_bf16 v[216:219], a[0:3], a[168:171], 0
v_mfma_f32_16x16x32_bf16 v[220:223], a[4:7], a[168:171], 0
v_mfma_f32_16x16x32_bf16 v[224:227], a[8:11], a[168:171], 0
v_mfma_f32_16x16x32_bf16 v[228:231], a[12:15], a[168:171], 0
v_mfma_f32_16x16x32_bf16 v[232:235], a[16:19], a[168:171], 0
s_waitcnt vmcnt(28)
v_mfma_f32_16x16x32_bf16 v[236:239], a[0:3], a[172:175], 0
v_mfma_f32_16x16x32_bf16 v[240:243], a[4:7], a[172:175], 0
v_mfma_f32_16x16x32_bf16 v[244:247], a[8:11], a[172:175], 0
v_mfma_f32_16x16x32_bf16 v[248:251], a[12:15], a[172:175], 0
v_mfma_f32_16x16x32_bf16 v[252:255], a[16:19], a[172:175], 0
s_waitcnt vmcnt(27)
v_mfma_f32_16x16x32_bf16 v[176:179], a[20:23], a[176:179], v[176:179]
buffer_load_dwordx4 a[160:163], v2, s[8:11], s42 offen offset:0 sc1
v_mfma_f32_16x16x32_bf16 v[180:183], a[24:27], a[176:179], v[180:183]
buffer_load_dwordx4 a[164:167], v2, s[8:11], s42 offen offset:256 sc1
v_mfma_f32_16x16x32_bf16 v[184:187], a[28:31], a[176:179], v[184:187]
buffer_load_dwordx4 a[168:171], v3, s[8:11], s42 offen offset:0 sc1
v_mfma_f32_16x16x32_bf16 v[188:191], a[32:35], a[176:179], v[188:191]
buffer_load_dwordx4 a[172:175], v3, s[8:11], s42 offen offset:256 sc1
v_mfma_f32_16x16x32_bf16 v[192:195], a[36:39], a[176:179], v[192:195]
s_add_u32 s42, s42, 8192
s_waitcnt vmcnt(30)
v_mfma_f32_16x16x32_bf16 v[196:199], a[20:23], a[180:183], v[196:199]
v_mfma_f32_16x16x32_bf16 v[200:203], a[24:27], a[180:183], v[200:203]
v_mfma_f32_16x16x32_bf16 v[204:207], a[28:31], a[180:183], v[204:207]
v_mfma_f32_16x16x32_bf16 v[208:211], a[32:35], a[180:183], v[208:211]
v_mfma_f32_16x16x32_bf16 v[212:215], a[36:39], a[180:183], v[212:215]
s_waitcnt vmcnt(29)
v_mfma_f32_16x16x32_bf16 v[216:219], a[20:23], a[184:187], v[216:219]
v_mfma_f32_16x16x32_bf16 v[220:223], a[24:27], a[184:187], v[220:223]
v_mfma_f32_16x16x32_bf16 v[224:227], a[28:31], a[184:187], v[224:227]
v_mfma_f32_16x16x32_bf16 v[228:231], a[32:35], a[184:187], v[228:231]
v_mfma_f32_16x16x32_bf16 v[232:235], a[36:39], a[184:187], v[232:235]
s_waitcnt vmcnt(28)
v_mfma_f32_16x16x32_bf16 v[236:239], a[20:23], a[188:191], v[236:239]
v_mfma_f32_16x16x32_bf16 v[240:243], a[24:27], a[188:191], v[240:243]
v_mfma_f32_16x16x32_bf16 v[244:247], a[28:31], a[188:191], v[244:247]
v_mfma_f32_16x16x32_bf16 v[248:251], a[32:35], a[188:191], v[248:251]
v_mfma_f32_16x16x32_bf16 v[252:255], a[36:39], a[188:191], v[252:255]
s_waitcnt vmcnt(22)
v_xor_b32 v53, v99, v30
s_waitcnt vmcnt(21)
v_xor_b32 v54, v103, v30
v_or_b32 v53, v53, v54
s_waitcnt vmcnt(20)
v_xor_b32 v54, v107, v30
v_or_b32 v53, v53, v54
s_waitcnt vmcnt(19)
v_xor_b32 v54, v111, v30
v_or_b32 v53, v53, v54
s_waitcnt vmcnt(18)
v_xor_b32 v54, v115, v30
v_or_b32 v53, v53, v54
s_waitcnt vmcnt(17)
v_xor_b32 v54, v119, v30
v_or_b32 v53, v53, v54
s_waitcnt vmcnt(16)
v_xor_b32 v54, v123, v30
v_or_b32 v53, v53, v54
s_waitcnt vmcnt(15)
v_xor_b32 v54, v127, v30
v_or_b32 v53, v53, v54
s_waitcnt vmcnt(14)
v_xor_b32 v54, v131, v30
v_or_b32 v53, v53, v54
s_waitcnt vmcnt(13)
v_xor_b32 v54, v135, v30
v_or_b32 v53, v53, v54
s_waitcnt vmcnt(12)
v_xor_b32 v54, v139, v30
v_or_b32 v53, v53, v54
s_waitcnt vmcnt(11)
v_xor_b32 v54, v143, v30
v_or_b32 v53, v53, v54
s_waitcnt vmcnt(10)
v_xor_b32 v54, v147, v30
v_or_b32 v53, v53, v54
s_waitcnt vmcnt(9)
v_xor_b32 v54, v151, v30
v_or_b32 v53, v53, v54
s_waitcnt vmcnt(8)
v_xor_b32 v54, v155, v30
v_or_b32 v53, v53, v54
s_waitcnt vmcnt(7)
v_xor_b32 v54, v159, v30
v_or_b32 v53, v53, v54
v_cmp_ne_u32 vcc, 0, v53
v_cmp_ne_u32 s[60:61], v31, v52
s_nop 3
s_and_b64 vcc, vcc, s[60:61]
s_cbranch_vccz PPOKBQ
s_mov_b32 s77, 4000
PPSPBQ:
s_sleep 3
s_lshl_b32 s64, s44, 16
s_add_u32 s64, s64, 12582912
buffer_load_dwordx4 v[96:99], v52, s[24:27], s64 offen sc1
s_add_u32 s64, s64, 4096
buffer_load_dwordx4 v[100:103], v52, s[24:27], s64 offen sc1
s_add_u32 s64, s64, 4096
buffer_load_dwordx4 v[104:107], v52, s[24:27], s64 offen sc1
s_add_u32 s64, s64, 4096
buffer_load_dwordx4 v[108:111], v52, s[24:27], s64 offen sc1
s_add_u32 s64, s64, 4096
buffer_load_dwordx4 v[112:115], v52, s[24:27], s64 offen sc1
s_add_u32 s64, s64, 4096
buffer_load_dwordx4 v[116:119], v52, s[24:27], s64 offen sc1
s_add_u32 s64, s64, 4096
buffer_load_dwordx4 v[120:123], v52, s[24:27], s64 offen sc1
s_add_u32 s64, s64, 4096
buffer_load_dwordx4 v[124:127], v52, s[24:27], s64 offen sc1
s_add_u32 s64, s64, 4096
buffer_load_dwordx4 v[128:131], v52, s[24:27], s64 offen sc1
s_add_u32 s64, s64, 4096
buffer_load_dwordx4 v[132:135], v52, s[24:27], s64 offen sc1
s_add_u32 s64, s64, 4096
buffer_load_dwordx4 v[136:139], v52, s[24:27], s64 offen sc1
s_add_u32 s64, s64, 4096
buffer_load_dwordx4 v[140:143], v52, s[24:27], s64 offen sc1
s_add_u32 s64, s64, 4096
buffer_load_dwordx4 v[144:147], v52, s[24:27], s64 offen sc1
s_add_u32 s64, s64, 4096
buffer_load_dwordx4 v[148:151], v52, s[24:27], s64 offen sc1
s_add_u32 s64, s64, 4096
buffer_load_dwordx4 v[152:155], v52, s[24:27], s64 offen sc1
s_add_u32 s64, s64, 4096
buffer_load_dwordx4 v[156:159], v52, s[24:27], s64 offen sc1
s_waitcnt vmcnt(0)
v_xor_b32 v53, v99, v30
v_xor_b32 v54, v103, v30
v_or_b32 v53, v53, v54
v_xor_b32 v54, v107, v30
v_or_b32 v53, v53, v54
v_xor_b32 v54, v111, v30
v_or_b32 v53, v53, v54
v_xor_b32 v54, v115, v30
v_or_b32 v53, v53, v54
v_xor_b32 v54, v119, v30
v_or_b32 v53, v53, v54
v_xor_b32 v54, v123, v30
v_or_b32 v53, v53, v54
v_xor_b32 v54, v127, v30
v_or_b32 v53, v53, v54
v_xor_b32 v54, v131, v30
v_or_b32 v53, v53, v54
v_xor_b32 v54, v135, v30
v_or_b32 v53, v53, v54
v_xor_b32 v54, v139, v30
v_or_b32 v53, v53, v54
v_xor_b32 v54, v143, v30
v_or_b32 v53, v53, v54
v_xor_b32 v54, v147, v30
v_or_b32 v53, v53, v54
v_xor_b32 v54, v151, v30
v_or_b32 v53, v53, v54
v_xor_b32 v54, v155, v30
v_or_b32 v53, v53, v54
v_xor_b32 v54, v159, v30
v_or_b32 v53, v53, v54
v_cmp_ne_u32 vcc, 0, v53
v_cmp_ne_u32 s[60:61], v31, v52
s_nop 3
s_and_b64 vcc, vcc, s[60:61]
s_sub_u32 s77, s77, 1
s_cbranch_vccz PPOKBQ
s_cmp_lg_u32 s77, 0
s_cbranch_scc1 PPSPBQ
PPOKBQ:
v_mfma_f32_16x16x32_bf16 v[176:179], a[40:43], a[192:195], v[176:179]
buffer_load_dwordx4 a[176:179], v2, s[8:11], s42 offen offset:0 sc1
v_add_f32 v96, v96, v128
v_add_f32 v97, v97, v129
v_add_f32 v98, v98, v130
v_add_f32 v100, v100, v132
v_mfma_f32_16x16x32_bf16 v[180:183], a[44:47], a[192:195], v[180:183]
buffer_load_dwordx4 a[180:183], v2, s[8:11], s42 offen offset:256 sc1
v_add_f32 v101, v101, v133
v_add_f32 v102, v102, v134
v_add_f32 v104, v104, v136
v_add_f32 v105, v105, v137
v_mfma_f32_16x16x32_bf16 v[184:187], a[48:51], a[192:195], v[184:187]
buffer_load_dwordx4 a[184:187], v3, s[8:11], s42 offen offset:0 sc1
v_add_f32 v106, v106, v138
v_add_f32 v108, v108, v140
v_add_f32 v109, v109, v141
v_add_f32 v110, v110, v142
v_mfma_f32_16x16x32_bf16 v[188:191], a[52:55], a[192:195], v[188:191]
buffer_load_dwordx4 a[188:191], v3, s[8:11], s42 offen offset:256 sc1
v_add_f32 v112, v112, v144
v_add_f32 v113, v113, v145
v_add_f32 v114, v114, v146
v_add_f32 v116, v116, v148
v_mfma_f32_16x16x32_bf16 v[192:195], a[56:59], a[192:195], v[192:195]
s_add_u32 s42, s42, 8192
v_add_f32 v117, v117, v149
v_add_f32 v118, v118, v150
v_add_f32 v120, v120, v152
v_add_f32 v121, v121, v153
v_mfma_f32_16x16x32_bf16 v[196:199], a[40:43], a[196:199], v[196:199]
v_add_f32 v122, v122, v154
v_add_f32 v124, v124, v156
v_add_f32 v125, v125, v157
v_add_f32 v126, v126, v158
v_add_f32 v96, v96, v112
v_mfma_f32_16x16x32_bf16 v[200:203], a[44:47], a[196:199], v[200:203]
v_add_f32 v97, v97, v113
v_add_f32 v98, v98, v114
v_add_f32 v100, v100, v116
v_add_f32 v101, v101, v117
v_add_f32 v102, v102, v118
v_mfma_f32_16x16x32_bf16 v[204:207], a[48:51], a[196:199], v[204:207]
v_add_f32 v104, v104, v120
v_add_f32 v105, v105, v121
v_add_f32 v106, v106, v122
v_add_f32 v108, v108, v124
v_add_f32 v109, v109, v125
v_mfma_f32_16x16x32_bf16 v[208:211], a[52:55], a[196:199], v[208:211]
v_add_f32 v110, v110, v126
v_add_f32 v96, v96, v104
v_add_f32 v97, v97, v105
v_add_f32 v98, v98, v106
v_add_f32 v100, v100, v108
v_mfma_f32_16x16x32_bf16 v[212:215], a[56:59], a[196:199], v[212:215]
v_add_f32 v101, v101, v109
v_add_f32 v102, v102, v110
v_add_f32 v96, v96, v100
v_add_f32 v97, v97, v101
v_add_f32 v98, v98, v102
v_mfma_f32_16x16x32_bf16 v[216:219], a[40:43], a[200:203], v[216:219]
v_lshrrev_b32 v52, 3, v0
v_bfe_u32 v53, v0, 2, 1
v_and_b32 v54, 3, v0
v_mul_u32_u24 v54, 3, v54
v_lshlrev_b32 v53, 2, v53
v_mfma_f32_16x16x32_bf16 v[220:223], a[44:47], a[200:203], v[220:223]
v_lshlrev_b32 v59, 6, v52
v_add_u32 v59, 65536, v59
v_lshlrev_b32 v58, 2, v52
v_add_u32 v58, 73728, v58
v_cvt_pk_bf16_f32 v100, v96, v97
v_mfma_f32_16x16x32_bf16 v[224:227], a[48:51], a[200:203], v[224:227]
v_cvt_pk_bf16_f32 v101, v98, v98
v_add_u32 v55, 0, v54
v_lshrrev_b32 v56, 2, v55
v_and_b32 v55, 3, v55
v_lshl_add_u32 v55, v56, 3, v55
v_mfma_f32_16x16x32_bf16 v[228:231], a[52:55], a[200:203], v[228:231]
v_add_u32 v55, v55, v53
v_lshl_add_u32 v56, v55, 1, v59
v_cmp_gt_u32 vcc, 20, v55
s_nop 1
v_cndmask_b32 v57, 0, v100, vcc
ds_write_b16 v56, v57 offset:20480
v_mfma_f32_16x16x32_bf16 v[232:235], a[56:59], a[200:203], v[232:235]
v_add_u32 v55, 1, v54
v_lshrrev_b32 v56, 2, v55
v_and_b32 v55, 3, v55
v_lshl_add_u32 v55, v56, 3, v55
v_add_u32 v55, v55, v53
v_mfma_f32_16x16x32_bf16 v[236:239], a[40:43], a[204:207], v[236:239]
v_lshl_add_u32 v56, v55, 1, v59
v_cmp_gt_u32 vcc, 20, v55
s_nop 1
v_cndmask_b32 v57, 0, v100, vcc
ds_write_b16_d16_hi v56, v57 offset:20480
v_add_u32 v55, 2, v54
v_mfma_f32_16x16x32_bf16 v[240:243], a[44:47], a[204:207], v[240:243]
v_lshrrev_b32 v56, 2, v55
v_and_b32 v55, 3, v55
v_lshl_add_u32 v55, v56, 3, v55
v_add_u32 v55, v55, v53
v_lshl_add_u32 v56, v55, 1, v59
v_mfma_f32_16x16x32_bf16 v[244:247], a[48:51], a[204:207], v[244:247]
v_cmp_gt_u32 vcc, 20, v55
s_nop 1
v_cndmask_b32 v57, 0, v101, vcc
ds_write_b16 v56, v57 offset:20480
v_cmp_eq_u32 vcc, 20, v55
s_mov_b64 s[60:61], exec
s_nop 2
s_mov_b64 exec, vcc
ds_write_b32 v58, v98 offset:20480
s_mov_b64 exec, s[60:61]
v_and_b32 v55, 3, v0
v_mfma_f32_16x16x32_bf16 v[248:251], a[52:55], a[204:207], v[248:251]
v_cmp_eq_u32 vcc, 3, v55
v_lshlrev_b32 v56, 1, v53
v_add_u32 v56, v56, v59
v_mov_b32 v102, 0
v_mov_b32 v103, 0
v_mfma_f32_16x16x32_bf16 v[252:255], a[56:59], a[204:207], v[252:255]
s_mov_b64 s[60:61], exec
s_mov_b64 exec, vcc
ds_write_b64 v56, v[102:103] offset:20528
s_mov_b64 exec, s[60:61]
v_and_b32 v52, 15, v1
v_mfma_f32_16x16x32_bf16 v[176:179], a[60:63], a[208:211], v[176:179]
buffer_load_dwordx4 a[192:195], v2, s[8:11], s42 offen offset:0 sc1
v_lshrrev_b32 v53, 4, v1
v_lshlrev_b32 v54, 6, v52
v_lshl_add_u32 v54, v53, 4, v54
v_add_u32 v54, 65536, v54
v_mfma_f32_16x16x32_bf16 v[180:183], a[64:67], a[208:211], v[180:183]
buffer_load_dwordx4 a[196:199], v2, s[8:11], s42 offen offset:256 sc1
v_lshrrev_b32 v56, 2, v52
v_lshl_add_u32 v55, v53, 3, v56
v_mul_u32_u24 v55, 160, v55
v_and_b32 v56, 3, v1
v_mfma_f32_16x16x32_bf16 v[184:187], a[68:71], a[208:211], v[184:187]
buffer_load_dwordx4 a[200:203], v3, s[8:11], s42 offen offset:0 sc1
v_lshl_add_u32 v55, v56, 3, v55
v_add_u32 v55, 65536, v55
v_lshlrev_b32 v68, 7, v53
v_lshl_add_u32 v68, v52, 3, v68
v_mfma_f32_16x16x32_bf16 v[188:191], a[72:75], a[208:211], v[188:191]
buffer_load_dwordx4 a[204:207], v3, s[8:11], s42 offen offset:256 sc1
v_lshlrev_b32 v56, 3, v52
v_add_u32 v56, 512, v56
v_cmp_eq_u32 vcc, 0, v53
s_nop 1
v_cndmask_b32 v69, v31, v56, vcc
s_lshl_b32 s66, s44, 3
s_add_u32 s66, s66, s45
s_mul_i32 s66, s66, 3200
s_add_u32 s66, s66, 11534336
s_waitcnt lgkmcnt(0)
s_barrier
v_mfma_f32_16x16x32_bf16 v[192:195], a[76:79], a[208:211], v[192:195]
s_add_u32 s42, s42, 8192
ds_read_b128 v[60:63], v54 offset:20480
ds_read_b128 v[64:67], v54 offset:21504
s_lshl_b32 s51, s48, 5
v_add_u32 v56, s51, v55
s_waitcnt vmcnt(14)
v_mfma_f32_16x16x32_bf16 v[196:199], a[60:63], a[212:215], v[196:199]
v_add_u32 v57, 128, v55
ds_read_b64_tr_b16 v[72:73], v56 offset:22528
ds_read_b64_tr_b16 v[74:75], v56 offset:23168
ds_read_b64_tr_b16 v[84:85], v57 offset:22528
ds_read_b64_tr_b16 v[86:87], v57 offset:23168
v_mfma_f32_16x16x32_bf16 v[200:203], a[64:67], a[212:215], v[200:203]
s_mul_i32 s67, s48, 640
s_add_u32 s67, s67, s66
s_add_u32 s68, s66, 2560
s_cmp_eq_u32 s48, 0
s_cselect_b32 s68, s68, 17825792
s_waitcnt lgkmcnt(2)
v_mfma_f32_16x16x32_bf16 v[76:79], v[60:63], v[72:75], 0
v_mfma_f32_16x16x32_bf16 v[204:207], a[68:71], a[212:215], v[204:207]
v_mfma_f32_16x16x32_bf16 v[80:83], v[64:67], v[72:75], 0
s_waitcnt lgkmcnt(0)
v_mfma_f32_16x16x32_bf16 v[88:91], v[60:63], v[84:87], 0
v_mfma_f32_16x16x32_bf16 v[92:95], v[64:67], v[84:87], 0
s_nop 2
v_cvt_pk_bf16_f32 v76, v76, v77
v_cvt_pk_bf16_f32 v77, v78, v79
v_mfma_f32_16x16x32_bf16 v[208:211], a[72:75], a[212:215], v[208:211]
buffer_store_dwordx2 v[76:77], v68, s[24:27], s67 offen sc1
v_cvt_pk_bf16_f32 v80, v80, v81
v_cvt_pk_bf16_f32 v81, v82, v83
buffer_store_dwordx2 v[80:81], v69, s[24:27], s67 offen sc1
v_cvt_pk_bf16_f32 v88, v88, v89
v_mfma_f32_16x16x32_bf16 v[212:215], a[76:79], a[212:215], v[212:215]
v_cvt_pk_bf16_f32 v89, v90, v91
buffer_store_dwordx2 v[88:89], v68, s[24:27], s68 offen sc1
v_cvt_pk_bf16_f32 v92, v92, v93
v_cvt_pk_bf16_f32 v93, v94, v95
buffer_store_dwordx2 v[92:93], v69, s[24:27], s68 offen sc1
s_waitcnt vmcnt(17)
v_mfma_f32_16x16x32_bf16 v[216:219], a[60:63], a[216:219], v[216:219]
ds_read_b64_tr_b16 v[72:73], v56 offset:39168
ds_read_b64_tr_b16 v[74:75], v56 offset:39808
ds_read_b64_tr_b16 v[84:85], v57 offset:39168
ds_read_b64_tr_b16 v[86:87], v57 offset:39808
s_sub_u32 s66, s66, 6400
s_mul_i32 s67, s48, 640
s_add_u32 s67, s67, s66
s_add_u32 s68, s66, 2560
s_cmp_eq_u32 s48, 0
s_cselect_b32 s68, s68, 17825792
s_waitcnt lgkmcnt(2)
v_mfma_f32_16x16x32_bf16 v[76:79], v[60:63], v[72:75], 0
v_mfma_f32_16x16x32_bf16 v[220:223], a[64:67], a[216:219], v[220:223]
v_mfma_f32_16x16x32_bf16 v[80:83], v[64:67], v[72:75], 0
s_waitcnt lgkmcnt(0)
v_mfma_f32_16x16x32_bf16 v[88:91], v[60:63], v[84:87], 0
v_mfma_f32_16x16x32_bf16 v[92:95], v[64:67], v[84:87], 0
s_nop 2
v_cvt_pk_bf16_f32 v76, v76, v77
v_cvt_pk_bf16_f32 v77, v78, v79
v_mfma_f32_16x16x32_bf16 v[224:227], a[68:71], a[216:219], v[224:227]
buffer_store_dwordx2 v[76:77], v68, s[24:27], s67 offen sc1
v_cvt_pk_bf16_f32 v80, v80, v81
v_cvt_pk_bf16_f32 v81, v82, v83
buffer_store_dwordx2 v[80:81], v69, s[24:27], s67 offen sc1
v_cvt_pk_bf16_f32 v88, v88, v89
v_mfma_f32_16x16x32_bf16 v[228:231], a[72:75], a[216:219], v[228:231]
v_cvt_pk_bf16_f32 v89, v90, v91
buffer_store_dwordx2 v[88:89], v68, s[24:27], s68 offen sc1
v_cvt_pk_bf16_f32 v92, v92, v93
v_cvt_pk_bf16_f32 v93, v94, v95
buffer_store_dwordx2 v[92:93], v69, s[24:27], s68 offen sc1
v_mfma_f32_16x16x32_bf16 v[232:235], a[76:79], a[216:219], v[232:235]
s_mul_i32 s64, s48, 10240
s_add_u32 s64, s64, 98304
buffer_load_dwordx4 v[96:99], v2, s[8:11], s64 offen offset:0 sc1
buffer_load_dwordx4 v[100:103], v2, s[8:11], s64 offen offset:256 sc1
buffer_load_dwordx4 v[104:107], v3, s[8:11], s64 offen offset:0 sc1
s_waitcnt vmcnt(23)
v_mfma_f32_16x16x32_bf16 v[236:239], a[60:63], a[220:223], v[236:239]
buffer_load_dwordx4 v[108:111], v3, s[8:11], s64 offen offset:256 sc1
s_add_u32 s64, s64, 2048
buffer_load_dwordx4 v[112:115], v2, s[8:11], s64 offen offset:0 sc1
buffer_load_dwordx4 v[116:119], v2, s[8:11], s64 offen offset:256 sc1
buffer_load_dwordx4 v[120:123], v3, s[8:11], s64 offen offset:0 sc1
v_mfma_f32_16x16x32_bf16 v[240:243], a[64:67], a[220:223], v[240:243]
buffer_load_dwordx4 v[124:127], v3, s[8:11], s64 offen offset:256 sc1
s_add_u32 s64, s64, 2048
buffer_load_dwordx4 v[128:131], v2, s[8:11], s64 offen offset:0 sc1
buffer_load_dwordx4 v[132:135], v2, s[8:11], s64 offen offset:256 sc1
buffer_load_dwordx4 v[136:139], v3, s[8:11], s64 offen offset:0 sc1
v_mfma_f32_16x16x32_bf16 v[244:247], a[68:71], a[220:223], v[244:247]
buffer_load_dwordx4 v[140:143], v3, s[8:11], s64 offen offset:256 sc1
s_add_u32 s64, s64, 2048
buffer_load_dwordx4 v[144:147], v2, s[8:11], s64 offen offset:0 sc1
buffer_load_dwordx4 v[148:151], v2, s[8:11], s64 offen offset:256 sc1
buffer_load_dwordx4 v[152:155], v3, s[8:11], s64 offen offset:0 sc1
v_mfma_f32_16x16x32_bf16 v[248:251], a[72:75], a[220:223], v[248:251]
buffer_load_dwordx4 v[156:159], v3, s[8:11], s64 offen offset:256 sc1
s_add_u32 s64, s64, 2048
buffer_load_dwordx4 v[160:163], v2, s[8:11], s64 offen offset:0 sc1
buffer_load_dwordx4 v[164:167], v2, s[8:11], s64 offen offset:256 sc1
buffer_load_dwordx4 v[168:171], v3, s[8:11], s64 offen offset:0 sc1
v_mfma_f32_16x16x32_bf16 v[252:255], a[76:79], a[220:223], v[252:255]
buffer_load_dwordx4 v[172:175], v3, s[8:11], s64 offen offset:256 sc1
s_add_u32 s64, s64, 2048
s_waitcnt vmcnt(39)
v_mfma_f32_16x16x32_bf16 v[176:179], a[80:83], a[160:163], v[176:179]
buffer_load_dwordx4 a[208:211], v2, s[8:11], s42 offen offset:0 sc1
v_mfma_f32_16x16x32_bf16 v[180:183], a[84:87], a[160:163], v[180:183]
buffer_load_dwordx4 a[212:215], v2, s[8:11], s42 offen offset:256 sc1
v_mfma_f32_16x16x32_bf16 v[184:187], a[88:91], a[160:163], v[184:187]
buffer_load_dwordx4 a[216:219], v3, s[8:11], s42 offen offset:0 sc1
v_mfma_f32_16x16x32_bf16 v[188:191], a[92:95], a[160:163], v[188:191]
buffer_load_dwordx4 a[220:223], v3, s[8:11], s42 offen offset:256 sc1
v_mfma_f32_16x16x32_bf16 v[192:195], a[96:99], a[160:163], v[192:195]
s_add_u32 s42, s42, 8192
s_waitcnt vmcnt(42)
v_mfma_f32_16x16x32_bf16 v[196:199], a[80:83], a[164:167], v[196:199]
buffer_load_dwordx4 a[0:3], v4, s[12:15], s43 offen offset:0 sc1
v_mfma_f32_16x16x32_bf16 v[200:203], a[84:87], a[164:167], v[200:203]
buffer_load_dwordx4 a[4:7], v4, s[12:15], s43 offen offset:1024 sc1
v_mfma_f32_16x16x32_bf16 v[204:207], a[88:91], a[164:167], v[204:207]
buffer_load_dwordx4 a[8:11], v4, s[12:15], s43 offen offset:2048 sc1
v_mfma_f32_16x16x32_bf16 v[208:211], a[92:95], a[164:167], v[208:211]
buffer_load_dwordx4 a[12:15], v4, s[12:15], s43 offen offset:3072 sc1
v_mfma_f32_16x16x32_bf16 v[212:215], a[96:99], a[164:167], v[212:215]
buffer_load_dwordx4 a[16:19], v5, s[12:15], s43 offen sc1
s_waitcnt vmcnt(46)
v_mfma_f32_16x16x32_bf16 v[216:219], a[80:83], a[168:171], v[216:219]
s_add_u32 s43, s43, 20480
v_mfma_f32_16x16x32_bf16 v[220:223], a[84:87], a[168:171], v[220:223]
v_mfma_f32_16x16x32_bf16 v[224:227], a[88:91], a[168:171], v[224:227]
v_mfma_f32_16x16x32_bf16 v[228:231], a[92:95], a[168:171], v[228:231]
v_mfma_f32_16x16x32_bf16 v[232:235], a[96:99], a[168:171], v[232:235]
s_waitcnt vmcnt(45)
v_mfma_f32_16x16x32_bf16 v[236:239], a[80:83], a[172:175], v[236:239]
v_mfma_f32_16x16x32_bf16 v[240:243], a[84:87], a[172:175], v[240:243]
v_mfma_f32_16x16x32_bf16 v[244:247], a[88:91], a[172:175], v[244:247]
v_mfma_f32_16x16x32_bf16 v[248:251], a[92:95], a[172:175], v[248:251]
v_mfma_f32_16x16x32_bf16 v[252:255], a[96:99], a[172:175], v[252:255]
s_waitcnt vmcnt(29)
s_barrier
v_mul_u32_u24 v52, 12, v1
v_add_u32 v52, 65536, v52
ds_read_b32 v60, v52 offset:28672
ds_read_b32 v61, v52 offset:28676
ds_read_b32 v62, v52 offset:28680
s_lshl_b32 s51, s44, 3
s_add_u32 s51, s51, s45
s_lshl_b32 s51, s51, 7
s_add_u32 s51, s51, 12386304
s_cmp_eq_u32 s48, 0
s_cselect_b32 s69, s51, 17825792
v_lshlrev_b32 v53, 4, v1
v_cmp_gt_u32 vcc, 8, v1
v_mov_b32 v63, v30
s_nop 0
v_cndmask_b32 v53, v31, v53, vcc
s_waitcnt lgkmcnt(0)
buffer_store_dwordx4 v[60:63], v53, s[24:27], s69 offen sc1
s_sub_u32 s51, s51, 256
s_cmp_eq_u32 s48, 0
s_cselect_b32 s69, s51, 17825792
buffer_store_dwordx4 v[60:63], v53, s[24:27], s69 offen sc1
v_mfma_f32_16x16x32_bf16 v[176:179], a[100:103], a[176:179], v[176:179]
buffer_load_dwordx4 a[160:163], v2, s[8:11], s42 offen offset:0 sc1
v_mfma_f32_16x16x32_bf16 v[180:183], a[104:107], a[176:179], v[180:183]
buffer_load_dwordx4 a[164:167], v2, s[8:11], s42 offen offset:256 sc1
v_mfma_f32_16x16x32_bf16 v[184:187], a[108:111], a[176:179], v[184:187]
buffer_load_dwordx4 a[168:171], v3, s[8:11], s42 offen offset:0 sc1
v_mfma_f32_16x16x32_bf16 v[188:191], a[112:115], a[176:179], v[188:191]
buffer_load_dwordx4 a[172:175], v3, s[8:11], s42 offen offset:256 sc1
v_mfma_f32_16x16x32_bf16 v[192:195], a[116:119], a[176:179], v[192:195]
s_add_u32 s42, s42, 8192
v_mfma_f32_16x16x32_bf16 v[196:199], a[100:103], a[180:183], v[196:199]
buffer_load_dwordx4 a[20:23], v4, s[12:15], s43 offen offset:0 sc1
v_mfma_f32_16x16x32_bf16 v[200:203], a[104:107], a[180:183], v[200:203]
buffer_load_dwordx4 a[24:27], v4, s[12:15], s43 offen offset:1024 sc1
v_mfma_f32_16x16x32_bf16 v[204:207], a[108:111], a[180:183], v[204:207]
buffer_load_dwordx4 a[28:31], v4, s[12:15], s43 offen offset:2048 sc1
v_mfma_f32_16x16x32_bf16 v[208:211], a[112:115], a[180:183], v[208:211]
buffer_load_dwordx4 a[32:35], v4, s[12:15], s43 offen offset:3072 sc1
v_mfma_f32_16x16x32_bf16 v[212:215], a[116:119], a[180:183], v[212:215]
buffer_load_dwordx4 a[36:39], v5, s[12:15], s43 offen sc1
v_mfma_f32_16x16x32_bf16 v[216:219], a[100:103], a[184:187], v[216:219]
s_add_u32 s43, s43, 20480
v_mfma_f32_16x16x32_bf16 v[220:223], a[104:107], a[184:187], v[220:223]
v_mfma_f32_16x16x32_bf16 v[224:227], a[108:111], a[184:187], v[224:227]
v_mfma_f32_16x16x32_bf16 v[228:231], a[112:115], a[184:187], v[228:231]
v_mfma_f32_16x16x32_bf16 v[232:235], a[116:119], a[184:187], v[232:235]
v_mfma_f32_16x16x32_bf16 v[236:239], a[100:103], a[188:191], v[236:239]
v_mfma_f32_16x16x32_bf16 v[240:243], a[104:107], a[188:191], v[240:243]
v_mfma_f32_16x16x32_bf16 v[244:247], a[108:111], a[188:191], v[244:247]
v_mfma_f32_16x16x32_bf16 v[248:251], a[112:115], a[188:191], v[248:251]
v_mfma_f32_16x16x32_bf16 v[252:255], a[116:119], a[188:191], v[252:255]
v_mfma_f32_16x16x32_bf16 v[176:179], a[120:123], a[192:195], v[176:179]
buffer_load_dwordx4 a[176:179], v2, s[8:11], s42 offen offset:0 sc1
v_mfma_f32_16x16x32_bf16 v[180:183], a[124:127], a[192:195], v[180:183]
buffer_load_dwordx4 a[180:183], v2, s[8:11], s42 offen offset:256 sc1
v_mfma_f32_16x16x32_bf16 v[184:187], a[128:131], a[192:195], v[184:187]
buffer_load_dwordx4 a[184:187], v3, s[8:11], s42 offen offset:0 sc1
v_mfma_f32_16x16x32_bf16 v[188:191], a[132:135], a[192:195], v[188:191]
buffer_load_dwordx4 a[188:191], v3, s[8:11], s42 offen offset:256 sc1
v_mfma_f32_16x16x32_bf16 v[192:195], a[136:139], a[192:195], v[192:195]
s_add_u32 s42, s42, 8192
v_mfma_f32_16x16x32_bf16 v[196:199], a[120:123], a[196:199], v[196:199]
buffer_load_dwordx4 a[40:43], v4, s[12:15], s43 offen offset:0 sc1
v_mfma_f32_16x16x32_bf16 v[200:203], a[124:127], a[196:199], v[200:203]
buffer_load_dwordx4 a[44:47], v4, s[12:15], s43 offen offset:1024 sc1
v_mfma_f32_16x16x32_bf16 v[204:207], a[128:131], a[196:199], v[204:207]
buffer_load_dwordx4 a[48:51], v4, s[12:15], s43 offen offset:2048 sc1
v_mfma_f32_16x16x32_bf16 v[208:211], a[132:135], a[196:199], v[208:211]
buffer_load_dwordx4 a[52:55], v4, s[12:15], s43 offen offset:3072 sc1
v_mfma_f32_16x16x32_bf16 v[212:215], a[136:139], a[196:199], v[212:215]
buffer_load_dwordx4 a[56:59], v5, s[12:15], s43 offen sc1
v_mfma_f32_16x16x32_bf16 v[216:219], a[120:123], a[200:203], v[216:219]
s_add_u32 s43, s43, 20480
v_mfma_f32_16x16x32_bf16 v[220:223], a[124:127], a[200:203], v[220:223]
v_mfma_f32_16x16x32_bf16 v[224:227], a[128:131], a[200:203], v[224:227]
v_mfma_f32_16x16x32_bf16 v[228:231], a[132:135], a[200:203], v[228:231]
v_mfma_f32_16x16x32_bf16 v[232:235], a[136:139], a[200:203], v[232:235]
v_mfma_f32_16x16x32_bf16 v[236:239], a[120:123], a[204:207], v[236:239]
v_mfma_f32_16x16x32_bf16 v[240:243], a[124:127], a[204:207], v[240:243]
v_mfma_f32_16x16x32_bf16 v[244:247], a[128:131], a[204:207], v[244:247]
v_mfma_f32_16x16x32_bf16 v[248:251], a[132:135], a[204:207], v[248:251]
v_mfma_f32_16x16x32_bf16 v[252:255], a[136:139], a[204:207], v[252:255]
v_lshrrev_b32 v54, 3, v1
v_lshlrev_b32 v54, 10, v54
v_and_b32 v55, 7, v1
v_lshl_add_u32 v54, v55, 4, v54
s_lshl_b32 s65, s48, 6
s_add_u32 s65, s65, s41
s_lshl_b32 s65, s65, 7
s_add_u32 s65, s65, 12386304
buffer_load_dwordx4 v[64:67], v54, s[24:27], s65 offen sc1
s_waitcnt vmcnt(29)
v_mfma_f32_16x16x32_bf16 v[176:179], a[140:143], a[208:211], v[176:179]
buffer_load_dwordx4 a[192:195], v2, s[8:11], s42 offen offset:0 sc1
v_mfma_f32_16x16x32_bf16 v[180:183], a[144:147], a[208:211], v[180:183]
buffer_load_dwordx4 a[196:199], v2, s[8:11], s42 offen offset:256 sc1
v_mfma_f32_16x16x32_bf16 v[184:187], a[148:151], a[208:211], v[184:187]
buffer_load_dwordx4 a[200:203], v3, s[8:11], s42 offen offset:0 sc1
v_mfma_f32_16x16x32_bf16 v[188:191], a[152:155], a[208:211], v[188:191]
buffer_load_dwordx4 a[204:207], v3, s[8:11], s42 offen offset:256 sc1
v_mfma_f32_16x16x32_bf16 v[192:195], a[156:159], a[208:211], v[192:195]
s_add_u32 s42, s42, 8192
s_waitcnt vmcnt(32)
v_mfma_f32_16x16x32_bf16 v[196:199], a[140:143], a[212:215], v[196:199]
buffer_load_dwordx4 a[60:63], v4, s[12:15], s43 offen offset:0 sc1
v_mfma_f32_16x16x32_bf16 v[200:203], a[144:147], a[212:215], v[200:203]
buffer_load_dwordx4 a[64:67], v4, s[12:15], s43 offen offset:1024 sc1
v_mfma_f32_16x16x32_bf16 v[204:207], a[148:151], a[212:215], v[204:207]
buffer_load_dwordx4 a[68:71], v4, s[12:15], s43 offen offset:2048 sc1
v_mfma_f32_16x16x32_bf16 v[208:211], a[152:155], a[212:215], v[208:211]
buffer_load_dwordx4 a[72:75], v4, s[12:15], s43 offen offset:3072 sc1
v_mfma_f32_16x16x32_bf16 v[212:215], a[156:159], a[212:215], v[212:215]
buffer_load_dwordx4 a[76:79], v5, s[12:15], s43 offen sc1
s_waitcnt vmcnt(36)
v_mfma_f32_16x16x32_bf16 v[216:219], a[140:143], a[216:219], v[216:219]
s_add_u32 s43, s43, 20480
v_mfma_f32_16x16x32_bf16 v[220:223], a[144:147], a[216:219], v[220:223]
v_mfma_f32_16x16x32_bf16 v[224:227], a[148:151], a[216:219], v[224:227]
v_mfma_f32_16x16x32_bf16 v[228:231], a[152:155], a[216:219], v[228:231]
v_mfma_f32_16x16x32_bf16 v[232:235], a[156:159], a[216:219], v[232:235]
s_waitcnt vmcnt(35)
v_mfma_f32_16x16x32_bf16 v[236:239], a[140:143], a[220:223], v[236:239]
v_mfma_f32_16x16x32_bf16 v[240:243], a[144:147], a[220:223], v[240:243]
v_mfma_f32_16x16x32_bf16 v[244:247], a[148:151], a[220:223], v[244:247]
v_mfma_f32_16x16x32_bf16 v[248:251], a[152:155], a[220:223], v[248:251]
v_mfma_f32_16x16x32_bf16 v[252:255], a[156:159], a[220:223], v[252:255]
s_waitcnt vmcnt(27)
v_mfma_f32_16x16x32_bf16 v[176:179], a[0:3], a[160:163], v[176:179]
buffer_load_dwordx4 a[208:211], v2, s[8:11], s42 offen offset:0 sc1
v_mfma_f32_16x16x32_bf16 v[180:183], a[4:7], a[160:163], v[180:183]
buffer_load_dwordx4 a[212:215], v2, s[8:11], s42 offen offset:256 sc1
v_mfma_f32_16x16x32_bf16 v[184:187], a[8:11], a[160:163], v[184:187]
buffer_load_dwordx4 a[216:219], v3, s[8:11], s42 offen offset:0 sc1
v_mfma_f32_16x16x32_bf16 v[188:191], a[12:15], a[160:163], v[188:191]
buffer_load_dwordx4 a[220:223], v3, s[8:11], s42 offen offset:256 sc1
v_mfma_f32_16x16x32_bf16 v[192:195], a[16:19], a[160:163], v[192:195]
s_add_u32 s42, s42, 8192
s_waitcnt vmcnt(30)
v_mfma_f32_16x16x32_bf16 v[196:199], a[0:3], a[164:167], v[196:199]
v_mfma_f32_16x16x32_bf16 v[200:203], a[4:7], a[164:167], v[200:203]
v_mfma_f32_16x16x32_bf16 v[204:207], a[8:11], a[164:167], v[204:207]
v_mfma_f32_16x16x32_bf16 v[208:211], a[12:15], a[164:167], v[208:211]
v_mfma_f32_16x16x32_bf16 v[212:215], a[16:19], a[164:167], v[212:215]
s_waitcnt vmcnt(13)
v_cmp_ne_u32 vcc, v67, v30
s_nop 3
s_cbranch_vccz K2COKBQ
s_mov_b32 s77, 4000
K2CSPBQ:
s_sleep 3
buffer_load_dwordx4 v[64:67], v54, s[24:27], s65 offen sc1
s_waitcnt vmcnt(0)
v_cmp_ne_u32 vcc, v67, v30
s_sub_u32 s77, s77, 1
s_nop 2
s_cbranch_vccz K2COKBQ
s_cmp_lg_u32 s77, 0
s_cbranch_scc1 K2CSPBQ
K2COKBQ:
v_mfma_f32_16x16x32_bf16 v[216:219], a[0:3], a[168:171], v[216:219]
v_cvt_pk_bf16_f32 v64, v64, v65
v_cvt_pk_bf16_f32 v66, v66, v66
s_mov_b64 s[60:61], exec
s_mov_b32 exec_lo, 0x7f7f7f7f
s_mov_b32 exec_hi, 0x7f7f7f7f
ds_write_b16 v17, v64
ds_write_b16_d16_hi v17, v64 offset:2
s_mov_b32 exec_lo, 0x3f3f3f3f
s_mov_b32 exec_hi, 0x3f3f3f3f
ds_write_b16 v17, v66 offset:4
s_mov_b64 exec, s[60:61]
v_mfma_f32_16x16x32_bf16 v[220:223], a[4:7], a[168:171], v[220:223]
s_waitcnt lgkmcnt(0)
ds_read_b64 v[72:73], v28 offset:0
ds_read_b64 v[74:75], v28 offset:16
ds_read_b64 v[76:77], v28 offset:64
ds_read_b64 v[78:79], v28 offset:80
ds_read_b64 v[80:81], v28 offset:128
ds_read_b64 v[82:83], v28 offset:144
ds_read_b64 v[84:85], v28 offset:192
ds_read_b64 v[86:87], v28 offset:208
ds_read_b64 v[88:89], v28 offset:256
ds_read_b64 v[90:91], v28 offset:272
v_mfma_f32_16x16x32_bf16 v[224:227], a[8:11], a[168:171], v[224:227]
s_waitcnt lgkmcnt(8)
v_mfma_f32_16x16x32_bf16 v[54:57], v[72:75], v[96:99], 0
v_mfma_f32_16x16x32_bf16 v[58:61], v[72:75], v[100:103], 0
v_mfma_f32_16x16x32_bf16 v[62:65], v[72:75], v[104:107], 0
v_mfma_f32_16x16x32_bf16 v[66:69], v[72:75], v[108:111], 0
s_waitcnt lgkmcnt(6)
v_mfma_f32_16x16x32_bf16 v[54:57], v[76:79], v[112:115], v[54:57]
v_mfma_f32_16x16x32_bf16 v[228:231], a[12:15], a[168:171], v[228:231]
v_mfma_f32_16x16x32_bf16 v[58:61], v[76:79], v[116:119], v[58:61]
v_mfma_f32_16x16x32_bf16 v[62:65], v[76:79], v[120:123], v[62:65]
v_mfma_f32_16x16x32_bf16 v[66:69], v[76:79], v[124:127], v[66:69]
s_waitcnt lgkmcnt(4)
v_mfma_f32_16x16x32_bf16 v[54:57], v[80:83], v[128:131], v[54:57]
v_mfma_f32_16x16x32_bf16 v[58:61], v[80:83], v[132:135], v[58:61]
v_mfma_f32_16x16x32_bf16 v[232:235], a[16:19], a[168:171], v[232:235]
v_mfma_f32_16x16x32_bf16 v[62:65], v[80:83], v[136:139], v[62:65]
v_mfma_f32_16x16x32_bf16 v[66:69], v[80:83], v[140:143], v[66:69]
s_waitcnt lgkmcnt(2)
v_mfma_f32_16x16x32_bf16 v[54:57], v[84:87], v[144:147], v[54:57]
v_mfma_f32_16x16x32_bf16 v[58:61], v[84:87], v[148:151], v[58:61]
v_mfma_f32_16x16x32_bf16 v[62:65], v[84:87], v[152:155], v[62:65]
v_mfma_f32_16x16x32_bf16 v[236:239], a[0:3], a[172:175], v[236:239]
v_mfma_f32_16x16x32_bf16 v[66:69], v[84:87], v[156:159], v[66:69]
s_waitcnt lgkmcnt(0)
v_mfma_f32_16x16x32_bf16 v[54:57], v[88:91], v[160:163], v[54:57]
v_mfma_f32_16x16x32_bf16 v[58:61], v[88:91], v[164:167], v[58:61]
v_mfma_f32_16x16x32_bf16 v[62:65], v[88:91], v[168:171], v[62:65]
v_mfma_f32_16x16x32_bf16 v[66:69], v[88:91], v[172:175], v[66:69]
v_mfma_f32_16x16x32_bf16 v[240:243], a[4:7], a[172:175], v[240:243]
v_and_b32 v70, 15, v1
v_lshlrev_b32 v70, 5, v70
v_lshrrev_b32 v71, 4, v1
v_lshl_add_u32 v70, v71, 4, v70
s_lshl_b32 s51, s48, 11
v_mfma_f32_16x16x32_bf16 v[244:247], a[8:11], a[172:175], v[244:247]
s_add_u32 s64, s51, 96512
v_add_u32 v70, s64, v70
v_add_f32 v54, s63, v54
v_add_f32 v55, s63, v55
v_add_f32 v56, s63, v56
v_mfma_f32_16x16x32_bf16 v[248:251], a[12:15], a[172:175], v[248:251]
v_add_f32 v57, s63, v57
v_add_f32 v58, s63, v58
v_add_f32 v59, s63, v59
v_add_f32 v60, s63, v60
v_add_f32 v61, s63, v61
v_mfma_f32_16x16x32_bf16 v[252:255], a[16:19], a[172:175], v[252:255]
v_add_f32 v62, s63, v62
v_add_f32 v63, s63, v63
v_add_f32 v64, s63, v64
v_add_f32 v65, s63, v65
v_add_f32 v66, s63, v66
v_mfma_f32_16x16x32_bf16 v[176:179], a[20:23], a[176:179], v[176:179]
buffer_load_dwordx2 a[80:81], v32, s[24:27], s62 offen offset:0 sc1
v_add_f32 v67, s63, v67
v_add_f32 v68, s63, v68
v_add_f32 v69, s63, v69
v_rcp_f32 v54, v54
v_mfma_f32_16x16x32_bf16 v[180:183], a[24:27], a[176:179], v[180:183]
buffer_load_dwordx2 a[82:83], v33, s[24:27], s62 offen offset:0 sc1
v_rcp_f32 v55, v55
v_rcp_f32 v56, v56
v_rcp_f32 v57, v57
v_rcp_f32 v58, v58
v_mfma_f32_16x16x32_bf16 v[184:187], a[28:31], a[176:179], v[184:187]
buffer_load_dwordx2 a[84:85], v32, s[24:27], s62 offen offset:640 sc1
v_rcp_f32 v59, v59
v_rcp_f32 v60, v60
v_rcp_f32 v61, v61
v_rcp_f32 v62, v62
v_mfma_f32_16x16x32_bf16 v[188:191], a[32:35], a[176:179], v[188:191]
buffer_load_dwordx2 a[86:87], v33, s[24:27], s62 offen offset:640 sc1
v_rcp_f32 v63, v63
v_rcp_f32 v64, v64
v_rcp_f32 v65, v65
v_rcp_f32 v66, v66
v_mfma_f32_16x16x32_bf16 v[192:195], a[36:39], a[176:179], v[192:195]
buffer_load_dwordx2 a[88:89], v32, s[24:27], s62 offen offset:1280 sc1
v_rcp_f32 v67, v67
v_rcp_f32 v68, v68
v_rcp_f32 v69, v69
s_mov_b64 s[60:61], exec
s_mov_b64 exec, 0xffffffff
ds_write_b128 v70, v[54:57] offset:0
ds_write_b128 v70, v[58:61] offset:512
ds_write_b128 v70, v[62:65] offset:1024
ds_write_b128 v70, v[66:69] offset:1536
s_mov_b64 exec, s[60:61]
v_mfma_f32_16x16x32_bf16 v[196:199], a[20:23], a[180:183], v[196:199]
buffer_load_dwordx2 a[90:91], v33, s[24:27], s62 offen offset:1280 sc1
s_waitcnt lgkmcnt(0)
ds_read_b32 v72, v42 offset:0
ds_read_b32 v73, v43 offset:0
ds_read_b32 v74, v42 offset:512
ds_read_b32 v75, v43 offset:512
ds_read_b32 v76, v42 offset:1024
ds_read_b32 v77, v43 offset:1024
ds_read_b32 v78, v42 offset:1536
ds_read_b32 v79, v43 offset:1536
v_mfma_f32_16x16x32_bf16 v[200:203], a[24:27], a[180:183], v[200:203]
buffer_load_dwordx2 a[92:93], v32, s[24:27], s62 offen offset:1920 sc1
v_lshlrev_b32 v88, 16, v96
v_and_b32 v89, 0xffff0000, v96
v_lshlrev_b32 v90, 16, v97
v_and_b32 v91, 0xffff0000, v97
v_mfma_f32_16x16x32_bf16 v[204:207], a[28:31], a[180:183], v[204:207]
buffer_load_dwordx2 a[94:95], v33, s[24:27], s62 offen offset:1920 sc1
v_lshlrev_b32 v92, 16, v98
v_and_b32 v93, 0xffff0000, v98
v_lshlrev_b32 v94, 16, v99
v_and_b32 v95, 0xffff0000, v99
v_mfma_f32_16x16x32_bf16 v[208:211], a[32:35], a[180:183], v[208:211]
buffer_load_dwordx2 a[96:97], v32, s[24:27], s62 offen offset:2560 sc1
s_waitcnt lgkmcnt(7)
v_mul_f32 v88, v88, v72
v_mul_f32 v89, v89, v72
v_mul_f32 v90, v90, v72
v_mul_f32 v91, v91, v72
v_mfma_f32_16x16x32_bf16 v[212:215], a[36:39], a[180:183], v[212:215]
buffer_load_dwordx2 a[98:99], v33, s[24:27], s62 offen offset:2560 sc1
s_waitcnt lgkmcnt(6)
v_mul_f32 v92, v92, v73
v_mul_f32 v93, v93, v73
v_mul_f32 v94, v94, v73
v_mul_f32 v95, v95, v73
v_mfma_f32_16x16x32_bf16 v[216:219], a[20:23], a[184:187], v[216:219]
buffer_load_dwordx2 a[100:101], v34, s[24:27], s62 offen offset:0 sc1
v_cvt_pk_bf16_f32 v96, v88, v89
v_cvt_pk_bf16_f32 v97, v90, v91
v_cvt_pk_bf16_f32 v98, v92, v93
v_cvt_pk_bf16_f32 v99, v94, v95
v_mfma_f32_16x16x32_bf16 v[220:223], a[24:27], a[184:187], v[220:223]
buffer_load_dwordx2 a[102:103], v35, s[24:27], s62 offen offset:0 sc1
v_lshlrev_b32 v88, 16, v100
v_and_b32 v89, 0xffff0000, v100
v_lshlrev_b32 v90, 16, v101
v_and_b32 v91, 0xffff0000, v101
v_mfma_f32_16x16x32_bf16 v[224:227], a[28:31], a[184:187], v[224:227]
buffer_load_dwordx2 a[104:105], v34, s[24:27], s62 offen offset:640 sc1
v_lshlrev_b32 v92, 16, v102
v_and_b32 v93, 0xffff0000, v102
v_lshlrev_b32 v94, 16, v103
v_and_b32 v95, 0xffff0000, v103
v_mfma_f32_16x16x32_bf16 v[228:231], a[32:35], a[184:187], v[228:231]
buffer_load_dwordx2 a[106:107], v35, s[24:27], s62 offen offset:640 sc1
s_waitcnt lgkmcnt(5)
v_mul_f32 v88, v88, v74
v_mul_f32 v89, v89, v74
v_mul_f32 v90, v90, v74
v_mul_f32 v91, v91, v74
v_mfma_f32_16x16x32_bf16 v[232:235], a[36:39], a[184:187], v[232:235]
buffer_load_dwordx2 a[108:109], v34, s[24:27], s62 offen offset:1280 sc1
s_waitcnt lgkmcnt(4)
v_mul_f32 v92, v92, v75
v_mul_f32 v93, v93, v75
v_mul_f32 v94, v94, v75
v_mul_f32 v95, v95, v75
v_mfma_f32_16x16x32_bf16 v[236:239], a[20:23], a[188:191], v[236:239]
buffer_load_dwordx2 a[110:111], v35, s[24:27], s62 offen offset:1280 sc1
v_cvt_pk_bf16_f32 v100, v88, v89
v_cvt_pk_bf16_f32 v101, v90, v91
v_cvt_pk_bf16_f32 v102, v92, v93
v_cvt_pk_bf16_f32 v103, v94, v95
v_mfma_f32_16x16x32_bf16 v[240:243], a[24:27], a[188:191], v[240:243]
buffer_load_dwordx2 a[112:113], v34, s[24:27], s62 offen offset:1920 sc1
v_lshlrev_b32 v88, 16, v104
v_and_b32 v89, 0xffff0000, v104
v_lshlrev_b32 v90, 16, v105
v_and_b32 v91, 0xffff0000, v105
v_mfma_f32_16x16x32_bf16 v[244:247], a[28:31], a[188:191], v[244:247]
buffer_load_dwordx2 a[114:115], v35, s[24:27], s62 offen offset:1920 sc1
v_lshlrev_b32 v92, 16, v106
v_and_b32 v93, 0xffff0000, v106
v_lshlrev_b32 v94, 16, v107
v_and_b32 v95, 0xffff0000, v107
v_mfma_f32_16x16x32_bf16 v[248:251], a[32:35], a[188:191], v[248:251]
buffer_load_dwordx2 a[116:117], v34, s[24:27], s62 offen offset:2560 sc1
s_waitcnt lgkmcnt(3)
v_mul_f32 v88, v88, v76
v_mul_f32 v89, v89, v76
v_mul_f32 v90, v90, v76
v_mul_f32 v91, v91, v76
v_mfma_f32_16x16x32_bf16 v[252:255], a[36:39], a[188:191], v[252:255]
buffer_load_dwordx2 a[118:119], v35, s[24:27], s62 offen offset:2560 sc1
s_waitcnt lgkmcnt(2)
v_mul_f32 v92, v92, v77
v_mul_f32 v93, v93, v77
v_mul_f32 v94, v94, v77
v_mul_f32 v95, v95, v77
s_waitcnt vmcnt(32)
v_mfma_f32_16x16x32_bf16 v[176:179], a[40:43], a[192:195], v[176:179]
buffer_load_dwordx2 a[120:121], v36, s[24:27], s62 offen offset:0 sc1
v_cvt_pk_bf16_f32 v104, v88, v89
v_cvt_pk_bf16_f32 v105, v90, v91
v_cvt_pk_bf16_f32 v106, v92, v93
v_cvt_pk_bf16_f32 v107, v94, v95
v_mfma_f32_16x16x32_bf16 v[180:183], a[44:47], a[192:195], v[180:183]
buffer_load_dwordx2 a[122:123], v37, s[24:27], s62 offen offset:0 sc1
v_lshlrev_b32 v88, 16, v108
v_and_b32 v89, 0xffff0000, v108
v_lshlrev_b32 v90, 16, v109
v_and_b32 v91, 0xffff0000, v109
v_mfma_f32_16x16x32_bf16 v[184:187], a[48:51], a[192:195], v[184:187]
buffer_load_dwordx2 a[124:125], v36, s[24:27], s62 offen offset:640 sc1
v_lshlrev_b32 v92, 16, v110
v_and_b32 v93, 0xffff0000, v110
v_lshlrev_b32 v94, 16, v111
v_and_b32 v95, 0xffff0000, v111
v_mfma_f32_16x16x32_bf16 v[188:191], a[52:55], a[192:195], v[188:191]
buffer_load_dwordx2 a[126:127], v37, s[24:27], s62 offen offset:640 sc1
s_waitcnt lgkmcnt(1)
v_mul_f32 v88, v88, v78
v_mul_f32 v89, v89, v78
v_mul_f32 v90, v90, v78
v_mul_f32 v91, v91, v78
v_mfma_f32_16x16x32_bf16 v[192:195], a[56:59], a[192:195], v[192:195]
buffer_load_dwordx2 a[128:129], v36, s[24:27], s62 offen offset:1280 sc1
s_waitcnt lgkmcnt(0)
v_mul_f32 v92, v92, v79
v_mul_f32 v93, v93, v79
v_mul_f32 v94, v94, v79
v_mul_f32 v95, v95, v79
s_waitcnt vmcnt(36)
v_mfma_f32_16x16x32_bf16 v[196:199], a[40:43], a[196:199], v[196:199]
buffer_load_dwordx2 a[130:131], v37, s[24:27], s62 offen offset:1280 sc1
v_cvt_pk_bf16_f32 v108, v88, v89
v_cvt_pk_bf16_f32 v109, v90, v91
v_cvt_pk_bf16_f32 v110, v92, v93
v_cvt_pk_bf16_f32 v111, v94, v95
v_mfma_f32_16x16x32_bf16 v[200:203], a[44:47], a[196:199], v[200:203]
buffer_load_dwordx2 a[132:133], v36, s[24:27], s62 offen offset:1920 sc1
ds_read_b32 v80, v44 offset:0
ds_read_b32 v81, v45 offset:0
ds_read_b32 v82, v44 offset:512
ds_read_b32 v83, v45 offset:512
ds_read_b32 v84, v44 offset:1024
ds_read_b32 v85, v45 offset:1024
ds_read_b32 v86, v44 offset:1536
ds_read_b32 v87, v45 offset:1536
v_mfma_f32_16x16x32_bf16 v[204:207], a[48:51], a[196:199], v[204:207]
buffer_load_dwordx2 a[134:135], v37, s[24:27], s62 offen offset:1920 sc1
v_lshlrev_b32 v88, 16, v112
v_and_b32 v89, 0xffff0000, v112
v_lshlrev_b32 v90, 16, v113
v_and_b32 v91, 0xffff0000, v113
v_mfma_f32_16x16x32_bf16 v[208:211], a[52:55], a[196:199], v[208:211]
buffer_load_dwordx2 a[136:137], v36, s[24:27], s62 offen offset:2560 sc1
v_lshlrev_b32 v92, 16, v114
v_and_b32 v93, 0xffff0000, v114
v_lshlrev_b32 v94, 16, v115
v_and_b32 v95, 0xffff0000, v115
v_mfma_f32_16x16x32_bf16 v[212:215], a[56:59], a[196:199], v[212:215]
buffer_load_dwordx2 a[138:139], v37, s[24:27], s62 offen offset:2560 sc1
s_waitcnt lgkmcnt(7)
v_mul_f32 v88, v88, v80
v_mul_f32 v89, v89, v80
v_mul_f32 v90, v90, v80
v_mul_f32 v91, v91, v80
s_waitcnt vmcnt(40)
v_mfma_f32_16x16x32_bf16 v[216:219], a[40:43], a[200:203], v[216:219]
s_waitcnt lgkmcnt(6)
v_mul_f32 v92, v92, v81
v_mul_f32 v93, v93, v81
v_mul_f32 v94, v94, v81
v_mul_f32 v95, v95, v81
v_cvt_pk_bf16_f32 v112, v88, v89
v_mfma_f32_16x16x32_bf16 v[220:223], a[44:47], a[200:203], v[220:223]
v_cvt_pk_bf16_f32 v113, v90, v91
v_cvt_pk_bf16_f32 v114, v92, v93
v_cvt_pk_bf16_f32 v115, v94, v95
v_lshlrev_b32 v88, 16, v116
v_and_b32 v89, 0xffff0000, v116
v_mfma_f32_16x16x32_bf16 v[224:227], a[48:51], a[200:203], v[224:227]
v_lshlrev_b32 v90, 16, v117
v_and_b32 v91, 0xffff0000, v117
v_lshlrev_b32 v92, 16, v118
v_and_b32 v93, 0xffff0000, v118
v_lshlrev_b32 v94, 16, v119
v_mfma_f32_16x16x32_bf16 v[228:231], a[52:55], a[200:203], v[228:231]
v_and_b32 v95, 0xffff0000, v119
s_waitcnt lgkmcnt(5)
v_mul_f32 v88, v88, v82
v_mul_f32 v89, v89, v82
v_mul_f32 v90, v90, v82
v_mul_f32 v91, v91, v82
v_mfma_f32_16x16x32_bf16 v[232:235], a[56:59], a[200:203], v[232:235]
s_waitcnt lgkmcnt(4)
v_mul_f32 v92, v92, v83
v_mul_f32 v93, v93, v83
v_mul_f32 v94, v94, v83
v_mul_f32 v95, v95, v83
v_cvt_pk_bf16_f32 v116, v88, v89
s_waitcnt vmcnt(39)
v_mfma_f32_16x16x32_bf16 v[236:239], a[40:43], a[204:207], v[236:239]
v_cvt_pk_bf16_f32 v117, v90, v91
v_cvt_pk_bf16_f32 v118, v92, v93
v_cvt_pk_bf16_f32 v119, v94, v95
v_lshlrev_b32 v88, 16, v120
v_and_b32 v89, 0xffff0000, v120
v_mfma_f32_16x16x32_bf16 v[240:243], a[44:47], a[204:207], v[240:243]
v_lshlrev_b32 v90, 16, v121
v_and_b32 v91, 0xffff0000, v121
v_lshlrev_b32 v92, 16, v122
v_and_b32 v93, 0xffff0000, v122
v_lshlrev_b32 v94, 16, v123
v_mfma_f32_16x16x32_bf16 v[244:247], a[48:51], a[204:207], v[244:247]
v_and_b32 v95, 0xffff0000, v123
s_waitcnt lgkmcnt(3)
v_mul_f32 v88, v88, v84
v_mul_f32 v89, v89, v84
v_mul_f32 v90, v90, v84
v_mul_f32 v91, v91, v84
v_mfma_f32_16x16x32_bf16 v[248:251], a[52:55], a[204:207], v[248:251]
s_waitcnt lgkmcnt(2)
v_mul_f32 v92, v92, v85
v_mul_f32 v93, v93, v85
v_mul_f32 v94, v94, v85
v_mul_f32 v95, v95, v85
v_cvt_pk_bf16_f32 v120, v88, v89
v_mfma_f32_16x16x32_bf16 v[252:255], a[56:59], a[204:207], v[252:255]
v_cvt_pk_bf16_f32 v121, v90, v91
v_cvt_pk_bf16_f32 v122, v92, v93
v_cvt_pk_bf16_f32 v123, v94, v95
v_lshlrev_b32 v88, 16, v124
v_and_b32 v89, 0xffff0000, v124
s_waitcnt vmcnt(33)
v_mfma_f32_16x16x32_bf16 v[176:179], a[60:63], a[208:211], v[176:179]
buffer_load_dwordx2 a[140:141], v38, s[24:27], s62 offen offset:0 sc1
v_lshlrev_b32 v90, 16, v125
v_and_b32 v91, 0xffff0000, v125
v_lshlrev_b32 v92, 16, v126
v_and_b32 v93, 0xffff0000, v126
v_mfma_f32_16x16x32_bf16 v[180:183], a[64:67], a[208:211], v[180:183]
buffer_load_dwordx2 a[142:143], v39, s[24:27], s62 offen offset:0 sc1
v_lshlrev_b32 v94, 16, v127
v_and_b32 v95, 0xffff0000, v127
s_waitcnt lgkmcnt(1)
v_mul_f32 v88, v88, v86
v_mul_f32 v89, v89, v86
v_mfma_f32_16x16x32_bf16 v[184:187], a[68:71], a[208:211], v[184:187]
buffer_load_dwordx2 a[144:145], v38, s[24:27], s62 offen offset:640 sc1
v_mul_f32 v90, v90, v86
v_mul_f32 v91, v91, v86
s_waitcnt lgkmcnt(0)
v_mul_f32 v92, v92, v87
v_mul_f32 v93, v93, v87
v_mfma_f32_16x16x32_bf16 v[188:191], a[72:75], a[208:211], v[188:191]
buffer_load_dwordx2 a[146:147], v39, s[24:27], s62 offen offset:640 sc1
v_mul_f32 v94, v94, v87
v_mul_f32 v95, v95, v87
v_cvt_pk_bf16_f32 v124, v88, v89
v_cvt_pk_bf16_f32 v125, v90, v91
v_mfma_f32_16x16x32_bf16 v[192:195], a[76:79], a[208:211], v[192:195]
buffer_load_dwordx2 a[148:149], v38, s[24:27], s62 offen offset:1280 sc1
v_cvt_pk_bf16_f32 v126, v92, v93
v_cvt_pk_bf16_f32 v127, v94, v95
ds_read_b32 v72, v46 offset:0
ds_read_b32 v73, v47 offset:0
ds_read_b32 v74, v46 offset:512
ds_read_b32 v75, v47 offset:512
ds_read_b32 v76, v46 offset:1024
ds_read_b32 v77, v47 offset:1024
ds_read_b32 v78, v46 offset:1536
ds_read_b32 v79, v47 offset:1536
s_waitcnt vmcnt(37)
v_mfma_f32_16x16x32_bf16 v[196:199], a[60:63], a[212:215], v[196:199]
buffer_load_dwordx2 a[150:151], v39, s[24:27], s62 offen offset:1280 sc1
v_lshlrev_b32 v88, 16, v128
v_and_b32 v89, 0xffff0000, v128
v_lshlrev_b32 v90, 16, v129
v_and_b32 v91, 0xffff0000, v129
v_mfma_f32_16x16x32_bf16 v[200:203], a[64:67], a[212:215], v[200:203]
buffer_load_dwordx2 a[152:153], v38, s[24:27], s62 offen offset:1920 sc1
v_lshlrev_b32 v92, 16, v130
v_and_b32 v93, 0xffff0000, v130
v_lshlrev_b32 v94, 16, v131
v_and_b32 v95, 0xffff0000, v131
v_mfma_f32_16x16x32_bf16 v[204:207], a[68:71], a[212:215], v[204:207]
buffer_load_dwordx2 a[154:155], v39, s[24:27], s62 offen offset:1920 sc1
s_waitcnt lgkmcnt(7)
v_mul_f32 v88, v88, v72
v_mul_f32 v89, v89, v72
v_mul_f32 v90, v90, v72
v_mul_f32 v91, v91, v72
v_mfma_f32_16x16x32_bf16 v[208:211], a[72:75], a[212:215], v[208:211]
buffer_load_dwordx2 a[156:157], v38, s[24:27], s62 offen offset:2560 sc1
s_waitcnt lgkmcnt(6)
v_mul_f32 v92, v92, v73
v_mul_f32 v93, v93, v73
v_mul_f32 v94, v94, v73
v_mul_f32 v95, v95, v73
v_mfma_f32_16x16x32_bf16 v[212:215], a[76:79], a[212:215], v[212:215]
buffer_load_dwordx2 a[158:159], v39, s[24:27], s62 offen offset:2560 sc1
v_cvt_pk_bf16_f32 v128, v88, v89
v_cvt_pk_bf16_f32 v129, v90, v91
v_cvt_pk_bf16_f32 v130, v92, v93
v_cvt_pk_bf16_f32 v131, v94, v95
s_waitcnt vmcnt(41)
v_mfma_f32_16x16x32_bf16 v[216:219], a[60:63], a[216:219], v[216:219]
v_lshlrev_b32 v88, 16, v132
v_and_b32 v89, 0xffff0000, v132
v_lshlrev_b32 v90, 16, v133
v_and_b32 v91, 0xffff0000, v133
v_lshlrev_b32 v92, 16, v134
v_mfma_f32_16x16x32_bf16 v[220:223], a[64:67], a[216:219], v[220:223]
v_and_b32 v93, 0xffff0000, v134
v_lshlrev_b32 v94, 16, v135
v_and_b32 v95, 0xffff0000, v135
s_waitcnt lgkmcnt(5)
v_mul_f32 v88, v88, v74
v_mul_f32 v89, v89, v74
v_mfma_f32_16x16x32_bf16 v[224:227], a[68:71], a[216:219], v[224:227]
v_mul_f32 v90, v90, v74
v_mul_f32 v91, v91, v74
s_waitcnt lgkmcnt(4)
v_mul_f32 v92, v92, v75
v_mul_f32 v93, v93, v75
v_mul_f32 v94, v94, v75
v_mfma_f32_16x16x32_bf16 v[228:231], a[72:75], a[216:219], v[228:231]
v_mul_f32 v95, v95, v75
v_cvt_pk_bf16_f32 v132, v88, v89
v_cvt_pk_bf16_f32 v133, v90, v91
v_cvt_pk_bf16_f32 v134, v92, v93
v_cvt_pk_bf16_f32 v135, v94, v95
v_mfma_f32_16x16x32_bf16 v[232:235], a[76:79], a[216:219], v[232:235]
v_lshlrev_b32 v88, 16, v136
v_and_b32 v89, 0xffff0000, v136
v_lshlrev_b32 v90, 16, v137
v_and_b32 v91, 0xffff0000, v137
v_lshlrev_b32 v92, 16, v138
s_waitcnt vmcnt(40)
v_mfma_f32_16x16x32_bf16 v[236:239], a[60:63], a[220:223], v[236:239]
v_and_b32 v93, 0xffff0000, v138
v_lshlrev_b32 v94, 16, v139
v_and_b32 v95, 0xffff0000, v139
s_waitcnt lgkmcnt(3)
v_mul_f32 v88, v88, v76
v_mul_f32 v89, v89, v76
v_mfma_f32_16x16x32_bf16 v[240:243], a[64:67], a[220:223], v[240:243]
v_mul_f32 v90, v90, v76
v_mul_f32 v91, v91, v76
s_waitcnt lgkmcnt(2)
v_mul_f32 v92, v92, v77
v_mul_f32 v93, v93, v77
v_mul_f32 v94, v94, v77
v_mfma_f32_16x16x32_bf16 v[244:247], a[68:71], a[220:223], v[244:247]
v_mul_f32 v95, v95, v77
v_cvt_pk_bf16_f32 v136, v88, v89
v_cvt_pk_bf16_f32 v137, v90, v91
v_cvt_pk_bf16_f32 v138, v92, v93
v_cvt_pk_bf16_f32 v139, v94, v95
v_mfma_f32_16x16x32_bf16 v[248:251], a[72:75], a[220:223], v[248:251]
v_lshlrev_b32 v88, 16, v140
v_and_b32 v89, 0xffff0000, v140
v_lshlrev_b32 v90, 16, v141
v_and_b32 v91, 0xffff0000, v141
v_lshlrev_b32 v92, 16, v142
v_mfma_f32_16x16x32_bf16 v[252:255], a[76:79], a[220:223], v[252:255]
v_and_b32 v93, 0xffff0000, v142
v_lshlrev_b32 v94, 16, v143
v_and_b32 v95, 0xffff0000, v143
s_waitcnt lgkmcnt(1)
v_mul_f32 v88, v88, v78
v_mul_f32 v89, v89, v78
s_waitcnt vmcnt(38)
v_mfma_f32_16x16x32_bf16 v[176:179], a[80:83], v[96:99], v[176:179]
buffer_load_dwordx2 a[0:1], v40, s[24:27], s62 offen offset:0 sc1
v_mul_f32 v90, v90, v78
v_mul_f32 v91, v91, v78
s_waitcnt lgkmcnt(0)
v_mul_f32 v92, v92, v79
v_mul_f32 v93, v93, v79
s_waitcnt vmcnt(37)
v_mfma_f32_16x16x32_bf16 v[180:183], a[84:87], v[96:99], v[180:183]
buffer_load_dwordx2 a[2:3], v41, s[24:27], s62 offen offset:0 sc1
v_mul_f32 v94, v94, v79
v_mul_f32 v95, v95, v79
v_cvt_pk_bf16_f32 v140, v88, v89
v_cvt_pk_bf16_f32 v141, v90, v91
s_waitcnt vmcnt(36)
v_mfma_f32_16x16x32_bf16 v[184:187], a[88:91], v[96:99], v[184:187]
buffer_load_dwordx2 a[4:5], v40, s[24:27], s62 offen offset:640 sc1
v_cvt_pk_bf16_f32 v142, v92, v93
v_cvt_pk_bf16_f32 v143, v94, v95
ds_read_b32 v80, v48 offset:0
ds_read_b32 v81, v49 offset:0
ds_read_b32 v82, v48 offset:512
ds_read_b32 v83, v49 offset:512
ds_read_b32 v84, v48 offset:1024
ds_read_b32 v85, v49 offset:1024
ds_read_b32 v86, v48 offset:1536
ds_read_b32 v87, v49 offset:1536
s_waitcnt vmcnt(35)
v_mfma_f32_16x16x32_bf16 v[188:191], a[92:95], v[96:99], v[188:191]
buffer_load_dwordx2 a[6:7], v41, s[24:27], s62 offen offset:640 sc1
v_lshlrev_b32 v88, 16, v144
v_and_b32 v89, 0xffff0000, v144
v_lshlrev_b32 v90, 16, v145
v_and_b32 v91, 0xffff0000, v145
s_waitcnt vmcnt(34)
v_mfma_f32_16x16x32_bf16 v[192:195], a[96:99], v[96:99], v[192:195]
buffer_load_dwordx2 a[8:9], v40, s[24:27], s62 offen offset:1280 sc1
v_lshlrev_b32 v92, 16, v146
v_and_b32 v93, 0xffff0000, v146
v_lshlrev_b32 v94, 16, v147
v_and_b32 v95, 0xffff0000, v147
v_mfma_f32_16x16x32_bf16 v[196:199], a[80:83], v[100:103], v[196:199]
buffer_load_dwordx2 a[10:11], v41, s[24:27], s62 offen offset:1280 sc1
s_waitcnt lgkmcnt(7)
v_mul_f32 v88, v88, v80
v_mul_f32 v89, v89, v80
v_mul_f32 v90, v90, v80
v_mul_f32 v91, v91, v80
v_mfma_f32_16x16x32_bf16 v[200:203], a[84:87], v[100:103], v[200:203]
buffer_load_dwordx2 a[12:13], v40, s[24:27], s62 offen offset:1920 sc1
s_waitcnt lgkmcnt(6)
v_mul_f32 v92, v92, v81
v_mul_f32 v93, v93, v81
v_mul_f32 v94, v94, v81
v_mul_f32 v95, v95, v81
v_mfma_f32_16x16x32_bf16 v[204:207], a[88:91], v[100:103], v[204:207]
buffer_load_dwordx2 a[14:15], v41, s[24:27], s62 offen offset:1920 sc1
v_cvt_pk_bf16_f32 v144, v88, v89
v_cvt_pk_bf16_f32 v145, v90, v91
v_cvt_pk_bf16_f32 v146, v92, v93
v_cvt_pk_bf16_f32 v147, v94, v95
v_mfma_f32_16x16x32_bf16 v[208:211], a[92:95], v[100:103], v[208:211]
buffer_load_dwordx2 a[16:17], v40, s[24:27], s62 offen offset:2560 sc1
v_lshlrev_b32 v88, 16, v148
v_and_b32 v89, 0xffff0000, v148
v_lshlrev_b32 v90, 16, v149
v_and_b32 v91, 0xffff0000, v149
v_mfma_f32_16x16x32_bf16 v[212:215], a[96:99], v[100:103], v[212:215]
buffer_load_dwordx2 a[18:19], v41, s[24:27], s62 offen offset:2560 sc1
v_lshlrev_b32 v92, 16, v150
v_and_b32 v93, 0xffff0000, v150
v_lshlrev_b32 v94, 16, v151
v_and_b32 v95, 0xffff0000, v151
v_mfma_f32_16x16x32_bf16 v[216:219], a[80:83], v[104:107], v[216:219]
s_waitcnt lgkmcnt(5)
v_mul_f32 v88, v88, v82
v_mul_f32 v89, v89, v82
v_mul_f32 v90, v90, v82
v_mul_f32 v91, v91, v82
s_waitcnt lgkmcnt(4)
v_mul_f32 v92, v92, v83
v_mfma_f32_16x16x32_bf16 v[220:223], a[84:87], v[104:107], v[220:223]
v_mul_f32 v93, v93, v83
v_mul_f32 v94, v94, v83
v_mul_f32 v95, v95, v83
v_cvt_pk_bf16_f32 v148, v88, v89
v_cvt_pk_bf16_f32 v149, v90, v91
v_mfma_f32_16x16x32_bf16 v[224:227], a[88:91], v[104:107], v[224:227]
v_cvt_pk_bf16_f32 v150, v92, v93
v_cvt_pk_bf16_f32 v151, v94, v95
v_lshlrev_b32 v88, 16, v152
v_and_b32 v89, 0xffff0000, v152
v_lshlrev_b32 v90, 16, v153
v_mfma_f32_16x16x32_bf16 v[228:231], a[92:95], v[104:107], v[228:231]
v_and_b32 v91, 0xffff0000, v153
v_lshlrev_b32 v92, 16, v154
v_and_b32 v93, 0xffff0000, v154
v_lshlrev_b32 v94, 16, v155
v_and_b32 v95, 0xffff0000, v155
v_mfma_f32_16x16x32_bf16 v[232:235], a[96:99], v[104:107], v[232:235]
s_waitcnt lgkmcnt(3)
v_mul_f32 v88, v88, v84
v_mul_f32 v89, v89, v84
v_mul_f32 v90, v90, v84
v_mul_f32 v91, v91, v84
s_waitcnt lgkmcnt(2)
v_mul_f32 v92, v92, v85
v_mfma_f32_16x16x32_bf16 v[236:239], a[80:83], v[108:111], v[236:239]
v_mul_f32 v93, v93, v85
v_mul_f32 v94, v94, v85
v_mul_f32 v95, v95, v85
v_cvt_pk_bf16_f32 v152, v88, v89
v_cvt_pk_bf16_f32 v153, v90, v91
v_mfma_f32_16x16x32_bf16 v[240:243], a[84:87], v[108:111], v[240:243]
v_cvt_pk_bf16_f32 v154, v92, v93
v_cvt_pk_bf16_f32 v155, v94, v95
v_lshlrev_b32 v88, 16, v156
v_and_b32 v89, 0xffff0000, v156
v_lshlrev_b32 v90, 16, v157
v_mfma_f32_16x16x32_bf16 v[244:247], a[88:91], v[108:111], v[244:247]
v_and_b32 v91, 0xffff0000, v157
v_lshlrev_b32 v92, 16, v158
v_and_b32 v93, 0xffff0000, v158
v_lshlrev_b32 v94, 16, v159
v_and_b32 v95, 0xffff0000, v159
v_mfma_f32_16x16x32_bf16 v[248:251], a[92:95], v[108:111], v[248:251]
s_waitcnt lgkmcnt(1)
v_mul_f32 v88, v88, v86
v_mul_f32 v89, v89, v86
v_mul_f32 v90, v90, v86
v_mul_f32 v91, v91, v86
s_waitcnt lgkmcnt(0)
v_mul_f32 v92, v92, v87
v_mfma_f32_16x16x32_bf16 v[252:255], a[96:99], v[108:111], v[252:255]
v_mul_f32 v93, v93, v87
v_mul_f32 v94, v94, v87
v_mul_f32 v95, v95, v87
v_cvt_pk_bf16_f32 v156, v88, v89
v_cvt_pk_bf16_f32 v157, v90, v91
s_waitcnt vmcnt(38)
v_mfma_f32_16x16x32_bf16 v[176:179], a[100:103], v[112:115], v[176:179]
v_cvt_pk_bf16_f32 v158, v92, v93
v_cvt_pk_bf16_f32 v159, v94, v95
ds_read_b32 v72, v50 offset:0
ds_read_b32 v73, v51 offset:0
ds_read_b32 v74, v50 offset:512
ds_read_b32 v75, v51 offset:512
ds_read_b32 v76, v50 offset:1024
ds_read_b32 v77, v51 offset:1024
ds_read_b32 v78, v50 offset:1536
ds_read_b32 v79, v51 offset:1536
s_waitcnt vmcnt(36)
v_mfma_f32_16x16x32_bf16 v[180:183], a[104:107], v[112:115], v[180:183]
v_lshlrev_b32 v88, 16, v160
v_and_b32 v89, 0xffff0000, v160
v_lshlrev_b32 v90, 16, v161
v_and_b32 v91, 0xffff0000, v161
v_lshlrev_b32 v92, 16, v162
s_waitcnt vmcnt(34)
v_mfma_f32_16x16x32_bf16 v[184:187], a[108:111], v[112:115], v[184:187]
v_and_b32 v93, 0xffff0000, v162
v_lshlrev_b32 v94, 16, v163
v_and_b32 v95, 0xffff0000, v163
s_waitcnt lgkmcnt(7)
v_mul_f32 v88, v88, v72
v_mul_f32 v89, v89, v72
s_waitcnt vmcnt(32)
v_mfma_f32_16x16x32_bf16 v[188:191], a[112:115], v[112:115], v[188:191]
v_mul_f32 v90, v90, v72
v_mul_f32 v91, v91, v72
s_waitcnt lgkmcnt(6)
v_mul_f32 v92, v92, v73
v_mul_f32 v93, v93, v73
v_mul_f32 v94, v94, v73
s_waitcnt vmcnt(30)
v_mfma_f32_16x16x32_bf16 v[192:195], a[116:119], v[112:115], v[192:195]
v_mul_f32 v95, v95, v73
v_cvt_pk_bf16_f32 v160, v88, v89
v_cvt_pk_bf16_f32 v161, v90, v91
v_cvt_pk_bf16_f32 v162, v92, v93
v_cvt_pk_bf16_f32 v163, v94, v95
v_mfma_f32_16x16x32_bf16 v[196:199], a[100:103], v[116:119], v[196:199]
v_lshlrev_b32 v88, 16, v164
v_and_b32 v89, 0xffff0000, v164
v_lshlrev_b32 v90, 16, v165
v_and_b32 v91, 0xffff0000, v165
v_lshlrev_b32 v92, 16, v166
v_mfma_f32_16x16x32_bf16 v[200:203], a[104:107], v[116:119], v[200:203]
v_and_b32 v93, 0xffff0000, v166
v_lshlrev_b32 v94, 16, v167
v_and_b32 v95, 0xffff0000, v167
s_waitcnt lgkmcnt(5)
v_mul_f32 v88, v88, v74
v_mul_f32 v89, v89, v74
v_mfma_f32_16x16x32_bf16 v[204:207], a[108:111], v[116:119], v[204:207]
v_mul_f32 v90, v90, v74
v_mul_f32 v91, v91, v74
s_waitcnt lgkmcnt(4)
v_mul_f32 v92, v92, v75
v_mul_f32 v93, v93, v75
v_mul_f32 v94, v94, v75
v_mfma_f32_16x16x32_bf16 v[208:211], a[112:115], v[116:119], v[208:211]
v_mul_f32 v95, v95, v75
v_cvt_pk_bf16_f32 v164, v88, v89
v_cvt_pk_bf16_f32 v165, v90, v91
v_cvt_pk_bf16_f32 v166, v92, v93
v_cvt_pk_bf16_f32 v167, v94, v95
v_mfma_f32_16x16x32_bf16 v[212:215], a[116:119], v[116:119], v[212:215]
v_lshlrev_b32 v88, 16, v168
v_and_b32 v89, 0xffff0000, v168
v_lshlrev_b32 v90, 16, v169
v_and_b32 v91, 0xffff0000, v169
v_lshlrev_b32 v92, 16, v170
v_mfma_f32_16x16x32_bf16 v[216:219], a[100:103], v[120:123], v[216:219]
v_and_b32 v93, 0xffff0000, v170
v_lshlrev_b32 v94, 16, v171
v_and_b32 v95, 0xffff0000, v171
s_waitcnt lgkmcnt(3)
v_mul_f32 v88, v88, v76
v_mul_f32 v89, v89, v76
v_mfma_f32_16x16x32_bf16 v[220:223], a[104:107], v[120:123], v[220:223]
v_mul_f32 v90, v90, v76
v_mul_f32 v91, v91, v76
s_waitcnt lgkmcnt(2)
v_mul_f32 v92, v92, v77
v_mul_f32 v93, v93, v77
v_mul_f32 v94, v94, v77
v_mfma_f32_16x16x32_bf16 v[224:227], a[108:111], v[120:123], v[224:227]
v_mul_f32 v95, v95, v77
v_cvt_pk_bf16_f32 v168, v88, v89
v_cvt_pk_bf16_f32 v169, v90, v91
v_cvt_pk_bf16_f32 v170, v92, v93
v_cvt_pk_bf16_f32 v171, v94, v95
v_mfma_f32_16x16x32_bf16 v[228:231], a[112:115], v[120:123], v[228:231]
v_lshlrev_b32 v88, 16, v172
v_and_b32 v89, 0xffff0000, v172
v_lshlrev_b32 v90, 16, v173
v_and_b32 v91, 0xffff0000, v173
v_lshlrev_b32 v92, 16, v174
v_mfma_f32_16x16x32_bf16 v[232:235], a[116:119], v[120:123], v[232:235]
v_and_b32 v93, 0xffff0000, v174
v_lshlrev_b32 v94, 16, v175
v_and_b32 v95, 0xffff0000, v175
s_waitcnt lgkmcnt(1)
v_mul_f32 v88, v88, v78
v_mul_f32 v89, v89, v78
v_mfma_f32_16x16x32_bf16 v[236:239], a[100:103], v[124:127], v[236:239]
v_mul_f32 v90, v90, v78
v_mul_f32 v91, v91, v78
s_waitcnt lgkmcnt(0)
v_mul_f32 v92, v92, v79
v_mul_f32 v93, v93, v79
v_mul_f32 v94, v94, v79
v_mfma_f32_16x16x32_bf16 v[240:243], a[104:107], v[124:127], v[240:243]
v_mul_f32 v95, v95, v79
v_cvt_pk_bf16_f32 v172, v88, v89
v_cvt_pk_bf16_f32 v173, v90, v91
v_cvt_pk_bf16_f32 v174, v92, v93
v_cvt_pk_bf16_f32 v175, v94, v95
v_mfma_f32_16x16x32_bf16 v[244:247], a[108:111], v[124:127], v[244:247]
v_mfma_f32_16x16x32_bf16 v[248:251], a[112:115], v[124:127], v[248:251]
v_mfma_f32_16x16x32_bf16 v[252:255], a[116:119], v[124:127], v[252:255]
s_waitcnt vmcnt(28)
v_mfma_f32_16x16x32_bf16 v[176:179], a[120:123], v[128:131], v[176:179]
s_waitcnt vmcnt(26)
v_mfma_f32_16x16x32_bf16 v[180:183], a[124:127], v[128:131], v[180:183]
s_waitcnt vmcnt(24)
v_mfma_f32_16x16x32_bf16 v[184:187], a[128:131], v[128:131], v[184:187]
s_waitcnt vmcnt(22)
v_mfma_f32_16x16x32_bf16 v[188:191], a[132:135], v[128:131], v[188:191]
s_waitcnt vmcnt(20)
v_mfma_f32_16x16x32_bf16 v[192:195], a[136:139], v[128:131], v[192:195]
v_mfma_f32_16x16x32_bf16 v[196:199], a[120:123], v[132:135], v[196:199]
v_mfma_f32_16x16x32_bf16 v[200:203], a[124:127], v[132:135], v[200:203]
v_mfma_f32_16x16x32_bf16 v[204:207], a[128:131], v[132:135], v[204:207]
v_mfma_f32_16x16x32_bf16 v[208:211], a[132:135], v[132:135], v[208:211]
v_mfma_f32_16x16x32_bf16 v[212:215], a[136:139], v[132:135], v[212:215]
v_mfma_f32_16x16x32_bf16 v[216:219], a[120:123], v[136:139], v[216:219]
v_mfma_f32_16x16x32_bf16 v[220:223], a[124:127], v[136:139], v[220:223]
v_mfma_f32_16x16x32_bf16 v[224:227], a[128:131], v[136:139], v[224:227]
v_mfma_f32_16x16x32_bf16 v[228:231], a[132:135], v[136:139], v[228:231]
v_mfma_f32_16x16x32_bf16 v[232:235], a[136:139], v[136:139], v[232:235]
v_mfma_f32_16x16x32_bf16 v[236:239], a[120:123], v[140:143], v[236:239]
v_mfma_f32_16x16x32_bf16 v[240:243], a[124:127], v[140:143], v[240:243]
v_mfma_f32_16x16x32_bf16 v[244:247], a[128:131], v[140:143], v[244:247]
v_mfma_f32_16x16x32_bf16 v[248:251], a[132:135], v[140:143], v[248:251]
v_mfma_f32_16x16x32_bf16 v[252:255], a[136:139], v[140:143], v[252:255]
s_waitcnt vmcnt(18)
v_mfma_f32_16x16x32_bf16 v[176:179], a[140:143], v[144:147], v[176:179]
s_waitcnt vmcnt(16)
v_mfma_f32_16x16x32_bf16 v[180:183], a[144:147], v[144:147], v[180:183]
s_waitcnt vmcnt(14)
v_mfma_f32_16x16x32_bf16 v[184:187], a[148:151], v[144:147], v[184:187]
s_waitcnt vmcnt(12)
v_mfma_f32_16x16x32_bf16 v[188:191], a[152:155], v[144:147], v[188:191]
s_waitcnt vmcnt(10)
v_mfma_f32_16x16x32_bf16 v[192:195], a[156:159], v[144:147], v[192:195]
v_mfma_f32_16x16x32_bf16 v[196:199], a[140:143], v[148:151], v[196:199]
v_mfma_f32_16x16x32_bf16 v[200:203], a[144:147], v[148:151], v[200:203]
v_mfma_f32_16x16x32_bf16 v[204:207], a[148:151], v[148:151], v[204:207]
v_mfma_f32_16x16x32_bf16 v[208:211], a[152:155], v[148:151], v[208:211]
v_mfma_f32_16x16x32_bf16 v[212:215], a[156:159], v[148:151], v[212:215]
v_mfma_f32_16x16x32_bf16 v[216:219], a[140:143], v[152:155], v[216:219]
v_mfma_f32_16x16x32_bf16 v[220:223], a[144:147], v[152:155], v[220:223]
v_mfma_f32_16x16x32_bf16 v[224:227], a[148:151], v[152:155], v[224:227]
v_mfma_f32_16x16x32_bf16 v[228:231], a[152:155], v[152:155], v[228:231]
v_mfma_f32_16x16x32_bf16 v[232:235], a[156:159], v[152:155], v[232:235]
v_mfma_f32_16x16x32_bf16 v[236:239], a[140:143], v[156:159], v[236:239]
v_mfma_f32_16x16x32_bf16 v[240:243], a[144:147], v[156:159], v[240:243]
v_mfma_f32_16x16x32_bf16 v[244:247], a[148:151], v[156:159], v[244:247]
v_mfma_f32_16x16x32_bf16 v[248:251], a[152:155], v[156:159], v[248:251]
v_mfma_f32_16x16x32_bf16 v[252:255], a[156:159], v[156:159], v[252:255]
s_waitcnt vmcnt(8)
v_mfma_f32_16x16x32_bf16 v[176:179], a[0:3], v[160:163], v[176:179]
s_waitcnt vmcnt(6)
v_mfma_f32_16x16x32_bf16 v[180:183], a[4:7], v[160:163], v[180:183]
s_waitcnt vmcnt(4)
v_mfma_f32_16x16x32_bf16 v[184:187], a[8:11], v[160:163], v[184:187]
s_waitcnt vmcnt(2)
v_mfma_f32_16x16x32_bf16 v[188:191], a[12:15], v[160:163], v[188:191]
s_waitcnt vmcnt(0)
v_mfma_f32_16x16x32_bf16 v[192:195], a[16:19], v[160:163], v[192:195]
v_mfma_f32_16x16x32_bf16 v[196:199], a[0:3], v[164:167], v[196:199]
v_mfma_f32_16x16x32_bf16 v[200:203], a[4:7], v[164:167], v[200:203]
v_mfma_f32_16x16x32_bf16 v[204:207], a[8:11], v[164:167], v[204:207]
v_mfma_f32_16x16x32_bf16 v[208:211], a[12:15], v[164:167], v[208:211]
v_mfma_f32_16x16x32_bf16 v[212:215], a[16:19], v[164:167], v[212:215]
ds_write_b128 v6, v[176:179] offset:0
v_mfma_f32_16x16x32_bf16 v[216:219], a[0:3], v[168:171], v[216:219]
ds_write_b128 v6, v[180:183] offset:1024
v_mfma_f32_16x16x32_bf16 v[220:223], a[4:7], v[168:171], v[220:223]
ds_write_b128 v6, v[184:187] offset:2048
v_mfma_f32_16x16x32_bf16 v[224:227], a[8:11], v[168:171], v[224:227]
ds_write_b128 v6, v[188:191] offset:3072
v_mfma_f32_16x16x32_bf16 v[228:231], a[12:15], v[168:171], v[228:231]
ds_write_b128 v6, v[192:195] offset:4096
v_mfma_f32_16x16x32_bf16 v[232:235], a[16:19], v[168:171], v[232:235]
ds_write_b128 v6, v[196:199] offset:5120
v_mfma_f32_16x16x32_bf16 v[236:239], a[0:3], v[172:175], v[236:239]
ds_write_b128 v6, v[200:203] offset:6144
v_mfma_f32_16x16x32_bf16 v[240:243], a[4:7], v[172:175], v[240:243]
ds_write_b128 v6, v[204:207] offset:7168
v_mfma_f32_16x16x32_bf16 v[244:247], a[8:11], v[172:175], v[244:247]
ds_write_b128 v6, v[208:211] offset:8192
v_mfma_f32_16x16x32_bf16 v[248:251], a[12:15], v[172:175], v[248:251]
ds_write_b128 v6, v[212:215] offset:9216
v_mfma_f32_16x16x32_bf16 v[252:255], a[16:19], v[172:175], v[252:255]
ds_write_b128 v6, v[216:219] offset:10240
ds_write_b128 v6, v[220:223] offset:11264
ds_write_b128 v6, v[224:227] offset:12288
ds_write_b128 v6, v[228:231] offset:13312
ds_write_b128 v6, v[232:235] offset:14336
ds_write_b128 v6, v[236:239] offset:15360
ds_write_b128 v6, v[240:243] offset:16384
ds_write_b128 v6, v[244:247] offset:17408
ds_write_b128 v6, v[248:251] offset:18432
ds_write_b128 v6, v[252:255] offset:19456
s_waitcnt lgkmcnt(0)
s_barrier
ds_read_b128 v[96:99], v7 offset:0
ds_read_b128 v[100:103], v7 offset:20480
ds_read_b128 v[104:107], v8 offset:0
ds_read_b128 v[108:111], v8 offset:20480
ds_read_b128 v[112:115], v7 offset:1024
ds_read_b128 v[116:119], v7 offset:21504
ds_read_b128 v[120:123], v8 offset:1024
ds_read_b128 v[124:127], v8 offset:21504
ds_read_b128 v[128:131], v7 offset:2048
ds_read_b128 v[132:135], v7 offset:22528
ds_read_b128 v[136:139], v8 offset:2048
ds_read_b128 v[140:143], v8 offset:22528
ds_read_b128 v[144:147], v7 offset:3072
ds_read_b128 v[148:151], v7 offset:23552
ds_read_b128 v[152:155], v8 offset:3072
ds_read_b128 v[156:159], v8 offset:23552
ds_read_b128 v[160:163], v7 offset:4096
ds_read_b128 v[164:167], v7 offset:24576
ds_read_b128 v[168:171], v8 offset:4096
ds_read_b128 v[172:175], v8 offset:24576
v_lshlrev_b32 v176, 16, v18
v_and_b32 v177, 0xffff0000, v18
v_lshlrev_b32 v178, 16, v19
v_and_b32 v179, 0xffff0000, v19
s_waitcnt lgkmcnt(15)
v_add_f32 v96, v96, v100
v_add_f32 v97, v97, v101
v_add_f32 v98, v98, v102
v_add_f32 v99, v99, v103
v_add_f32 v104, v104, v108
v_add_f32 v105, v105, v109
v_add_f32 v106, v106, v110
v_add_f32 v107, v107, v111
v_add_f32 v176, v176, v96
v_add_f32 v177, v177, v97
v_add_f32 v178, v178, v98
v_add_f32 v179, v179, v99
v_add_f32 v176, v176, v104
v_add_f32 v177, v177, v105
v_add_f32 v178, v178, v106
v_add_f32 v179, v179, v107
v_cvt_pk_bf16_f32 v180, v176, v177
v_cvt_pk_bf16_f32 v181, v178, v179
buffer_store_dwordx2 v[180:181], v12, s[20:23], s46 offen
v_lshlrev_b32 v182, 16, v20
v_and_b32 v183, 0xffff0000, v20
v_lshlrev_b32 v184, 16, v21
v_and_b32 v185, 0xffff0000, v21
s_waitcnt lgkmcnt(14)
v_add_f32 v112, v112, v116
v_add_f32 v113, v113, v117
v_add_f32 v114, v114, v118
v_add_f32 v115, v115, v119
s_waitcnt lgkmcnt(12)
v_add_f32 v120, v120, v124
v_add_f32 v121, v121, v125
v_add_f32 v122, v122, v126
v_add_f32 v123, v123, v127
v_add_f32 v182, v182, v112
v_add_f32 v183, v183, v113
v_add_f32 v184, v184, v114
v_add_f32 v185, v185, v115
v_add_f32 v182, v182, v120
v_add_f32 v183, v183, v121
v_add_f32 v184, v184, v122
v_add_f32 v185, v185, v123
v_cvt_pk_bf16_f32 v186, v182, v183
v_cvt_pk_bf16_f32 v187, v184, v185
buffer_store_dwordx2 v[186:187], v12, s[20:23], s46 offen offset:32
v_lshlrev_b32 v188, 16, v22
v_and_b32 v189, 0xffff0000, v22
v_lshlrev_b32 v190, 16, v23
v_and_b32 v191, 0xffff0000, v23
s_waitcnt lgkmcnt(10)
v_add_f32 v128, v128, v132
v_add_f32 v129, v129, v133
v_add_f32 v130, v130, v134
v_add_f32 v131, v131, v135
s_waitcnt lgkmcnt(8)
v_add_f32 v136, v136, v140
v_add_f32 v137, v137, v141
v_add_f32 v138, v138, v142
v_add_f32 v139, v139, v143
v_add_f32 v188, v188, v128
v_add_f32 v189, v189, v129
v_add_f32 v190, v190, v130
v_add_f32 v191, v191, v131
v_add_f32 v188, v188, v136
v_add_f32 v189, v189, v137
v_add_f32 v190, v190, v138
v_add_f32 v191, v191, v139
v_cvt_pk_bf16_f32 v192, v188, v189
v_cvt_pk_bf16_f32 v193, v190, v191
buffer_store_dwordx2 v[192:193], v12, s[20:23], s46 offen offset:64
v_lshlrev_b32 v194, 16, v24
v_and_b32 v195, 0xffff0000, v24
v_lshlrev_b32 v196, 16, v25
v_and_b32 v197, 0xffff0000, v25
s_waitcnt lgkmcnt(6)
v_add_f32 v144, v144, v148
v_add_f32 v145, v145, v149
v_add_f32 v146, v146, v150
v_add_f32 v147, v147, v151
s_waitcnt lgkmcnt(4)
v_add_f32 v152, v152, v156
v_add_f32 v153, v153, v157
v_add_f32 v154, v154, v158
v_add_f32 v155, v155, v159
v_add_f32 v194, v194, v144
v_add_f32 v195, v195, v145
v_add_f32 v196, v196, v146
v_add_f32 v197, v197, v147
v_add_f32 v194, v194, v152
v_add_f32 v195, v195, v153
v_add_f32 v196, v196, v154
v_add_f32 v197, v197, v155
v_cvt_pk_bf16_f32 v198, v194, v195
v_cvt_pk_bf16_f32 v199, v196, v197
buffer_store_dwordx2 v[198:199], v12, s[20:23], s46 offen offset:96
v_lshlrev_b32 v200, 16, v26
v_and_b32 v201, 0xffff0000, v26
v_lshlrev_b32 v202, 16, v27
v_and_b32 v203, 0xffff0000, v27
s_waitcnt lgkmcnt(2)
v_add_f32 v160, v160, v164
v_add_f32 v161, v161, v165
v_add_f32 v162, v162, v166
v_add_f32 v163, v163, v167
s_waitcnt lgkmcnt(0)
v_add_f32 v168, v168, v172
v_add_f32 v169, v169, v173
v_add_f32 v170, v170, v174
v_add_f32 v171, v171, v175
v_add_f32 v200, v200, v160
v_add_f32 v201, v201, v161
v_add_f32 v202, v202, v162
v_add_f32 v203, v203, v163
v_add_f32 v200, v200, v168
v_add_f32 v201, v201, v169
v_add_f32 v202, v202, v170
v_add_f32 v203, v203, v171
v_cvt_pk_bf16_f32 v204, v200, v201
v_cvt_pk_bf16_f32 v205, v202, v203
buffer_store_dwordx2 v[204:205], v12, s[20:23], s46 offen offset:128
s_endpgm
.section .rodata,"a"
.p2align 6
.amdhsa_kernel parallel_sum__linear_attn_block__glu_gated_swiglu__prompt_kernel
  .amdhsa_next_free_vgpr 512
  .amdhsa_next_free_sgpr 102
  .amdhsa_accum_offset 256
  .amdhsa_group_segment_fixed_size 0
  .amdhsa_kernarg_size 80
  .amdhsa_user_sgpr_count 2
  .amdhsa_user_sgpr_kernarg_segment_ptr 1
  .amdhsa_system_sgpr_workgroup_id_x 1
.end_amdhsa_kernel
```
